```python
import torch

def _softmax(x, axis=-1):
    return torch.softmax(x, dim=axis)
def _gelu(x):
    return torch.nn.functional.gelu(x, approximate="tanh")
def _silu(x):
    return torch.nn.functional.silu(x)
def _sigmoid(x):
    return torch.sigmoid(x)
def _layernorm(x, axis=-1, eps=1e-5):
    m = x.mean(dim=axis, keepdim=True)
    v = x.var(dim=axis, keepdim=True, unbiased=False)
    return (x - m) / torch.sqrt(v + eps)
def _scatter_add(tgt, idx, src, axis=0):
    return tgt.clone().index_add_(axis, idx, src)
def _segment_sum(src, seg, n):
    out = torch.zeros((n,) + src.shape[1:], dtype=src.dtype)
    return out.index_add_(0, seg, src)
def _pad(x, pw):
    flat = tuple(v for pair in reversed(pw) for v in pair)
    return torch.nn.functional.pad(x, flat)

kernel_name = 'gated_mix__grouped_kv_mqa__dense_activation_gelu__prompt'

def setup_inputs():

    _w = (lambda a: (lambda t: t.to(torch.bfloat16) if t.is_floating_point() else t)(torch.as_tensor(a)))
    def _A_setup():
        B, S, D, H = 1, 2048, 576, 32
        Dh = D // H
        return {
            "x": _w((lambda *s: torch.randn(*s, dtype=torch.bfloat16) * 0.05)(B, S, D)),
            "wq": _w((lambda *s: torch.randn(*s, dtype=torch.bfloat16) * 0.8)(D, H * Dh)),
            "wk": _w((lambda *s: torch.randn(*s, dtype=torch.bfloat16) * 0.8)(D, Dh)),
            "wv": _w((lambda *s: torch.randn(*s, dtype=torch.bfloat16) * 0.05)(D, Dh)),
            "wo": _w((lambda *s: torch.randn(*s, dtype=torch.bfloat16) * 0.05)(H * Dh, D)),
        }
    _A_in = _A_setup()

    def _B_setup():
        B, S, D, F = 1, 2048, 576, 4608
        return {
            "x": _w((lambda *s: torch.randn(*s, dtype=torch.bfloat16) * 0.05)(B, S, D)),
            "w1": _w((lambda *s: torch.randn(*s, dtype=torch.bfloat16) * 3.2)(D, F) * (D ** -0.5)),
            "b1": _w((lambda *s: torch.randn(*s, dtype=torch.bfloat16) * 3.2)(F) * 0.01),
            "w2": _w((lambda *s: torch.randn(*s, dtype=torch.bfloat16) * 0.05)(F, D) * (F ** -0.5)),
            "b2": _w((lambda *s: torch.randn(*s, dtype=torch.bfloat16) * 0.1)(D) * 0.01),
        }
    _B_in = _B_setup()

    return {
        "A_x": _A_in["x"],
        "A_wq": _A_in["wq"],
        "A_wk": _A_in["wk"],
        "A_wv": _A_in["wv"],
        "A_wo": _A_in["wo"],
        "B_x": _B_in["x"],
        "B_w1": _B_in["w1"],
        "B_b1": _B_in["b1"],
        "B_w2": _B_in["w2"],
        "B_b2": _B_in["b2"],
        "gate_w": _w((lambda *s: torch.randn(*s, dtype=torch.bfloat16) * 0.05)(576) * 16.0),
    }

def reference(A_x, A_wq, A_wk, A_wv, A_wo, B_x, B_w1, B_b1, B_w2, B_b2, gate_w):
    def _A_ref(x, wq, wk, wv, wo):
        B, S, D = x.shape
        H = 32
        Dh = D // H
        q = (lambda x, *d: x.permute(*d))((x @ wq).reshape(B, S, H, Dh), 0, 2, 1, 3)
        k = x @ wk
        v = x @ wv
        scores = torch.einsum("bhqd,bkd->bhqk", q, k) * (Dh ** -0.5)
        p = _softmax(scores, axis=-1)
        o = torch.einsum("bhqk,bkd->bhqd", p, v)
        return (lambda x, *d: x.permute(*d))(o, 0, 2, 1, 3).reshape(B, S, H * Dh) @ wo

    def _B_ref(x, w1, b1, w2, b2):
        h = torch.einsum("bsd,df->bsf", x, w1) + b1
        h = _gelu(h)
        return torch.einsum("bsf,fd->bsd", h, w2) + b2

    x = A_x
    g = _sigmoid((x * gate_w).sum(-1, keepdims=True))
    a = _A_ref(x, A_wq, A_wk, A_wv, A_wo)
    b = _B_ref(x, B_w1, B_b1, B_w2, B_b2)
    return g * a + (1 - g) * b
```

```asm
; @launch grid=(256,1,1) block=(256,1,1) lds=163840
.amdgcn_target "amdgcn-amd-amdhsa--gfx950"
.text
.globl gated_mix__grouped_kv_mqa__dense_activation_gelu__prompt_kernel
.p2align 8
.type gated_mix__grouped_kv_mqa__dense_activation_gelu__prompt_kernel,@function
gated_mix__grouped_kv_mqa__dense_activation_gelu__prompt_kernel:
    s_getpc_b64 s[62:63]
L_pc:
    s_cmp_ge_u32 s2, 256
    s_cbranch_scc1 L_end
    s_load_dwordx4 s[52:55], s[0:1], 0
    s_load_dwordx2 s[8:9], s[0:1], 48
    s_lshr_b32 s69, s2, 3
    v_mul_u32_u24 v1, 5, v0
    v_lshrrev_b32 v1, 6, v1
    v_mad_u32_u24 v1, s69, 20, v1
    v_lshlrev_b32 v1, 7, v1
    v_min_u32 v15, L_codeend-L_pc-4, v1
    global_load_dword v8, v15, s[62:63]
    s_load_dwordx4 s[16:19], s[0:1], 16
    s_load_dwordx2 s[36:37], s[0:1], 56
    v_lshrrev_b32 v1, 6, v0
    v_mov_b32 v201, v0
    v_readfirstlane_b32 s58, v1
    v_and_b32 v0, 63, v0
    s_and_b32 s56, s2, 4
    s_lshl_b32 s56, s56, 1
    s_and_b32 s60, s69, 7
    s_add_u32 s56, s56, s60
    s_and_b32 s57, s2, 3
    s_lshl_b32 s57, s57, 2
    s_lshr_b32 s76, s2, 6
    s_add_u32 s57, s57, s76
    s_add_u32 s77, s56, s57
    s_and_b32 s77, s77, 7
    s_lshl_b32 s60, s77, 2
    s_lshr_b32 s66, 0x10210210, s60
    s_and_b32 s66, s66, 15
    s_lshl_b32 s78, s66, 7
    s_add_u32 s68, s78, 18432
    s_lshl_b32 s79, s58, 12
    s_lshl_b32 s60, s56, 2
    s_add_u32 s60, s60, s58
    s_mul_i32 s60, s60, 36864
    v_lshrrev_b32 v2, 4, v0
    v_lshrrev_b32 v1, 3, v0
    v_mul_u32_u24 v5, 1152, v1
    v_add_u32 v1, 2, v2
    v_xor_b32 v1, v1, v0
    v_and_b32 v1, 7, v1
    v_add_u32 v5, s60, v5
    s_bfe_u32 s61, s57, 0x10000
    s_lshl_b32 s72, s61, 10
    s_xor_b32 s73, s72, 1024
    s_add_u32 s72, s72, s79
    s_add_u32 s73, s73, s79
    s_lshl_b32 s60, s61, 2
    v_xor_b32 v1, s60, v1
    s_mul_i32 s60, s61, 9216
    v_add_u32 v5, s60, v5
    s_mul_i32 s61, s61, -18432
    s_add_u32 s61, s61, 9216
    v_lshl_add_u32 v195, v1, 4, v5
    s_mov_b32 s6, 2359296
    s_mov_b32 s7, 0x20000
    s_waitcnt lgkmcnt(0)
    s_mov_b64 s[4:5], s[52:53]
    s_add_u32 m0, s72, 129408
    v_xor_b32 v1, 4, v1
    buffer_load_dwordx4 v195, s[4:7], s78 offen lds
    s_add_u32 m0, s72, 131456
    v_lshl_add_u32 v196, v1, 4, v5
    buffer_load_dwordx4 v195, s[4:7], s68 offen lds
    s_add_u32 m0, s73, 129408
    v_add_u32 v196, s61, v196
    buffer_load_dwordx4 v196, s[4:7], s78 offen lds
    s_add_u32 m0, s73, 131456
    v_bfe_u32 v1, v0, 2, 3
    buffer_load_dwordx4 v196, s[4:7], s68 offen lds
    s_mov_b32 s10, 5308416
    s_mov_b32 s11, 0x20000
    s_mul_i32 s59, s58, 10784
    s_mul_i32 s64, s66, 589824
    s_lshr_b32 s71, s56, 2
    s_and_b32 s71, s71, 2
    s_xor_b32 s71, s71, s56
    s_and_b32 s71, s71, 3
    s_lshl_b32 s71, s71, 7
    v_lshl_add_u32 v1, s58, 4, v1
    v_mul_u32_u24 v1, 9216, v1
    v_and_b32 v4, 3, v0
    v_lshl_add_u32 v1, v4, 4, v1
    v_lshrrev_b32 v5, 5, v0
    v_lshl_add_u32 v1, v5, 6, v1
    s_mul_i32 s61, s57, 576
    s_and_b32 s75, s57, 1
    s_lshl_b32 s60, s75, 6
    s_add_u32 s60, s60, s61
    v_add_u32 v191, s60, v1
    v_add_u32 v208, 73728, v191
    s_lshr_b32 s60, s57, 3
    s_lshl2_add_u32 s53, s60, s76
    s_bfe_u32 s101, s57, 0x10002
    s_lshl1_add_u32 s100, s53, s101
    s_lshl3_add_u32 s53, s101, s53
    v_lshrrev_b32 v1, 2, v201
    s_xor_b32 s60, s75, 1
    s_lshl_b32 s60, s60, 9
    s_add_u32 s60, s60, s61
    v_mul_u32_u24 v5, 9216, v1
    v_lshl_add_u32 v5, v4, 4, v5
    v_add_u32 v206, s60, v5
    s_mul_i32 s65, s66, 73728
    s_mul_i32 s66, s66, 2304
    s_mul_i32 s60, s100, 72
    s_lshl3_add_u32 s60, s101, s60
    v_mul_u32_u24 v5, 1152, v1
    v_add_u32 v5, s60, v5
    v_lshl_add_u32 v192, v4, 4, v5
    v_lshl_add_u32 v193, v4, 2, v5
    s_lshl_b32 s60, s101, 30
    s_add_u32 s60, s60, 64
    v_add_u32 v193, s60, v193
    s_lshl_b32 s60, s75, 4
    s_cmp_ge_u32 s53, 4
    s_cselect_b32 s60, 20, s60
    v_mul_u32_u24 v5, 36, v1
    v_lshl_add_u32 v5, v4, 2, v5
    v_add_u32 v194, s60, v5
    v_min_u32 v6, 143, v201
    v_lshlrev_b32 v6, 2, v6
    s_mov_b32 s14, 663552
    s_mov_b32 s15, 0x20000
    s_mov_b32 s38, 9216
    s_mov_b32 s39, 0x20000
    s_mov_b64 s[12:13], s[54:55]
    s_lshr_b32 s60, 0x2c, s53
    s_bitcmp1_b32 s60, 0
    s_cselect_b32 s16, s18, s16
    s_cselect_b32 s17, s19, s17
    s_cmp_lt_u32 s53, 6
    s_cselect_b32 s18, 20736, 0
    s_mov_b32 s19, 0x20000
    s_add_u32 m0, s59, 8192
    s_nop 0
    buffer_load_dwordx4 v206, s[8:11], s64 offen lds
    s_add_u32 s67, s64, s71
    s_add_u32 m0, s59, 0
    s_load_dwordx2 s[20:21], s[0:1], 64
    buffer_load_dwordx4 v191, s[8:11], s67 offen lds
    s_add_u32 m0, s59, 1024
    s_load_dwordx2 s[24:25], s[0:1], 32
    buffer_load_dwordx4 v208, s[8:11], s67 offen lds
    s_xor_b32 s67, s67, 128
    s_add_u32 m0, s59, 2048
    s_load_dwordx2 s[28:29], s[0:1], 104
    buffer_load_dwordx4 v191, s[8:11], s67 offen lds
    s_add_u32 m0, s59, 9216
    s_load_dwordx2 s[32:33], s[0:1], 88
    buffer_load_dwordx4 v192, s[12:15], s65 offen lds
    s_add_u32 m0, s59, 10240
    s_load_dwordx2 s[40:41], s[0:1], 72
    buffer_load_dword v193, s[12:15], s65 offen lds
    s_add_u32 m0, s59, 10496
    s_load_dwordx2 s[44:45], s[0:1], 80
    buffer_load_dword v194, s[16:19], s66 offen lds
    s_add_u32 m0, s59, 3072
    s_load_dwordx2 s[48:49], s[0:1], 96
    buffer_load_dwordx4 v208, s[8:11], s67 offen lds
    s_mov_b64 exec, 0
    s_cmp_lt_u32 s53, 8
    s_cbranch_scc1 L_dispe
    s_cmp_eq_u32 s58, 0
    s_cbranch_scc1 L_po0
    s_cmp_eq_u32 s58, 1
    s_cbranch_scc1 L_po1
    s_cmp_eq_u32 s58, 2
    s_cbranch_scc1 L_po2
    s_branch L_po3
L_dispe:
    s_cmp_eq_u32 s58, 0
    s_cbranch_scc1 L_pe0
    s_cmp_eq_u32 s58, 1
    s_cbranch_scc1 L_pe1
    s_cmp_eq_u32 s58, 2
    s_cbranch_scc1 L_pe2
    s_branch L_pe3
L_wret:
    s_mov_b64 exec, -1
    buffer_load_dword v7, v6, s[36:39], s61 offen
    s_xor_b32 s67, s67, 384
    s_add_u32 m0, s59, 4096
    s_mov_b32 s60, 0x87654231
    s_cmp_eq_u32 s77, 1
    s_cselect_b32 s60, 0x87654032, s60
    s_cmp_eq_u32 s77, 2
    s_cselect_b32 s60, 0x87653410, s60
    buffer_load_dwordx4 v191, s[8:11], s67 offen lds
    s_add_u32 m0, s59, 5120
    s_cmp_eq_u32 s77, 3
    s_cselect_b32 s60, 0x87653421, s60
    s_cmp_eq_u32 s77, 4
    s_cselect_b32 s60, 0x87645302, s60
    s_cmp_eq_u32 s77, 5
    s_cselect_b32 s60, 0x87564310, s60
    buffer_load_dwordx4 v208, s[8:11], s67 offen lds
    s_xor_b32 s67, s67, 128
    s_add_u32 m0, s59, 6144
    s_cmp_eq_u32 s77, 6
    s_cselect_b32 s60, 0x86754321, s60
    s_cmp_eq_u32 s77, 7
    s_cselect_b32 s77, 0x78654302, s60
    s_waitcnt lgkmcnt(0)
    buffer_load_dwordx4 v191, s[8:11], s67 offen lds
    s_add_u32 m0, s59, 7168
    s_mov_b64 s[0:1], s[62:63]
    s_mov_b32 s46, 1152
    s_mov_b32 s47, 0x20000
    v_and_b32 v207, 31, v0
    v_lshlrev_b32 v207, 2, v207
    v_lshlrev_b32 v3, 5, v0
    buffer_load_dwordx4 v208, s[8:11], s67 offen lds
    buffer_load_dword v172, v207, s[44:47], s78 offen
    buffer_load_dword v8, v3, s[44:47], 0 offen
    s_bfe_u32 s66, s77, 0x40000
    s_mul_i32 s64, s66, 589824
    s_mul_i32 s65, s66, 73728
    s_lshl_b32 s78, s66, 7
    s_add_u32 s68, s78, 18432
    s_mul_i32 s66, s66, 2304
    s_add_u32 m0, s72, 145792
    s_mul_i32 s63, s75, -128
    s_and_b32 s75, s58, 1
    v_bfe_u32 v5, v0, 2, 2
    v_mul_u32_u24 v197, 10784, v2
    v_lshl_add_u32 v199, v5, 4, v197
    v_lshl_add_u32 v197, v5, 6, v197
    v_lshl_add_u32 v197, v4, 3, v197
    buffer_load_dwordx4 v195, s[4:7], s78 offen lds
    s_add_u32 m0, s72, 147840
    s_lshl_b32 s62, s75, 5
    v_add_u32 v197, s62, v197
    v_add_u32 v198, 86272, v197
    v_lshrrev_b32 v5, 1, v4
    v_and_b32 v1, 1, v4
    v_lshl_add_u32 v199, v5, 8, v199
    v_lshl_add_u32 v199, v1, 3, v199
    v_add_u32 v199, 10240, v199
    buffer_load_dwordx4 v195, s[4:7], s68 offen lds
    s_add_u32 m0, s73, 145792
    v_add_u32 v200, 86272, v199
    v_bfe_u32 v5, v0, 1, 3
    v_add_u32 v5, 2, v5
    v_lshlrev_b32 v1, 1, v2
    v_xor_b32 v5, v5, v1
    v_and_b32 v5, 7, v5
    v_and_b32 v1, 15, v0
    v_lshlrev_b32 v1, 7, v1
    buffer_load_dwordx4 v196, s[4:7], s78 offen lds
    s_add_u32 m0, s73, 147840
    v_lshl_add_u32 v5, v5, 4, v1
    s_add_u32 s62, s79, 129408
    v_add_u32 v202, s62, v5
    v_xor_b32 v203, 16, v202
    s_xor_b32 s62, s79, 4096
    s_add_u32 s62, s62, 129408
    v_add_u32 v204, s62, v5
    v_xor_b32 v205, 16, v204
    buffer_load_dwordx4 v196, s[4:7], s68 offen lds
    s_lshl_b32 s62, s75, 6
    s_add_u32 s62, s62, 162176
    v_lshl_add_u32 v221, v2, 4, s62
    v_lshl_add_u32 v5, v6, 1, s63
    v_add_u32 v1, 1152, v5
    v_min_u32 v5, v5, v1
    s_lshl_b32 s63, s71, 1
    buffer_load_dword v173, v207, s[44:47], s78 offen
    s_add_u32 m0, s59, 51328
    v_cmp_gt_u32 vcc, 1024, v5
    v_xor_b32 v1, s63, v5
    s_nop 0
    v_cndmask_b32 v5, v5, v1, vcc
    v_add_u32 v5, 162176, v5
    v_mov_b32 v11, 262144
    s_mov_b32 s62, 163328
    v_writelane_b32 v11, s62, 0
    buffer_load_dwordx4 v206, s[8:11], s64 offen lds
    s_add_u32 s67, s64, s71
    s_add_u32 m0, s59, 43136
    v_mov_b32 v9, 0
    s_lshl_b32 s62, s57, 2
    s_add_u32 s62, s62, s58
    s_add_u32 s63, s62, 2
    s_and_b32 s63, s63, 7
    s_lshl_b32 s63, s63, 4
    v_lshlrev_b32 v1, 2, v0
    v_xor_b32 v1, s63, v1
    buffer_load_dwordx4 v191, s[8:11], s67 offen lds
    s_add_u32 m0, s59, 44160
    s_lshl_b32 s62, s62, 8
    s_add_u32 s62, s62, 129408
    v_add_u32 v222, s62, v1
    v_mov_b32 v177, 0
    s_mov_b32 s22, 5308416
    s_mov_b32 s23, 0x20000
    s_mov_b32 s26, 663552
    s_mov_b32 s27, 0x20000
    buffer_load_dwordx4 v208, s[8:11], s67 offen lds
    s_xor_b32 s67, s67, 128
    s_add_u32 m0, s59, 45184
    s_mov_b32 s30, 268435456
    s_mov_b32 s31, 0x20000
    s_mov_b32 s34, 2359296
    s_mov_b32 s35, 0x20000
    s_mov_b32 s42, 1152
    s_mov_b32 s43, 0x20000
    s_mov_b32 s50, 256
    s_mov_b32 s51, 0x20000
    buffer_load_dwordx4 v191, s[8:11], s67 offen lds
    ds_write_b32 v11, v9
    s_waitcnt vmcnt(15)
    v_lshlrev_b32 v6, 16, v7
    v_and_b32 v7, 0xffff0000, v7
    v_mov_b32 v9, 1
    ds_write_b64 v5, v[6:7]
    s_cmp_lt_u32 s53, 8
    s_cbranch_scc1 L_p1e
    s_branch L_main
.p2align 12
L_main:
    s_waitcnt vmcnt(10) lgkmcnt(0)
    s_barrier
    ds_read_b64_tr_b16 v[144:145], v197 offset:9216
    ds_read_b64_tr_b16 v[146:147], v197 offset:9472
    ds_read_b64_tr_b16 v[148:149], v197 offset:9728
    ds_read_b64_tr_b16 v[150:151], v197 offset:9984
    ds_read_b128 v[80:83], v202 offset:2048
    ds_read_b128 v[84:87], v203 offset:2048
    ds_read_b128 v[72:75], v202 offset:0
    ds_read_b128 v[76:79], v203 offset:0
    ds_read_b128 v[96:99], v204 offset:2048
    ds_read_b128 v[100:103], v205 offset:2048
    ds_read_b128 v[88:91], v204 offset:0
    ds_read_b128 v[92:95], v205 offset:0
    ds_read_b32 v174, v222 offset:0
    ds_read_b128 v[224:227], v221 offset:0
    s_waitcnt lgkmcnt(6)
    v_mfma_f32_16x16x32_bf16 v[52:55], v[148:151], v[84:87], 0
    s_add_u32 m0, s59, 52352
    ds_read_b64_tr_b16 v[152:153], v197 offset:0
    ds_read_b64_tr_b16 v[154:155], v197 offset:256
    v_mfma_f32_16x16x32_bf16 v[52:55], v[144:147], v[80:83], v[52:55]
    ds_read_b64_tr_b16 v[156:157], v197 offset:1024
    buffer_load_dwordx4 v192, s[12:15], s65 offen lds
    v_mfma_f32_16x16x32_bf16 v[48:51], v[144:147], v[72:75], 0
    ds_read_b64_tr_b16 v[158:159], v197 offset:1280
    v_mfma_f32_16x16x32_bf16 v[48:51], v[148:151], v[76:79], v[48:51]
    s_waitcnt lgkmcnt(5)
    ds_read_b128 v[240:243], v221 offset:128
    v_mfma_f32_16x16x32_bf16 v[60:63], v[148:151], v[100:103], 0
    s_add_u32 m0, s59, 46208
    ds_read_b64_tr_b16 v[160:161], v197 offset:512
    v_mfma_f32_16x16x32_bf16 v[60:63], v[144:147], v[96:99], v[60:63]
    ds_read_b64_tr_b16 v[162:163], v197 offset:768
    buffer_load_dwordx4 v208, s[8:11], s67 offen lds
    v_mfma_f32_16x16x32_bf16 v[56:59], v[144:147], v[88:91], 0
    s_xor_b32 s67, s67, 384
    ds_read_b64_tr_b16 v[164:165], v197 offset:1536
    v_mfma_f32_16x16x32_bf16 v[56:59], v[148:151], v[92:95], v[56:59]
    s_waitcnt lgkmcnt(4)
    ds_read_b64_tr_b16 v[166:167], v197 offset:1792
    v_mfma_f32_16x16x32_bf16 v[236:239], v[156:159], v[100:103], v[224:227]
    s_add_u32 m0, s59, 47232
    ds_read_b128 a[0:3], v221 offset:256
    v_mfma_f32_16x16x32_bf16 v[236:239], v[152:155], v[96:99], v[236:239]
    buffer_load_dwordx4 v191, s[8:11], s67 offen lds
    v_mfma_f32_16x16x32_bf16 v[232:235], v[152:155], v[88:91], v[224:227]
    ds_read_b64_tr_b16 v[136:137], v197 offset:2048
    v_mfma_f32_16x16x32_bf16 v[232:235], v[156:159], v[92:95], v[232:235]
    ds_read_b64_tr_b16 v[138:139], v197 offset:2304
    v_mfma_f32_16x16x32_bf16 v[228:231], v[156:159], v[84:87], v[224:227]
    ds_read_b64_tr_b16 v[140:141], v197 offset:3072
    v_lshlrev_b32 v178, 16, v174
    v_mfma_f32_16x16x32_bf16 v[228:231], v[152:155], v[80:83], v[228:231]
    ds_read_b64_tr_b16 v[142:143], v197 offset:3328
    v_lshlrev_b32 v179, 16, v172
    v_mfma_f32_16x16x32_bf16 v[224:227], v[152:155], v[72:75], v[224:227]
    s_add_u32 m0, s59, 48256
    ds_read_b128 a[16:19], v221 offset:384
    v_and_b32 v180, 0xffff0000, v174
    v_mfma_f32_16x16x32_bf16 v[224:227], v[156:159], v[76:79], v[224:227]
    s_waitcnt lgkmcnt(6)
    buffer_load_dwordx4 v208, s[8:11], s67 offen lds
    v_mfma_f32_16x16x32_bf16 v[252:255], v[164:167], v[100:103], v[240:243]
    ds_read_b64_tr_b16 v[144:145], v197 offset:2560
    v_and_b32 v181, 0xffff0000, v172
    v_mfma_f32_16x16x32_bf16 v[252:255], v[160:163], v[96:99], v[252:255]
    s_xor_b32 s67, s67, 128
    ds_read_b64_tr_b16 v[146:147], v197 offset:2816
    v_fmac_f32 v177, v178, v179
    v_mfma_f32_16x16x32_bf16 v[248:251], v[160:163], v[88:91], v[240:243]
    s_add_u32 m0, s59, 49280
    ds_read_b64_tr_b16 v[148:149], v197 offset:3584
    v_fmac_f32 v177, v180, v181
    v_mfma_f32_16x16x32_bf16 v[248:251], v[164:167], v[92:95], v[248:251]
    ds_read_b64_tr_b16 v[150:151], v197 offset:3840
    buffer_load_dwordx4 v191, s[8:11], s67 offen lds
    v_mfma_f32_16x16x32_bf16 v[244:247], v[164:167], v[84:87], v[240:243]
    ds_read_b128 a[32:35], v221 offset:512
    v_mfma_f32_16x16x32_bf16 v[244:247], v[160:163], v[80:83], v[244:247]
    v_mfma_f32_16x16x32_bf16 v[240:243], v[160:163], v[72:75], v[240:243]
    s_add_u32 m0, s59, 50304
    ds_read_b64_tr_b16 v[152:153], v197 offset:4096
    v_mfma_f32_16x16x32_bf16 v[240:243], v[164:167], v[76:79], v[240:243]
    s_waitcnt lgkmcnt(7)
    ds_read_b64_tr_b16 v[154:155], v197 offset:4352
    buffer_load_dwordx4 v208, s[8:11], s67 offen lds
    v_mfma_f32_16x16x32_bf16 a[12:15], v[140:143], v[100:103], a[0:3]
    ds_read_b64_tr_b16 v[156:157], v197 offset:5120
    v_mfma_f32_16x16x32_bf16 a[12:15], v[136:139], v[96:99], a[12:15]
    s_bfe_u32 s66, s77, 0x40004
    ds_read_b64_tr_b16 v[158:159], v197 offset:5376
    v_mfma_f32_16x16x32_bf16 a[8:11], v[136:139], v[88:91], a[0:3]
    s_mul_i32 s64, s66, 589824
    ds_read_b128 a[48:51], v221 offset:640
    v_mfma_f32_16x16x32_bf16 a[8:11], v[140:143], v[92:95], a[8:11]
    s_mul_i32 s65, s66, 73728
    v_mfma_f32_16x16x32_bf16 a[4:7], v[140:143], v[84:87], a[0:3]
    s_add_u32 m0, s59, 94464
    ds_read_b64_tr_b16 v[160:161], v197 offset:4608
    v_mfma_f32_16x16x32_bf16 a[4:7], v[136:139], v[80:83], a[4:7]
    ds_read_b64_tr_b16 v[162:163], v197 offset:4864
    buffer_load_dwordx4 v206, s[8:11], s64 offen lds
    v_mfma_f32_16x16x32_bf16 a[0:3], v[136:139], v[72:75], a[0:3]
    s_lshl_b32 s78, s66, 7
    ds_read_b64_tr_b16 v[164:165], v197 offset:5632
    v_mfma_f32_16x16x32_bf16 a[0:3], v[140:143], v[76:79], a[0:3]
    s_waitcnt lgkmcnt(9)
    ds_read_b64_tr_b16 v[166:167], v197 offset:5888
    v_mfma_f32_16x16x32_bf16 a[28:31], v[148:151], v[100:103], a[16:19]
    s_add_u32 s68, s78, 18432
    ds_read_b128 a[64:67], v221 offset:768
    s_add_u32 s67, s64, s71
    s_add_u32 m0, s59, 86272
    v_mfma_f32_16x16x32_bf16 a[28:31], v[144:147], v[96:99], a[28:31]
    buffer_load_dwordx4 v191, s[8:11], s67 offen lds
    v_mfma_f32_16x16x32_bf16 a[24:27], v[144:147], v[88:91], a[16:19]
    ds_read_b64_tr_b16 v[136:137], v197 offset:6144
    v_mfma_f32_16x16x32_bf16 a[24:27], v[148:151], v[92:95], a[24:27]
    ds_read_b64_tr_b16 v[138:139], v197 offset:6400
    v_mfma_f32_16x16x32_bf16 a[20:23], v[148:151], v[84:87], a[16:19]
    ds_read_b64_tr_b16 v[140:141], v197 offset:7168
    v_mfma_f32_16x16x32_bf16 a[20:23], v[144:147], v[80:83], a[20:23]
    s_mul_i32 s66, s66, 2304
    ds_read_b64_tr_b16 v[142:143], v197 offset:7424
    v_mfma_f32_16x16x32_bf16 a[16:19], v[144:147], v[72:75], a[16:19]
    s_add_u32 m0, s59, 87296
    ds_read_b128 a[80:83], v221 offset:896
    v_mfma_f32_16x16x32_bf16 a[16:19], v[148:151], v[76:79], a[16:19]
    s_waitcnt lgkmcnt(11)
    buffer_load_dwordx4 v208, s[8:11], s67 offen lds
    v_mfma_f32_16x16x32_bf16 a[44:47], v[156:159], v[100:103], a[32:35]
    ds_read_b64_tr_b16 v[144:145], v197 offset:6656
    v_mfma_f32_16x16x32_bf16 a[44:47], v[152:155], v[96:99], a[44:47]
    s_xor_b32 s67, s67, 128
    ds_read_b64_tr_b16 v[146:147], v197 offset:6912
    v_mfma_f32_16x16x32_bf16 a[40:43], v[152:155], v[88:91], a[32:35]
    s_add_u32 m0, s59, 88320
    ds_read_b64_tr_b16 v[148:149], v197 offset:7680
    v_mfma_f32_16x16x32_bf16 a[40:43], v[156:159], v[92:95], a[40:43]
    ds_read_b64_tr_b16 v[150:151], v197 offset:7936
    buffer_load_dwordx4 v191, s[8:11], s67 offen lds
    v_mfma_f32_16x16x32_bf16 a[36:39], v[156:159], v[84:87], a[32:35]
    ds_read_b128 a[96:99], v221 offset:1024
    v_mfma_f32_16x16x32_bf16 a[36:39], v[152:155], v[80:83], a[36:39]
    v_mfma_f32_16x16x32_bf16 a[32:35], v[152:155], v[72:75], a[32:35]
    s_add_u32 m0, s59, 95488
    ds_read_b64_tr_b16 v[152:153], v197 offset:8192
    v_mfma_f32_16x16x32_bf16 a[32:35], v[156:159], v[76:79], a[32:35]
    s_waitcnt lgkmcnt(12)
    ds_read_b64_tr_b16 v[154:155], v197 offset:8448
    buffer_load_dwordx4 v192, s[12:15], s65 offen lds
    v_mfma_f32_16x16x32_bf16 a[60:63], v[164:167], v[100:103], a[48:51]
    ds_read_b64_tr_b16 v[156:157], v197 offset:8704
    v_mfma_f32_16x16x32_bf16 a[60:63], v[160:163], v[96:99], a[60:63]
    ds_read_b64_tr_b16 v[158:159], v197 offset:8960
    v_mfma_f32_16x16x32_bf16 a[56:59], v[160:163], v[88:91], a[48:51]
    v_mfma_f32_16x16x32_bf16 a[56:59], v[164:167], v[92:95], a[56:59]
    s_add_u32 m0, s59, 89344
    v_mfma_f32_16x16x32_bf16 a[52:55], v[164:167], v[84:87], a[48:51]
    s_waitcnt vmcnt(5)
    ds_add_u32 v11, v9
    v_mfma_f32_16x16x32_bf16 a[52:55], v[160:163], v[80:83], a[52:55]
    buffer_load_dwordx4 v208, s[8:11], s67 offen lds
    v_mfma_f32_16x16x32_bf16 a[48:51], v[160:163], v[72:75], a[48:51]
    s_xor_b32 s67, s67, 384
    v_mfma_f32_16x16x32_bf16 a[48:51], v[164:167], v[76:79], a[48:51]
    s_waitcnt lgkmcnt(11)
    v_mfma_f32_16x16x32_bf16 a[76:79], v[140:143], v[100:103], a[64:67]
    s_add_u32 m0, s59, 90368
    v_mfma_f32_16x16x32_bf16 a[76:79], v[136:139], v[96:99], a[76:79]
    ds_read_b32 v6, v11
    buffer_load_dwordx4 v191, s[8:11], s67 offen lds
    v_mfma_f32_16x16x32_bf16 a[72:75], v[136:139], v[88:91], a[64:67]
    v_mfma_f32_16x16x32_bf16 a[72:75], v[140:143], v[92:95], a[72:75]
    v_mfma_f32_16x16x32_bf16 a[68:71], v[140:143], v[84:87], a[64:67]
    v_mfma_f32_16x16x32_bf16 a[68:71], v[136:139], v[80:83], a[68:71]
    s_add_u32 m0, s72, 129408
    v_mfma_f32_16x16x32_bf16 a[64:67], v[136:139], v[72:75], a[64:67]
    s_waitcnt lgkmcnt(0)
    v_cmp_le_u32 vcc, 4, v6
    v_mfma_f32_16x16x32_bf16 a[64:67], v[140:143], v[76:79], a[64:67]
    s_waitcnt lgkmcnt(7)
    v_mfma_f32_16x16x32_bf16 a[92:95], v[148:151], v[100:103], a[80:83]
    s_cbranch_vccz L_spin0
L_back0:
    ds_read_b128 v[112:115], v202 offset:18432
    v_mfma_f32_16x16x32_bf16 a[92:95], v[144:147], v[96:99], a[92:95]
    buffer_load_dwordx4 v195, s[4:7], s78 offen lds
    v_mfma_f32_16x16x32_bf16 a[88:91], v[144:147], v[88:91], a[80:83]
    ds_read_b128 v[116:119], v203 offset:18432
    v_mfma_f32_16x16x32_bf16 a[88:91], v[148:151], v[92:95], a[88:91]
    ds_read_b128 v[104:107], v202 offset:16384
    v_mfma_f32_16x16x32_bf16 a[84:87], v[148:151], v[84:87], a[80:83]
    s_add_u32 m0, s72, 131456
    ds_read_b128 v[108:111], v203 offset:16384
    v_mfma_f32_16x16x32_bf16 a[84:87], v[144:147], v[80:83], a[84:87]
    buffer_load_dwordx4 v195, s[4:7], s68 offen lds
    v_mfma_f32_16x16x32_bf16 a[80:83], v[144:147], v[72:75], a[80:83]
    ds_read_b64_tr_b16 v[160:161], v197 offset:52352
    ds_read_b64_tr_b16 v[162:163], v197 offset:52608
    v_mfma_f32_16x16x32_bf16 a[80:83], v[148:151], v[76:79], a[80:83]
    s_waitcnt lgkmcnt(8)
    ds_read_b64_tr_b16 v[164:165], v197 offset:52864
    v_mfma_f32_16x16x32_bf16 a[108:111], v[156:159], v[100:103], a[96:99]
    s_add_u32 m0, s73, 129408
    ds_read_b64_tr_b16 v[166:167], v197 offset:53120
    v_mfma_f32_16x16x32_bf16 a[108:111], v[152:155], v[96:99], a[108:111]
    buffer_load_dwordx4 v196, s[4:7], s78 offen lds
    v_mfma_f32_16x16x32_bf16 a[104:107], v[152:155], v[88:91], a[96:99]
    ds_read_b128 v[128:131], v204 offset:18432
    v_mfma_f32_16x16x32_bf16 a[104:107], v[156:159], v[92:95], a[104:107]
    ds_read_b128 v[132:135], v205 offset:18432
    v_mfma_f32_16x16x32_bf16 a[100:103], v[156:159], v[84:87], a[96:99]
    s_add_u32 m0, s73, 131456
    ds_read_b128 v[120:123], v204 offset:16384
    v_mfma_f32_16x16x32_bf16 a[100:103], v[152:155], v[80:83], a[100:103]
    buffer_load_dwordx4 v196, s[4:7], s68 offen lds
    v_mfma_f32_16x16x32_bf16 a[96:99], v[152:155], v[72:75], a[96:99]
    ds_read_b128 v[124:127], v205 offset:16384
    ds_read_b32 v174, v222 offset:16384
    v_mfma_f32_16x16x32_bf16 a[96:99], v[156:159], v[76:79], a[96:99]
    s_waitcnt lgkmcnt(5)
    buffer_load_dword v172, v207, s[44:47], s78 offen
    v_mfma_f32_16x16x32_bf16 v[52:55], v[164:167], v[116:119], v[52:55]
    ds_read_b64_tr_b16 v[136:137], v197 offset:43136
    ds_read_b64_tr_b16 v[138:139], v197 offset:43392
    v_mfma_f32_16x16x32_bf16 v[52:55], v[160:163], v[112:115], v[52:55]
    ds_read_b64_tr_b16 v[140:141], v197 offset:44160
    v_mfma_f32_16x16x32_bf16 v[48:51], v[160:163], v[104:107], v[48:51]
    s_add_u32 m0, s59, 91392
    ds_read_b64_tr_b16 v[142:143], v197 offset:44416
    v_mfma_f32_16x16x32_bf16 v[48:51], v[164:167], v[108:111], v[48:51]
    s_waitcnt lgkmcnt(4)
    buffer_load_dwordx4 v208, s[8:11], s67 offen lds
    v_mfma_f32_16x16x32_bf16 v[60:63], v[164:167], v[132:135], v[60:63]
    s_xor_b32 s67, s67, 128
    ds_read_b64_tr_b16 v[144:145], v197 offset:43648
    v_lshlrev_b32 v178, 16, v174
    v_mfma_f32_16x16x32_bf16 v[60:63], v[160:163], v[128:131], v[60:63]
    s_add_u32 m0, s59, 92416
    ds_read_b64_tr_b16 v[146:147], v197 offset:43904
    v_lshlrev_b32 v179, 16, v173
    v_mfma_f32_16x16x32_bf16 v[56:59], v[160:163], v[120:123], v[56:59]
    s_lshl_b32 s62, s56, 4
    buffer_load_dwordx4 v191, s[8:11], s67 offen lds
    v_mfma_f32_16x16x32_bf16 v[56:59], v[164:167], v[124:127], v[56:59]
    s_waitcnt lgkmcnt(2)
    ds_read_b64_tr_b16 v[148:149], v197 offset:44672
    v_and_b32 v180, 0xffff0000, v174
    v_mfma_f32_16x16x32_bf16 v[236:239], v[140:143], v[132:135], v[236:239]
    s_add_u32 s62, s62, s57
    ds_read_b64_tr_b16 v[150:151], v197 offset:44928
    v_and_b32 v181, 0xffff0000, v173
    v_mfma_f32_16x16x32_bf16 v[236:239], v[136:139], v[128:131], v[236:239]
    s_lshl_b32 s63, s62, 10
    v_fmac_f32 v177, v178, v179
    v_fmac_f32 v177, v180, v181
    v_mfma_f32_16x16x32_bf16 v[232:235], v[136:139], v[120:123], v[232:235]
    s_add_u32 s63, s63, 3145728
    ds_read_b64_tr_b16 v[152:153], v197 offset:45184
    v_lshl_add_u32 v220, v201, 2, s63
    v_mfma_f32_16x16x32_bf16 v[232:235], v[140:143], v[124:127], v[232:235]
    s_add_u32 m0, s59, 93440
    ds_read_b64_tr_b16 v[154:155], v197 offset:45440
    v_mfma_f32_16x16x32_bf16 v[228:231], v[140:143], v[116:119], v[228:231]
    s_lshl_b32 s62, s62, 2
    buffer_load_dwordx4 v208, s[8:11], s67 offen lds
    v_mfma_f32_16x16x32_bf16 v[228:231], v[136:139], v[112:115], v[228:231]
    s_bfe_u32 s66, s77, 0x40008
    ds_read_b64_tr_b16 v[156:157], v197 offset:46208
    v_mfma_f32_16x16x32_bf16 v[224:227], v[136:139], v[104:107], v[224:227]
    s_mul_i32 s64, s66, 589824
    ds_read_b64_tr_b16 v[158:159], v197 offset:46464
    s_mul_i32 s65, s66, 73728
    s_add_u32 m0, s59, 8192
    v_mfma_f32_16x16x32_bf16 v[224:227], v[140:143], v[108:111], v[224:227]
    s_waitcnt lgkmcnt(4)
    buffer_load_dwordx4 v206, s[8:11], s64 offen lds
    v_mfma_f32_16x16x32_bf16 v[252:255], v[148:151], v[132:135], v[252:255]
    s_add_u32 s62, s62, s58
    ds_read_b64_tr_b16 v[160:161], v197 offset:45696
    v_mfma_f32_16x16x32_bf16 v[252:255], v[144:147], v[128:131], v[252:255]
    s_lshl_b32 s78, s66, 7
    ds_read_b64_tr_b16 v[162:163], v197 offset:45952
    v_mfma_f32_16x16x32_bf16 v[248:251], v[144:147], v[120:123], v[248:251]
    s_add_u32 s68, s78, 18432
    v_mfma_f32_16x16x32_bf16 v[248:251], v[148:151], v[124:127], v[248:251]
    s_add_u32 s67, s64, s71
    ds_read_b64_tr_b16 v[164:165], v197 offset:46720
    v_mfma_f32_16x16x32_bf16 v[244:247], v[148:151], v[116:119], v[244:247]
    s_add_u32 m0, s59, 0
    ds_read_b64_tr_b16 v[166:167], v197 offset:46976
    v_mfma_f32_16x16x32_bf16 v[244:247], v[144:147], v[112:115], v[244:247]
    s_lshl_b32 s62, s62, 7
    buffer_load_dwordx4 v191, s[8:11], s67 offen lds
    v_mfma_f32_16x16x32_bf16 v[240:243], v[144:147], v[104:107], v[240:243]
    s_add_u32 s3, s62, 196608
    ds_read_b64_tr_b16 v[136:137], v197 offset:47232
    v_mfma_f32_16x16x32_bf16 v[240:243], v[148:151], v[108:111], v[240:243]
    s_waitcnt lgkmcnt(5)
    ds_read_b64_tr_b16 v[138:139], v197 offset:47488
    v_mfma_f32_16x16x32_bf16 a[12:15], v[156:159], v[132:135], a[12:15]
    s_lshl_b32 s62, s56, 13
    v_mfma_f32_16x16x32_bf16 a[12:15], v[152:155], v[128:131], a[12:15]
    s_mul_i32 s66, s66, 2304
    ds_read_b64_tr_b16 v[140:141], v197 offset:48256
    v_mfma_f32_16x16x32_bf16 a[8:11], v[152:155], v[120:123], a[8:11]
    s_add_u32 m0, s59, 1024
    ds_read_b64_tr_b16 v[142:143], v197 offset:48512
    v_mfma_f32_16x16x32_bf16 a[8:11], v[156:159], v[124:127], a[8:11]
    s_add_u32 s62, s62, 196608
    buffer_load_dwordx4 v208, s[8:11], s67 offen lds
    v_mfma_f32_16x16x32_bf16 a[4:7], v[156:159], v[116:119], a[4:7]
    s_xor_b32 s67, s67, 128
    ds_read_b64_tr_b16 v[144:145], v197 offset:47744
    v_mfma_f32_16x16x32_bf16 a[4:7], v[152:155], v[112:115], a[4:7]
    s_add_u32 m0, s59, 2048
    ds_read_b64_tr_b16 v[146:147], v197 offset:48000
    v_mfma_f32_16x16x32_bf16 a[0:3], v[152:155], v[104:107], a[0:3]
    s_lshr_b32 s63, s53, 1
    buffer_load_dwordx4 v191, s[8:11], s67 offen lds
    v_mfma_f32_16x16x32_bf16 a[0:3], v[156:159], v[108:111], a[0:3]
    s_waitcnt lgkmcnt(6)
    ds_read_b64_tr_b16 v[148:149], v197 offset:48768
    v_mfma_f32_16x16x32_bf16 a[28:31], v[164:167], v[132:135], a[28:31]
    s_mul_i32 s63, s63, 131072
    ds_read_b64_tr_b16 v[150:151], v197 offset:49024
    v_mfma_f32_16x16x32_bf16 a[28:31], v[160:163], v[128:131], a[28:31]
    s_add_u32 s62, s62, s63
    v_mfma_f32_16x16x32_bf16 a[24:27], v[160:163], v[120:123], a[24:27]
    s_and_b32 s63, s57, 1
    ds_read_b64_tr_b16 v[152:153], v197 offset:49280
    v_mfma_f32_16x16x32_bf16 a[24:27], v[164:167], v[124:127], a[24:27]
    s_add_u32 m0, s59, 9216
    ds_read_b64_tr_b16 v[154:155], v197 offset:49536
    v_mfma_f32_16x16x32_bf16 a[20:23], v[164:167], v[116:119], a[20:23]
    s_lshl_b32 s63, s63, 12
    buffer_load_dwordx4 v192, s[12:15], s65 offen lds
    v_mfma_f32_16x16x32_bf16 a[20:23], v[160:163], v[112:115], a[20:23]
    s_add_u32 s62, s62, s63
    ds_read_b64_tr_b16 v[156:157], v197 offset:50304
    v_mfma_f32_16x16x32_bf16 a[16:19], v[160:163], v[104:107], a[16:19]
    s_add_u32 m0, s59, 3072
    ds_read_b64_tr_b16 v[158:159], v197 offset:50560
    v_mfma_f32_16x16x32_bf16 a[16:19], v[164:167], v[108:111], a[16:19]
    s_waitcnt lgkmcnt(8)
    buffer_load_dwordx4 v208, s[8:11], s67 offen lds
    v_mfma_f32_16x16x32_bf16 a[44:47], v[140:143], v[132:135], a[44:47]
    s_cmp_lt_u32 s53, 6
    s_cselect_b32 s62, s62, 1073741824
    ds_read_b64_tr_b16 v[160:161], v197 offset:49792
    v_mfma_f32_16x16x32_bf16 a[44:47], v[136:139], v[128:131], a[44:47]
    ds_read_b64_tr_b16 v[162:163], v197 offset:50048
    v_lshl_add_u32 v175, v201, 4, s62
    v_mfma_f32_16x16x32_bf16 a[40:43], v[136:139], v[120:123], a[40:43]
    v_mov_b32 v5, 0xc0135761
    v_mov_b32 v13, 0xdddddddd
    v_mfma_f32_16x16x32_bf16 a[40:43], v[140:143], v[124:127], a[40:43]
    s_xor_b32 s67, s67, 384
    ds_read_b64_tr_b16 v[164:165], v197 offset:50816
    v_lshlrev_b32 v7, 4, v0
    v_mfma_f32_16x16x32_bf16 a[36:39], v[140:143], v[116:119], a[36:39]
    s_add_u32 m0, s59, 4096
    ds_read_b64_tr_b16 v[166:167], v197 offset:51072
    v_and_b32 v14, 0xf0, v7
    v_mfma_f32_16x16x32_bf16 a[36:39], v[136:139], v[112:115], a[36:39]
    s_mov_b32 s70, 0xbdd2d3e8
    buffer_load_dwordx4 v191, s[8:11], s67 offen lds
    v_mfma_f32_16x16x32_bf16 a[32:35], v[136:139], v[104:107], a[32:35]
    ds_read_b64_tr_b16 v[136:137], v197 offset:51328
    v_mov_b32 v168, 0
    v_mfma_f32_16x16x32_bf16 a[32:35], v[140:143], v[108:111], a[32:35]
    s_waitcnt lgkmcnt(9)
    ds_read_b64_tr_b16 v[138:139], v197 offset:51584
    v_mov_b32 v169, 0
    v_mfma_f32_16x16x32_bf16 a[60:63], v[148:151], v[132:135], a[60:63]
    v_mov_b32 v170, 0
    v_mov_b32 v171, 0
    v_mfma_f32_16x16x32_bf16 a[60:63], v[144:147], v[128:131], a[60:63]
    s_lshl_b32 s62, s56, 2
    ds_read_b64_tr_b16 v[140:141], v197 offset:51840
    v_mfma_f32_16x16x32_bf16 a[56:59], v[144:147], v[120:123], a[56:59]
    s_add_u32 m0, s59, 5120
    ds_read_b64_tr_b16 v[142:143], v197 offset:52096
    v_mfma_f32_16x16x32_bf16 a[56:59], v[148:151], v[124:127], a[56:59]
    s_add_u32 s62, s62, s58
    buffer_load_dwordx4 v208, s[8:11], s67 offen lds
    v_mfma_f32_16x16x32_bf16 a[52:55], v[148:151], v[116:119], a[52:55]
    s_waitcnt vmcnt(8)
    ds_add_u32 v11, v9
    v_mfma_f32_16x16x32_bf16 a[52:55], v[144:147], v[112:115], a[52:55]
    s_xor_b32 s67, s67, 128
    s_add_u32 m0, s59, 6144
    v_mfma_f32_16x16x32_bf16 a[48:51], v[144:147], v[104:107], a[48:51]
    s_mul_i32 s62, s62, 36864
    buffer_load_dwordx4 v191, s[8:11], s67 offen lds
    v_mfma_f32_16x16x32_bf16 a[48:51], v[148:151], v[108:111], a[48:51]
    s_waitcnt lgkmcnt(9)
    v_mfma_f32_16x16x32_bf16 a[76:79], v[156:159], v[132:135], a[76:79]
    s_add_u32 s62, s62, 673792
    v_mfma_f32_16x16x32_bf16 a[76:79], v[152:155], v[128:131], a[76:79]
    s_lshl_b32 s63, s100, 10
    ds_read_b32 v6, v11
    v_mfma_f32_16x16x32_bf16 a[72:75], v[152:155], v[120:123], a[72:75]
    s_add_u32 m0, s59, 7168
    v_mfma_f32_16x16x32_bf16 a[72:75], v[156:159], v[124:127], a[72:75]
    s_add_u32 s63, s63, s62
    buffer_load_dwordx4 v208, s[8:11], s67 offen lds
    v_mfma_f32_16x16x32_bf16 a[68:71], v[156:159], v[116:119], a[68:71]
    v_lshl_add_u32 v182, v0, 4, s63
    v_mfma_f32_16x16x32_bf16 a[68:71], v[152:155], v[112:115], a[68:71]
    s_add_u32 m0, s72, 145792
    v_mfma_f32_16x16x32_bf16 a[64:67], v[152:155], v[104:107], a[64:67]
    s_waitcnt lgkmcnt(0)
    v_cmp_le_u32 vcc, 8, v6
    v_mfma_f32_16x16x32_bf16 a[64:67], v[156:159], v[108:111], a[64:67]
    s_waitcnt lgkmcnt(6)
    v_mfma_f32_16x16x32_bf16 a[92:95], v[164:167], v[132:135], a[92:95]
    s_cbranch_vccz L_spin1
L_back1:
    ds_read_b128 v[80:83], v202 offset:2048
    v_mfma_f32_16x16x32_bf16 a[92:95], v[160:163], v[128:131], a[92:95]
    buffer_load_dwordx4 v195, s[4:7], s78 offen lds
    v_mfma_f32_16x16x32_bf16 a[88:91], v[160:163], v[120:123], a[88:91]
    ds_read_b128 v[84:87], v203 offset:2048
    v_mfma_f32_16x16x32_bf16 a[88:91], v[164:167], v[124:127], a[88:91]
    ds_read_b128 v[72:75], v202 offset:0
    v_mfma_f32_16x16x32_bf16 a[84:87], v[164:167], v[116:119], a[84:87]
    s_add_u32 m0, s72, 147840
    ds_read_b128 v[76:79], v203 offset:0
    v_mfma_f32_16x16x32_bf16 a[84:87], v[160:163], v[112:115], a[84:87]
    buffer_load_dwordx4 v195, s[4:7], s68 offen lds
    v_mfma_f32_16x16x32_bf16 a[80:83], v[160:163], v[104:107], a[80:83]
    ds_read_b64_tr_b16 v[144:145], v198 offset:9216
    ds_read_b64_tr_b16 v[146:147], v198 offset:9472
    v_mfma_f32_16x16x32_bf16 a[80:83], v[164:167], v[108:111], a[80:83]
    s_waitcnt lgkmcnt(8)
    ds_read_b64_tr_b16 v[148:149], v198 offset:9728
    v_mfma_f32_16x16x32_bf16 a[108:111], v[140:143], v[132:135], a[108:111]
    s_add_u32 m0, s73, 145792
    ds_read_b64_tr_b16 v[150:151], v198 offset:9984
    v_mfma_f32_16x16x32_bf16 a[108:111], v[136:139], v[128:131], a[108:111]
    buffer_load_dwordx4 v196, s[4:7], s78 offen lds
    v_mfma_f32_16x16x32_bf16 a[104:107], v[136:139], v[120:123], a[104:107]
    ds_read_b128 v[96:99], v204 offset:2048
    v_mfma_f32_16x16x32_bf16 a[104:107], v[140:143], v[124:127], a[104:107]
    ds_read_b128 v[100:103], v205 offset:2048
    v_mfma_f32_16x16x32_bf16 a[100:103], v[140:143], v[116:119], a[100:103]
    s_add_u32 m0, s73, 147840
    ds_read_b128 v[88:91], v204 offset:0
    v_mfma_f32_16x16x32_bf16 a[100:103], v[136:139], v[112:115], a[100:103]
    buffer_load_dwordx4 v196, s[4:7], s68 offen lds
    v_mfma_f32_16x16x32_bf16 a[96:99], v[136:139], v[104:107], a[96:99]
    ds_read_b128 v[92:95], v205 offset:0
    ds_read_b32 v174, v222 offset:0
    v_mfma_f32_16x16x32_bf16 a[96:99], v[140:143], v[108:111], a[96:99]
    s_waitcnt lgkmcnt(5)
    buffer_load_dword v173, v207, s[44:47], s78 offen
    v_mfma_f32_16x16x32_bf16 v[52:55], v[148:151], v[84:87], v[52:55]
    s_bfe_u32 s66, s77, 0x4000c
    ds_read_b64_tr_b16 v[152:153], v198 offset:0
    ds_read_b64_tr_b16 v[154:155], v198 offset:256
    v_mfma_f32_16x16x32_bf16 v[52:55], v[144:147], v[80:83], v[52:55]
    s_mul_i32 s64, s66, 589824
    ds_read_b64_tr_b16 v[156:157], v198 offset:1024
    v_mfma_f32_16x16x32_bf16 v[48:51], v[144:147], v[72:75], v[48:51]
    s_mul_i32 s65, s66, 73728
    ds_read_b64_tr_b16 v[158:159], v198 offset:1280
    s_add_u32 m0, s59, 51328
    v_mfma_f32_16x16x32_bf16 v[48:51], v[148:151], v[76:79], v[48:51]
    s_waitcnt lgkmcnt(4)
    buffer_load_dwordx4 v206, s[8:11], s64 offen lds
    v_mfma_f32_16x16x32_bf16 v[60:63], v[148:151], v[100:103], v[60:63]
    s_lshl_b32 s63, s100, 7
    ds_read_b64_tr_b16 v[160:161], v198 offset:512
    v_lshlrev_b32 v178, 16, v174
    v_mfma_f32_16x16x32_bf16 v[60:63], v[144:147], v[96:99], v[60:63]
    s_lshl_b32 s78, s66, 7
    ds_read_b64_tr_b16 v[162:163], v198 offset:768
    v_lshlrev_b32 v179, 16, v172
    v_mfma_f32_16x16x32_bf16 v[56:59], v[144:147], v[88:91], v[56:59]
    s_add_u32 s68, s78, 18432
    v_and_b32 v180, 0xffff0000, v174
    v_and_b32 v181, 0xffff0000, v172
    v_mfma_f32_16x16x32_bf16 v[56:59], v[148:151], v[92:95], v[56:59]
    s_waitcnt lgkmcnt(2)
    ds_read_b64_tr_b16 v[164:165], v198 offset:1536
    v_fmac_f32 v177, v178, v179
    v_mfma_f32_16x16x32_bf16 v[236:239], v[156:159], v[100:103], v[236:239]
    s_add_u32 s67, s64, s71
    ds_read_b64_tr_b16 v[166:167], v198 offset:1792
    s_add_u32 m0, s59, 43136
    v_mfma_f32_16x16x32_bf16 v[236:239], v[152:155], v[96:99], v[236:239]
    s_add_u32 s63, s63, s62
    buffer_load_dwordx4 v191, s[8:11], s67 offen lds
    v_mfma_f32_16x16x32_bf16 v[232:235], v[152:155], v[88:91], v[232:235]
    s_add_u32 s63, s63, 16384
    ds_read_b64_tr_b16 v[136:137], v198 offset:2048
    v_fmac_f32 v177, v180, v181
    v_mfma_f32_16x16x32_bf16 v[232:235], v[156:159], v[92:95], v[232:235]
    ds_read_b64_tr_b16 v[138:139], v198 offset:2304
    v_add_u32 v183, s63, v207
    v_mfma_f32_16x16x32_bf16 v[228:231], v[156:159], v[84:87], v[228:231]
    v_mov_b32 v184, -1
    v_mov_b32 v185, -1
    v_mfma_f32_16x16x32_bf16 v[228:231], v[152:155], v[80:83], v[228:231]
    s_mul_i32 s66, s66, 2304
    ds_read_b64_tr_b16 v[140:141], v198 offset:3072
    v_mov_b32 v186, -1
    v_mfma_f32_16x16x32_bf16 v[224:227], v[152:155], v[72:75], v[224:227]
    s_add_u32 m0, s59, 44160
    ds_read_b64_tr_b16 v[142:143], v198 offset:3328
    v_mov_b32 v187, -1
    v_mfma_f32_16x16x32_bf16 v[224:227], v[156:159], v[76:79], v[224:227]
    s_waitcnt lgkmcnt(4)
    buffer_load_dwordx4 v208, s[8:11], s67 offen lds
    v_mfma_f32_16x16x32_bf16 v[252:255], v[164:167], v[100:103], v[252:255]
    s_mul_i32 s62, s57, 288
    ds_read_b64_tr_b16 v[144:145], v198 offset:2560
    v_mfma_f32_16x16x32_bf16 v[252:255], v[160:163], v[96:99], v[252:255]
    s_lshl_b32 s63, s58, 3
    ds_read_b64_tr_b16 v[146:147], v198 offset:2816
    v_mfma_f32_16x16x32_bf16 v[248:251], v[160:163], v[88:91], v[248:251]
    s_add_u32 s62, s62, s63
    v_mfma_f32_16x16x32_bf16 v[248:251], v[164:167], v[92:95], v[248:251]
    s_xor_b32 s67, s67, 128
    ds_read_b64_tr_b16 v[148:149], v198 offset:3584
    v_mfma_f32_16x16x32_bf16 v[244:247], v[164:167], v[84:87], v[244:247]
    s_add_u32 m0, s59, 45184
    ds_read_b64_tr_b16 v[150:151], v198 offset:3840
    v_mfma_f32_16x16x32_bf16 v[244:247], v[160:163], v[80:83], v[244:247]
    s_and_b32 s63, s57, 1
    buffer_load_dwordx4 v191, s[8:11], s67 offen lds
    v_mfma_f32_16x16x32_bf16 v[240:243], v[160:163], v[72:75], v[240:243]
    s_lshl_b32 s63, s63, 5
    ds_read_b64_tr_b16 v[152:153], v198 offset:4096
    v_mfma_f32_16x16x32_bf16 v[240:243], v[164:167], v[76:79], v[240:243]
    s_waitcnt lgkmcnt(5)
    ds_read_b64_tr_b16 v[154:155], v198 offset:4352
    v_mfma_f32_16x16x32_bf16 a[12:15], v[140:143], v[100:103], a[12:15]
    s_add_u32 s62, s62, s63
    v_bfe_u32 v214, v0, 2, 3
    v_add_u32 v214, s62, v214
    v_mfma_f32_16x16x32_bf16 a[12:15], v[136:139], v[96:99], a[12:15]
    ds_read_b64_tr_b16 v[156:157], v198 offset:5120
    v_mul_u32_u24 v2, 1152, v214
    v_mfma_f32_16x16x32_bf16 a[8:11], v[136:139], v[88:91], a[8:11]
    s_add_u32 m0, s59, 52352
    ds_read_b64_tr_b16 v[158:159], v198 offset:5376
    v_lshrrev_b32 v215, 5, v0
    v_mfma_f32_16x16x32_bf16 a[8:11], v[140:143], v[92:95], a[8:11]
    buffer_load_dwordx4 v192, s[12:15], s65 offen lds
    v_mfma_f32_16x16x32_bf16 a[4:7], v[140:143], v[84:87], a[4:7]
    ds_read_b64_tr_b16 v[160:161], v198 offset:4608
    v_lshl_add_u32 v2, v215, 6, v2
    v_mfma_f32_16x16x32_bf16 a[4:7], v[136:139], v[80:83], a[4:7]
    ds_read_b64_tr_b16 v[162:163], v198 offset:4864
    v_and_b32 v214, 3, v0
    v_mfma_f32_16x16x32_bf16 a[0:3], v[136:139], v[72:75], a[0:3]
    v_lshl_add_u32 v2, v214, 4, v2
    v_mul_u32_u24 v1, 10784, v215
    v_mfma_f32_16x16x32_bf16 a[0:3], v[140:143], v[76:79], a[0:3]
    s_waitcnt lgkmcnt(6)
    ds_read_b64_tr_b16 v[164:165], v198 offset:5632
    v_bfe_u32 v214, v0, 2, 2
    v_mfma_f32_16x16x32_bf16 a[28:31], v[148:151], v[100:103], a[28:31]
L_q0:
    s_cbranch_execz L_wret
    s_add_u32 m0, s59, 46208
    ds_read_b64_tr_b16 v[166:167], v198 offset:5888
    v_lshl_add_u32 v1, v214, 6, v1
    v_mfma_f32_16x16x32_bf16 a[28:31], v[144:147], v[96:99], a[28:31]
    buffer_load_dwordx4 v208, s[8:11], s67 offen lds
    v_mfma_f32_16x16x32_bf16 a[24:27], v[144:147], v[88:91], a[24:27]
    ds_read_b64_tr_b16 v[136:137], v198 offset:6144
    v_bfe_u32 v214, v0, 4, 1
    v_mfma_f32_16x16x32_bf16 a[24:27], v[148:151], v[92:95], a[24:27]
    ds_read_b64_tr_b16 v[138:139], v198 offset:6400
    v_lshl_add_u32 v1, v214, 5, v1
    v_mfma_f32_16x16x32_bf16 a[20:23], v[148:151], v[84:87], a[20:23]
    v_and_b32 v214, 1, v0
    v_lshl_add_u32 v1, v214, 4, v1
    v_mfma_f32_16x16x32_bf16 a[20:23], v[144:147], v[80:83], a[20:23]
    s_xor_b32 s67, s67, 384
    ds_read_b64_tr_b16 v[140:141], v198 offset:7168
    v_bfe_u32 v214, v0, 1, 1
    v_mfma_f32_16x16x32_bf16 a[16:19], v[144:147], v[72:75], a[16:19]
    s_add_u32 m0, s59, 47232
    ds_read_b64_tr_b16 v[142:143], v198 offset:7424
    v_lshl_add_u32 v1, v214, 3, v1
    v_mfma_f32_16x16x32_bf16 a[16:19], v[148:151], v[76:79], a[16:19]
    s_waitcnt lgkmcnt(8)
    buffer_load_dwordx4 v191, s[8:11], s67 offen lds
    v_mfma_f32_16x16x32_bf16 a[44:47], v[156:159], v[100:103], a[44:47]
    s_lshr_b32 s62, s58, 1
    ds_read_b64_tr_b16 v[144:145], v198 offset:6656
    v_mfma_f32_16x16x32_bf16 a[44:47], v[152:155], v[96:99], a[44:47]
    s_mul_i32 s62, s62, 4608
    ds_read_b64_tr_b16 v[146:147], v198 offset:6912
    v_mfma_f32_16x16x32_bf16 a[40:43], v[152:155], v[88:91], a[40:43]
    s_add_u32 s63, s62, 2048
    v_add_u32 v10, s63, v1
    v_mfma_f32_16x16x32_bf16 a[40:43], v[156:159], v[92:95], a[40:43]
    s_mul_i32 s63, s75, 2560
    ds_read_b64_tr_b16 v[148:149], v198 offset:7680
    v_mfma_f32_16x16x32_bf16 a[36:39], v[156:159], v[84:87], a[36:39]
    s_add_u32 m0, s59, 48256
    ds_read_b64_tr_b16 v[150:151], v198 offset:7936
    v_mfma_f32_16x16x32_bf16 a[36:39], v[152:155], v[80:83], a[36:39]
    s_add_u32 s62, s62, s63
    buffer_load_dwordx4 v208, s[8:11], s67 offen lds
    v_mfma_f32_16x16x32_bf16 a[32:35], v[152:155], v[72:75], a[32:35]
    ds_read_b64_tr_b16 v[152:153], v198 offset:8192
    v_add_u32 v1, s62, v1
    v_mfma_f32_16x16x32_bf16 a[32:35], v[156:159], v[76:79], a[32:35]
    s_waitcnt lgkmcnt(9)
    ds_read_b64_tr_b16 v[154:155], v198 offset:8448
    v_mfma_f32_16x16x32_bf16 a[60:63], v[164:167], v[100:103], a[60:63]
    s_lshl_b32 s62, s58, 11
    v_mfma_f32_16x16x32_bf16 a[60:63], v[160:163], v[96:99], a[60:63]
    s_xor_b32 s67, s67, 128
    ds_read_b64_tr_b16 v[156:157], v198 offset:8704
    v_mfma_f32_16x16x32_bf16 a[56:59], v[160:163], v[88:91], a[56:59]
    s_add_u32 m0, s59, 49280
    ds_read_b64_tr_b16 v[158:159], v198 offset:8960
    v_mfma_f32_16x16x32_bf16 a[56:59], v[164:167], v[92:95], a[56:59]
    s_add_u32 s63, s62, 129408
    buffer_load_dwordx4 v191, s[8:11], s67 offen lds
    v_mfma_f32_16x16x32_bf16 a[52:55], v[164:167], v[84:87], a[52:55]
    s_waitcnt vmcnt(9)
    ds_add_u32 v11, v9
    v_and_b32 v214, 0x2f, v0
    v_mfma_f32_16x16x32_bf16 a[52:55], v[160:163], v[80:83], a[52:55]
    v_lshl_add_u32 v3, v214, 4, s63
    v_bfe_u32 v214, v0, 4, 1
    v_mfma_f32_16x16x32_bf16 a[48:51], v[160:163], v[72:75], a[48:51]
    s_add_u32 m0, s59, 50304
    v_lshl_add_u32 v3, v214, 3, v3
    v_mfma_f32_16x16x32_bf16 a[48:51], v[164:167], v[76:79], a[48:51]
    s_waitcnt lgkmcnt(9)
    v_mfma_f32_16x16x32_bf16 a[76:79], v[140:143], v[100:103], a[76:79]
    s_lshl_b32 s62, s75, 12
    buffer_load_dwordx4 v208, s[8:11], s67 offen lds
    v_mfma_f32_16x16x32_bf16 a[76:79], v[136:139], v[96:99], a[76:79]
    s_add_u32 s63, s62, 129408
    ds_read_b32 v6, v11
    v_lshl_add_u32 v44, v0, 4, s63
    v_mfma_f32_16x16x32_bf16 a[72:75], v[136:139], v[88:91], a[72:75]
    s_xor_b32 s62, s62, 4096
    v_mfma_f32_16x16x32_bf16 a[72:75], v[140:143], v[92:95], a[72:75]
    s_add_u32 s63, s62, 129408
    v_lshl_add_u32 v4, v0, 4, s63
    v_mfma_f32_16x16x32_bf16 a[68:71], v[140:143], v[84:87], a[68:71]
    s_mul_i32 s62, s69, 18
    v_mfma_f32_16x16x32_bf16 a[68:71], v[136:139], v[80:83], a[68:71]
    s_add_u32 m0, s72, 129408
    v_mfma_f32_16x16x32_bf16 a[64:67], v[136:139], v[72:75], a[64:67]
    s_waitcnt lgkmcnt(0)
    v_cmp_le_u32 vcc, 12, v6
    v_mfma_f32_16x16x32_bf16 a[64:67], v[140:143], v[76:79], a[64:67]
    s_waitcnt lgkmcnt(6)
    v_mfma_f32_16x16x32_bf16 a[92:95], v[148:151], v[100:103], a[92:95]
    s_cbranch_vccz L_spin2
L_back2:
    ds_read_b128 v[112:115], v202 offset:18432
    v_mfma_f32_16x16x32_bf16 a[92:95], v[144:147], v[96:99], a[92:95]
    buffer_load_dwordx4 v195, s[4:7], s78 offen lds
    v_mfma_f32_16x16x32_bf16 a[88:91], v[144:147], v[88:91], a[88:91]
    ds_read_b128 v[116:119], v203 offset:18432
    v_mfma_f32_16x16x32_bf16 a[88:91], v[148:151], v[92:95], a[88:91]
    ds_read_b128 v[104:107], v202 offset:16384
    v_mfma_f32_16x16x32_bf16 a[84:87], v[148:151], v[84:87], a[84:87]
    s_add_u32 m0, s72, 131456
    ds_read_b128 v[108:111], v203 offset:16384
    v_mfma_f32_16x16x32_bf16 a[84:87], v[144:147], v[80:83], a[84:87]
    buffer_load_dwordx4 v195, s[4:7], s68 offen lds
    v_mfma_f32_16x16x32_bf16 a[80:83], v[144:147], v[72:75], a[80:83]
    ds_read_b64_tr_b16 v[160:161], v197 offset:9216
    ds_read_b64_tr_b16 v[162:163], v197 offset:9472
    v_mfma_f32_16x16x32_bf16 a[80:83], v[148:151], v[76:79], a[80:83]
    s_waitcnt lgkmcnt(8)
    ds_read_b64_tr_b16 v[164:165], v197 offset:9728
    v_mfma_f32_16x16x32_bf16 a[108:111], v[156:159], v[100:103], a[108:111]
    s_add_u32 m0, s73, 129408
    ds_read_b64_tr_b16 v[166:167], v197 offset:9984
    v_mfma_f32_16x16x32_bf16 a[108:111], v[152:155], v[96:99], a[108:111]
    buffer_load_dwordx4 v196, s[4:7], s78 offen lds
    v_mfma_f32_16x16x32_bf16 a[104:107], v[152:155], v[88:91], a[104:107]
    ds_read_b128 v[128:131], v204 offset:18432
    v_mfma_f32_16x16x32_bf16 a[104:107], v[156:159], v[92:95], a[104:107]
    ds_read_b128 v[132:135], v205 offset:18432
    v_mfma_f32_16x16x32_bf16 a[100:103], v[156:159], v[84:87], a[100:103]
    s_add_u32 m0, s73, 131456
    ds_read_b128 v[120:123], v204 offset:16384
    v_mfma_f32_16x16x32_bf16 a[100:103], v[152:155], v[80:83], a[100:103]
    buffer_load_dwordx4 v196, s[4:7], s68 offen lds
    v_mfma_f32_16x16x32_bf16 a[96:99], v[152:155], v[72:75], a[96:99]
    ds_read_b128 v[124:127], v205 offset:16384
    ds_read_b32 v174, v222 offset:16384
    v_mfma_f32_16x16x32_bf16 a[96:99], v[156:159], v[76:79], a[96:99]
    s_waitcnt lgkmcnt(5)
    buffer_load_dword v172, v207, s[44:47], s78 offen
    v_mfma_f32_16x16x32_bf16 v[52:55], v[164:167], v[116:119], v[52:55]
    s_bfe_u32 s66, s77, 0x40010
    ds_read_b64_tr_b16 v[136:137], v197 offset:0
    ds_read_b64_tr_b16 v[138:139], v197 offset:256
    v_mfma_f32_16x16x32_bf16 v[52:55], v[160:163], v[112:115], v[52:55]
    s_mul_i32 s64, s66, 589824
    ds_read_b64_tr_b16 v[140:141], v197 offset:1024
    v_mfma_f32_16x16x32_bf16 v[48:51], v[160:163], v[104:107], v[48:51]
    s_mul_i32 s65, s66, 73728
    ds_read_b64_tr_b16 v[142:143], v197 offset:1280
    s_add_u32 m0, s59, 94464
    v_mfma_f32_16x16x32_bf16 v[48:51], v[164:167], v[108:111], v[48:51]
    s_waitcnt lgkmcnt(4)
    buffer_load_dwordx4 v206, s[8:11], s64 offen lds
    v_mfma_f32_16x16x32_bf16 v[60:63], v[164:167], v[132:135], v[60:63]
    s_mul_i32 s63, s58, 9
    ds_read_b64_tr_b16 v[144:145], v197 offset:512
    v_lshlrev_b32 v178, 16, v174
    v_mfma_f32_16x16x32_bf16 v[60:63], v[160:163], v[128:131], v[60:63]
    s_lshl_b32 s78, s66, 7
    ds_read_b64_tr_b16 v[146:147], v197 offset:768
    v_lshlrev_b32 v179, 16, v173
    v_mfma_f32_16x16x32_bf16 v[56:59], v[160:163], v[120:123], v[56:59]
    s_add_u32 s68, s78, 18432
    v_and_b32 v180, 0xffff0000, v174
    v_and_b32 v181, 0xffff0000, v173
    v_mfma_f32_16x16x32_bf16 v[56:59], v[164:167], v[124:127], v[56:59]
    s_waitcnt lgkmcnt(2)
    ds_read_b64_tr_b16 v[148:149], v197 offset:1536
    v_fmac_f32 v177, v178, v179
    v_mfma_f32_16x16x32_bf16 v[236:239], v[140:143], v[132:135], v[236:239]
    s_add_u32 s67, s64, s71
    ds_read_b64_tr_b16 v[150:151], v197 offset:1792
    s_add_u32 m0, s59, 86272
    v_mfma_f32_16x16x32_bf16 v[236:239], v[136:139], v[128:131], v[236:239]
    s_lshr_b32 s63, s63, 1
    buffer_load_dwordx4 v191, s[8:11], s67 offen lds
    v_mfma_f32_16x16x32_bf16 v[232:235], v[136:139], v[120:123], v[232:235]
    s_add_u32 s62, s62, s63
    ds_read_b64_tr_b16 v[152:153], v197 offset:2048
    v_fmac_f32 v177, v180, v181
    v_mfma_f32_16x16x32_bf16 v[232:235], v[140:143], v[124:127], v[232:235]
    s_lshl_b32 s62, s62, 1
    ds_read_b64_tr_b16 v[154:155], v197 offset:2304
    v_mfma_f32_16x16x32_bf16 v[228:231], v[140:143], v[116:119], v[228:231]
    s_bfe_u32 s63, s57, 0x10002
    v_mfma_f32_16x16x32_bf16 v[228:231], v[136:139], v[112:115], v[228:231]
    s_mul_i32 s66, s66, 2304
    ds_read_b64_tr_b16 v[156:157], v197 offset:3072
    v_mfma_f32_16x16x32_bf16 v[224:227], v[136:139], v[104:107], v[224:227]
    s_add_u32 m0, s59, 87296
    ds_read_b64_tr_b16 v[158:159], v197 offset:3328
    v_mfma_f32_16x16x32_bf16 v[224:227], v[140:143], v[108:111], v[224:227]
    s_waitcnt lgkmcnt(4)
    buffer_load_dwordx4 v208, s[8:11], s67 offen lds
    v_mfma_f32_16x16x32_bf16 v[252:255], v[148:151], v[132:135], v[252:255]
    s_add_u32 s62, s62, s63
    ds_read_b64_tr_b16 v[160:161], v197 offset:2560
    v_mfma_f32_16x16x32_bf16 v[252:255], v[144:147], v[128:131], v[252:255]
    s_mul_i32 s62, s62, 576
    ds_read_b64_tr_b16 v[162:163], v197 offset:2816
    v_lshrrev_b32 v45, 3, v0
    v_mfma_f32_16x16x32_bf16 v[248:251], v[144:147], v[120:123], v[248:251]
    v_min_u32 v45, 4, v45
    v_and_b32 v46, 7, v0
    v_mfma_f32_16x16x32_bf16 v[248:251], v[148:151], v[124:127], v[248:251]
    s_xor_b32 s67, s67, 128
    ds_read_b64_tr_b16 v[164:165], v197 offset:3584
    v_lshlrev_b32 v46, 7, v46
    v_mfma_f32_16x16x32_bf16 v[244:247], v[148:151], v[116:119], v[244:247]
    s_add_u32 m0, s59, 88320
    ds_read_b64_tr_b16 v[166:167], v197 offset:3840
    v_min_u32 v46, 572, v46
    v_mfma_f32_16x16x32_bf16 v[244:247], v[144:147], v[112:115], v[244:247]
    buffer_load_dwordx4 v191, s[8:11], s67 offen lds
    v_mfma_f32_16x16x32_bf16 v[240:243], v[144:147], v[104:107], v[240:243]
    ds_read_b64_tr_b16 v[136:137], v197 offset:4096
    v_mul_u32_u24 v45, 1152, v45
    v_mfma_f32_16x16x32_bf16 v[240:243], v[148:151], v[108:111], v[240:243]
    s_waitcnt lgkmcnt(5)
    ds_read_b64_tr_b16 v[138:139], v197 offset:4352
    v_add3_u32 v45, v45, v46, s62
    v_mfma_f32_16x16x32_bf16 a[12:15], v[156:159], v[132:135], a[12:15]
    s_lshl_b32 s62, s69, 2
    v_mfma_f32_16x16x32_bf16 a[12:15], v[152:155], v[128:131], a[12:15]
    s_add_u32 s62, s62, s58
    ds_read_b64_tr_b16 v[140:141], v197 offset:5120
    v_mfma_f32_16x16x32_bf16 a[8:11], v[152:155], v[120:123], a[8:11]
    s_add_u32 m0, s59, 95488
    ds_read_b64_tr_b16 v[142:143], v197 offset:5376
    v_mfma_f32_16x16x32_bf16 a[8:11], v[156:159], v[124:127], a[8:11]
    s_mul_i32 s63, s62, 1280
    buffer_load_dwordx4 v192, s[12:15], s65 offen lds
    v_mfma_f32_16x16x32_bf16 a[4:7], v[156:159], v[116:119], a[4:7]
    ds_read_b64_tr_b16 v[144:145], v197 offset:4608
    v_mul_u32_u24 v46, 10, v0
    v_mfma_f32_16x16x32_bf16 a[4:7], v[152:155], v[112:115], a[4:7]
    ds_read_b64_tr_b16 v[146:147], v197 offset:4864
    v_lshrrev_b32 v46, 6, v46
    v_mfma_f32_16x16x32_bf16 a[0:3], v[152:155], v[104:107], a[0:3]
    v_lshl_add_u32 v46, v46, 7, s63
    v_mfma_f32_16x16x32_bf16 a[0:3], v[156:159], v[108:111], a[0:3]
    s_waitcnt lgkmcnt(6)
    ds_read_b64_tr_b16 v[148:149], v197 offset:5632
    v_mfma_f32_16x16x32_bf16 a[28:31], v[164:167], v[132:135], a[28:31]
    s_add_u32 m0, s59, 89344
    ds_read_b64_tr_b16 v[150:151], v197 offset:5888
    v_mfma_f32_16x16x32_bf16 a[28:31], v[160:163], v[128:131], a[28:31]
    s_mul_i32 s62, s62, 640
    buffer_load_dwordx4 v208, s[8:11], s67 offen lds
    v_mfma_f32_16x16x32_bf16 a[24:27], v[160:163], v[120:123], a[24:27]
    ds_read_b64_tr_b16 v[152:153], v197 offset:6144
    v_mul_u32_u24 v12, 5, v0
    v_mfma_f32_16x16x32_bf16 a[24:27], v[164:167], v[124:127], a[24:27]
    ds_read_b64_tr_b16 v[154:155], v197 offset:6400
    v_lshrrev_b32 v12, 6, v12
    v_mfma_f32_16x16x32_bf16 a[20:23], v[164:167], v[116:119], a[20:23]
    v_lshl_add_u32 v12, v12, 7, s62
    v_min_u32 v12, L_codeend-L_pc-4, v12
    v_mfma_f32_16x16x32_bf16 a[20:23], v[160:163], v[112:115], a[20:23]
    s_xor_b32 s67, s67, 384
    ds_read_b64_tr_b16 v[156:157], v197 offset:7168
    v_bfe_u32 v214, v0, 3, 2
    v_mfma_f32_16x16x32_bf16 a[16:19], v[160:163], v[104:107], a[16:19]
    s_add_u32 m0, s59, 90368
    ds_read_b64_tr_b16 v[158:159], v197 offset:7424
    v_and_b32 v215, 3, v0
    v_mfma_f32_16x16x32_bf16 a[16:19], v[164:167], v[108:111], a[16:19]
    s_waitcnt lgkmcnt(8)
    buffer_load_dwordx4 v191, s[8:11], s67 offen lds
    v_mfma_f32_16x16x32_bf16 a[44:47], v[140:143], v[132:135], a[44:47]
    ds_read_b64_tr_b16 v[160:161], v197 offset:6656
    v_lshl_add_u32 v214, v214, 2, v215
    v_mfma_f32_16x16x32_bf16 a[44:47], v[136:139], v[128:131], a[44:47]
    ds_read_b64_tr_b16 v[162:163], v197 offset:6912
    v_lshrrev_b32 v215, 2, v0
    v_mfma_f32_16x16x32_bf16 a[40:43], v[136:139], v[120:123], a[40:43]
    v_or_b32 v215, v215, v0
    v_and_b32 v215, 4, v215
    v_mfma_f32_16x16x32_bf16 a[40:43], v[140:143], v[124:127], a[40:43]
    ds_read_b64_tr_b16 v[164:165], v197 offset:7680
    v_lshl_add_u32 v214, v215, 1, v214
    v_mfma_f32_16x16x32_bf16 a[36:39], v[140:143], v[116:119], a[36:39]
    s_add_u32 m0, s59, 91392
    ds_read_b64_tr_b16 v[166:167], v197 offset:7936
    v_lshrrev_b32 v215, 5, v0
    v_mfma_f32_16x16x32_bf16 a[36:39], v[136:139], v[112:115], a[36:39]
    buffer_load_dwordx4 v208, s[8:11], s67 offen lds
    v_mfma_f32_16x16x32_bf16 a[32:35], v[136:139], v[104:107], a[32:35]
    ds_read_b64_tr_b16 v[136:137], v197 offset:8192
    v_mad_u32_u24 v214, v215, 19, v214
    v_mfma_f32_16x16x32_bf16 a[32:35], v[140:143], v[108:111], a[32:35]
    s_waitcnt lgkmcnt(9)
    ds_read_b64_tr_b16 v[138:139], v197 offset:8448
    v_lshlrev_b32 v214, 4, v214
    v_mfma_f32_16x16x32_bf16 a[60:63], v[148:151], v[132:135], a[60:63]
    s_mov_b32 s82, 0x47ffff
    v_mfma_f32_16x16x32_bf16 a[60:63], v[144:147], v[128:131], a[60:63]
    s_xor_b32 s67, s67, 128
    ds_read_b64_tr_b16 v[140:141], v197 offset:8704
    v_mfma_f32_16x16x32_bf16 a[56:59], v[144:147], v[120:123], a[56:59]
    s_add_u32 m0, s59, 92416
    ds_read_b64_tr_b16 v[142:143], v197 offset:8960
    v_mfma_f32_16x16x32_bf16 a[56:59], v[148:151], v[124:127], a[56:59]
    s_mov_b32 s83, 0x47ffff
    buffer_load_dwordx4 v191, s[8:11], s67 offen lds
    v_mfma_f32_16x16x32_bf16 a[52:55], v[148:151], v[116:119], a[52:55]
    s_waitcnt vmcnt(9)
    ds_add_u32 v11, v9
    v_mov_b32 v215, 262144
    v_mfma_f32_16x16x32_bf16 a[52:55], v[144:147], v[112:115], a[52:55]
    v_cndmask_b32 v47, v215, v214, s[82:83]
    v_mfma_f32_16x16x32_bf16 a[48:51], v[144:147], v[104:107], a[48:51]
    s_add_u32 m0, s59, 93440
    v_mfma_f32_16x16x32_bf16 a[48:51], v[148:151], v[108:111], a[48:51]
    s_waitcnt lgkmcnt(9)
    v_mfma_f32_16x16x32_bf16 a[76:79], v[156:159], v[132:135], a[76:79]
    s_lshr_b32 s62, s58, 1
    buffer_load_dwordx4 v208, s[8:11], s67 offen lds
    v_mfma_f32_16x16x32_bf16 a[76:79], v[152:155], v[128:131], a[76:79]
    s_mul_i32 s62, s62, 36
    ds_read_b32 v6, v11
    v_mfma_f32_16x16x32_bf16 a[72:75], v[152:155], v[120:123], a[72:75]
    s_lshl3_add_u32 s62, s75, s62
    v_lshrrev_b32 v214, 5, v0
    v_mul_u32_u24 v214, 72, v214
    v_mfma_f32_16x16x32_bf16 a[72:75], v[156:159], v[124:127], a[72:75]
    v_bfe_u32 v215, v0, 2, 3
    v_add3_u32 v214, v214, s62, v215
    v_mfma_f32_16x16x32_bf16 a[68:71], v[156:159], v[116:119], a[68:71]
    v_mul_u32_u24 v214, 1152, v214
    v_and_b32 v216, 3, v0
    v_mfma_f32_16x16x32_bf16 a[68:71], v[152:155], v[112:115], a[68:71]
    s_add_u32 m0, s72, 145792
    v_mfma_f32_16x16x32_bf16 a[64:67], v[152:155], v[104:107], a[64:67]
    s_waitcnt lgkmcnt(0)
    v_cmp_le_u32 vcc, 16, v6
    v_mfma_f32_16x16x32_bf16 a[64:67], v[156:159], v[108:111], a[64:67]
    s_waitcnt lgkmcnt(6)
    v_mfma_f32_16x16x32_bf16 a[92:95], v[164:167], v[132:135], a[92:95]
    s_cbranch_vccz L_spin3
L_back3:
    ds_read_b128 v[80:83], v202 offset:2048
    v_mfma_f32_16x16x32_bf16 a[92:95], v[160:163], v[128:131], a[92:95]
    buffer_load_dwordx4 v195, s[4:7], s78 offen lds
    v_mfma_f32_16x16x32_bf16 a[88:91], v[160:163], v[120:123], a[88:91]
    ds_read_b128 v[84:87], v203 offset:2048
    v_mfma_f32_16x16x32_bf16 a[88:91], v[164:167], v[124:127], a[88:91]
    ds_read_b128 v[72:75], v202 offset:0
    v_mfma_f32_16x16x32_bf16 a[84:87], v[164:167], v[116:119], a[84:87]
    s_add_u32 m0, s72, 147840
    ds_read_b128 v[76:79], v203 offset:0
    v_mfma_f32_16x16x32_bf16 a[84:87], v[160:163], v[112:115], a[84:87]
    buffer_load_dwordx4 v195, s[4:7], s68 offen lds
    v_mfma_f32_16x16x32_bf16 a[80:83], v[160:163], v[104:107], a[80:83]
    ds_read_b64_tr_b16 v[144:145], v197 offset:52352
    ds_read_b64_tr_b16 v[146:147], v197 offset:52608
    v_mfma_f32_16x16x32_bf16 a[80:83], v[164:167], v[108:111], a[80:83]
    s_waitcnt lgkmcnt(8)
    ds_read_b64_tr_b16 v[148:149], v197 offset:52864
    v_mfma_f32_16x16x32_bf16 a[108:111], v[140:143], v[132:135], a[108:111]
    s_add_u32 m0, s73, 145792
    ds_read_b64_tr_b16 v[150:151], v197 offset:53120
    v_mfma_f32_16x16x32_bf16 a[108:111], v[136:139], v[128:131], a[108:111]
    buffer_load_dwordx4 v196, s[4:7], s78 offen lds
    v_mfma_f32_16x16x32_bf16 a[104:107], v[136:139], v[120:123], a[104:107]
    ds_read_b128 v[96:99], v204 offset:2048
    v_mfma_f32_16x16x32_bf16 a[104:107], v[140:143], v[124:127], a[104:107]
    ds_read_b128 v[100:103], v205 offset:2048
    v_mfma_f32_16x16x32_bf16 a[100:103], v[140:143], v[116:119], a[100:103]
    s_add_u32 m0, s73, 147840
    ds_read_b128 v[88:91], v204 offset:0
    v_mfma_f32_16x16x32_bf16 a[100:103], v[136:139], v[112:115], a[100:103]
    buffer_load_dwordx4 v196, s[4:7], s68 offen lds
    v_mfma_f32_16x16x32_bf16 a[96:99], v[136:139], v[104:107], a[96:99]
    ds_read_b128 v[92:95], v205 offset:0
    ds_read_b32 v174, v222 offset:0
    v_mfma_f32_16x16x32_bf16 a[96:99], v[140:143], v[108:111], a[96:99]
    s_waitcnt lgkmcnt(5)
    buffer_load_dword v173, v207, s[44:47], s78 offen
    v_mfma_f32_16x16x32_bf16 v[52:55], v[148:151], v[84:87], v[52:55]
    s_bfe_u32 s66, s77, 0x40014
    ds_read_b64_tr_b16 v[152:153], v197 offset:43136
    ds_read_b64_tr_b16 v[154:155], v197 offset:43392
    v_mfma_f32_16x16x32_bf16 v[52:55], v[144:147], v[80:83], v[52:55]
    s_mul_i32 s64, s66, 589824
    ds_read_b64_tr_b16 v[156:157], v197 offset:44160
    v_mfma_f32_16x16x32_bf16 v[48:51], v[144:147], v[72:75], v[48:51]
    s_mul_i32 s65, s66, 73728
    ds_read_b64_tr_b16 v[158:159], v197 offset:44416
    s_add_u32 m0, s59, 8192
    v_mfma_f32_16x16x32_bf16 v[48:51], v[148:151], v[76:79], v[48:51]
    s_waitcnt lgkmcnt(4)
    buffer_load_dwordx4 v206, s[8:11], s64 offen lds
    v_mfma_f32_16x16x32_bf16 v[60:63], v[148:151], v[100:103], v[60:63]
    ds_read_b64_tr_b16 v[160:161], v197 offset:43648
    v_lshlrev_b32 v178, 16, v174
    v_mfma_f32_16x16x32_bf16 v[60:63], v[144:147], v[96:99], v[60:63]
    s_lshl_b32 s78, s66, 7
    ds_read_b64_tr_b16 v[162:163], v197 offset:43904
    v_lshlrev_b32 v179, 16, v172
    v_mfma_f32_16x16x32_bf16 v[56:59], v[144:147], v[88:91], v[56:59]
    s_add_u32 s68, s78, 18432
    v_and_b32 v180, 0xffff0000, v174
    v_and_b32 v181, 0xffff0000, v172
    v_mfma_f32_16x16x32_bf16 v[56:59], v[148:151], v[92:95], v[56:59]
    s_waitcnt lgkmcnt(2)
    ds_read_b64_tr_b16 v[164:165], v197 offset:44672
    v_fmac_f32 v177, v178, v179
    v_mfma_f32_16x16x32_bf16 v[236:239], v[156:159], v[100:103], v[236:239]
    s_add_u32 s67, s64, s71
    ds_read_b64_tr_b16 v[166:167], v197 offset:44928
    s_add_u32 m0, s59, 0
    v_mfma_f32_16x16x32_bf16 v[236:239], v[152:155], v[96:99], v[236:239]
    buffer_load_dwordx4 v191, s[8:11], s67 offen lds
    v_mfma_f32_16x16x32_bf16 v[232:235], v[152:155], v[88:91], v[232:235]
    ds_read_b64_tr_b16 v[136:137], v197 offset:45184
    v_fmac_f32 v177, v180, v181
    v_mfma_f32_16x16x32_bf16 v[232:235], v[156:159], v[92:95], v[232:235]
    ds_read_b64_tr_b16 v[138:139], v197 offset:45440
    v_lshl_add_u32 v215, v216, 2, v214
    v_mfma_f32_16x16x32_bf16 v[228:231], v[156:159], v[84:87], v[228:231]
    v_lshl_add_u32 v214, v216, 4, v214
    v_accvgpr_write_b32 a235, v215
    v_mfma_f32_16x16x32_bf16 v[228:231], v[152:155], v[80:83], v[228:231]
    s_mul_i32 s66, s66, 2304
    ds_read_b64_tr_b16 v[140:141], v197 offset:46208
    v_accvgpr_write_b32 a234, v214
    v_mfma_f32_16x16x32_bf16 v[224:227], v[152:155], v[72:75], v[224:227]
    s_add_u32 m0, s59, 1024
    ds_read_b64_tr_b16 v[142:143], v197 offset:46464
    v_bfe_u32 v214, v0, 3, 2
    v_mfma_f32_16x16x32_bf16 v[224:227], v[156:159], v[76:79], v[224:227]
    s_waitcnt lgkmcnt(4)
    buffer_load_dwordx4 v208, s[8:11], s67 offen lds
    v_mfma_f32_16x16x32_bf16 v[252:255], v[164:167], v[100:103], v[252:255]
    ds_read_b64_tr_b16 v[144:145], v197 offset:45696
    v_lshl_add_u32 v214, s58, 2, v214
    v_mfma_f32_16x16x32_bf16 v[252:255], v[160:163], v[96:99], v[252:255]
    ds_read_b64_tr_b16 v[146:147], v197 offset:45952
    v_lshrrev_b32 v215, 5, v0
    v_mfma_f32_16x16x32_bf16 v[248:251], v[160:163], v[88:91], v[248:251]
    v_lshl_add_u32 v214, v214, 1, v215
    v_mad_u32_u24 v214, v214, 18, 16
    v_mfma_f32_16x16x32_bf16 v[248:251], v[164:167], v[92:95], v[248:251]
    s_xor_b32 s67, s67, 128
    ds_read_b64_tr_b16 v[148:149], v197 offset:46720
    v_bfe_u32 v215, v0, 2, 1
    v_mfma_f32_16x16x32_bf16 v[244:247], v[164:167], v[84:87], v[244:247]
    s_add_u32 m0, s59, 2048
    ds_read_b64_tr_b16 v[150:151], v197 offset:46976
    v_add_u32 v214, v214, v215
    v_mfma_f32_16x16x32_bf16 v[244:247], v[160:163], v[80:83], v[244:247]
    buffer_load_dwordx4 v191, s[8:11], s67 offen lds
    v_mfma_f32_16x16x32_bf16 v[240:243], v[160:163], v[72:75], v[240:243]
    ds_read_b64_tr_b16 v[152:153], v197 offset:47232
    v_mul_u32_u24 v214, 1152, v214
    v_mfma_f32_16x16x32_bf16 v[240:243], v[164:167], v[76:79], v[240:243]
    s_waitcnt lgkmcnt(5)
    ds_read_b64_tr_b16 v[154:155], v197 offset:47488
    v_lshl_add_u32 v215, v216, 2, v214
    v_mfma_f32_16x16x32_bf16 a[12:15], v[140:143], v[100:103], a[12:15]
    v_lshl_add_u32 v214, v216, 4, v214
    v_accvgpr_write_b32 a237, v215
    v_mfma_f32_16x16x32_bf16 a[12:15], v[136:139], v[96:99], a[12:15]
    ds_read_b64_tr_b16 v[156:157], v197 offset:48256
    v_accvgpr_write_b32 a236, v214
    v_mfma_f32_16x16x32_bf16 a[8:11], v[136:139], v[88:91], a[8:11]
    s_add_u32 m0, s59, 9216
    ds_read_b64_tr_b16 v[158:159], v197 offset:48512
    v_lshrrev_b32 v214, 4, v0
    v_mfma_f32_16x16x32_bf16 a[8:11], v[140:143], v[92:95], a[8:11]
    buffer_load_dwordx4 v192, s[12:15], s65 offen lds
    v_mfma_f32_16x16x32_bf16 a[4:7], v[140:143], v[84:87], a[4:7]
    ds_read_b64_tr_b16 v[160:161], v197 offset:47744
    v_mul_u32_u24 v214, 20768, v214
    v_mfma_f32_16x16x32_bf16 a[4:7], v[136:139], v[80:83], a[4:7]
    ds_read_b64_tr_b16 v[162:163], v197 offset:48000
    v_add_u32 v214, 61440, v214
    v_mfma_f32_16x16x32_bf16 a[0:3], v[136:139], v[72:75], a[0:3]
    v_bfe_u32 v209, v0, 2, 2
    v_lshl_add_u32 v215, v209, 4, v214
    v_mfma_f32_16x16x32_bf16 a[0:3], v[140:143], v[76:79], a[0:3]
    s_waitcnt lgkmcnt(6)
    ds_read_b64_tr_b16 v[164:165], v197 offset:48768
    v_lshl_add_u32 v214, v209, 6, v214
    v_mfma_f32_16x16x32_bf16 a[28:31], v[148:151], v[100:103], a[28:31]
    s_add_u32 m0, s59, 3072
    ds_read_b64_tr_b16 v[166:167], v197 offset:49024
    v_lshl_add_u32 v214, v216, 3, v214
    v_mfma_f32_16x16x32_bf16 a[28:31], v[144:147], v[96:99], a[28:31]
    buffer_load_dwordx4 v208, s[8:11], s67 offen lds
    v_mfma_f32_16x16x32_bf16 a[24:27], v[144:147], v[88:91], a[24:27]
    ds_read_b64_tr_b16 v[136:137], v197 offset:49280
    v_and_b32 v216, 1, v0
    v_mfma_f32_16x16x32_bf16 a[24:27], v[148:151], v[92:95], a[24:27]
    ds_read_b64_tr_b16 v[138:139], v197 offset:49536
    v_lshl_add_u32 v215, v216, 3, v215
    v_mfma_f32_16x16x32_bf16 a[20:23], v[148:151], v[84:87], a[20:23]
    v_accvgpr_write_b32 a238, v214
    v_accvgpr_write_b32 a239, v215
    v_mfma_f32_16x16x32_bf16 a[20:23], v[144:147], v[80:83], a[20:23]
    s_xor_b32 s67, s67, 384
    ds_read_b64_tr_b16 v[140:141], v197 offset:50304
    v_mfma_f32_16x16x32_bf16 a[16:19], v[144:147], v[72:75], a[16:19]
    s_add_u32 m0, s59, 4096
    ds_read_b64_tr_b16 v[142:143], v197 offset:50560
    v_mfma_f32_16x16x32_bf16 a[16:19], v[148:151], v[76:79], a[16:19]
    s_waitcnt lgkmcnt(8)
    buffer_load_dwordx4 v191, s[8:11], s67 offen lds
    v_mfma_f32_16x16x32_bf16 a[44:47], v[156:159], v[100:103], a[44:47]
    s_mul_i32 s62, s58, 3328
    ds_read_b64_tr_b16 v[144:145], v197 offset:49792
    v_mfma_f32_16x16x32_bf16 a[44:47], v[152:155], v[96:99], a[44:47]
    s_add_u32 s62, s62, 145792
    ds_read_b64_tr_b16 v[146:147], v197 offset:50048
    v_and_b32 v218, 15, v0
    v_mfma_f32_16x16x32_bf16 a[40:43], v[152:155], v[88:91], a[40:43]
    v_lshrrev_b32 v219, 4, v0
    v_mul_u32_u24 v211, 104, v218
    v_mfma_f32_16x16x32_bf16 a[40:43], v[156:159], v[92:95], a[40:43]
    ds_read_b64_tr_b16 v[148:149], v197 offset:50816
    v_add_u32 v211, s62, v211
    v_mfma_f32_16x16x32_bf16 a[36:39], v[156:159], v[84:87], a[36:39]
    s_add_u32 m0, s59, 5120
    ds_read_b64_tr_b16 v[150:151], v197 offset:51072
    v_lshl_add_u32 v209, v219, 3, v211
    v_mfma_f32_16x16x32_bf16 a[36:39], v[152:155], v[80:83], a[36:39]
    buffer_load_dwordx4 v208, s[8:11], s67 offen lds
    v_mfma_f32_16x16x32_bf16 a[32:35], v[152:155], v[72:75], a[32:35]
    ds_read_b64_tr_b16 v[152:153], v197 offset:51328
    v_mov_b32 v211, v209
    v_mfma_f32_16x16x32_bf16 a[32:35], v[156:159], v[76:79], a[32:35]
    s_waitcnt lgkmcnt(9)
    ds_read_b64_tr_b16 v[154:155], v197 offset:51584
    v_mfma_f32_16x16x32_bf16 a[60:63], v[164:167], v[100:103], a[60:63]
    s_lshl_b32 s63, s75, 5
    v_mfma_f32_16x16x32_bf16 a[60:63], v[160:163], v[96:99], a[60:63]
    s_xor_b32 s67, s67, 128
    ds_read_b64_tr_b16 v[156:157], v197 offset:51840
    v_mfma_f32_16x16x32_bf16 a[56:59], v[160:163], v[88:91], a[56:59]
    s_add_u32 m0, s59, 6144
    ds_read_b64_tr_b16 v[158:159], v197 offset:52096
    v_mfma_f32_16x16x32_bf16 a[56:59], v[164:167], v[92:95], a[56:59]
    s_lshl3_add_u32 s63, s101, s63
    buffer_load_dwordx4 v191, s[8:11], s67 offen lds
    v_mfma_f32_16x16x32_bf16 a[52:55], v[164:167], v[84:87], a[52:55]
    s_waitcnt vmcnt(9)
    ds_add_u32 v11, v9
    v_add_u32 v209, s63, v209
    v_mfma_f32_16x16x32_bf16 a[52:55], v[160:163], v[80:83], a[52:55]
    s_mul_i32 s63, s75, -6656
    v_mfma_f32_16x16x32_bf16 a[48:51], v[160:163], v[72:75], a[48:51]
    s_add_u32 m0, s59, 7168
    v_mfma_f32_16x16x32_bf16 a[48:51], v[164:167], v[76:79], a[48:51]
    s_waitcnt lgkmcnt(9)
    v_mfma_f32_16x16x32_bf16 a[76:79], v[140:143], v[100:103], a[76:79]
    s_add_u32 s63, s63, 3328
    buffer_load_dwordx4 v208, s[8:11], s67 offen lds
    v_mfma_f32_16x16x32_bf16 a[76:79], v[136:139], v[96:99], a[76:79]
    ds_read_b32 v6, v11
    v_add_u32 v210, s63, v209
    v_mfma_f32_16x16x32_bf16 a[72:75], v[136:139], v[88:91], a[72:75]
L_po3:
L_q1:
    s_cbranch_execz L_q9
    v_cmp_gt_u32 s[82:83], 32, v0
    v_mov_b32 v217, 0x3eae1a93
    v_mfma_f32_16x16x32_bf16 a[72:75], v[140:143], v[92:95], a[72:75]
    v_and_b32 v216, 31, v0
    v_cndmask_b32 v217, 1.0, v217, s[82:83]
    v_mfma_f32_16x16x32_bf16 a[68:71], v[140:143], v[84:87], a[68:71]
    v_mul_u32_u24 v212, 104, v216
    v_add_u32 v212, s62, v212
    v_mfma_f32_16x16x32_bf16 a[68:71], v[136:139], v[80:83], a[68:71]
    s_add_u32 m0, s72, 129408
    v_mfma_f32_16x16x32_bf16 a[64:67], v[136:139], v[72:75], a[64:67]
    s_waitcnt lgkmcnt(0)
    v_cmp_le_u32 vcc, 20, v6
    v_mfma_f32_16x16x32_bf16 a[64:67], v[140:143], v[76:79], a[64:67]
    s_waitcnt lgkmcnt(6)
    v_mfma_f32_16x16x32_bf16 a[92:95], v[148:151], v[100:103], a[92:95]
    s_cbranch_vccz L_spin4
L_back4:
    ds_read_b128 v[112:115], v202 offset:18432
    v_mfma_f32_16x16x32_bf16 a[92:95], v[144:147], v[96:99], a[92:95]
    buffer_load_dwordx4 v195, s[4:7], s78 offen lds
    v_mfma_f32_16x16x32_bf16 a[88:91], v[144:147], v[88:91], a[88:91]
    ds_read_b128 v[116:119], v203 offset:18432
    v_mfma_f32_16x16x32_bf16 a[88:91], v[148:151], v[92:95], a[88:91]
    ds_read_b128 v[104:107], v202 offset:16384
    v_mfma_f32_16x16x32_bf16 a[84:87], v[148:151], v[84:87], a[84:87]
    s_add_u32 m0, s72, 131456
    ds_read_b128 v[108:111], v203 offset:16384
    v_mfma_f32_16x16x32_bf16 a[84:87], v[144:147], v[80:83], a[84:87]
    buffer_load_dwordx4 v195, s[4:7], s68 offen lds
    v_mfma_f32_16x16x32_bf16 a[80:83], v[144:147], v[72:75], a[80:83]
    ds_read_b64_tr_b16 v[160:161], v198 offset:9216
    ds_read_b64_tr_b16 v[162:163], v198 offset:9472
    v_mfma_f32_16x16x32_bf16 a[80:83], v[148:151], v[76:79], a[80:83]
    s_waitcnt lgkmcnt(8)
    ds_read_b64_tr_b16 v[164:165], v198 offset:9728
    v_mfma_f32_16x16x32_bf16 a[108:111], v[156:159], v[100:103], a[108:111]
    s_add_u32 m0, s73, 129408
    ds_read_b64_tr_b16 v[166:167], v198 offset:9984
    v_mfma_f32_16x16x32_bf16 a[108:111], v[152:155], v[96:99], a[108:111]
    buffer_load_dwordx4 v196, s[4:7], s78 offen lds
    v_mfma_f32_16x16x32_bf16 a[104:107], v[152:155], v[88:91], a[104:107]
    ds_read_b128 v[128:131], v204 offset:18432
    v_mfma_f32_16x16x32_bf16 a[104:107], v[156:159], v[92:95], a[104:107]
    ds_read_b128 v[132:135], v205 offset:18432
    v_mfma_f32_16x16x32_bf16 a[100:103], v[156:159], v[84:87], a[100:103]
    s_add_u32 m0, s73, 131456
    ds_read_b128 v[120:123], v204 offset:16384
    v_mfma_f32_16x16x32_bf16 a[100:103], v[152:155], v[80:83], a[100:103]
    buffer_load_dwordx4 v196, s[4:7], s68 offen lds
    v_mfma_f32_16x16x32_bf16 a[96:99], v[152:155], v[72:75], a[96:99]
    ds_read_b128 v[124:127], v205 offset:16384
    ds_read_b32 v174, v222 offset:16384
    v_mfma_f32_16x16x32_bf16 a[96:99], v[156:159], v[76:79], a[96:99]
    s_waitcnt lgkmcnt(5)
    buffer_load_dword v172, v207, s[44:47], s78 offen
    v_mfma_f32_16x16x32_bf16 v[52:55], v[164:167], v[116:119], v[52:55]
    s_bfe_u32 s66, s77, 0x40018
    ds_read_b64_tr_b16 v[136:137], v198 offset:0
    ds_read_b64_tr_b16 v[138:139], v198 offset:256
    v_mfma_f32_16x16x32_bf16 v[52:55], v[160:163], v[112:115], v[52:55]
    s_mul_i32 s64, s66, 589824
    ds_read_b64_tr_b16 v[140:141], v198 offset:1024
    v_mfma_f32_16x16x32_bf16 v[48:51], v[160:163], v[104:107], v[48:51]
    s_mul_i32 s65, s66, 73728
    ds_read_b64_tr_b16 v[142:143], v198 offset:1280
    s_add_u32 m0, s59, 51328
    v_mfma_f32_16x16x32_bf16 v[48:51], v[164:167], v[108:111], v[48:51]
    s_waitcnt lgkmcnt(4)
    buffer_load_dwordx4 v206, s[8:11], s64 offen lds
    v_mfma_f32_16x16x32_bf16 v[60:63], v[164:167], v[132:135], v[60:63]
    ds_read_b64_tr_b16 v[144:145], v198 offset:512
    v_lshlrev_b32 v178, 16, v174
    v_mfma_f32_16x16x32_bf16 v[60:63], v[160:163], v[128:131], v[60:63]
    s_lshl_b32 s78, s66, 7
    ds_read_b64_tr_b16 v[146:147], v198 offset:768
    v_lshlrev_b32 v179, 16, v173
    v_mfma_f32_16x16x32_bf16 v[56:59], v[160:163], v[120:123], v[56:59]
    s_add_u32 s68, s78, 18432
    v_and_b32 v180, 0xffff0000, v174
    v_and_b32 v181, 0xffff0000, v173
    v_mfma_f32_16x16x32_bf16 v[56:59], v[164:167], v[124:127], v[56:59]
    s_waitcnt lgkmcnt(2)
    ds_read_b64_tr_b16 v[148:149], v198 offset:1536
    v_fmac_f32 v177, v178, v179
    v_mfma_f32_16x16x32_bf16 v[236:239], v[140:143], v[132:135], v[236:239]
    s_add_u32 s67, s64, s71
    ds_read_b64_tr_b16 v[150:151], v198 offset:1792
    s_add_u32 m0, s59, 43136
    v_mfma_f32_16x16x32_bf16 v[236:239], v[136:139], v[128:131], v[236:239]
    buffer_load_dwordx4 v191, s[8:11], s67 offen lds
    v_mfma_f32_16x16x32_bf16 v[232:235], v[136:139], v[120:123], v[232:235]
    ds_read_b64_tr_b16 v[152:153], v198 offset:2048
    v_fmac_f32 v177, v180, v181
    v_mfma_f32_16x16x32_bf16 v[232:235], v[140:143], v[124:127], v[232:235]
    ds_read_b64_tr_b16 v[154:155], v198 offset:2304
    v_bfe_u32 v213, v0, 2, 2
    v_mfma_f32_16x16x32_bf16 v[228:231], v[140:143], v[116:119], v[228:231]
    v_lshl_add_u32 v213, v219, 3, v213
    v_mul_u32_u24 v213, 104, v213
    v_mfma_f32_16x16x32_bf16 v[228:231], v[136:139], v[112:115], v[228:231]
    s_mul_i32 s66, s66, 2304
    ds_read_b64_tr_b16 v[156:157], v198 offset:3072
    v_and_b32 v214, 3, v0
    v_mfma_f32_16x16x32_bf16 v[224:227], v[136:139], v[104:107], v[224:227]
    s_add_u32 m0, s59, 44160
    ds_read_b64_tr_b16 v[158:159], v198 offset:3328
    v_lshl_add_u32 v213, v214, 3, v213
    v_mfma_f32_16x16x32_bf16 v[224:227], v[140:143], v[108:111], v[224:227]
    s_waitcnt lgkmcnt(4)
    buffer_load_dwordx4 v208, s[8:11], s67 offen lds
    v_mfma_f32_16x16x32_bf16 v[252:255], v[148:151], v[132:135], v[252:255]
    ds_read_b64_tr_b16 v[160:161], v198 offset:2560
    v_add_u32 v213, s62, v213
    v_mfma_f32_16x16x32_bf16 v[252:255], v[144:147], v[128:131], v[252:255]
    s_mul_i32 s60, s56, 9472
    ds_read_b64_tr_b16 v[162:163], v198 offset:2816
    v_mfma_f32_16x16x32_bf16 v[248:251], v[144:147], v[120:123], v[248:251]
    s_lshl_b32 s62, s58, 10
    v_mfma_f32_16x16x32_bf16 v[248:251], v[148:151], v[124:127], v[248:251]
    s_xor_b32 s67, s67, 128
    ds_read_b64_tr_b16 v[164:165], v198 offset:3584
    v_mfma_f32_16x16x32_bf16 v[244:247], v[148:151], v[116:119], v[244:247]
    s_add_u32 m0, s59, 45184
    ds_read_b64_tr_b16 v[166:167], v198 offset:3840
    v_mfma_f32_16x16x32_bf16 v[244:247], v[144:147], v[112:115], v[244:247]
    s_lshl_b32 s63, s53, 9
    buffer_load_dwordx4 v191, s[8:11], s67 offen lds
    v_mfma_f32_16x16x32_bf16 v[240:243], v[144:147], v[104:107], v[240:243]
    s_add_u32 s62, s62, s63
    ds_read_b64_tr_b16 v[136:137], v198 offset:4096
    v_mfma_f32_16x16x32_bf16 v[240:243], v[148:151], v[108:111], v[240:243]
    s_waitcnt lgkmcnt(5)
    ds_read_b64_tr_b16 v[138:139], v198 offset:4352
    v_mfma_f32_16x16x32_bf16 a[12:15], v[156:159], v[132:135], a[12:15]
    s_add_u32 s62, s62, s60
    v_mfma_f32_16x16x32_bf16 a[12:15], v[152:155], v[128:131], a[12:15]
    s_cmp_lt_u32 s53, 2
    s_cselect_b32 s62, s62, 1073741824
    ds_read_b64_tr_b16 v[140:141], v198 offset:5120
    v_mfma_f32_16x16x32_bf16 a[8:11], v[152:155], v[120:123], a[8:11]
    s_add_u32 m0, s59, 52352
    ds_read_b64_tr_b16 v[142:143], v198 offset:5376
    v_lshl_add_u32 v214, v216, 4, s62
    v_mfma_f32_16x16x32_bf16 a[8:11], v[156:159], v[124:127], a[8:11]
    s_lshr_b32 s62, s58, 1
    buffer_load_dwordx4 v192, s[12:15], s65 offen lds
    v_mfma_f32_16x16x32_bf16 a[4:7], v[156:159], v[116:119], a[4:7]
    s_lshl_b32 s62, s62, 8
    ds_read_b64_tr_b16 v[144:145], v198 offset:4608
    v_mfma_f32_16x16x32_bf16 a[4:7], v[152:155], v[112:115], a[4:7]
    s_lshl_b32 s63, s75, 2
    ds_read_b64_tr_b16 v[146:147], v198 offset:4864
    v_mfma_f32_16x16x32_bf16 a[0:3], v[152:155], v[104:107], a[0:3]
    s_add_u32 s62, s62, s63
    v_mfma_f32_16x16x32_bf16 a[0:3], v[156:159], v[108:111], a[0:3]
    s_waitcnt lgkmcnt(6)
    ds_read_b64_tr_b16 v[148:149], v198 offset:5632
    v_mfma_f32_16x16x32_bf16 a[28:31], v[164:167], v[132:135], a[28:31]
    s_add_u32 m0, s59, 46208
    ds_read_b64_tr_b16 v[150:151], v198 offset:5888
    v_mfma_f32_16x16x32_bf16 a[28:31], v[160:163], v[128:131], a[28:31]
    s_add_u32 s62, s62, s60
    buffer_load_dwordx4 v208, s[8:11], s67 offen lds
    v_mfma_f32_16x16x32_bf16 a[24:27], v[160:163], v[120:123], a[24:27]
    s_add_u32 s62, s62, 4096
    ds_read_b64_tr_b16 v[152:153], v198 offset:6144
    v_mfma_f32_16x16x32_bf16 a[24:27], v[164:167], v[124:127], a[24:27]
    s_cmp_eq_u32 s53, 4
    s_cselect_b32 s62, s62, 1073741824
    ds_read_b64_tr_b16 v[154:155], v198 offset:6400
    v_mfma_f32_16x16x32_bf16 a[20:23], v[164:167], v[116:119], a[20:23]
    v_lshl_add_u32 v215, v216, 3, s62
    v_mov_b32 v221, 1073741824
    v_mfma_f32_16x16x32_bf16 a[20:23], v[160:163], v[112:115], a[20:23]
    s_xor_b32 s67, s67, 384
    ds_read_b64_tr_b16 v[156:157], v198 offset:7168
    v_cndmask_b32 v214, v221, v214, s[82:83]
    v_mfma_f32_16x16x32_bf16 a[16:19], v[160:163], v[104:107], a[16:19]
    s_add_u32 m0, s59, 47232
    ds_read_b64_tr_b16 v[158:159], v198 offset:7424
    v_cndmask_b32 v215, v221, v215, s[82:83]
    v_mfma_f32_16x16x32_bf16 a[16:19], v[164:167], v[108:111], a[16:19]
    s_waitcnt lgkmcnt(8)
    buffer_load_dwordx4 v191, s[8:11], s67 offen lds
    v_mfma_f32_16x16x32_bf16 a[44:47], v[140:143], v[132:135], a[44:47]
    s_mul_i32 s62, s58, 1216
    ds_read_b64_tr_b16 v[160:161], v198 offset:6656
    v_mfma_f32_16x16x32_bf16 a[44:47], v[136:139], v[128:131], a[44:47]
    s_add_u32 s62, s62, s60
    ds_read_b64_tr_b16 v[162:163], v198 offset:6912
    v_mfma_f32_16x16x32_bf16 a[40:43], v[136:139], v[120:123], a[40:43]
    s_add_u32 s62, s62, 4480
    v_mfma_f32_16x16x32_bf16 a[40:43], v[140:143], v[124:127], a[40:43]
    s_cmp_eq_u32 s53, 3
    s_cselect_b32 s63, 128, 0
    ds_read_b64_tr_b16 v[164:165], v198 offset:7680
    v_mfma_f32_16x16x32_bf16 a[36:39], v[140:143], v[116:119], a[36:39]
    s_add_u32 m0, s59, 48256
    ds_read_b64_tr_b16 v[166:167], v198 offset:7936
    v_mfma_f32_16x16x32_bf16 a[36:39], v[136:139], v[112:115], a[36:39]
    buffer_load_dwordx4 v208, s[8:11], s67 offen lds
    v_mfma_f32_16x16x32_bf16 a[32:35], v[136:139], v[104:107], a[32:35]
    ds_read_b64_tr_b16 v[136:137], v198 offset:8192
    v_mfma_f32_16x16x32_bf16 a[32:35], v[140:143], v[108:111], a[32:35]
    s_waitcnt lgkmcnt(9)
    ds_read_b64_tr_b16 v[138:139], v198 offset:8448
    v_mfma_f32_16x16x32_bf16 a[60:63], v[148:151], v[132:135], a[60:63]
    s_cmp_eq_u32 s53, 5
    s_cselect_b32 s63, 160, s63
    s_cselect_b32 s61, 13, 8
    s_cselect_b32 s60, 13, 99
    v_mfma_f32_16x16x32_bf16 a[60:63], v[144:147], v[128:131], a[60:63]
    s_xor_b32 s67, s67, 128
    ds_read_b64_tr_b16 v[140:141], v198 offset:8704
    v_mfma_f32_16x16x32_bf16 a[56:59], v[144:147], v[120:123], a[56:59]
    s_add_u32 m0, s59, 49280
    ds_read_b64_tr_b16 v[142:143], v198 offset:8960
    v_mfma_f32_16x16x32_bf16 a[56:59], v[148:151], v[124:127], a[56:59]
    s_add_u32 s62, s62, s63
    buffer_load_dwordx4 v191, s[8:11], s67 offen lds
    v_mfma_f32_16x16x32_bf16 a[52:55], v[148:151], v[116:119], a[52:55]
    s_waitcnt vmcnt(9)
    ds_add_u32 v11, v9
    v_mfma_f32_16x16x32_bf16 a[52:55], v[144:147], v[112:115], a[52:55]
    s_lshr_b32 s63, 0x2c, s53
    v_mfma_f32_16x16x32_bf16 a[48:51], v[144:147], v[104:107], a[48:51]
    s_add_u32 m0, s59, 50304
    v_mfma_f32_16x16x32_bf16 a[48:51], v[148:151], v[108:111], a[48:51]
    s_waitcnt lgkmcnt(9)
    v_mfma_f32_16x16x32_bf16 a[76:79], v[156:159], v[132:135], a[76:79]
    buffer_load_dwordx4 v208, s[8:11], s67 offen lds
    v_mfma_f32_16x16x32_bf16 a[76:79], v[152:155], v[128:131], a[76:79]
    s_bitcmp1_b32 s63, 0
    s_cselect_b32 s61, s61, 99
    ds_read_b32 v6, v11
    v_mfma_f32_16x16x32_bf16 a[72:75], v[152:155], v[120:123], a[72:75]
    v_mul_u32_u24 v216, 304, v219
    v_lshl_add_u32 v216, v218, 4, v216
    v_mfma_f32_16x16x32_bf16 a[72:75], v[156:159], v[124:127], a[72:75]
    v_add_u32 v216, s62, v216
    v_cmp_eq_u32 s[82:83], s60, v218
    v_mfma_f32_16x16x32_bf16 a[68:71], v[156:159], v[116:119], a[68:71]
    v_add_u32 v219, 48, v216
    v_cmp_le_u32 s[54:55], s61, v218
    v_mfma_f32_16x16x32_bf16 a[68:71], v[152:155], v[112:115], a[68:71]
    s_add_u32 m0, s72, 145792
    v_mfma_f32_16x16x32_bf16 a[64:67], v[152:155], v[104:107], a[64:67]
    s_waitcnt lgkmcnt(0)
    v_cmp_le_u32 vcc, 24, v6
    v_mfma_f32_16x16x32_bf16 a[64:67], v[156:159], v[108:111], a[64:67]
    s_waitcnt lgkmcnt(6)
    v_mfma_f32_16x16x32_bf16 a[92:95], v[164:167], v[132:135], a[92:95]
    s_cbranch_vccz L_spin5
L_back5:
    ds_read_b128 v[80:83], v202 offset:2048
    v_mfma_f32_16x16x32_bf16 a[92:95], v[160:163], v[128:131], a[92:95]
    buffer_load_dwordx4 v195, s[4:7], s78 offen lds
    v_mfma_f32_16x16x32_bf16 a[88:91], v[160:163], v[120:123], a[88:91]
    ds_read_b128 v[84:87], v203 offset:2048
    v_mfma_f32_16x16x32_bf16 a[88:91], v[164:167], v[124:127], a[88:91]
    ds_read_b128 v[72:75], v202 offset:0
    v_mfma_f32_16x16x32_bf16 a[84:87], v[164:167], v[116:119], a[84:87]
    s_add_u32 m0, s72, 147840
    ds_read_b128 v[76:79], v203 offset:0
    v_mfma_f32_16x16x32_bf16 a[84:87], v[160:163], v[112:115], a[84:87]
    buffer_load_dwordx4 v195, s[4:7], s68 offen lds
    v_mfma_f32_16x16x32_bf16 a[80:83], v[160:163], v[104:107], a[80:83]
    ds_read_b64_tr_b16 v[144:145], v197 offset:9216
    ds_read_b64_tr_b16 v[146:147], v197 offset:9472
    v_mfma_f32_16x16x32_bf16 a[80:83], v[164:167], v[108:111], a[80:83]
    s_waitcnt lgkmcnt(8)
    ds_read_b64_tr_b16 v[148:149], v197 offset:9728
    v_mfma_f32_16x16x32_bf16 a[108:111], v[140:143], v[132:135], a[108:111]
    s_add_u32 m0, s73, 145792
    ds_read_b64_tr_b16 v[150:151], v197 offset:9984
    v_mfma_f32_16x16x32_bf16 a[108:111], v[136:139], v[128:131], a[108:111]
    buffer_load_dwordx4 v196, s[4:7], s78 offen lds
    v_mfma_f32_16x16x32_bf16 a[104:107], v[136:139], v[120:123], a[104:107]
    ds_read_b128 v[96:99], v204 offset:2048
    v_mfma_f32_16x16x32_bf16 a[104:107], v[140:143], v[124:127], a[104:107]
    ds_read_b128 v[100:103], v205 offset:2048
    v_mfma_f32_16x16x32_bf16 a[100:103], v[140:143], v[116:119], a[100:103]
    s_add_u32 m0, s73, 147840
    ds_read_b128 v[88:91], v204 offset:0
    v_mfma_f32_16x16x32_bf16 a[100:103], v[136:139], v[112:115], a[100:103]
    buffer_load_dwordx4 v196, s[4:7], s68 offen lds
    v_mfma_f32_16x16x32_bf16 a[96:99], v[136:139], v[104:107], a[96:99]
    ds_read_b128 v[92:95], v205 offset:0
    ds_read_b32 v174, v222 offset:0
    v_mfma_f32_16x16x32_bf16 a[96:99], v[140:143], v[108:111], a[96:99]
    s_waitcnt lgkmcnt(5)
    buffer_load_dword v173, v207, s[44:47], s78 offen
    v_mfma_f32_16x16x32_bf16 v[52:55], v[148:151], v[84:87], v[52:55]
    s_bfe_u32 s66, s77, 0x4001c
    ds_read_b64_tr_b16 v[152:153], v197 offset:0
    ds_read_b64_tr_b16 v[154:155], v197 offset:256
    v_mfma_f32_16x16x32_bf16 v[52:55], v[144:147], v[80:83], v[52:55]
    s_mul_i32 s64, s66, 589824
    ds_read_b64_tr_b16 v[156:157], v197 offset:1024
    v_mfma_f32_16x16x32_bf16 v[48:51], v[144:147], v[72:75], v[48:51]
    s_mul_i32 s65, s66, 73728
    ds_read_b64_tr_b16 v[158:159], v197 offset:1280
    s_add_u32 m0, s59, 94464
    v_mfma_f32_16x16x32_bf16 v[48:51], v[148:151], v[76:79], v[48:51]
    s_waitcnt lgkmcnt(4)
    buffer_load_dwordx4 v206, s[8:11], s64 offen lds
    v_mfma_f32_16x16x32_bf16 v[60:63], v[148:151], v[100:103], v[60:63]
    ds_read_b64_tr_b16 v[160:161], v197 offset:512
    v_lshlrev_b32 v178, 16, v174
    v_mfma_f32_16x16x32_bf16 v[60:63], v[144:147], v[96:99], v[60:63]
    s_lshl_b32 s78, s66, 7
    ds_read_b64_tr_b16 v[162:163], v197 offset:768
    v_lshlrev_b32 v179, 16, v172
    v_mfma_f32_16x16x32_bf16 v[56:59], v[144:147], v[88:91], v[56:59]
    s_add_u32 s68, s78, 18432
    v_and_b32 v180, 0xffff0000, v174
    v_and_b32 v181, 0xffff0000, v172
    v_mfma_f32_16x16x32_bf16 v[56:59], v[148:151], v[92:95], v[56:59]
    s_waitcnt lgkmcnt(2)
    ds_read_b64_tr_b16 v[164:165], v197 offset:1536
    v_fmac_f32 v177, v178, v179
    v_mfma_f32_16x16x32_bf16 v[236:239], v[156:159], v[100:103], v[236:239]
    s_add_u32 s67, s64, s71
    ds_read_b64_tr_b16 v[166:167], v197 offset:1792
    s_add_u32 m0, s59, 86272
    v_mfma_f32_16x16x32_bf16 v[236:239], v[152:155], v[96:99], v[236:239]
    buffer_load_dwordx4 v191, s[8:11], s67 offen lds
    v_mfma_f32_16x16x32_bf16 v[232:235], v[152:155], v[88:91], v[232:235]
    ds_read_b64_tr_b16 v[136:137], v197 offset:2048
    v_fmac_f32 v177, v180, v181
    v_mfma_f32_16x16x32_bf16 v[232:235], v[156:159], v[92:95], v[232:235]
    ds_read_b64_tr_b16 v[138:139], v197 offset:2304
    v_cndmask_b32 v216, v216, v219, s[82:83]
    v_mfma_f32_16x16x32_bf16 v[228:231], v[156:159], v[84:87], v[228:231]
    v_mov_b32 v218, 0x3f803f80
    v_cndmask_b32 v216, v221, v216, s[54:55]
    v_mfma_f32_16x16x32_bf16 v[228:231], v[152:155], v[80:83], v[228:231]
    s_mul_i32 s66, s66, 2304
    ds_read_b64_tr_b16 v[140:141], v197 offset:3072
    v_lshrrev_b32 v219, 5, v0
    v_mfma_f32_16x16x32_bf16 v[224:227], v[152:155], v[72:75], v[224:227]
    s_add_u32 m0, s59, 87296
    ds_read_b64_tr_b16 v[142:143], v197 offset:3328
    v_lshlrev_b32 v189, 1, v207
    v_mfma_f32_16x16x32_bf16 v[224:227], v[156:159], v[76:79], v[224:227]
    s_waitcnt lgkmcnt(4)
    buffer_load_dwordx4 v208, s[8:11], s67 offen lds
    v_mfma_f32_16x16x32_bf16 v[252:255], v[164:167], v[100:103], v[252:255]
    ds_read_b64_tr_b16 v[144:145], v197 offset:2560
    v_lshl_add_u32 v189, v219, 30, v189
    v_mfma_f32_16x16x32_bf16 v[252:255], v[160:163], v[96:99], v[252:255]
    ds_read_b64_tr_b16 v[146:147], v197 offset:2816
    v_lshl_add_u32 v219, v219, 4, v212
    v_mfma_f32_16x16x32_bf16 v[248:251], v[160:163], v[88:91], v[248:251]
    v_mfma_f32_16x16x32_bf16 v[248:251], v[164:167], v[92:95], v[248:251]
    s_xor_b32 s67, s67, 128
    ds_read_b64_tr_b16 v[148:149], v197 offset:3584
    v_mfma_f32_16x16x32_bf16 v[244:247], v[164:167], v[84:87], v[244:247]
    s_add_u32 m0, s59, 88320
    ds_read_b64_tr_b16 v[150:151], v197 offset:3840
    v_mfma_f32_16x16x32_bf16 v[244:247], v[160:163], v[80:83], v[244:247]
    buffer_load_dwordx4 v191, s[8:11], s67 offen lds
    v_mfma_f32_16x16x32_bf16 v[240:243], v[160:163], v[72:75], v[240:243]
    ds_read_b64_tr_b16 v[152:153], v197 offset:4096
    v_mfma_f32_16x16x32_bf16 v[240:243], v[164:167], v[76:79], v[240:243]
    s_waitcnt lgkmcnt(5)
    ds_read_b64_tr_b16 v[154:155], v197 offset:4352
    v_mfma_f32_16x16x32_bf16 a[12:15], v[140:143], v[100:103], a[12:15]
    v_mfma_f32_16x16x32_bf16 a[12:15], v[136:139], v[96:99], a[12:15]
    ds_read_b64_tr_b16 v[156:157], v197 offset:5120
    v_mfma_f32_16x16x32_bf16 a[8:11], v[136:139], v[88:91], a[8:11]
    s_add_u32 m0, s59, 95488
    ds_read_b64_tr_b16 v[158:159], v197 offset:5376
    v_mfma_f32_16x16x32_bf16 a[8:11], v[140:143], v[92:95], a[8:11]
    buffer_load_dwordx4 v192, s[12:15], s65 offen lds
    v_mfma_f32_16x16x32_bf16 a[4:7], v[140:143], v[84:87], a[4:7]
    ds_read_b64_tr_b16 v[160:161], v197 offset:4608
    v_mfma_f32_16x16x32_bf16 a[4:7], v[136:139], v[80:83], a[4:7]
    ds_read_b64_tr_b16 v[162:163], v197 offset:4864
    v_mfma_f32_16x16x32_bf16 a[0:3], v[136:139], v[72:75], a[0:3]
    v_mfma_f32_16x16x32_bf16 a[0:3], v[140:143], v[76:79], a[0:3]
    s_waitcnt lgkmcnt(6)
    ds_read_b64_tr_b16 v[164:165], v197 offset:5632
    v_mfma_f32_16x16x32_bf16 a[28:31], v[148:151], v[100:103], a[28:31]
    s_add_u32 m0, s59, 89344
    ds_read_b64_tr_b16 v[166:167], v197 offset:5888
    v_mfma_f32_16x16x32_bf16 a[28:31], v[144:147], v[96:99], a[28:31]
    buffer_load_dwordx4 v208, s[8:11], s67 offen lds
    v_mfma_f32_16x16x32_bf16 a[24:27], v[144:147], v[88:91], a[24:27]
    ds_read_b64_tr_b16 v[136:137], v197 offset:6144
    v_mfma_f32_16x16x32_bf16 a[24:27], v[148:151], v[92:95], a[24:27]
    ds_read_b64_tr_b16 v[138:139], v197 offset:6400
    v_mfma_f32_16x16x32_bf16 a[20:23], v[148:151], v[84:87], a[20:23]
    v_mfma_f32_16x16x32_bf16 a[20:23], v[144:147], v[80:83], a[20:23]
    s_xor_b32 s67, s67, 384
    ds_read_b64_tr_b16 v[140:141], v197 offset:7168
    v_mfma_f32_16x16x32_bf16 a[16:19], v[144:147], v[72:75], a[16:19]
    s_add_u32 m0, s59, 90368
    ds_read_b64_tr_b16 v[142:143], v197 offset:7424
    v_mfma_f32_16x16x32_bf16 a[16:19], v[148:151], v[76:79], a[16:19]
    s_waitcnt lgkmcnt(8)
    buffer_load_dwordx4 v191, s[8:11], s67 offen lds
    v_mfma_f32_16x16x32_bf16 a[44:47], v[156:159], v[100:103], a[44:47]
    ds_read_b64_tr_b16 v[144:145], v197 offset:6656
    v_mfma_f32_16x16x32_bf16 a[44:47], v[152:155], v[96:99], a[44:47]
    ds_read_b64_tr_b16 v[146:147], v197 offset:6912
    v_mfma_f32_16x16x32_bf16 a[40:43], v[152:155], v[88:91], a[40:43]
    v_mfma_f32_16x16x32_bf16 a[40:43], v[156:159], v[92:95], a[40:43]
    ds_read_b64_tr_b16 v[148:149], v197 offset:7680
    v_mfma_f32_16x16x32_bf16 a[36:39], v[156:159], v[84:87], a[36:39]
    s_add_u32 m0, s59, 91392
    ds_read_b64_tr_b16 v[150:151], v197 offset:7936
    v_mfma_f32_16x16x32_bf16 a[36:39], v[152:155], v[80:83], a[36:39]
    buffer_load_dwordx4 v208, s[8:11], s67 offen lds
    v_mfma_f32_16x16x32_bf16 a[32:35], v[152:155], v[72:75], a[32:35]
    ds_read_b64_tr_b16 v[152:153], v197 offset:8192
    v_mfma_f32_16x16x32_bf16 a[32:35], v[156:159], v[76:79], a[32:35]
    s_waitcnt lgkmcnt(9)
    ds_read_b64_tr_b16 v[154:155], v197 offset:8448
    v_mfma_f32_16x16x32_bf16 a[60:63], v[164:167], v[100:103], a[60:63]
    v_mfma_f32_16x16x32_bf16 a[60:63], v[160:163], v[96:99], a[60:63]
    s_xor_b32 s67, s67, 128
    ds_read_b64_tr_b16 v[156:157], v197 offset:8704
    v_mfma_f32_16x16x32_bf16 a[56:59], v[160:163], v[88:91], a[56:59]
    s_add_u32 m0, s59, 92416
    ds_read_b64_tr_b16 v[158:159], v197 offset:8960
    v_mfma_f32_16x16x32_bf16 a[56:59], v[164:167], v[92:95], a[56:59]
    buffer_load_dwordx4 v191, s[8:11], s67 offen lds
    v_mfma_f32_16x16x32_bf16 a[52:55], v[164:167], v[84:87], a[52:55]
    s_waitcnt vmcnt(9)
    ds_add_u32 v11, v9
    v_mfma_f32_16x16x32_bf16 a[52:55], v[160:163], v[80:83], a[52:55]
    v_mfma_f32_16x16x32_bf16 a[48:51], v[160:163], v[72:75], a[48:51]
    s_add_u32 m0, s59, 93440
    v_mfma_f32_16x16x32_bf16 a[48:51], v[164:167], v[76:79], a[48:51]
    s_waitcnt lgkmcnt(9)
    v_mfma_f32_16x16x32_bf16 a[76:79], v[140:143], v[100:103], a[76:79]
    buffer_load_dwordx4 v208, s[8:11], s67 offen lds
    v_mfma_f32_16x16x32_bf16 a[76:79], v[136:139], v[96:99], a[76:79]
    ds_read_b32 v6, v11
    v_mfma_f32_16x16x32_bf16 a[72:75], v[136:139], v[88:91], a[72:75]
    v_mfma_f32_16x16x32_bf16 a[72:75], v[140:143], v[92:95], a[72:75]
    v_mfma_f32_16x16x32_bf16 a[68:71], v[140:143], v[84:87], a[68:71]
    v_mfma_f32_16x16x32_bf16 a[68:71], v[136:139], v[80:83], a[68:71]
    s_add_u32 m0, s72, 129408
    v_mfma_f32_16x16x32_bf16 a[64:67], v[136:139], v[72:75], a[64:67]
    s_waitcnt lgkmcnt(0)
    v_cmp_le_u32 vcc, 28, v6
    v_mfma_f32_16x16x32_bf16 a[64:67], v[140:143], v[76:79], a[64:67]
    s_waitcnt lgkmcnt(6)
    v_mfma_f32_16x16x32_bf16 a[92:95], v[148:151], v[100:103], a[92:95]
    s_cbranch_vccz L_spin6
L_back6:
    ds_read_b128 v[112:115], v202 offset:18432
    v_mfma_f32_16x16x32_bf16 a[92:95], v[144:147], v[96:99], a[92:95]
    buffer_load_dwordx4 v195, s[4:7], s78 offen lds
    v_mfma_f32_16x16x32_bf16 a[88:91], v[144:147], v[88:91], a[88:91]
    ds_read_b128 v[116:119], v203 offset:18432
    v_mfma_f32_16x16x32_bf16 a[88:91], v[148:151], v[92:95], a[88:91]
    ds_read_b128 v[104:107], v202 offset:16384
    v_mfma_f32_16x16x32_bf16 a[84:87], v[148:151], v[84:87], a[84:87]
    s_add_u32 m0, s72, 131456
    ds_read_b128 v[108:111], v203 offset:16384
    v_mfma_f32_16x16x32_bf16 a[84:87], v[144:147], v[80:83], a[84:87]
    buffer_load_dwordx4 v195, s[4:7], s68 offen lds
    v_mfma_f32_16x16x32_bf16 a[80:83], v[144:147], v[72:75], a[80:83]
    ds_read_b64_tr_b16 v[160:161], v197 offset:52352
    ds_read_b64_tr_b16 v[162:163], v197 offset:52608
    v_mfma_f32_16x16x32_bf16 a[80:83], v[148:151], v[76:79], a[80:83]
    s_waitcnt lgkmcnt(8)
    ds_read_b64_tr_b16 v[164:165], v197 offset:52864
    v_mfma_f32_16x16x32_bf16 a[108:111], v[156:159], v[100:103], a[108:111]
    s_add_u32 m0, s73, 129408
    ds_read_b64_tr_b16 v[166:167], v197 offset:53120
    v_mfma_f32_16x16x32_bf16 a[108:111], v[152:155], v[96:99], a[108:111]
    buffer_load_dwordx4 v196, s[4:7], s78 offen lds
    v_mfma_f32_16x16x32_bf16 a[104:107], v[152:155], v[88:91], a[104:107]
    ds_read_b128 v[128:131], v204 offset:18432
    v_mfma_f32_16x16x32_bf16 a[104:107], v[156:159], v[92:95], a[104:107]
    ds_read_b128 v[132:135], v205 offset:18432
    v_mfma_f32_16x16x32_bf16 a[100:103], v[156:159], v[84:87], a[100:103]
    s_add_u32 m0, s73, 131456
    ds_read_b128 v[120:123], v204 offset:16384
    v_mfma_f32_16x16x32_bf16 a[100:103], v[152:155], v[80:83], a[100:103]
    buffer_load_dwordx4 v196, s[4:7], s68 offen lds
    v_mfma_f32_16x16x32_bf16 a[96:99], v[152:155], v[72:75], a[96:99]
    ds_read_b128 v[124:127], v205 offset:16384
    ds_read_b32 v174, v222 offset:16384
    v_mfma_f32_16x16x32_bf16 a[96:99], v[156:159], v[76:79], a[96:99]
    s_waitcnt lgkmcnt(5)
    buffer_load_dword v172, v207, s[44:47], s78 offen
    v_mfma_f32_16x16x32_bf16 v[52:55], v[164:167], v[116:119], v[52:55]
    s_xor_b32 s64, s71, 0
    ds_read_b64_tr_b16 v[136:137], v197 offset:43136
    ds_read_b64_tr_b16 v[138:139], v197 offset:43392
    v_mfma_f32_16x16x32_bf16 v[52:55], v[160:163], v[112:115], v[52:55]
    s_mul_i32 s64, s64, 576
    ds_read_b64_tr_b16 v[140:141], v197 offset:44160
    v_mfma_f32_16x16x32_bf16 v[48:51], v[160:163], v[104:107], v[48:51]
    s_add_u32 m0, s59, 0
    ds_read_b64_tr_b16 v[142:143], v197 offset:44416
    s_lshr_b32 s19, s100, 1
    v_mfma_f32_16x16x32_bf16 v[48:51], v[164:167], v[108:111], v[48:51]
    s_waitcnt lgkmcnt(4)
    buffer_load_dwordx4 v2, s[20:23], s64 offen offset:0 lds
    v_mfma_f32_16x16x32_bf16 v[60:63], v[164:167], v[132:135], v[60:63]
    s_lshl3_add_u32 s19, s56, s19
    ds_read_b64_tr_b16 v[144:145], v197 offset:43648
    v_lshlrev_b32 v178, 16, v174
    v_mfma_f32_16x16x32_bf16 v[60:63], v[160:163], v[128:131], v[60:63]
    s_add_u32 m0, s59, 896
    ds_read_b64_tr_b16 v[146:147], v197 offset:43904
    v_lshlrev_b32 v179, 16, v173
    v_mfma_f32_16x16x32_bf16 v[56:59], v[160:163], v[120:123], v[56:59]
    s_lshl2_add_u32 s19, s19, s58
    buffer_load_dwordx4 v2, s[20:23], s64 offen offset:128 lds
    v_mfma_f32_16x16x32_bf16 v[56:59], v[164:167], v[124:127], v[56:59]
    s_waitcnt lgkmcnt(2)
    ds_read_b64_tr_b16 v[148:149], v197 offset:44672
    v_and_b32 v180, 0xffff0000, v174
    v_mfma_f32_16x16x32_bf16 v[236:239], v[140:143], v[132:135], v[236:239]
    s_add_u32 m0, s59, 1792
    ds_read_b64_tr_b16 v[150:151], v197 offset:44928
    v_and_b32 v181, 0xffff0000, v173
    v_mfma_f32_16x16x32_bf16 v[236:239], v[136:139], v[128:131], v[236:239]
    s_lshl_b32 s19, s19, 8
    buffer_load_dwordx4 v2, s[20:23], s64 offen offset:256 lds
    v_mfma_f32_16x16x32_bf16 v[232:235], v[136:139], v[120:123], v[232:235]
    s_add_u32 s19, s19, 3407872
    ds_read_b64_tr_b16 v[152:153], v197 offset:45184
    v_fmac_f32 v177, v178, v179
    v_mfma_f32_16x16x32_bf16 v[232:235], v[140:143], v[124:127], v[232:235]
    s_add_u32 m0, s59, 2688
    ds_read_b64_tr_b16 v[154:155], v197 offset:45440
    v_fmac_f32 v177, v180, v181
    v_mfma_f32_16x16x32_bf16 v[228:231], v[140:143], v[116:119], v[228:231]
    s_lshl_b32 s72, s58, 10
    buffer_load_dwordx4 v2, s[20:23], s64 offen offset:384 lds
    v_mfma_f32_16x16x32_bf16 v[228:231], v[136:139], v[112:115], v[228:231]
    s_mul_i32 s73, s58, 20768
    ds_read_b64_tr_b16 v[156:157], v197 offset:46208
    s_add_u32 s73, s73, 61440
    v_mfma_f32_16x16x32_bf16 v[224:227], v[136:139], v[104:107], v[224:227]
    s_lshl_b32 s55, s56, 4
    ds_read_b64_tr_b16 v[158:159], v197 offset:46464
    v_mfma_f32_16x16x32_bf16 v[224:227], v[140:143], v[108:111], v[224:227]
    s_waitcnt lgkmcnt(4)
    v_mfma_f32_16x16x32_bf16 v[252:255], v[148:151], v[132:135], v[252:255]
    s_cmp_lt_u32 s53, 8
    s_cselect_b32 s55, s55, 0x1000
    ds_read_b64_tr_b16 v[160:161], v197 offset:45696
    v_mfma_f32_16x16x32_bf16 v[252:255], v[144:147], v[128:131], v[252:255]
    s_add_u32 m0, s59, 3584
    ds_read_b64_tr_b16 v[162:163], v197 offset:45952
    v_mfma_f32_16x16x32_bf16 v[248:251], v[144:147], v[120:123], v[248:251]
    buffer_load_dwordx4 v2, s[20:23], s64 offen offset:512 lds
    v_mfma_f32_16x16x32_bf16 v[248:251], v[148:151], v[124:127], v[248:251]
    s_cmp_eq_u32 s58, 0
    s_cselect_b32 s55, s55, 0x1000
    ds_read_b64_tr_b16 v[164:165], v197 offset:46720
    v_mfma_f32_16x16x32_bf16 v[244:247], v[148:151], v[116:119], v[244:247]
    s_add_u32 m0, s59, 4480
    ds_read_b64_tr_b16 v[166:167], v197 offset:46976
    s_lshl_b32 s62, s56, 5
    v_mfma_f32_16x16x32_bf16 v[244:247], v[144:147], v[112:115], v[244:247]
L_po2:
L_q2:
    s_cbranch_execz L_q8
    s_add_u32 s62, s62, s57
    buffer_load_dwordx4 v2, s[20:23], s64 offen offset:640 lds
    v_mfma_f32_16x16x32_bf16 v[240:243], v[144:147], v[104:107], v[240:243]
    s_add_u32 m0, s59, 5376
    ds_read_b64_tr_b16 v[136:137], v197 offset:47232
    s_mul_i32 s62, s62, 73728
    v_mfma_f32_16x16x32_bf16 v[240:243], v[148:151], v[108:111], v[240:243]
    s_waitcnt lgkmcnt(5)
    ds_read_b64_tr_b16 v[138:139], v197 offset:47488
    s_lshr_b32 s63, s58, 1
    v_mfma_f32_16x16x32_bf16 a[12:15], v[156:159], v[132:135], a[12:15]
    s_mul_i32 s63, s63, 36864
    buffer_load_dwordx4 v2, s[20:23], s64 offen offset:768 lds
    v_mfma_f32_16x16x32_bf16 a[12:15], v[152:155], v[128:131], a[12:15]
    s_add_u32 s62, s62, s63
    ds_read_b64_tr_b16 v[140:141], v197 offset:48256
    s_add_u32 s62, s62, 4194304
    v_mfma_f32_16x16x32_bf16 a[8:11], v[152:155], v[120:123], a[8:11]
    s_mul_i32 s63, s75, 1179648
    ds_read_b64_tr_b16 v[142:143], v197 offset:48512
    s_add_u32 s18, s62, s63
    v_mfma_f32_16x16x32_bf16 a[8:11], v[156:159], v[124:127], a[8:11]
    s_sub_u32 s37, s62, s63
    s_add_u32 s37, s37, 1179648
    s_mul_i32 s63, s75, 20480
    v_mfma_f32_16x16x32_bf16 a[4:7], v[156:159], v[116:119], a[4:7]
    s_add_u32 s36, s18, s63
    ds_read_b64_tr_b16 v[144:145], v197 offset:47744
    s_add_u32 s37, s37, s63
    v_mfma_f32_16x16x32_bf16 a[4:7], v[152:155], v[112:115], a[4:7]
    s_add_u32 m0, s59, 6272
    ds_read_b64_tr_b16 v[146:147], v197 offset:48000
    s_add_u32 s18, s18, 16384
    v_mfma_f32_16x16x32_bf16 a[0:3], v[152:155], v[104:107], a[0:3]
    s_lshl_b32 s63, s56, 1
    buffer_load_dwordx4 v2, s[20:23], s64 offen offset:896 lds
    v_mfma_f32_16x16x32_bf16 a[0:3], v[156:159], v[108:111], a[0:3]
    s_waitcnt lgkmcnt(6)
    ds_read_b64_tr_b16 v[148:149], v197 offset:48768
    s_lshr_b32 s62, s57, 3
    v_mfma_f32_16x16x32_bf16 a[28:31], v[164:167], v[132:135], a[28:31]
    s_add_u32 m0, s59, 7168
    ds_read_b64_tr_b16 v[150:151], v197 offset:49024
    s_add_u32 s63, s63, s62
    v_mfma_f32_16x16x32_bf16 a[28:31], v[160:163], v[128:131], a[28:31]
    s_mul_i32 s38, s63, 1179648
    buffer_load_dwordx4 v2, s[20:23], s64 offen offset:1024 lds
    v_mfma_f32_16x16x32_bf16 a[24:27], v[160:163], v[120:123], a[24:27]
    s_and_b32 s66, s57, 1
    ds_read_b64_tr_b16 v[152:153], v197 offset:49280
    s_lshl_b32 s54, s63, 2
    v_mfma_f32_16x16x32_bf16 a[24:27], v[164:167], v[124:127], a[24:27]
    s_mul_i32 s66, s66, -331776
    ds_read_b64_tr_b16 v[154:155], v197 offset:49536
    s_add_u32 s54, s54, s58
    v_mfma_f32_16x16x32_bf16 a[20:23], v[164:167], v[116:119], a[20:23]
    s_add_u32 s66, s66, 294912
    s_lshl_b32 s47, s54, 11
    s_add_u32 s47, s47, 3145852
    v_mfma_f32_16x16x32_bf16 a[20:23], v[160:163], v[112:115], a[20:23]
    s_lshr_b32 s53, s54, 1
    ds_read_b64_tr_b16 v[156:157], v197 offset:50304
    s_mul_i32 s53, s53, 36864
    v_mfma_f32_16x16x32_bf16 a[16:19], v[160:163], v[104:107], a[16:19]
    s_add_u32 s53, s53, 655360
    ds_read_b64_tr_b16 v[158:159], v197 offset:50560
    s_mul_i32 s54, s54, 18432
    v_mfma_f32_16x16x32_bf16 a[16:19], v[164:167], v[108:111], a[16:19]
    s_waitcnt lgkmcnt(8)
    s_lshl_b32 s45, s56, 5
    s_add_u32 s45, s45, s62
    v_mfma_f32_16x16x32_bf16 a[44:47], v[140:143], v[132:135], a[44:47]
    s_lshl_b32 s45, s45, 1
    ds_read_b64_tr_b16 v[160:161], v197 offset:49792
    s_bfe_u32 s62, s57, 0x10002
    v_mfma_f32_16x16x32_bf16 a[44:47], v[136:139], v[128:131], a[44:47]
    s_lshl_b32 s44, s56, 5
    ds_read_b64_tr_b16 v[162:163], v197 offset:50048
    s_add_u32 s44, s44, s62
    v_mfma_f32_16x16x32_bf16 a[40:43], v[136:139], v[120:123], a[40:43]
    s_lshl_b32 s44, s44, 8
    s_add_u32 s44, s44, 196608
    s_lshr_b32 s62, s58, 1
    v_mfma_f32_16x16x32_bf16 a[40:43], v[140:143], v[124:127], a[40:43]
    s_add_u32 s45, s45, s62
    ds_read_b64_tr_b16 v[164:165], v197 offset:50816
    s_lshl_b32 s45, s45, 7
    v_mfma_f32_16x16x32_bf16 a[36:39], v[140:143], v[116:119], a[36:39]
    s_add_u32 s45, s45, 327680
    ds_read_b64_tr_b16 v[166:167], v197 offset:51072
    s_lshl_b32 s62, s56, 2
    v_mfma_f32_16x16x32_bf16 a[36:39], v[136:139], v[112:115], a[36:39]
    s_add_u32 s62, s62, s58
    s_lshl_b32 s46, s62, 12
    s_add_u32 s46, s46, 3145852
    v_mfma_f32_16x16x32_bf16 a[32:35], v[136:139], v[104:107], a[32:35]
    s_mul_i32 s52, s62, 36864
    ds_read_b64_tr_b16 v[136:137], v197 offset:51328
    s_add_u32 s52, s52, 655360
    v_mfma_f32_16x16x32_bf16 a[32:35], v[140:143], v[108:111], a[32:35]
    s_waitcnt lgkmcnt(9)
    ds_read_b64_tr_b16 v[138:139], v197 offset:51584
    s_and_b32 s62, s57, 7
    v_mfma_f32_16x16x32_bf16 a[60:63], v[148:151], v[132:135], a[60:63]
    s_mul_i32 s62, s62, 144
    s_add_u32 s54, s54, s62
    s_and_b32 s63, s57, 1
    v_mfma_f32_16x16x32_bf16 a[60:63], v[144:147], v[128:131], a[60:63]
    s_lshl_b32 s60, s63, 4
    ds_read_b64_tr_b16 v[140:141], v197 offset:51840
    s_add_u32 s60, s60, s62
    v_mfma_f32_16x16x32_bf16 a[56:59], v[144:147], v[120:123], a[56:59]
    s_xor_b32 s63, s63, 1
    ds_read_b64_tr_b16 v[142:143], v197 offset:52096
    s_lshl_b32 s61, s63, 7
    v_mfma_f32_16x16x32_bf16 a[56:59], v[148:151], v[124:127], a[56:59]
    s_add_u32 s61, s61, s62
    s_lshl_b32 s62, s58, 8
    s_add_u32 s38, s38, s62
    v_mfma_f32_16x16x32_bf16 a[52:55], v[148:151], v[116:119], a[52:55]
    s_waitcnt vmcnt(9)
    ds_add_u32 v11, v9
    s_add_u32 s38, s38, 4194304
    v_mfma_f32_16x16x32_bf16 a[52:55], v[144:147], v[112:115], a[52:55]
    s_lshl_b32 s62, s61, 6
    s_add_u32 s39, s38, s62
    s_lshl_b32 s62, s60, 6
    v_mfma_f32_16x16x32_bf16 a[48:51], v[144:147], v[104:107], a[48:51]
    s_add_u32 s38, s38, s62
    s_lshl_b32 s4, s100, 10
    s_add_u32 s4, s4, s52
    v_mfma_f32_16x16x32_bf16 a[48:51], v[148:151], v[108:111], a[48:51]
    s_waitcnt lgkmcnt(9)
    s_lshl_b32 s5, s100, 7
    s_add_u32 s5, s5, s52
    v_mfma_f32_16x16x32_bf16 a[76:79], v[156:159], v[132:135], a[76:79]
    s_add_u32 s5, s5, 16384
    s_add_u32 s7, s4, 18432
    s_add_u32 s8, s5, 18432
    v_mfma_f32_16x16x32_bf16 a[76:79], v[152:155], v[128:131], a[76:79]
    s_mov_b32 s6, s3
    ds_read_b32 v6, v11
    s_sub_u32 s9, s45, 131072
    v_mfma_f32_16x16x32_bf16 a[72:75], v[152:155], v[120:123], a[72:75]
    s_lshl_b32 s62, s76, 12
    s_add_u32 s13, s62, s53
    s_xor_b32 s63, s62, 4096
    v_mfma_f32_16x16x32_bf16 a[72:75], v[156:159], v[124:127], a[72:75]
    s_add_u32 s14, s63, s53
    s_xor_b32 s63, s62, 8192
    s_add_u32 s15, s63, s53
    v_mfma_f32_16x16x32_bf16 a[68:71], v[156:159], v[116:119], a[68:71]
    s_xor_b32 s63, s62, 12288
    s_add_u32 s16, s63, s53
    s_add_u32 s17, s53, 16384
    v_mfma_f32_16x16x32_bf16 a[68:71], v[152:155], v[112:115], a[68:71]
    s_mov_b32 s10, 0x45000000
    s_mov_b32 s11, 0x45000000
    v_mfma_f32_16x16x32_bf16 a[64:67], v[152:155], v[104:107], a[64:67]
    s_waitcnt lgkmcnt(0)
    v_cmp_le_u32 vcc, 32, v6
    v_mfma_f32_16x16x32_bf16 a[64:67], v[156:159], v[108:111], a[64:67]
    s_waitcnt lgkmcnt(6)
    v_mfma_f32_16x16x32_bf16 a[92:95], v[164:167], v[132:135], a[92:95]
    s_cbranch_vccz L_spin7
L_back7:
    ds_read_b128 v[80:83], v202 offset:2048
    v_mfma_f32_16x16x32_bf16 a[92:95], v[160:163], v[128:131], a[92:95]
    buffer_store_dwordx4 v[184:187], v182, s[28:31], 0 offen sc1
    v_mfma_f32_16x16x32_bf16 a[88:91], v[160:163], v[120:123], a[88:91]
    ds_read_b128 v[84:87], v203 offset:2048
    v_mfma_f32_16x16x32_bf16 a[88:91], v[164:167], v[124:127], a[88:91]
    ds_read_b128 v[72:75], v202 offset:0
    v_mfma_f32_16x16x32_bf16 a[84:87], v[164:167], v[116:119], a[84:87]
    ds_read_b128 v[76:79], v203 offset:0
    v_mfma_f32_16x16x32_bf16 a[84:87], v[160:163], v[112:115], a[84:87]
    buffer_store_dword v184, v183, s[28:31], 0 offen sc1
    v_mfma_f32_16x16x32_bf16 a[80:83], v[160:163], v[104:107], a[80:83]
    ds_read_b64_tr_b16 v[144:145], v198 offset:9216
    ds_read_b64_tr_b16 v[146:147], v198 offset:9472
    v_mfma_f32_16x16x32_bf16 a[80:83], v[164:167], v[108:111], a[80:83]
    s_waitcnt lgkmcnt(8)
    ds_read_b64_tr_b16 v[148:149], v198 offset:9728
    v_mfma_f32_16x16x32_bf16 a[108:111], v[140:143], v[132:135], a[108:111]
    ds_read_b64_tr_b16 v[150:151], v198 offset:9984
    v_mfma_f32_16x16x32_bf16 a[108:111], v[136:139], v[128:131], a[108:111]
    global_load_dword v8, v12, s[0:1]
    v_mfma_f32_16x16x32_bf16 a[104:107], v[136:139], v[120:123], a[104:107]
    ds_read_b128 v[96:99], v204 offset:2048
    v_mfma_f32_16x16x32_bf16 a[104:107], v[140:143], v[124:127], a[104:107]
    ds_read_b128 v[100:103], v205 offset:2048
    v_mfma_f32_16x16x32_bf16 a[100:103], v[140:143], v[116:119], a[100:103]
    ds_read_b128 v[88:91], v204 offset:0
    v_mfma_f32_16x16x32_bf16 a[100:103], v[136:139], v[112:115], a[100:103]
    v_mfma_f32_16x16x32_bf16 a[96:99], v[136:139], v[104:107], a[96:99]
    ds_read_b128 v[92:95], v205 offset:0
    ds_read_b32 v174, v222 offset:0
    v_mfma_f32_16x16x32_bf16 a[96:99], v[140:143], v[108:111], a[96:99]
    s_waitcnt lgkmcnt(5)
    v_mfma_f32_16x16x32_bf16 v[52:55], v[148:151], v[84:87], v[52:55]
    s_xor_b32 s64, s71, 64
    ds_read_b64_tr_b16 v[152:153], v198 offset:0
    ds_read_b64_tr_b16 v[154:155], v198 offset:256
    v_mfma_f32_16x16x32_bf16 v[52:55], v[144:147], v[80:83], v[52:55]
    s_mul_i32 s64, s64, 576
    ds_read_b64_tr_b16 v[156:157], v198 offset:1024
    v_mfma_f32_16x16x32_bf16 v[48:51], v[144:147], v[72:75], v[48:51]
    s_add_u32 m0, s59, 43136
    ds_read_b64_tr_b16 v[158:159], v198 offset:1280
    v_mfma_f32_16x16x32_bf16 v[48:51], v[148:151], v[76:79], v[48:51]
    s_waitcnt lgkmcnt(4)
    buffer_load_dwordx4 v2, s[20:23], s64 offen offset:0 lds
    v_mfma_f32_16x16x32_bf16 v[60:63], v[148:151], v[100:103], v[60:63]
    ds_read_b64_tr_b16 v[160:161], v198 offset:512
    v_lshlrev_b32 v178, 16, v174
    v_mfma_f32_16x16x32_bf16 v[60:63], v[144:147], v[96:99], v[60:63]
    ds_read_b64_tr_b16 v[162:163], v198 offset:768
    v_lshlrev_b32 v179, 16, v172
    v_mfma_f32_16x16x32_bf16 v[56:59], v[144:147], v[88:91], v[56:59]
    v_and_b32 v180, 0xffff0000, v174
    v_and_b32 v181, 0xffff0000, v172
    v_mfma_f32_16x16x32_bf16 v[56:59], v[148:151], v[92:95], v[56:59]
    s_waitcnt lgkmcnt(2)
    ds_read_b64_tr_b16 v[164:165], v198 offset:1536
    v_fmac_f32 v177, v178, v179
    v_mfma_f32_16x16x32_bf16 v[236:239], v[156:159], v[100:103], v[236:239]
    s_add_u32 m0, s59, 44032
    ds_read_b64_tr_b16 v[166:167], v198 offset:1792
    v_fmac_f32 v177, v180, v181
    v_mfma_f32_16x16x32_bf16 v[236:239], v[152:155], v[96:99], v[236:239]
    buffer_load_dwordx4 v2, s[20:23], s64 offen offset:128 lds
    v_mfma_f32_16x16x32_bf16 v[232:235], v[152:155], v[88:91], v[232:235]
    ds_read_b64_tr_b16 v[136:137], v198 offset:2048
    v_add_f32_dpp v177, v177, v177 row_shr:1 row_mask:0xf bank_mask:0xf bound_ctrl:1
    v_mfma_f32_16x16x32_bf16 v[232:235], v[156:159], v[92:95], v[232:235]
    ds_read_b64_tr_b16 v[138:139], v198 offset:2304
    v_mfma_f32_16x16x32_bf16 v[228:231], v[156:159], v[84:87], v[228:231]
    v_add_f32_dpp v177, v177, v177 row_shr:2 row_mask:0xf bank_mask:0xf bound_ctrl:1
    v_mul_f32 v52, 0x3eae1a93, v52
    v_mul_f32 v53, 0x3eae1a93, v53
    v_mfma_f32_16x16x32_bf16 v[228:231], v[152:155], v[80:83], v[228:231]
    ds_read_b64_tr_b16 v[140:141], v198 offset:3072
    v_mul_f32 v54, 0x3eae1a93, v54
    v_mfma_f32_16x16x32_bf16 v[224:227], v[152:155], v[72:75], v[224:227]
    s_add_u32 m0, s59, 44928
    ds_read_b64_tr_b16 v[142:143], v198 offset:3328
    v_add_f32_dpp v177, v177, v177 row_shr:4 row_mask:0xf bank_mask:0xf bound_ctrl:1
    v_mul_f32 v55, 0x3eae1a93, v55
    v_mfma_f32_16x16x32_bf16 v[224:227], v[156:159], v[76:79], v[224:227]
    s_waitcnt lgkmcnt(4)
    buffer_load_dwordx4 v2, s[20:23], s64 offen offset:256 lds
    v_cvt_pk_bf16_f32 v52, v52, v53
    v_mfma_f32_16x16x32_bf16 v[252:255], v[164:167], v[100:103], v[252:255]
    ds_read_b64_tr_b16 v[144:145], v198 offset:2560
    v_add_f32_dpp v177, v177, v177 row_shr:8 row_mask:0xf bank_mask:0xf bound_ctrl:1
    v_cvt_pk_bf16_f32 v53, v54, v55
    v_mfma_f32_16x16x32_bf16 v[252:255], v[160:163], v[96:99], v[252:255]
    ds_read_b64_tr_b16 v[146:147], v198 offset:2816
    ds_write_b64 v209, v[52:53] offset:1664
    v_mfma_f32_16x16x32_bf16 v[248:251], v[160:163], v[88:91], v[248:251]
    v_add_f32_dpp v177, v177, v177 row_bcast:15 row_mask:0xa bank_mask:0xf
    v_mfma_f32_16x16x32_bf16 v[248:251], v[164:167], v[92:95], v[248:251]
    ds_read_b64_tr_b16 v[148:149], v198 offset:3584
    v_mul_f32 v48, 0x3eae1a93, v48
    v_mul_f32 v49, 0x3eae1a93, v49
    v_mfma_f32_16x16x32_bf16 v[244:247], v[164:167], v[84:87], v[244:247]
    ds_read_b64_tr_b16 v[150:151], v198 offset:3840
    v_mul_f32 v177, 0xbfb8aa3b, v177
    v_mul_f32 v50, 0x3eae1a93, v50
    v_mfma_f32_16x16x32_bf16 v[244:247], v[160:163], v[80:83], v[244:247]
    v_mul_f32 v51, 0x3eae1a93, v51
    v_cvt_pk_bf16_f32 v48, v48, v49
    v_cvt_pk_bf16_f32 v49, v50, v51
    v_mfma_f32_16x16x32_bf16 v[240:243], v[160:163], v[72:75], v[240:243]
    s_add_u32 m0, s59, 45824
    ds_read_b64_tr_b16 v[152:153], v198 offset:4096
    v_exp_f32 v177, v177
    v_mfma_f32_16x16x32_bf16 v[240:243], v[164:167], v[76:79], v[240:243]
    s_waitcnt lgkmcnt(6)
    ds_read_b64_tr_b16 v[154:155], v198 offset:4352
    ds_write_b64 v209, v[48:49] offset:0
    v_mfma_f32_16x16x32_bf16 a[12:15], v[140:143], v[100:103], a[12:15]
    buffer_load_dwordx4 v2, s[20:23], s64 offen offset:384 lds
    v_add_f32 v177, 1.0, v177
    v_mfma_f32_16x16x32_bf16 a[12:15], v[136:139], v[96:99], a[12:15]
    ds_read_b64_tr_b16 v[156:157], v198 offset:5120
    v_mul_f32 v60, 0x3eae1a93, v60
    v_mul_f32 v61, 0x3eae1a93, v61
    v_mfma_f32_16x16x32_bf16 a[8:11], v[136:139], v[88:91], a[8:11]
    ds_read_b64_tr_b16 v[158:159], v198 offset:5376
    v_rcp_f32 v177, v177
    v_mul_f32 v62, 0x3eae1a93, v62
    v_mfma_f32_16x16x32_bf16 a[8:11], v[140:143], v[92:95], a[8:11]
    v_mul_f32 v63, 0x3eae1a93, v63
    v_cvt_pk_bf16_f32 v60, v60, v61
    v_mfma_f32_16x16x32_bf16 a[4:7], v[140:143], v[84:87], a[4:7]
    ds_read_b64_tr_b16 v[160:161], v198 offset:4608
    v_cvt_pk_bf16_f32 v61, v62, v63
    v_mfma_f32_16x16x32_bf16 a[4:7], v[136:139], v[80:83], a[4:7]
    s_add_u32 m0, s59, 46720
    ds_read_b64_tr_b16 v[162:163], v198 offset:4864
    buffer_store_dword v177, v220, s[28:31], 0 offen sc1
    ds_write_b64 v210, v[60:61] offset:1664
    v_mfma_f32_16x16x32_bf16 a[0:3], v[136:139], v[72:75], a[0:3]
    buffer_load_dwordx4 v2, s[20:23], s64 offen offset:512 lds
    v_mfma_f32_16x16x32_bf16 a[0:3], v[140:143], v[76:79], a[0:3]
    s_waitcnt lgkmcnt(8)
    ds_read_b64_tr_b16 v[164:165], v198 offset:5632
    v_mul_f32 v56, 0x3eae1a93, v56
    v_mfma_f32_16x16x32_bf16 a[28:31], v[148:151], v[100:103], a[28:31]
    ds_read_b64_tr_b16 v[166:167], v198 offset:5888
    v_mul_f32 v57, 0x3eae1a93, v57
    v_mul_f32 v58, 0x3eae1a93, v58
    v_mfma_f32_16x16x32_bf16 a[28:31], v[144:147], v[96:99], a[28:31]
    v_mul_f32 v59, 0x3eae1a93, v59
    v_cvt_pk_bf16_f32 v56, v56, v57
    v_cvt_pk_bf16_f32 v57, v58, v59
    v_mfma_f32_16x16x32_bf16 a[24:27], v[144:147], v[88:91], a[24:27]
    ds_read_b64_tr_b16 v[136:137], v198 offset:6144
    v_mfma_f32_16x16x32_bf16 a[24:27], v[148:151], v[92:95], a[24:27]
    s_add_u32 m0, s59, 47616
    ds_read_b64_tr_b16 v[138:139], v198 offset:6400
    ds_write_b64 v210, v[56:57] offset:0
    v_mfma_f32_16x16x32_bf16 a[20:23], v[148:151], v[84:87], a[20:23]
    buffer_load_dwordx4 v2, s[20:23], s64 offen offset:640 lds
    v_mul_f32 v36, v224, v224
    v_mfma_f32_16x16x32_bf16 a[20:23], v[144:147], v[80:83], a[20:23]
    ds_read_b64_tr_b16 v[140:141], v198 offset:7168
    v_mul_f32 v37, v225, v225
    v_mul_f32 v38, v226, v226
    v_mfma_f32_16x16x32_bf16 a[16:19], v[144:147], v[72:75], a[16:19]
    ds_read_b64_tr_b16 v[142:143], v198 offset:7424
    v_mul_f32 v39, v227, v227
    v_fma_f32 v36, v36, s70, v5
    v_mfma_f32_16x16x32_bf16 a[16:19], v[148:151], v[76:79], a[16:19]
    s_waitcnt lgkmcnt(10)
    v_fma_f32 v37, v37, s70, v5
    v_fma_f32 v38, v38, s70, v5
    v_fma_f32 v39, v39, s70, v5
    v_mfma_f32_16x16x32_bf16 a[44:47], v[156:159], v[100:103], a[44:47]
    ds_read_b64_tr_b16 v[144:145], v198 offset:6656
    v_mul_f32 v36, v36, v224
    v_mul_f32 v37, v37, v225
    v_mfma_f32_16x16x32_bf16 a[44:47], v[152:155], v[96:99], a[44:47]
    ds_read_b64_tr_b16 v[146:147], v198 offset:6912
    v_mul_f32 v38, v38, v226
    v_mul_f32 v39, v39, v227
    v_mfma_f32_16x16x32_bf16 a[40:43], v[152:155], v[88:91], a[40:43]
    v_exp_f32 v36, v36
    v_mfma_f32_16x16x32_bf16 a[40:43], v[156:159], v[92:95], a[40:43]
    ds_read_b64_tr_b16 v[148:149], v198 offset:7680
    v_exp_f32 v37, v37
    v_mfma_f32_16x16x32_bf16 a[36:39], v[156:159], v[84:87], a[36:39]
    s_add_u32 m0, s59, 48512
    ds_read_b64_tr_b16 v[150:151], v198 offset:7936
    v_exp_f32 v38, v38
    v_mfma_f32_16x16x32_bf16 a[36:39], v[152:155], v[80:83], a[36:39]
    buffer_load_dwordx4 v2, s[20:23], s64 offen offset:768 lds
    v_exp_f32 v39, v39
    v_mfma_f32_16x16x32_bf16 a[32:35], v[152:155], v[72:75], a[32:35]
    ds_read_b64_tr_b16 v[152:153], v198 offset:8192
    v_add_f32 v36, 1.0, v36
    v_add_f32 v37, 1.0, v37
    v_mfma_f32_16x16x32_bf16 a[32:35], v[156:159], v[76:79], a[32:35]
    s_waitcnt lgkmcnt(10)
    ds_read_b64_tr_b16 v[154:155], v198 offset:8448
    v_add_f32 v38, 1.0, v38
    v_mfma_f32_16x16x32_bf16 a[60:63], v[164:167], v[100:103], a[60:63]
    v_add_f32 v39, 1.0, v39
    v_rcp_f32 v36, v36
    v_mfma_f32_16x16x32_bf16 a[60:63], v[160:163], v[96:99], a[60:63]
    ds_read_b64_tr_b16 v[156:157], v198 offset:8704
    v_rcp_f32 v37, v37
    v_mfma_f32_16x16x32_bf16 a[56:59], v[160:163], v[88:91], a[56:59]
    s_add_u32 m0, s59, 49408
    ds_read_b64_tr_b16 v[158:159], v198 offset:8960
    v_rcp_f32 v38, v38
    v_mfma_f32_16x16x32_bf16 a[56:59], v[164:167], v[92:95], a[56:59]
    buffer_load_dwordx4 v2, s[20:23], s64 offen offset:896 lds
    v_rcp_f32 v39, v39
    v_mfma_f32_16x16x32_bf16 a[52:55], v[164:167], v[84:87], a[52:55]
    s_waitcnt vmcnt(21)
    ds_add_u32 v11, v9
    v_mul_f32 v36, v36, v224
    v_mfma_f32_16x16x32_bf16 a[52:55], v[160:163], v[80:83], a[52:55]
    v_mul_f32 v37, v37, v225
    v_mul_f32 v38, v38, v226
    v_mul_f32 v39, v39, v227
    v_mfma_f32_16x16x32_bf16 a[48:51], v[160:163], v[72:75], a[48:51]
    s_add_u32 m0, s59, 50304
    v_cvt_pk_bf16_f32 v40, v36, v37
    v_cvt_pk_bf16_f32 v41, v38, v39
    v_mul_f32 v36, v228, v228
    v_mfma_f32_16x16x32_bf16 a[48:51], v[164:167], v[76:79], a[48:51]
    s_waitcnt lgkmcnt(9)
    v_mul_f32 v37, v229, v229
    v_mul_f32 v38, v230, v230
    v_mul_f32 v39, v231, v231
    v_mfma_f32_16x16x32_bf16 a[76:79], v[140:143], v[100:103], a[76:79]
    buffer_load_dwordx4 v2, s[20:23], s64 offen offset:1024 lds
    v_fma_f32 v36, v36, s70, v5
    v_mfma_f32_16x16x32_bf16 a[76:79], v[136:139], v[96:99], a[76:79]
    ds_read_b32 v6, v11
    v_fma_f32 v37, v37, s70, v5
    v_fma_f32 v38, v38, s70, v5
    v_mfma_f32_16x16x32_bf16 a[72:75], v[136:139], v[88:91], a[72:75]
    v_fma_f32 v39, v39, s70, v5
    v_mul_f32 v36, v36, v228
    v_mul_f32 v37, v37, v229
    v_mfma_f32_16x16x32_bf16 a[72:75], v[140:143], v[92:95], a[72:75]
    v_mul_f32 v38, v38, v230
    v_mul_f32 v39, v39, v231
    v_mfma_f32_16x16x32_bf16 a[68:71], v[140:143], v[84:87], a[68:71]
    v_exp_f32 v36, v36
    v_exp_f32 v37, v37
    v_mfma_f32_16x16x32_bf16 a[68:71], v[136:139], v[80:83], a[68:71]
    v_exp_f32 v38, v38
    v_mfma_f32_16x16x32_bf16 a[64:67], v[136:139], v[72:75], a[64:67]
    s_waitcnt lgkmcnt(0)
    v_cmp_le_u32 vcc, 36, v6
    v_exp_f32 v39, v39
    v_add_f32 v36, 1.0, v36
    v_mfma_f32_16x16x32_bf16 a[64:67], v[140:143], v[76:79], a[64:67]
    s_waitcnt lgkmcnt(6)
    v_add_f32 v37, 1.0, v37
    v_add_f32 v38, 1.0, v38
    v_mfma_f32_16x16x32_bf16 a[92:95], v[148:151], v[100:103], a[92:95]
    s_cbranch_vccz L_spin8
L_back8:
    v_add_f32 v39, 1.0, v39
    v_rcp_f32 v36, v36
    v_mfma_f32_16x16x32_bf16 a[92:95], v[144:147], v[96:99], a[92:95]
    v_rcp_f32 v37, v37
    v_rcp_f32 v38, v38
    v_mfma_f32_16x16x32_bf16 a[88:91], v[144:147], v[88:91], a[88:91]
    v_rcp_f32 v39, v39
    v_mfma_f32_16x16x32_bf16 a[88:91], v[148:151], v[92:95], a[88:91]
    v_mul_f32 v36, v36, v228
    v_mul_f32 v37, v37, v229
    v_mul_f32 v38, v38, v230
    v_mfma_f32_16x16x32_bf16 a[84:87], v[148:151], v[84:87], a[84:87]
    v_mul_f32 v39, v39, v231
    v_cvt_pk_bf16_f32 v42, v36, v37
    v_cvt_pk_bf16_f32 v43, v38, v39
    v_mfma_f32_16x16x32_bf16 a[84:87], v[144:147], v[80:83], a[84:87]
    ds_write_b64 v3, v[40:41] offset:0
    v_mfma_f32_16x16x32_bf16 a[80:83], v[144:147], v[72:75], a[80:83]
    ds_write_b64 v3, v[42:43] offset:256
    v_mfma_f32_16x16x32_bf16 a[80:83], v[148:151], v[76:79], a[80:83]
    s_waitcnt lgkmcnt(4)
    v_mul_f32 v36, v232, v232
    v_mul_f32 v37, v233, v233
    v_mfma_f32_16x16x32_bf16 a[108:111], v[156:159], v[100:103], a[108:111]
    v_mul_f32 v38, v234, v234
    v_mul_f32 v39, v235, v235
    v_mfma_f32_16x16x32_bf16 a[108:111], v[152:155], v[96:99], a[108:111]
    v_fma_f32 v36, v36, s70, v5
    v_fma_f32 v37, v37, s70, v5
    v_fma_f32 v38, v38, s70, v5
    v_mfma_f32_16x16x32_bf16 a[104:107], v[152:155], v[88:91], a[104:107]
    v_fma_f32 v39, v39, s70, v5
    v_mul_f32 v36, v36, v232
    v_mfma_f32_16x16x32_bf16 a[104:107], v[156:159], v[92:95], a[104:107]
    v_mul_f32 v37, v37, v233
    v_mul_f32 v38, v38, v234
    v_mul_f32 v39, v39, v235
    v_mfma_f32_16x16x32_bf16 a[100:103], v[156:159], v[84:87], a[100:103]
    v_exp_f32 v36, v36
    v_mfma_f32_16x16x32_bf16 a[100:103], v[152:155], v[80:83], a[100:103]
    v_exp_f32 v37, v37
    v_mfma_f32_16x16x32_bf16 a[96:99], v[152:155], v[72:75], a[96:99]
    v_exp_f32 v38, v38
    v_exp_f32 v39, v39
    v_mfma_f32_16x16x32_bf16 a[96:99], v[156:159], v[76:79], a[96:99]
    v_add_f32 v36, 1.0, v36
    v_add_f32 v37, 1.0, v37
    v_add_f32 v38, 1.0, v38
    v_add_f32 v39, 1.0, v39
    v_rcp_f32 v36, v36
    v_rcp_f32 v37, v37
    v_rcp_f32 v38, v38
    v_rcp_f32 v39, v39
    v_mul_f32 v36, v36, v232
    v_mul_f32 v37, v37, v233
    v_mul_f32 v38, v38, v234
    v_mul_f32 v39, v39, v235
    v_cvt_pk_bf16_f32 v40, v36, v37
    v_cvt_pk_bf16_f32 v41, v38, v39
    ds_write_b64 v3, v[40:41] offset:1024
    v_mul_f32 v36, v236, v236
    v_mul_f32 v37, v237, v237
    v_mul_f32 v38, v238, v238
    v_mul_f32 v39, v239, v239
    v_fma_f32 v36, v36, s70, v5
    v_fma_f32 v37, v37, s70, v5
    v_fma_f32 v38, v38, s70, v5
    v_fma_f32 v39, v39, s70, v5
    v_mul_f32 v36, v36, v236
    v_mul_f32 v37, v37, v237
    v_mul_f32 v38, v38, v238
    v_mul_f32 v39, v39, v239
    v_exp_f32 v36, v36
    v_exp_f32 v37, v37
    v_exp_f32 v38, v38
    v_exp_f32 v39, v39
    v_add_f32 v36, 1.0, v36
    v_add_f32 v37, 1.0, v37
    v_add_f32 v38, 1.0, v38
    v_add_f32 v39, 1.0, v39
    v_rcp_f32 v36, v36
    v_rcp_f32 v37, v37
    v_rcp_f32 v38, v38
    v_rcp_f32 v39, v39
    v_mul_f32 v36, v36, v236
    v_mul_f32 v37, v37, v237
    v_mul_f32 v38, v38, v238
    v_mul_f32 v39, v39, v239
    v_cvt_pk_bf16_f32 v42, v36, v37
    v_cvt_pk_bf16_f32 v43, v38, v39
    ds_write_b64 v3, v[42:43] offset:1280
L_join:
L_q3:
    s_cbranch_execz L_q8
    s_waitcnt vmcnt(13)
    ds_add_u32 v11, v9
    v_mul_f32 v36, v240, v240
    v_mul_f32 v37, v241, v241
    v_mul_f32 v38, v242, v242
    v_mul_f32 v39, v243, v243
    v_fma_f32 v36, v36, s70, v5
    v_fma_f32 v37, v37, s70, v5
    v_fma_f32 v38, v38, s70, v5
    v_fma_f32 v39, v39, s70, v5
    v_mul_f32 v36, v36, v240
    v_mul_f32 v37, v37, v241
    v_mul_f32 v38, v38, v242
    v_mul_f32 v39, v39, v243
    ds_read_b32 v6, v11
    v_exp_f32 v36, v36
    v_exp_f32 v37, v37
    v_exp_f32 v38, v38
    v_exp_f32 v39, v39
    v_add_f32 v36, 1.0, v36
    v_add_f32 v37, 1.0, v37
    v_add_f32 v38, 1.0, v38
    v_add_f32 v39, 1.0, v39
    v_rcp_f32 v36, v36
    v_rcp_f32 v37, v37
    v_rcp_f32 v38, v38
    v_rcp_f32 v39, v39
    v_mul_f32 v36, v36, v240
    v_mul_f32 v37, v37, v241
    s_waitcnt lgkmcnt(0)
    v_cmp_le_u32 vcc, 40, v6
    v_mul_f32 v38, v38, v242
    v_mul_f32 v39, v39, v243
    v_cvt_pk_bf16_f32 v40, v36, v37
    v_cvt_pk_bf16_f32 v41, v38, v39
    ds_write_b64 v3, v[40:41] offset:8192
    v_mul_f32 v36, v244, v244
    v_mul_f32 v37, v245, v245
    v_mul_f32 v38, v246, v246
    s_cbranch_vccz L_spin9
L_back9:
    ds_read_b64_tr_b16 a[192:193], v1 offset:0
    ds_read_b64_tr_b16 a[194:195], v1 offset:256
    ds_read_b128 a[176:179], v44 offset:0
    ds_read_b128 a[180:183], v44 offset:1024
    ds_read_b128 a[184:187], v4 offset:0
    ds_read_b128 a[188:191], v4 offset:1024
    ds_read_b64_tr_b16 a[196:197], v1 offset:21568
    ds_read_b64_tr_b16 a[198:199], v1 offset:21824
    ds_read_b128 a[220:223], v4 offset:2048
    ds_read_b128 a[216:219], v4 offset:3072
    ds_read_b128 a[212:215], v44 offset:2048
    ds_read_b128 a[208:211], v44 offset:3072
    v_mul_f32 v39, v247, v247
    v_fma_f32 v36, v36, s70, v5
    v_fma_f32 v37, v37, s70, v5
    v_fma_f32 v38, v38, s70, v5
    v_fma_f32 v39, v39, s70, v5
    v_mul_f32 v36, v36, v244
    v_mul_f32 v37, v37, v245
    v_mul_f32 v38, v38, v246
    v_mul_f32 v39, v39, v247
    v_exp_f32 v36, v36
    v_exp_f32 v37, v37
    v_exp_f32 v38, v38
    v_exp_f32 v39, v39
    v_add_f32 v36, 1.0, v36
    v_add_f32 v37, 1.0, v37
    v_add_f32 v38, 1.0, v38
    v_add_f32 v39, 1.0, v39
    v_rcp_f32 v36, v36
    v_rcp_f32 v37, v37
    v_rcp_f32 v38, v38
    v_rcp_f32 v39, v39
    v_mul_f32 v36, v36, v244
    v_mul_f32 v37, v37, v245
    v_mul_f32 v38, v38, v246
    s_waitcnt lgkmcnt(8)
    v_mfma_f32_32x32x16_bf16 v[48:63], a[192:195], a[176:179], 0
    s_xor_b32 s64, s71, 128
    ds_read_b64_tr_b16 a[204:205], v1 offset:22080
    v_mul_f32 v39, v39, v247
    v_cvt_pk_bf16_f32 v42, v36, v37
    v_cvt_pk_bf16_f32 v43, v38, v39
    v_mfma_f32_32x32x16_bf16 a[112:127], a[192:195], a[180:183], 0
    s_waitcnt lgkmcnt(7)
    ds_read_b64_tr_b16 a[206:207], v1 offset:22336
    s_mul_i32 s64, s64, 576
    s_add_u32 m0, s59, 86272
    ds_write_b64 v3, v[42:43] offset:8448
    v_mul_f32 v36, v248, v248
    v_mfma_f32_32x32x16_bf16 v[64:79], a[192:195], a[184:187], 0
    buffer_load_dwordx4 v2, s[20:23], s64 offen offset:0 lds
    ds_read2_b64 a[224:227], v219 offset0:0 offset1:1
    v_mul_f32 v37, v249, v249
    v_mul_f32 v38, v250, v250
    v_mul_f32 v39, v251, v251
    v_mfma_f32_32x32x16_bf16 a[128:143], a[192:195], a[188:191], 0
    s_waitcnt lgkmcnt(6)
    ds_read_b64_tr_b16 a[200:201], v1 offset:512
    v_fma_f32 v36, v36, s70, v5
    v_fma_f32 v37, v37, s70, v5
    v_fma_f32 v38, v38, s70, v5
    v_fma_f32 v39, v39, s70, v5
    v_mfma_f32_32x32x16_bf16 a[128:143], a[196:199], a[220:223], a[128:143]
    s_add_u32 m0, s59, 87168
    ds_read_b64_tr_b16 a[202:203], v1 offset:768
    v_mul_f32 v36, v36, v248
    v_mul_f32 v37, v37, v249
    v_mul_f32 v38, v38, v250
    v_mul_f32 v39, v39, v251
    v_mfma_f32_32x32x16_bf16 v[64:79], a[196:199], a[216:219], v[64:79]
    s_waitcnt lgkmcnt(6)
    ds_read_b64_tr_b16 a[240:241], v10 offset:0
    v_exp_f32 v36, v36
    v_exp_f32 v37, v37
    v_mfma_f32_32x32x16_bf16 a[112:127], a[196:199], a[212:215], a[112:127]
L_po0:
L_q4:
    s_cbranch_execz L_q6
    buffer_load_dwordx4 v2, s[20:23], s64 offen offset:128 lds
    ds_read2_b32 a[228:229], v219 offset0:9 offset1:10
    v_exp_f32 v38, v38
    v_exp_f32 v39, v39
    v_mfma_f32_32x32x16_bf16 v[48:63], a[196:199], a[208:211], v[48:63]
    s_waitcnt lgkmcnt(2)
    ds_read_b64_tr_b16 a[242:243], v10 offset:256
    v_add_f32 v36, 1.0, v36
    v_add_f32 v37, 1.0, v37
    v_add_f32 v38, 1.0, v38
    v_add_f32 v39, 1.0, v39
    v_mfma_f32_32x32x16_bf16 v[80:95], a[204:207], a[208:211], 0
    ds_read_b64_tr_b16 a[244:245], v10 offset:21568
    v_rcp_f32 v36, v36
    v_rcp_f32 v37, v37
    v_mfma_f32_32x32x16_bf16 a[144:159], a[204:207], a[212:215], 0
    s_add_u32 m0, s59, 88064
    ds_read_b64_tr_b16 a[246:247], v10 offset:21824
    v_rcp_f32 v38, v38
    v_rcp_f32 v39, v39
    v_mul_f32 v36, v36, v248
    v_mfma_f32_32x32x16_bf16 v[96:111], a[204:207], a[216:219], 0
    buffer_load_dwordx4 v2, s[20:23], s64 offen offset:256 lds
    ds_read2_b32 a[230:231], v219 offset0:11 offset1:12
    v_mul_f32 v37, v37, v249
    v_mul_f32 v38, v38, v250
    v_mfma_f32_32x32x16_bf16 a[160:175], a[204:207], a[220:223], 0
    ds_read_b64_tr_b16 a[196:197], v1 offset:22592
    v_mul_f32 v39, v39, v251
    v_cvt_pk_bf16_f32 v40, v36, v37
    v_cvt_pk_bf16_f32 v41, v38, v39
    ds_write_b64 v3, v[40:41] offset:9216
    v_mfma_f32_32x32x16_bf16 a[160:175], a[200:203], a[188:191], a[160:175]
    ds_read_b64_tr_b16 a[198:199], v1 offset:22848
    v_mul_f32 v36, v252, v252
    v_mul_f32 v37, v253, v253
    v_mul_f32 v38, v254, v254
    v_mfma_f32_32x32x16_bf16 v[96:111], a[200:203], a[184:187], v[96:111]
    s_add_u32 m0, s59, 88960
    ds_read_b64_tr_b16 a[192:193], v1 offset:1024
    v_mul_f32 v39, v255, v255
    v_fma_f32 v36, v36, s70, v5
    v_fma_f32 v37, v37, s70, v5
    v_fma_f32 v38, v38, s70, v5
    v_fma_f32 v39, v39, s70, v5
    v_mfma_f32_32x32x16_bf16 a[144:159], a[200:203], a[180:183], a[144:159]
    buffer_load_dwordx4 v2, s[20:23], s64 offen offset:384 lds
    ds_read2_b32 a[232:233], v212 offset0:8 offset1:17
    v_mul_f32 v36, v36, v252
    v_mul_f32 v37, v37, v253
    v_mfma_f32_32x32x16_bf16 v[80:95], a[200:203], a[176:179], v[80:95]
    s_waitcnt lgkmcnt(6)
    ds_read_b64_tr_b16 a[194:195], v1 offset:1280
    v_mul_f32 v38, v38, v254
    v_mul_f32 v39, v39, v255
    v_exp_f32 v36, v36
    v_mfma_f32_32x32x16_bf16 v[112:127], a[240:243], a[176:179], 0
    ds_read_b64_tr_b16 a[200:201], v1 offset:1536
    v_exp_f32 v37, v37
    v_exp_f32 v38, v38
    v_exp_f32 v39, v39
    v_mfma_f32_32x32x16_bf16 v[16:31], a[240:243], a[180:183], 0
    s_add_u32 m0, s59, 89856
    ds_read_b64_tr_b16 a[202:203], v1 offset:1792
    v_add_f32 v36, 1.0, v36
    v_add_f32 v37, 1.0, v37
    v_add_f32 v38, 1.0, v38
    v_mfma_f32_32x32x16_bf16 v[16:31], a[244:247], a[212:215], v[16:31]
    buffer_load_dwordx4 v2, s[20:23], s64 offen offset:512 lds
    v_add_f32 v39, 1.0, v39
    v_rcp_f32 v36, v36
    v_mfma_f32_32x32x16_bf16 v[112:127], a[244:247], a[208:211], v[112:127]
    s_waitcnt lgkmcnt(2)
    ds_read_b64_tr_b16 a[204:205], v1 offset:23104
    v_rcp_f32 v37, v37
    v_rcp_f32 v38, v38
    v_rcp_f32 v39, v39
    v_mfma_f32_32x32x16_bf16 v[128:143], a[196:199], a[208:211], 0
    ds_read_b64_tr_b16 a[206:207], v1 offset:23360
    v_mul_f32 v36, v36, v252
    v_mul_f32 v37, v37, v253
    v_mul_f32 v38, v38, v254
    v_mul_f32 v39, v39, v255
    v_mfma_f32_32x32x16_bf16 v[144:159], a[196:199], a[212:215], 0
    v_cvt_pk_bf16_f32 v42, v36, v37
    v_cvt_pk_bf16_f32 v43, v38, v39
    ds_write_b64 v3, v[42:43] offset:9472
    v_mfma_f32_32x32x16_bf16 v[160:175], a[196:199], a[216:219], 0
    s_waitcnt vmcnt(5)
    ds_add_u32 v11, v9
    v_add_u32 v1, 43136, v1
    v_add_u32 v10, 43136, v10
    s_add_u32 m0, s59, 90752
    v_mfma_f32_32x32x16_bf16 v[176:191], a[196:199], a[220:223], 0
    buffer_load_dwordx4 v2, s[20:23], s64 offen offset:640 lds
    v_accvgpr_read_b32 v32, a0
    v_accvgpr_read_b32 v33, a1
    v_accvgpr_read_b32 v34, a2
    v_accvgpr_read_b32 v35, a3
    v_mul_f32 v36, v32, v32
    v_mfma_f32_32x32x16_bf16 v[176:191], a[192:195], a[188:191], v[176:191]
    v_mul_f32 v37, v33, v33
    v_mul_f32 v38, v34, v34
    v_mul_f32 v39, v35, v35
    v_fma_f32 v36, v36, s70, v5
    v_fma_f32 v37, v37, s70, v5
    v_fma_f32 v38, v38, s70, v5
    v_mfma_f32_32x32x16_bf16 v[160:175], a[192:195], a[184:187], v[160:175]
    s_add_u32 m0, s59, 91648
    ds_read_b32 v6, v11
    v_fma_f32 v39, v39, s70, v5
    v_mul_f32 v36, v36, v32
    v_mul_f32 v37, v37, v33
    v_mul_f32 v38, v38, v34
    v_mul_f32 v39, v39, v35
    v_mfma_f32_32x32x16_bf16 v[144:159], a[192:195], a[180:183], v[144:159]
    buffer_load_dwordx4 v2, s[20:23], s64 offen offset:768 lds
    v_exp_f32 v36, v36
    v_exp_f32 v37, v37
    v_exp_f32 v38, v38
    v_mfma_f32_32x32x16_bf16 v[128:143], a[192:195], a[176:179], v[128:143]
    s_waitcnt lgkmcnt(0)
    v_cmp_le_u32 vcc, 44, v6
    v_exp_f32 v39, v39
    v_add_f32 v36, 1.0, v36
    v_add_f32 v37, 1.0, v37
    v_add_f32 v38, 1.0, v38
    v_add_f32 v39, 1.0, v39
    v_mfma_f32_32x32x16_bf16 v[192:207], a[200:203], a[176:179], 0
    s_cbranch_vccz L_spin11
L_back11:
    ds_read_b128 a[176:179], v44 offset:8192
    ds_read_b64_tr_b16 a[240:241], v1 offset:0
    v_rcp_f32 v36, v36
    v_rcp_f32 v37, v37
    v_mfma_f32_32x32x16_bf16 v[208:223], a[200:203], a[180:183], 0
    s_add_u32 m0, s59, 92544
    ds_read_b128 a[180:183], v44 offset:9216
    ds_read_b64_tr_b16 a[242:243], v1 offset:256
    v_rcp_f32 v38, v38
    v_rcp_f32 v39, v39
    v_mul_f32 v36, v36, v32
    v_mfma_f32_32x32x16_bf16 v[224:239], a[200:203], a[184:187], 0
    ds_read_b128 a[184:187], v4 offset:8192
    buffer_load_dwordx4 v2, s[20:23], s64 offen offset:896 lds
    v_mul_f32 v37, v37, v33
    v_mul_f32 v38, v38, v34
    v_mul_f32 v39, v39, v35
    v_mfma_f32_32x32x16_bf16 v[240:255], a[200:203], a[188:191], 0
    ds_read_b128 a[188:191], v4 offset:9216
    ds_read_b64_tr_b16 a[244:245], v1 offset:21568
    v_cvt_pk_bf16_f32 v40, v36, v37
    v_cvt_pk_bf16_f32 v41, v38, v39
    ds_write_b64 v3, v[40:41] offset:0
    v_mfma_f32_32x32x16_bf16 v[240:255], a[204:207], a[220:223], v[240:255]
    ds_read_b128 a[220:223], v4 offset:10240
    ds_read_b64_tr_b16 a[246:247], v1 offset:21824
    v_accvgpr_read_b32 v32, a4
    v_accvgpr_read_b32 v33, a5
    v_accvgpr_read_b32 v34, a6
    v_accvgpr_read_b32 v35, a7
    v_mfma_f32_32x32x16_bf16 v[224:239], a[204:207], a[216:219], v[224:239]
    s_add_u32 m0, s59, 93440
    ds_read_b128 a[216:219], v4 offset:11264
    v_mul_f32 v36, v32, v32
    v_mul_f32 v37, v33, v33
    v_mul_f32 v38, v34, v34
    v_mul_f32 v39, v35, v35
    v_fma_f32 v36, v36, s70, v5
    v_fma_f32 v37, v37, s70, v5
    v_mfma_f32_32x32x16_bf16 v[208:223], a[204:207], a[212:215], v[208:223]
    ds_read_b128 a[212:215], v44 offset:10240
    buffer_load_dwordx4 v2, s[20:23], s64 offen offset:1024 lds
    v_fma_f32 v38, v38, s70, v5
    v_fma_f32 v39, v39, s70, v5
    v_mul_f32 v36, v36, v32
    v_mul_f32 v37, v37, v33
    v_mfma_f32_32x32x16_bf16 v[192:207], a[204:207], a[208:211], v[192:207]
    s_waitcnt lgkmcnt(8)
    ds_read_b128 a[208:211], v44 offset:11264
    v_mul_f32 v38, v38, v34
    v_mul_f32 v39, v39, v35
    v_exp_f32 v36, v36
    v_exp_f32 v37, v37
    v_mfma_f32_32x32x16_bf16 v[48:63], a[240:243], a[176:179], v[48:63]
    s_xor_b32 s64, s71, 192
    ds_read_b64_tr_b16 a[196:197], v1 offset:22080
    v_exp_f32 v38, v38
    v_exp_f32 v39, v39
    v_add_f32 v36, 1.0, v36
    v_mfma_f32_32x32x16_bf16 a[112:127], a[240:243], a[180:183], a[112:127]
    s_waitcnt lgkmcnt(8)
    ds_read_b64_tr_b16 a[198:199], v1 offset:22336
    s_mul_i32 s64, s64, 576
    s_add_u32 m0, s59, 0
    v_add_f32 v37, 1.0, v37
    v_add_f32 v38, 1.0, v38
    v_add_f32 v39, 1.0, v39
    v_mfma_f32_32x32x16_bf16 v[64:79], a[240:243], a[184:187], v[64:79]
    buffer_load_dwordx4 v2, s[20:23], s64 offen offset:0 lds
    v_rcp_f32 v36, v36
    v_rcp_f32 v37, v37
    v_mfma_f32_32x32x16_bf16 a[128:143], a[240:243], a[188:191], a[128:143]
    s_waitcnt lgkmcnt(4)
    ds_read_b64_tr_b16 a[192:193], v1 offset:512
    v_rcp_f32 v38, v38
    v_rcp_f32 v39, v39
    v_mul_f32 v36, v36, v32
    v_mul_f32 v37, v37, v33
    v_mfma_f32_32x32x16_bf16 a[128:143], a[244:247], a[220:223], a[128:143]
    s_add_u32 m0, s59, 896
    ds_read_b64_tr_b16 a[194:195], v1 offset:768
    v_mul_f32 v38, v38, v34
    v_mul_f32 v39, v39, v35
    v_cvt_pk_bf16_f32 v42, v36, v37
    v_cvt_pk_bf16_f32 v43, v38, v39
    ds_write_b64 v3, v[42:43] offset:256
    v_mfma_f32_32x32x16_bf16 v[64:79], a[244:247], a[216:219], v[64:79]
    s_waitcnt lgkmcnt(5)
    ds_read_b64_tr_b16 a[200:201], v10 offset:0
    v_accvgpr_read_b32 v32, a8
    v_accvgpr_read_b32 v33, a9
    v_accvgpr_read_b32 v34, a10
    v_accvgpr_read_b32 v35, a11
    v_mfma_f32_32x32x16_bf16 a[112:127], a[244:247], a[212:215], a[112:127]
    buffer_load_dwordx4 v2, s[20:23], s64 offen offset:128 lds
    v_mul_f32 v36, v32, v32
    v_mul_f32 v37, v33, v33
    v_mul_f32 v38, v34, v34
    v_mul_f32 v39, v35, v35
    v_fma_f32 v36, v36, s70, v5
    v_mfma_f32_32x32x16_bf16 v[48:63], a[244:247], a[208:211], v[48:63]
    s_waitcnt lgkmcnt(2)
    ds_read_b64_tr_b16 a[202:203], v10 offset:256
    v_fma_f32 v37, v37, s70, v5
    v_fma_f32 v38, v38, s70, v5
    v_fma_f32 v39, v39, s70, v5
    v_mul_f32 v36, v36, v32
    v_mul_f32 v37, v37, v33
    v_mfma_f32_32x32x16_bf16 v[80:95], a[196:199], a[208:211], v[80:95]
    ds_read_b64_tr_b16 a[204:205], v10 offset:21568
    v_mul_f32 v38, v38, v34
    v_mul_f32 v39, v39, v35
    v_exp_f32 v36, v36
    v_exp_f32 v37, v37
    v_mfma_f32_32x32x16_bf16 a[144:159], a[196:199], a[212:215], a[144:159]
    s_add_u32 m0, s59, 1792
    ds_read_b64_tr_b16 a[206:207], v10 offset:21824
    v_exp_f32 v38, v38
    v_exp_f32 v39, v39
    v_add_f32 v36, 1.0, v36
    v_mfma_f32_32x32x16_bf16 v[96:111], a[196:199], a[216:219], v[96:111]
    buffer_load_dwordx4 v2, s[20:23], s64 offen offset:256 lds
    v_add_f32 v37, 1.0, v37
    v_add_f32 v38, 1.0, v38
    v_add_f32 v39, 1.0, v39
    v_rcp_f32 v36, v36
    v_mfma_f32_32x32x16_bf16 a[160:175], a[196:199], a[220:223], a[160:175]
    ds_read_b64_tr_b16 a[244:245], v1 offset:22592
    v_rcp_f32 v37, v37
    v_rcp_f32 v38, v38
    v_rcp_f32 v39, v39
    v_mfma_f32_32x32x16_bf16 a[160:175], a[192:195], a[188:191], a[160:175]
    ds_read_b64_tr_b16 a[246:247], v1 offset:22848
    v_mul_f32 v36, v36, v32
    v_mul_f32 v37, v37, v33
    v_mul_f32 v38, v38, v34
    v_mul_f32 v39, v39, v35
    v_cvt_pk_bf16_f32 v40, v36, v37
    v_mfma_f32_32x32x16_bf16 v[96:111], a[192:195], a[184:187], v[96:111]
    s_add_u32 m0, s59, 2688
    ds_read_b64_tr_b16 a[240:241], v1 offset:1024
    v_cvt_pk_bf16_f32 v41, v38, v39
    ds_write_b64 v3, v[40:41] offset:1024
    v_accvgpr_read_b32 v32, a12
    v_accvgpr_read_b32 v33, a13
    v_mfma_f32_32x32x16_bf16 a[144:159], a[192:195], a[180:183], a[144:159]
    buffer_load_dwordx4 v2, s[20:23], s64 offen offset:384 lds
    v_accvgpr_read_b32 v34, a14
    v_accvgpr_read_b32 v35, a15
    v_mul_f32 v36, v32, v32
    v_mul_f32 v37, v33, v33
    v_mfma_f32_32x32x16_bf16 v[80:95], a[192:195], a[176:179], v[80:95]
    s_waitcnt lgkmcnt(4)
    ds_read_b64_tr_b16 a[242:243], v1 offset:1280
    v_mul_f32 v38, v34, v34
    v_mul_f32 v39, v35, v35
    v_fma_f32 v36, v36, s70, v5
    v_fma_f32 v37, v37, s70, v5
    v_fma_f32 v38, v38, s70, v5
    v_fma_f32 v39, v39, s70, v5
    v_mfma_f32_32x32x16_bf16 v[112:127], a[200:203], a[176:179], v[112:127]
    ds_read_b64_tr_b16 a[192:193], v1 offset:1536
    v_mul_f32 v36, v36, v32
    v_mul_f32 v37, v37, v33
    v_mul_f32 v38, v38, v34
    v_mul_f32 v39, v39, v35
    v_exp_f32 v36, v36
    v_mfma_f32_32x32x16_bf16 v[16:31], a[200:203], a[180:183], v[16:31]
    s_add_u32 m0, s59, 3584
    ds_read_b64_tr_b16 a[194:195], v1 offset:1792
    v_exp_f32 v37, v37
    v_exp_f32 v38, v38
    v_mfma_f32_32x32x16_bf16 v[16:31], a[204:207], a[212:215], v[16:31]
    buffer_load_dwordx4 v2, s[20:23], s64 offen offset:512 lds
    v_exp_f32 v39, v39
    v_add_f32 v36, 1.0, v36
    v_add_f32 v37, 1.0, v37
    v_add_f32 v38, 1.0, v38
    v_mfma_f32_32x32x16_bf16 v[112:127], a[204:207], a[208:211], v[112:127]
    s_waitcnt lgkmcnt(2)
    ds_read_b64_tr_b16 a[196:197], v1 offset:23104
    v_add_f32 v39, 1.0, v39
    v_rcp_f32 v36, v36
    v_rcp_f32 v37, v37
    v_mfma_f32_32x32x16_bf16 v[128:143], a[244:247], a[208:211], v[128:143]
    ds_read_b64_tr_b16 a[198:199], v1 offset:23360
    v_rcp_f32 v38, v38
    v_rcp_f32 v39, v39
    v_mul_f32 v36, v36, v32
    v_mul_f32 v37, v37, v33
    v_mfma_f32_32x32x16_bf16 v[144:159], a[244:247], a[212:215], v[144:159]
    v_mul_f32 v38, v38, v34
    v_mul_f32 v39, v39, v35
    v_cvt_pk_bf16_f32 v42, v36, v37
    v_cvt_pk_bf16_f32 v43, v38, v39
    ds_write_b64 v3, v[42:43] offset:1280
    v_mfma_f32_32x32x16_bf16 v[160:175], a[244:247], a[216:219], v[160:175]
    s_waitcnt vmcnt(5)
    ds_add_u32 v11, v9
    v_add_u32 v1, 43136, v1
    v_add_u32 v10, 43136, v10
    s_add_u32 m0, s59, 4480
    v_mfma_f32_32x32x16_bf16 v[176:191], a[244:247], a[220:223], v[176:191]
    buffer_load_dwordx4 v2, s[20:23], s64 offen offset:640 lds
    v_accvgpr_read_b32 v32, a16
    v_accvgpr_read_b32 v33, a17
    v_accvgpr_read_b32 v34, a18
    v_accvgpr_read_b32 v35, a19
    v_mul_f32 v36, v32, v32
    v_mfma_f32_32x32x16_bf16 v[176:191], a[240:243], a[188:191], v[176:191]
    v_mul_f32 v37, v33, v33
    v_mul_f32 v38, v34, v34
    v_mul_f32 v39, v35, v35
    v_fma_f32 v36, v36, s70, v5
    v_fma_f32 v37, v37, s70, v5
    v_fma_f32 v38, v38, s70, v5
    v_mfma_f32_32x32x16_bf16 v[160:175], a[240:243], a[184:187], v[160:175]
    s_add_u32 m0, s59, 5376
    ds_read_b32 v6, v11
    v_fma_f32 v39, v39, s70, v5
    v_mul_f32 v36, v36, v32
    v_mul_f32 v37, v37, v33
    v_mul_f32 v38, v38, v34
    v_mul_f32 v39, v39, v35
    v_mfma_f32_32x32x16_bf16 v[144:159], a[240:243], a[180:183], v[144:159]
    buffer_load_dwordx4 v2, s[20:23], s64 offen offset:768 lds
    v_exp_f32 v36, v36
    v_exp_f32 v37, v37
    v_exp_f32 v38, v38
    v_mfma_f32_32x32x16_bf16 v[128:143], a[240:243], a[176:179], v[128:143]
    s_waitcnt lgkmcnt(0)
    v_cmp_le_u32 vcc, 48, v6
    v_exp_f32 v39, v39
    v_add_f32 v36, 1.0, v36
    v_add_f32 v37, 1.0, v37
    v_add_f32 v38, 1.0, v38
    v_add_f32 v39, 1.0, v39
    v_mfma_f32_32x32x16_bf16 v[192:207], a[192:195], a[176:179], v[192:207]
    s_cbranch_vccz L_spin12
L_back12:
    ds_read_b128 a[176:179], v44 offset:0
    ds_read_b64_tr_b16 a[200:201], v1 offset:0
    v_rcp_f32 v36, v36
    v_rcp_f32 v37, v37
    v_mfma_f32_32x32x16_bf16 v[208:223], a[192:195], a[180:183], v[208:223]
    s_add_u32 m0, s59, 6272
    ds_read_b128 a[180:183], v44 offset:1024
    ds_read_b64_tr_b16 a[202:203], v1 offset:256
    v_rcp_f32 v38, v38
    v_rcp_f32 v39, v39
    v_mul_f32 v36, v36, v32
    v_mul_f32 v37, v37, v33
    v_mfma_f32_32x32x16_bf16 v[224:239], a[192:195], a[184:187], v[224:239]
    ds_read_b128 a[184:187], v4 offset:0
    buffer_load_dwordx4 v2, s[20:23], s64 offen offset:896 lds
    v_mul_f32 v38, v38, v34
    v_mul_f32 v39, v39, v35
    v_cvt_pk_bf16_f32 v40, v36, v37
    v_mfma_f32_32x32x16_bf16 v[240:255], a[192:195], a[188:191], v[240:255]
    ds_read_b128 a[188:191], v4 offset:1024
    ds_read_b64_tr_b16 a[204:205], v1 offset:21568
    v_cvt_pk_bf16_f32 v41, v38, v39
    ds_write_b64 v3, v[40:41] offset:8192
    v_accvgpr_read_b32 v32, a20
    v_mfma_f32_32x32x16_bf16 v[240:255], a[196:199], a[220:223], v[240:255]
    ds_read_b128 a[220:223], v4 offset:2048
    ds_read_b64_tr_b16 a[206:207], v1 offset:21824
    s_mov_b64 exec, 1
    buffer_atomic_add v9, off, s[48:51], s55 sc1
    s_mov_b64 exec, -1
    v_accvgpr_read_b32 v33, a21
    v_mfma_f32_32x32x16_bf16 v[224:239], a[196:199], a[216:219], v[224:239]
    s_add_u32 m0, s59, 7168
    ds_read_b128 a[216:219], v4 offset:3072
    v_accvgpr_read_b32 v34, a22
    v_accvgpr_read_b32 v35, a23
    v_mul_f32 v36, v32, v32
    v_mul_f32 v37, v33, v33
    v_mul_f32 v38, v34, v34
    v_mfma_f32_32x32x16_bf16 v[208:223], a[196:199], a[212:215], v[208:223]
    ds_read_b128 a[212:215], v44 offset:2048
    buffer_load_dwordx4 v2, s[20:23], s64 offen offset:1024 lds
    v_mul_f32 v39, v35, v35
    v_fma_f32 v36, v36, s70, v5
    v_fma_f32 v37, v37, s70, v5
    v_fma_f32 v38, v38, s70, v5
    v_mfma_f32_32x32x16_bf16 v[192:207], a[196:199], a[208:211], v[192:207]
    s_waitcnt lgkmcnt(8)
    ds_read_b128 a[208:211], v44 offset:3072
    v_fma_f32 v39, v39, s70, v5
    v_mul_f32 v36, v36, v32
    v_mul_f32 v37, v37, v33
    v_mul_f32 v38, v38, v34
    v_mul_f32 v39, v39, v35
    v_mfma_f32_32x32x16_bf16 v[48:63], a[200:203], a[176:179], v[48:63]
    s_xor_b32 s64, s71, 256
    ds_read_b64_tr_b16 a[244:245], v1 offset:22080
    v_exp_f32 v36, v36
    v_exp_f32 v37, v37
    v_exp_f32 v38, v38
    v_mfma_f32_32x32x16_bf16 a[112:127], a[200:203], a[180:183], a[112:127]
    s_waitcnt lgkmcnt(8)
    ds_read_b64_tr_b16 a[246:247], v1 offset:22336
    s_mul_i32 s64, s64, 576
    s_add_u32 m0, s59, 43136
    v_exp_f32 v39, v39
    v_add_f32 v36, 1.0, v36
    v_add_f32 v37, 1.0, v37
    v_mfma_f32_32x32x16_bf16 v[64:79], a[200:203], a[184:187], v[64:79]
    buffer_load_dwordx4 v2, s[20:23], s64 offen offset:0 lds
    v_add_f32 v38, 1.0, v38
    v_add_f32 v39, 1.0, v39
    v_rcp_f32 v36, v36
    v_mfma_f32_32x32x16_bf16 a[128:143], a[200:203], a[188:191], a[128:143]
    s_waitcnt lgkmcnt(4)
    ds_read_b64_tr_b16 a[240:241], v1 offset:512
    v_rcp_f32 v37, v37
    v_rcp_f32 v38, v38
    v_rcp_f32 v39, v39
    v_mfma_f32_32x32x16_bf16 a[128:143], a[204:207], a[220:223], a[128:143]
    s_add_u32 m0, s59, 44032
    ds_read_b64_tr_b16 a[242:243], v1 offset:768
    v_mul_f32 v36, v36, v32
    v_mul_f32 v37, v37, v33
    v_mul_f32 v38, v38, v34
    v_mul_f32 v39, v39, v35
    v_cvt_pk_bf16_f32 v42, v36, v37
    v_cvt_pk_bf16_f32 v43, v38, v39
    v_mfma_f32_32x32x16_bf16 v[64:79], a[204:207], a[216:219], v[64:79]
    s_waitcnt lgkmcnt(4)
    ds_read_b64_tr_b16 a[192:193], v10 offset:0
    ds_write_b64 v3, v[42:43] offset:8448
    v_accvgpr_read_b32 v32, a24
    v_accvgpr_read_b32 v33, a25
    v_accvgpr_read_b32 v34, a26
    v_mfma_f32_32x32x16_bf16 a[112:127], a[204:207], a[212:215], a[112:127]
    buffer_load_dwordx4 v2, s[20:23], s64 offen offset:128 lds
    v_accvgpr_read_b32 v35, a27
    v_mul_f32 v36, v32, v32
    v_mul_f32 v37, v33, v33
    v_mul_f32 v38, v34, v34
    v_mfma_f32_32x32x16_bf16 v[48:63], a[204:207], a[208:211], v[48:63]
    s_waitcnt lgkmcnt(2)
    ds_read_b64_tr_b16 a[194:195], v10 offset:256
    v_mul_f32 v39, v35, v35
    v_fma_f32 v36, v36, s70, v5
    v_fma_f32 v37, v37, s70, v5
    v_fma_f32 v38, v38, s70, v5
    v_fma_f32 v39, v39, s70, v5
    v_mul_f32 v36, v36, v32
    v_mfma_f32_32x32x16_bf16 v[80:95], a[244:247], a[208:211], v[80:95]
    ds_read_b64_tr_b16 a[196:197], v10 offset:21568
    v_mul_f32 v37, v37, v33
    v_mul_f32 v38, v38, v34
    v_mul_f32 v39, v39, v35
    v_exp_f32 v36, v36
    v_mfma_f32_32x32x16_bf16 a[144:159], a[244:247], a[212:215], a[144:159]
    s_add_u32 m0, s59, 44928
    ds_read_b64_tr_b16 a[198:199], v10 offset:21824
    v_exp_f32 v37, v37
    v_exp_f32 v38, v38
    v_exp_f32 v39, v39
    v_mfma_f32_32x32x16_bf16 v[96:111], a[244:247], a[216:219], v[96:111]
    buffer_load_dwordx4 v2, s[20:23], s64 offen offset:256 lds
    v_add_f32 v36, 1.0, v36
    v_add_f32 v37, 1.0, v37
    v_add_f32 v38, 1.0, v38
    v_add_f32 v39, 1.0, v39
    v_mfma_f32_32x32x16_bf16 a[160:175], a[244:247], a[220:223], a[160:175]
    ds_read_b64_tr_b16 a[204:205], v1 offset:22592
    v_rcp_f32 v36, v36
    v_rcp_f32 v37, v37
    v_rcp_f32 v38, v38
    v_mfma_f32_32x32x16_bf16 a[160:175], a[240:243], a[188:191], a[160:175]
    ds_read_b64_tr_b16 a[206:207], v1 offset:22848
    v_rcp_f32 v39, v39
    v_mul_f32 v36, v36, v32
    v_mul_f32 v37, v37, v33
    v_mul_f32 v38, v38, v34
    v_mul_f32 v39, v39, v35
    v_mfma_f32_32x32x16_bf16 v[96:111], a[240:243], a[184:187], v[96:111]
    s_add_u32 m0, s59, 45824
    ds_read_b64_tr_b16 a[200:201], v1 offset:1024
    v_cvt_pk_bf16_f32 v40, v36, v37
    v_cvt_pk_bf16_f32 v41, v38, v39
    ds_write_b64 v3, v[40:41] offset:9216
    v_accvgpr_read_b32 v32, a28
    v_mfma_f32_32x32x16_bf16 a[144:159], a[240:243], a[180:183], a[144:159]
    buffer_load_dwordx4 v2, s[20:23], s64 offen offset:384 lds
    v_accvgpr_read_b32 v33, a29
    v_accvgpr_read_b32 v34, a30
    v_accvgpr_read_b32 v35, a31
    v_mul_f32 v36, v32, v32
    v_mfma_f32_32x32x16_bf16 v[80:95], a[240:243], a[176:179], v[80:95]
    s_waitcnt lgkmcnt(4)
    ds_read_b64_tr_b16 a[202:203], v1 offset:1280
    v_mul_f32 v37, v33, v33
    v_mul_f32 v38, v34, v34
    v_mul_f32 v39, v35, v35
    v_fma_f32 v36, v36, s70, v5
    v_fma_f32 v37, v37, s70, v5
    v_fma_f32 v38, v38, s70, v5
    v_mfma_f32_32x32x16_bf16 v[112:127], a[192:195], a[176:179], v[112:127]
    ds_read_b64_tr_b16 a[240:241], v1 offset:1536
    v_fma_f32 v39, v39, s70, v5
    v_mul_f32 v36, v36, v32
    v_mul_f32 v37, v37, v33
    v_mul_f32 v38, v38, v34
    v_mul_f32 v39, v39, v35
    v_mfma_f32_32x32x16_bf16 v[16:31], a[192:195], a[180:183], v[16:31]
    s_add_u32 m0, s59, 46720
    ds_read_b64_tr_b16 a[242:243], v1 offset:1792
    v_exp_f32 v36, v36
    v_exp_f32 v37, v37
    v_exp_f32 v38, v38
    v_mfma_f32_32x32x16_bf16 v[16:31], a[196:199], a[212:215], v[16:31]
    buffer_load_dwordx4 v2, s[20:23], s64 offen offset:512 lds
    v_exp_f32 v39, v39
    v_add_f32 v36, 1.0, v36
    v_add_f32 v37, 1.0, v37
    v_add_f32 v38, 1.0, v38
    v_mfma_f32_32x32x16_bf16 v[112:127], a[196:199], a[208:211], v[112:127]
    s_waitcnt lgkmcnt(2)
    ds_read_b64_tr_b16 a[244:245], v1 offset:23104
    v_add_f32 v39, 1.0, v39
    v_rcp_f32 v36, v36
    v_rcp_f32 v37, v37
    v_mfma_f32_32x32x16_bf16 v[128:143], a[204:207], a[208:211], v[128:143]
    ds_read_b64_tr_b16 a[246:247], v1 offset:23360
    v_rcp_f32 v38, v38
    v_rcp_f32 v39, v39
    v_mul_f32 v36, v36, v32
    v_mul_f32 v37, v37, v33
    v_mfma_f32_32x32x16_bf16 v[144:159], a[204:207], a[212:215], v[144:159]
    v_mul_f32 v38, v38, v34
    v_mul_f32 v39, v39, v35
    v_cvt_pk_bf16_f32 v42, v36, v37
    v_cvt_pk_bf16_f32 v43, v38, v39
    ds_write_b64 v3, v[42:43] offset:9472
    v_mfma_f32_32x32x16_bf16 v[160:175], a[204:207], a[216:219], v[160:175]
    s_waitcnt vmcnt(5)
    ds_add_u32 v11, v9
    v_add_u32 v1, 4294881024, v1
    v_add_u32 v10, 4294881024, v10
    s_add_u32 m0, s59, 47616
    v_mfma_f32_32x32x16_bf16 v[176:191], a[204:207], a[220:223], v[176:191]
    buffer_load_dwordx4 v2, s[20:23], s64 offen offset:640 lds
    v_accvgpr_read_b32 v32, a32
    v_accvgpr_read_b32 v33, a33
    v_accvgpr_read_b32 v34, a34
    v_accvgpr_read_b32 v35, a35
    v_mul_f32 v36, v32, v32
    v_mfma_f32_32x32x16_bf16 v[176:191], a[200:203], a[188:191], v[176:191]
    v_mul_f32 v37, v33, v33
    v_mul_f32 v38, v34, v34
    v_mul_f32 v39, v35, v35
    v_fma_f32 v36, v36, s70, v5
    v_fma_f32 v37, v37, s70, v5
    v_fma_f32 v38, v38, s70, v5
    v_mfma_f32_32x32x16_bf16 v[160:175], a[200:203], a[184:187], v[160:175]
    s_add_u32 m0, s59, 48512
    ds_read_b32 v6, v11
    v_fma_f32 v39, v39, s70, v5
    v_mul_f32 v36, v36, v32
    v_mul_f32 v37, v37, v33
    v_mul_f32 v38, v38, v34
    v_mul_f32 v39, v39, v35
    v_mfma_f32_32x32x16_bf16 v[144:159], a[200:203], a[180:183], v[144:159]
    buffer_load_dwordx4 v2, s[20:23], s64 offen offset:768 lds
    v_exp_f32 v36, v36
    v_exp_f32 v37, v37
    v_exp_f32 v38, v38
    v_mfma_f32_32x32x16_bf16 v[128:143], a[200:203], a[176:179], v[128:143]
    s_waitcnt lgkmcnt(0)
    v_cmp_le_u32 vcc, 52, v6
    v_exp_f32 v39, v39
    v_add_f32 v36, 1.0, v36
    v_add_f32 v37, 1.0, v37
    v_add_f32 v38, 1.0, v38
    v_add_f32 v39, 1.0, v39
    v_mfma_f32_32x32x16_bf16 v[192:207], a[240:243], a[176:179], v[192:207]
    s_cbranch_vccz L_spin13
L_back13:
    ds_read_b128 a[176:179], v44 offset:8192
    ds_read_b64_tr_b16 a[192:193], v1 offset:0
    v_rcp_f32 v36, v36
    v_rcp_f32 v37, v37
    v_mfma_f32_32x32x16_bf16 v[208:223], a[240:243], a[180:183], v[208:223]
    s_add_u32 m0, s59, 49408
    ds_read_b128 a[180:183], v44 offset:9216
    ds_read_b64_tr_b16 a[194:195], v1 offset:256
    v_rcp_f32 v38, v38
    v_rcp_f32 v39, v39
    v_mul_f32 v36, v36, v32
    v_mfma_f32_32x32x16_bf16 v[224:239], a[240:243], a[184:187], v[224:239]
    ds_read_b128 a[184:187], v4 offset:8192
    buffer_load_dwordx4 v2, s[20:23], s64 offen offset:896 lds
    v_mul_f32 v37, v37, v33
    v_mul_f32 v38, v38, v34
    v_mul_f32 v39, v39, v35
    v_mfma_f32_32x32x16_bf16 v[240:255], a[240:243], a[188:191], v[240:255]
    ds_read_b128 a[188:191], v4 offset:9216
    ds_read_b64_tr_b16 a[196:197], v1 offset:21568
    v_cvt_pk_bf16_f32 v40, v36, v37
    v_cvt_pk_bf16_f32 v41, v38, v39
    ds_write_b64 v3, v[40:41] offset:0
    v_mfma_f32_32x32x16_bf16 v[240:255], a[244:247], a[220:223], v[240:255]
    ds_read_b128 a[220:223], v4 offset:10240
    ds_read_b64_tr_b16 a[198:199], v1 offset:21824
    v_accvgpr_read_b32 v32, a36
    v_accvgpr_read_b32 v33, a37
    v_accvgpr_read_b32 v34, a38
    v_accvgpr_read_b32 v35, a39
    v_mfma_f32_32x32x16_bf16 v[224:239], a[244:247], a[216:219], v[224:239]
    s_add_u32 m0, s59, 50304
    ds_read_b128 a[216:219], v4 offset:11264
    v_mul_f32 v36, v32, v32
    v_mul_f32 v37, v33, v33
    v_mul_f32 v38, v34, v34
    v_mul_f32 v39, v35, v35
    v_fma_f32 v36, v36, s70, v5
    v_fma_f32 v37, v37, s70, v5
    v_mfma_f32_32x32x16_bf16 v[208:223], a[244:247], a[212:215], v[208:223]
L_po1:
L_q5:
    s_cbranch_execz L_q7
    ds_read_b128 a[212:215], v44 offset:10240
    buffer_load_dwordx4 v2, s[20:23], s64 offen offset:1024 lds
    v_fma_f32 v38, v38, s70, v5
    v_fma_f32 v39, v39, s70, v5
    v_mul_f32 v36, v36, v32
    v_mul_f32 v37, v37, v33
    v_mfma_f32_32x32x16_bf16 v[192:207], a[244:247], a[208:211], v[192:207]
    s_waitcnt lgkmcnt(8)
    ds_read_b128 a[208:211], v44 offset:11264
    v_mul_f32 v38, v38, v34
    v_mul_f32 v39, v39, v35
    v_exp_f32 v36, v36
    v_exp_f32 v37, v37
    v_mfma_f32_32x32x16_bf16 v[48:63], a[192:195], a[176:179], v[48:63]
    s_xor_b32 s64, s71, 320
    ds_read_b64_tr_b16 a[204:205], v1 offset:22080
    v_exp_f32 v38, v38
    v_exp_f32 v39, v39
    v_add_f32 v36, 1.0, v36
    v_mfma_f32_32x32x16_bf16 a[112:127], a[192:195], a[180:183], a[112:127]
    s_waitcnt lgkmcnt(8)
    ds_read_b64_tr_b16 a[206:207], v1 offset:22336
    s_mul_i32 s64, s64, 576
    s_add_u32 m0, s59, 86272
    v_add_f32 v37, 1.0, v37
    v_add_f32 v38, 1.0, v38
    v_add_f32 v39, 1.0, v39
    v_mfma_f32_32x32x16_bf16 v[64:79], a[192:195], a[184:187], v[64:79]
    buffer_load_dwordx4 v2, s[20:23], s64 offen offset:0 lds
    v_rcp_f32 v36, v36
    v_rcp_f32 v37, v37
    v_mfma_f32_32x32x16_bf16 a[128:143], a[192:195], a[188:191], a[128:143]
    s_waitcnt lgkmcnt(4)
    ds_read_b64_tr_b16 a[200:201], v1 offset:512
    v_rcp_f32 v38, v38
    v_rcp_f32 v39, v39
    v_mul_f32 v36, v36, v32
    v_mul_f32 v37, v37, v33
    v_mfma_f32_32x32x16_bf16 a[128:143], a[196:199], a[220:223], a[128:143]
    s_add_u32 m0, s59, 87168
    ds_read_b64_tr_b16 a[202:203], v1 offset:768
    v_mul_f32 v38, v38, v34
    v_mul_f32 v39, v39, v35
    v_cvt_pk_bf16_f32 v42, v36, v37
    v_cvt_pk_bf16_f32 v43, v38, v39
    ds_write_b64 v3, v[42:43] offset:256
    v_mfma_f32_32x32x16_bf16 v[64:79], a[196:199], a[216:219], v[64:79]
    s_waitcnt lgkmcnt(5)
    ds_read_b64_tr_b16 a[240:241], v10 offset:0
    v_accvgpr_read_b32 v32, a40
    v_accvgpr_read_b32 v33, a41
    v_accvgpr_read_b32 v34, a42
    v_accvgpr_read_b32 v35, a43
    v_mfma_f32_32x32x16_bf16 a[112:127], a[196:199], a[212:215], a[112:127]
    buffer_load_dwordx4 v2, s[20:23], s64 offen offset:128 lds
    v_mul_f32 v36, v32, v32
    v_mul_f32 v37, v33, v33
    v_mul_f32 v38, v34, v34
    v_mul_f32 v39, v35, v35
    v_fma_f32 v36, v36, s70, v5
    v_mfma_f32_32x32x16_bf16 v[48:63], a[196:199], a[208:211], v[48:63]
    s_waitcnt lgkmcnt(2)
    ds_read_b64_tr_b16 a[242:243], v10 offset:256
    v_fma_f32 v37, v37, s70, v5
    v_fma_f32 v38, v38, s70, v5
    v_fma_f32 v39, v39, s70, v5
    v_mul_f32 v36, v36, v32
    v_mul_f32 v37, v37, v33
    v_mfma_f32_32x32x16_bf16 v[80:95], a[204:207], a[208:211], v[80:95]
    ds_read_b64_tr_b16 a[244:245], v10 offset:21568
    v_mul_f32 v38, v38, v34
    v_mul_f32 v39, v39, v35
    v_exp_f32 v36, v36
    v_exp_f32 v37, v37
    v_mfma_f32_32x32x16_bf16 a[144:159], a[204:207], a[212:215], a[144:159]
    s_add_u32 m0, s59, 88064
    ds_read_b64_tr_b16 a[246:247], v10 offset:21824
    v_exp_f32 v38, v38
    v_exp_f32 v39, v39
    v_add_f32 v36, 1.0, v36
    v_mfma_f32_32x32x16_bf16 v[96:111], a[204:207], a[216:219], v[96:111]
    buffer_load_dwordx4 v2, s[20:23], s64 offen offset:256 lds
    v_add_f32 v37, 1.0, v37
    v_add_f32 v38, 1.0, v38
    v_add_f32 v39, 1.0, v39
    v_rcp_f32 v36, v36
    v_mfma_f32_32x32x16_bf16 a[160:175], a[204:207], a[220:223], a[160:175]
    ds_read_b64_tr_b16 a[196:197], v1 offset:22592
    v_rcp_f32 v37, v37
    v_rcp_f32 v38, v38
    v_rcp_f32 v39, v39
    v_mfma_f32_32x32x16_bf16 a[160:175], a[200:203], a[188:191], a[160:175]
    ds_read_b64_tr_b16 a[198:199], v1 offset:22848
    v_mul_f32 v36, v36, v32
    v_mul_f32 v37, v37, v33
    v_mul_f32 v38, v38, v34
    v_mul_f32 v39, v39, v35
    v_cvt_pk_bf16_f32 v40, v36, v37
    v_mfma_f32_32x32x16_bf16 v[96:111], a[200:203], a[184:187], v[96:111]
    s_add_u32 m0, s59, 88960
    ds_read_b64_tr_b16 a[192:193], v1 offset:1024
    v_cvt_pk_bf16_f32 v41, v38, v39
    ds_write_b64 v3, v[40:41] offset:1024
    v_accvgpr_read_b32 v32, a44
    v_accvgpr_read_b32 v33, a45
    v_mfma_f32_32x32x16_bf16 a[144:159], a[200:203], a[180:183], a[144:159]
    buffer_load_dwordx4 v2, s[20:23], s64 offen offset:384 lds
    v_accvgpr_read_b32 v34, a46
    v_accvgpr_read_b32 v35, a47
    v_mul_f32 v36, v32, v32
    v_mul_f32 v37, v33, v33
    v_mfma_f32_32x32x16_bf16 v[80:95], a[200:203], a[176:179], v[80:95]
    s_waitcnt lgkmcnt(4)
    ds_read_b64_tr_b16 a[194:195], v1 offset:1280
    v_mul_f32 v38, v34, v34
    v_mul_f32 v39, v35, v35
    v_fma_f32 v36, v36, s70, v5
    v_fma_f32 v37, v37, s70, v5
    v_fma_f32 v38, v38, s70, v5
    v_fma_f32 v39, v39, s70, v5
    v_mfma_f32_32x32x16_bf16 v[112:127], a[240:243], a[176:179], v[112:127]
    ds_read_b64_tr_b16 a[200:201], v1 offset:1536
    v_mul_f32 v36, v36, v32
    v_mul_f32 v37, v37, v33
    v_mul_f32 v38, v38, v34
    v_mul_f32 v39, v39, v35
    v_exp_f32 v36, v36
    v_mfma_f32_32x32x16_bf16 v[16:31], a[240:243], a[180:183], v[16:31]
    s_add_u32 m0, s59, 89856
    ds_read_b64_tr_b16 a[202:203], v1 offset:1792
    v_exp_f32 v37, v37
    v_exp_f32 v38, v38
    v_mfma_f32_32x32x16_bf16 v[16:31], a[244:247], a[212:215], v[16:31]
    buffer_load_dwordx4 v2, s[20:23], s64 offen offset:512 lds
    v_exp_f32 v39, v39
    v_add_f32 v36, 1.0, v36
    v_add_f32 v37, 1.0, v37
    v_add_f32 v38, 1.0, v38
    v_mfma_f32_32x32x16_bf16 v[112:127], a[244:247], a[208:211], v[112:127]
    s_waitcnt lgkmcnt(2)
    ds_read_b64_tr_b16 a[204:205], v1 offset:23104
    v_add_f32 v39, 1.0, v39
    v_rcp_f32 v36, v36
    v_rcp_f32 v37, v37
    v_mfma_f32_32x32x16_bf16 v[128:143], a[196:199], a[208:211], v[128:143]
    ds_read_b64_tr_b16 a[206:207], v1 offset:23360
    v_rcp_f32 v38, v38
    v_rcp_f32 v39, v39
    v_mul_f32 v36, v36, v32
    v_mul_f32 v37, v37, v33
    v_mfma_f32_32x32x16_bf16 v[144:159], a[196:199], a[212:215], v[144:159]
    v_mul_f32 v38, v38, v34
    v_mul_f32 v39, v39, v35
    v_cvt_pk_bf16_f32 v42, v36, v37
    v_cvt_pk_bf16_f32 v43, v38, v39
    ds_write_b64 v3, v[42:43] offset:1280
    v_mfma_f32_32x32x16_bf16 v[160:175], a[196:199], a[216:219], v[160:175]
    s_waitcnt vmcnt(5)
    ds_add_u32 v11, v9
    v_add_u32 v1, 43136, v1
    v_add_u32 v10, 43136, v10
    s_add_u32 m0, s59, 90752
    v_mfma_f32_32x32x16_bf16 v[176:191], a[196:199], a[220:223], v[176:191]
    buffer_load_dwordx4 v2, s[20:23], s64 offen offset:640 lds
    v_accvgpr_read_b32 v32, a48
    v_accvgpr_read_b32 v33, a49
    v_accvgpr_read_b32 v34, a50
    v_accvgpr_read_b32 v35, a51
    v_mul_f32 v36, v32, v32
    v_mfma_f32_32x32x16_bf16 v[176:191], a[192:195], a[188:191], v[176:191]
    v_mul_f32 v37, v33, v33
    v_mul_f32 v38, v34, v34
    v_mul_f32 v39, v35, v35
    v_fma_f32 v36, v36, s70, v5
    v_fma_f32 v37, v37, s70, v5
    v_fma_f32 v38, v38, s70, v5
    v_mfma_f32_32x32x16_bf16 v[160:175], a[192:195], a[184:187], v[160:175]
    s_add_u32 m0, s59, 91648
    ds_read_b32 v6, v11
    v_fma_f32 v39, v39, s70, v5
    v_mul_f32 v36, v36, v32
    v_mul_f32 v37, v37, v33
    v_mul_f32 v38, v38, v34
    v_mul_f32 v39, v39, v35
    v_mfma_f32_32x32x16_bf16 v[144:159], a[192:195], a[180:183], v[144:159]
    buffer_load_dwordx4 v2, s[20:23], s64 offen offset:768 lds
    v_exp_f32 v36, v36
    v_exp_f32 v37, v37
    v_exp_f32 v38, v38
    v_mfma_f32_32x32x16_bf16 v[128:143], a[192:195], a[176:179], v[128:143]
    s_waitcnt lgkmcnt(0)
    v_cmp_le_u32 vcc, 56, v6
    v_exp_f32 v39, v39
    v_add_f32 v36, 1.0, v36
    v_add_f32 v37, 1.0, v37
    v_add_f32 v38, 1.0, v38
    v_add_f32 v39, 1.0, v39
    v_mfma_f32_32x32x16_bf16 v[192:207], a[200:203], a[176:179], v[192:207]
    s_cbranch_vccz L_spin14
L_back14:
    ds_read_b128 a[176:179], v44 offset:0
    ds_read_b64_tr_b16 a[240:241], v1 offset:0
    v_rcp_f32 v36, v36
    v_rcp_f32 v37, v37
    v_mfma_f32_32x32x16_bf16 v[208:223], a[200:203], a[180:183], v[208:223]
    s_add_u32 m0, s59, 92544
    ds_read_b128 a[180:183], v44 offset:1024
    ds_read_b64_tr_b16 a[242:243], v1 offset:256
    v_rcp_f32 v38, v38
    v_rcp_f32 v39, v39
    v_mul_f32 v36, v36, v32
    v_mfma_f32_32x32x16_bf16 v[224:239], a[200:203], a[184:187], v[224:239]
    ds_read_b128 a[184:187], v4 offset:0
    buffer_load_dwordx4 v2, s[20:23], s64 offen offset:896 lds
    v_mul_f32 v37, v37, v33
    v_mul_f32 v38, v38, v34
    v_mul_f32 v39, v39, v35
    v_mfma_f32_32x32x16_bf16 v[240:255], a[200:203], a[188:191], v[240:255]
    ds_read_b128 a[188:191], v4 offset:1024
    ds_read_b64_tr_b16 a[244:245], v1 offset:21568
    v_cvt_pk_bf16_f32 v40, v36, v37
    v_cvt_pk_bf16_f32 v41, v38, v39
    ds_write_b64 v3, v[40:41] offset:8192
    v_mfma_f32_32x32x16_bf16 v[240:255], a[204:207], a[220:223], v[240:255]
    ds_read_b128 a[220:223], v4 offset:2048
    ds_read_b64_tr_b16 a[246:247], v1 offset:21824
    v_accvgpr_read_b32 v32, a52
    v_accvgpr_read_b32 v33, a53
    v_accvgpr_read_b32 v34, a54
    v_accvgpr_read_b32 v35, a55
    v_mfma_f32_32x32x16_bf16 v[224:239], a[204:207], a[216:219], v[224:239]
    s_add_u32 m0, s59, 93440
    ds_read_b128 a[216:219], v4 offset:3072
    v_mul_f32 v36, v32, v32
    v_mul_f32 v37, v33, v33
    v_mul_f32 v38, v34, v34
    v_mul_f32 v39, v35, v35
    v_fma_f32 v36, v36, s70, v5
    v_fma_f32 v37, v37, s70, v5
    v_mfma_f32_32x32x16_bf16 v[208:223], a[204:207], a[212:215], v[208:223]
    ds_read_b128 a[212:215], v44 offset:2048
    buffer_load_dwordx4 v2, s[20:23], s64 offen offset:1024 lds
    v_fma_f32 v38, v38, s70, v5
    v_fma_f32 v39, v39, s70, v5
    v_mul_f32 v36, v36, v32
    v_mul_f32 v37, v37, v33
    v_mfma_f32_32x32x16_bf16 v[192:207], a[204:207], a[208:211], v[192:207]
    s_waitcnt lgkmcnt(8)
    ds_read_b128 a[208:211], v44 offset:3072
    v_mul_f32 v38, v38, v34
    v_mul_f32 v39, v39, v35
    v_exp_f32 v36, v36
    v_exp_f32 v37, v37
    v_mfma_f32_32x32x16_bf16 v[48:63], a[240:243], a[176:179], v[48:63]
    s_xor_b32 s64, s71, 384
    ds_read_b64_tr_b16 a[196:197], v1 offset:22080
    v_exp_f32 v38, v38
    v_exp_f32 v39, v39
    v_add_f32 v36, 1.0, v36
    v_mfma_f32_32x32x16_bf16 a[112:127], a[240:243], a[180:183], a[112:127]
    s_waitcnt lgkmcnt(8)
    ds_read_b64_tr_b16 a[198:199], v1 offset:22336
    s_mul_i32 s64, s64, 576
    s_add_u32 m0, s59, 0
    v_add_f32 v37, 1.0, v37
    v_add_f32 v38, 1.0, v38
    v_add_f32 v39, 1.0, v39
    v_mfma_f32_32x32x16_bf16 v[64:79], a[240:243], a[184:187], v[64:79]
    buffer_load_dwordx4 v2, s[20:23], s64 offen offset:0 lds
    v_rcp_f32 v36, v36
    v_rcp_f32 v37, v37
    v_mfma_f32_32x32x16_bf16 a[128:143], a[240:243], a[188:191], a[128:143]
    s_waitcnt lgkmcnt(4)
    ds_read_b64_tr_b16 a[192:193], v1 offset:512
    v_rcp_f32 v38, v38
    v_rcp_f32 v39, v39
    v_mul_f32 v36, v36, v32
    v_mul_f32 v37, v37, v33
    v_mfma_f32_32x32x16_bf16 a[128:143], a[244:247], a[220:223], a[128:143]
    s_add_u32 m0, s59, 896
    ds_read_b64_tr_b16 a[194:195], v1 offset:768
    v_mul_f32 v38, v38, v34
    v_mul_f32 v39, v39, v35
    v_cvt_pk_bf16_f32 v42, v36, v37
    v_cvt_pk_bf16_f32 v43, v38, v39
    ds_write_b64 v3, v[42:43] offset:8448
    v_mfma_f32_32x32x16_bf16 v[64:79], a[244:247], a[216:219], v[64:79]
    s_waitcnt lgkmcnt(5)
    ds_read_b64_tr_b16 a[200:201], v10 offset:0
    v_accvgpr_read_b32 v32, a56
    v_accvgpr_read_b32 v33, a57
    v_accvgpr_read_b32 v34, a58
    v_accvgpr_read_b32 v35, a59
    v_mfma_f32_32x32x16_bf16 a[112:127], a[244:247], a[212:215], a[112:127]
    buffer_load_dwordx4 v2, s[20:23], s64 offen offset:128 lds
    v_mul_f32 v36, v32, v32
    v_mul_f32 v37, v33, v33
    v_mul_f32 v38, v34, v34
    v_mul_f32 v39, v35, v35
    v_fma_f32 v36, v36, s70, v5
    v_mfma_f32_32x32x16_bf16 v[48:63], a[244:247], a[208:211], v[48:63]
    s_waitcnt lgkmcnt(2)
    ds_read_b64_tr_b16 a[202:203], v10 offset:256
    v_fma_f32 v37, v37, s70, v5
    v_fma_f32 v38, v38, s70, v5
    v_fma_f32 v39, v39, s70, v5
    v_mul_f32 v36, v36, v32
    v_mul_f32 v37, v37, v33
    v_mfma_f32_32x32x16_bf16 v[80:95], a[196:199], a[208:211], v[80:95]
    ds_read_b64_tr_b16 a[204:205], v10 offset:21568
    v_mul_f32 v38, v38, v34
    v_mul_f32 v39, v39, v35
    v_exp_f32 v36, v36
    v_exp_f32 v37, v37
    v_mfma_f32_32x32x16_bf16 a[144:159], a[196:199], a[212:215], a[144:159]
    s_add_u32 m0, s59, 1792
    ds_read_b64_tr_b16 a[206:207], v10 offset:21824
    v_exp_f32 v38, v38
    v_exp_f32 v39, v39
    v_add_f32 v36, 1.0, v36
    v_mfma_f32_32x32x16_bf16 v[96:111], a[196:199], a[216:219], v[96:111]
    buffer_load_dwordx4 v2, s[20:23], s64 offen offset:256 lds
    v_add_f32 v37, 1.0, v37
    v_add_f32 v38, 1.0, v38
    v_add_f32 v39, 1.0, v39
    v_rcp_f32 v36, v36
    v_mfma_f32_32x32x16_bf16 a[160:175], a[196:199], a[220:223], a[160:175]
    ds_read_b64_tr_b16 a[244:245], v1 offset:22592
    v_rcp_f32 v37, v37
    v_rcp_f32 v38, v38
    v_rcp_f32 v39, v39
    v_mfma_f32_32x32x16_bf16 a[160:175], a[192:195], a[188:191], a[160:175]
    ds_read_b64_tr_b16 a[246:247], v1 offset:22848
    v_mul_f32 v36, v36, v32
    v_mul_f32 v37, v37, v33
    v_mul_f32 v38, v38, v34
    v_mul_f32 v39, v39, v35
    v_cvt_pk_bf16_f32 v40, v36, v37
    v_mfma_f32_32x32x16_bf16 v[96:111], a[192:195], a[184:187], v[96:111]
    s_add_u32 m0, s59, 2688
    ds_read_b64_tr_b16 a[240:241], v1 offset:1024
    v_cvt_pk_bf16_f32 v41, v38, v39
    ds_write_b64 v3, v[40:41] offset:9216
    v_accvgpr_read_b32 v32, a60
    v_accvgpr_read_b32 v33, a61
    v_mfma_f32_32x32x16_bf16 a[144:159], a[192:195], a[180:183], a[144:159]
    buffer_load_dwordx4 v2, s[20:23], s64 offen offset:384 lds
    v_accvgpr_read_b32 v34, a62
    v_accvgpr_read_b32 v35, a63
    v_mul_f32 v36, v32, v32
    v_mul_f32 v37, v33, v33
    v_mfma_f32_32x32x16_bf16 v[80:95], a[192:195], a[176:179], v[80:95]
    s_waitcnt lgkmcnt(4)
    ds_read_b64_tr_b16 a[242:243], v1 offset:1280
    v_mul_f32 v38, v34, v34
    v_mul_f32 v39, v35, v35
    v_fma_f32 v36, v36, s70, v5
    v_fma_f32 v37, v37, s70, v5
    v_fma_f32 v38, v38, s70, v5
    v_fma_f32 v39, v39, s70, v5
    v_mfma_f32_32x32x16_bf16 v[112:127], a[200:203], a[176:179], v[112:127]
    ds_read_b64_tr_b16 a[192:193], v1 offset:1536
    v_mul_f32 v36, v36, v32
    v_mul_f32 v37, v37, v33
    v_mul_f32 v38, v38, v34
    v_mul_f32 v39, v39, v35
    v_exp_f32 v36, v36
    v_mfma_f32_32x32x16_bf16 v[16:31], a[200:203], a[180:183], v[16:31]
    s_add_u32 m0, s59, 3584
    ds_read_b64_tr_b16 a[194:195], v1 offset:1792
    v_exp_f32 v37, v37
    v_exp_f32 v38, v38
    v_mfma_f32_32x32x16_bf16 v[16:31], a[204:207], a[212:215], v[16:31]
    buffer_load_dwordx4 v2, s[20:23], s64 offen offset:512 lds
    v_exp_f32 v39, v39
    v_add_f32 v36, 1.0, v36
    v_add_f32 v37, 1.0, v37
    v_add_f32 v38, 1.0, v38
    v_mfma_f32_32x32x16_bf16 v[112:127], a[204:207], a[208:211], v[112:127]
    s_waitcnt lgkmcnt(2)
    ds_read_b64_tr_b16 a[196:197], v1 offset:23104
    v_add_f32 v39, 1.0, v39
    v_rcp_f32 v36, v36
    v_rcp_f32 v37, v37
    v_mfma_f32_32x32x16_bf16 v[128:143], a[244:247], a[208:211], v[128:143]
    ds_read_b64_tr_b16 a[198:199], v1 offset:23360
    v_rcp_f32 v38, v38
    v_rcp_f32 v39, v39
    v_mul_f32 v36, v36, v32
    v_mul_f32 v37, v37, v33
    v_mfma_f32_32x32x16_bf16 v[144:159], a[244:247], a[212:215], v[144:159]
    v_mul_f32 v38, v38, v34
    v_mul_f32 v39, v39, v35
    v_cvt_pk_bf16_f32 v42, v36, v37
    v_cvt_pk_bf16_f32 v43, v38, v39
    ds_write_b64 v3, v[42:43] offset:9472
    v_mfma_f32_32x32x16_bf16 v[160:175], a[244:247], a[216:219], v[160:175]
    s_waitcnt vmcnt(5)
    ds_add_u32 v11, v9
    v_add_u32 v1, 43136, v1
    v_add_u32 v10, 43136, v10
    s_add_u32 m0, s59, 4480
    v_mfma_f32_32x32x16_bf16 v[176:191], a[244:247], a[220:223], v[176:191]
    buffer_load_dwordx4 v2, s[20:23], s64 offen offset:640 lds
    v_accvgpr_read_b32 v32, a64
    v_accvgpr_read_b32 v33, a65
    v_accvgpr_read_b32 v34, a66
    v_accvgpr_read_b32 v35, a67
    v_mul_f32 v36, v32, v32
    v_mfma_f32_32x32x16_bf16 v[176:191], a[240:243], a[188:191], v[176:191]
    v_mul_f32 v37, v33, v33
    v_mul_f32 v38, v34, v34
    v_mul_f32 v39, v35, v35
    v_fma_f32 v36, v36, s70, v5
    v_fma_f32 v37, v37, s70, v5
    v_fma_f32 v38, v38, s70, v5
    v_mfma_f32_32x32x16_bf16 v[160:175], a[240:243], a[184:187], v[160:175]
    s_add_u32 m0, s59, 5376
    ds_read_b32 v6, v11
    v_fma_f32 v39, v39, s70, v5
    v_mul_f32 v36, v36, v32
    v_mul_f32 v37, v37, v33
    v_mul_f32 v38, v38, v34
    v_mul_f32 v39, v39, v35
    v_mfma_f32_32x32x16_bf16 v[144:159], a[240:243], a[180:183], v[144:159]
    buffer_load_dwordx4 v2, s[20:23], s64 offen offset:768 lds
    v_exp_f32 v36, v36
    v_exp_f32 v37, v37
    v_exp_f32 v38, v38
    v_mfma_f32_32x32x16_bf16 v[128:143], a[240:243], a[176:179], v[128:143]
    s_waitcnt lgkmcnt(0)
    v_cmp_le_u32 vcc, 60, v6
    v_exp_f32 v39, v39
    v_add_f32 v36, 1.0, v36
    v_add_f32 v37, 1.0, v37
    v_add_f32 v38, 1.0, v38
    v_add_f32 v39, 1.0, v39
    v_mfma_f32_32x32x16_bf16 v[192:207], a[192:195], a[176:179], v[192:207]
    s_cbranch_vccz L_spin15
L_back15:
    ds_read_b128 a[176:179], v44 offset:8192
    ds_read_b64_tr_b16 a[200:201], v1 offset:0
    v_rcp_f32 v36, v36
    v_rcp_f32 v37, v37
    v_mfma_f32_32x32x16_bf16 v[208:223], a[192:195], a[180:183], v[208:223]
    s_add_u32 m0, s59, 6272
    ds_read_b128 a[180:183], v44 offset:9216
    ds_read_b64_tr_b16 a[202:203], v1 offset:256
    v_rcp_f32 v38, v38
    v_rcp_f32 v39, v39
    v_mul_f32 v36, v36, v32
    v_mfma_f32_32x32x16_bf16 v[224:239], a[192:195], a[184:187], v[224:239]
    ds_read_b128 a[184:187], v4 offset:8192
    buffer_load_dwordx4 v2, s[20:23], s64 offen offset:896 lds
    v_mul_f32 v37, v37, v33
    v_mul_f32 v38, v38, v34
    v_mul_f32 v39, v39, v35
    v_cvt_pk_bf16_f32 v40, v36, v37
    v_mfma_f32_32x32x16_bf16 v[240:255], a[192:195], a[188:191], v[240:255]
    ds_read_b128 a[188:191], v4 offset:9216
    ds_read_b64_tr_b16 a[204:205], v1 offset:21568
    v_cvt_pk_bf16_f32 v41, v38, v39
    ds_write_b64 v3, v[40:41] offset:0
    v_mfma_f32_32x32x16_bf16 v[240:255], a[196:199], a[220:223], v[240:255]
    ds_read_b128 a[220:223], v4 offset:10240
    ds_read_b64_tr_b16 a[206:207], v1 offset:21824
    v_accvgpr_read_b32 v32, a68
    v_accvgpr_read_b32 v33, a69
    v_accvgpr_read_b32 v34, a70
    v_accvgpr_read_b32 v35, a71
    v_mul_f32 v36, v32, v32
    v_mfma_f32_32x32x16_bf16 v[224:239], a[196:199], a[216:219], v[224:239]
    s_add_u32 m0, s59, 7168
    ds_read_b128 a[216:219], v4 offset:11264
    v_mul_f32 v37, v33, v33
    v_mul_f32 v38, v34, v34
    v_mul_f32 v39, v35, v35
    v_fma_f32 v36, v36, s70, v5
    v_fma_f32 v37, v37, s70, v5
    v_fma_f32 v38, v38, s70, v5
    v_mfma_f32_32x32x16_bf16 v[208:223], a[196:199], a[212:215], v[208:223]
    ds_read_b128 a[212:215], v44 offset:10240
    buffer_load_dwordx4 v2, s[20:23], s64 offen offset:1024 lds
    v_fma_f32 v39, v39, s70, v5
    v_mul_f32 v36, v36, v32
    v_mul_f32 v37, v37, v33
    v_mfma_f32_32x32x16_bf16 v[192:207], a[196:199], a[208:211], v[192:207]
    s_waitcnt lgkmcnt(8)
    ds_read_b128 a[208:211], v44 offset:11264
    v_mul_f32 v38, v38, v34
    v_mul_f32 v39, v39, v35
    v_exp_f32 v36, v36
    v_exp_f32 v37, v37
    v_mfma_f32_32x32x16_bf16 v[48:63], a[200:203], a[176:179], v[48:63]
    s_xor_b32 s64, s71, 448
    ds_read_b64_tr_b16 a[244:245], v1 offset:22080
    v_exp_f32 v38, v38
    v_exp_f32 v39, v39
    v_add_f32 v36, 1.0, v36
    v_mfma_f32_32x32x16_bf16 a[112:127], a[200:203], a[180:183], a[112:127]
    s_waitcnt lgkmcnt(8)
    ds_read_b64_tr_b16 a[246:247], v1 offset:22336
    s_mul_i32 s64, s64, 576
    s_add_u32 m0, s59, 43136
    v_add_f32 v37, 1.0, v37
    v_add_f32 v38, 1.0, v38
    v_add_f32 v39, 1.0, v39
    v_rcp_f32 v36, v36
    v_mfma_f32_32x32x16_bf16 v[64:79], a[200:203], a[184:187], v[64:79]
    buffer_load_dwordx4 v2, s[20:23], s64 offen offset:0 lds
    v_rcp_f32 v37, v37
    v_rcp_f32 v38, v38
    v_mfma_f32_32x32x16_bf16 a[128:143], a[200:203], a[188:191], a[128:143]
    s_waitcnt lgkmcnt(4)
    ds_read_b64_tr_b16 a[240:241], v1 offset:512
    v_rcp_f32 v39, v39
    v_mul_f32 v36, v36, v32
    v_mul_f32 v37, v37, v33
    v_mul_f32 v38, v38, v34
    v_mfma_f32_32x32x16_bf16 a[128:143], a[204:207], a[220:223], a[128:143]
    s_add_u32 m0, s59, 44032
    ds_read_b64_tr_b16 a[242:243], v1 offset:768
    v_mul_f32 v39, v39, v35
    v_cvt_pk_bf16_f32 v42, v36, v37
    v_cvt_pk_bf16_f32 v43, v38, v39
    ds_write_b64 v3, v[42:43] offset:256
    v_mfma_f32_32x32x16_bf16 v[64:79], a[204:207], a[216:219], v[64:79]
    s_waitcnt lgkmcnt(5)
    ds_read_b64_tr_b16 a[192:193], v10 offset:0
    v_accvgpr_read_b32 v32, a72
    v_accvgpr_read_b32 v33, a73
    v_accvgpr_read_b32 v34, a74
    v_accvgpr_read_b32 v35, a75
    v_mul_f32 v36, v32, v32
    v_mfma_f32_32x32x16_bf16 a[112:127], a[204:207], a[212:215], a[112:127]
    buffer_load_dwordx4 v2, s[20:23], s64 offen offset:128 lds
    v_mul_f32 v37, v33, v33
    v_mul_f32 v38, v34, v34
    v_mul_f32 v39, v35, v35
    v_fma_f32 v36, v36, s70, v5
    v_fma_f32 v37, v37, s70, v5
    v_mfma_f32_32x32x16_bf16 v[48:63], a[204:207], a[208:211], v[48:63]
    s_waitcnt lgkmcnt(2)
    ds_read_b64_tr_b16 a[194:195], v10 offset:256
    v_fma_f32 v38, v38, s70, v5
    v_fma_f32 v39, v39, s70, v5
    v_mul_f32 v36, v36, v32
    v_mul_f32 v37, v37, v33
    v_mul_f32 v38, v38, v34
    v_mul_f32 v39, v39, v35
    v_mfma_f32_32x32x16_bf16 v[80:95], a[244:247], a[208:211], v[80:95]
    ds_read_b64_tr_b16 a[196:197], v10 offset:21568
    v_exp_f32 v36, v36
    v_exp_f32 v37, v37
    v_exp_f32 v38, v38
    v_mfma_f32_32x32x16_bf16 a[144:159], a[244:247], a[212:215], a[144:159]
    s_add_u32 m0, s59, 44928
    ds_read_b64_tr_b16 a[198:199], v10 offset:21824
    v_exp_f32 v39, v39
    v_add_f32 v36, 1.0, v36
    v_add_f32 v37, 1.0, v37
    v_add_f32 v38, 1.0, v38
    v_mfma_f32_32x32x16_bf16 v[96:111], a[244:247], a[216:219], v[96:111]
    buffer_load_dwordx4 v2, s[20:23], s64 offen offset:256 lds
    v_add_f32 v39, 1.0, v39
    v_rcp_f32 v36, v36
    v_rcp_f32 v37, v37
    v_mfma_f32_32x32x16_bf16 a[160:175], a[244:247], a[220:223], a[160:175]
    ds_read_b64_tr_b16 a[204:205], v1 offset:22592
    v_rcp_f32 v38, v38
    v_rcp_f32 v39, v39
    v_mul_f32 v36, v36, v32
    v_mfma_f32_32x32x16_bf16 a[160:175], a[240:243], a[188:191], a[160:175]
    ds_read_b64_tr_b16 a[206:207], v1 offset:22848
    v_mul_f32 v37, v37, v33
    v_mul_f32 v38, v38, v34
    v_mul_f32 v39, v39, v35
    v_cvt_pk_bf16_f32 v40, v36, v37
    v_cvt_pk_bf16_f32 v41, v38, v39
    v_mfma_f32_32x32x16_bf16 v[96:111], a[240:243], a[184:187], v[96:111]
    s_add_u32 m0, s59, 45824
    ds_read_b64_tr_b16 a[200:201], v1 offset:1024
    ds_write_b64 v3, v[40:41] offset:1024
    v_accvgpr_read_b32 v32, a76
    v_accvgpr_read_b32 v33, a77
    v_accvgpr_read_b32 v34, a78
    v_mfma_f32_32x32x16_bf16 a[144:159], a[240:243], a[180:183], a[144:159]
    buffer_load_dwordx4 v2, s[20:23], s64 offen offset:384 lds
    v_accvgpr_read_b32 v35, a79
    v_mul_f32 v36, v32, v32
    v_mul_f32 v37, v33, v33
    v_mul_f32 v38, v34, v34
    v_mul_f32 v39, v35, v35
    v_mfma_f32_32x32x16_bf16 v[80:95], a[240:243], a[176:179], v[80:95]
    s_waitcnt lgkmcnt(4)
    ds_read_b64_tr_b16 a[202:203], v1 offset:1280
    v_fma_f32 v36, v36, s70, v5
    v_fma_f32 v37, v37, s70, v5
    v_fma_f32 v38, v38, s70, v5
    v_fma_f32 v39, v39, s70, v5
    v_mul_f32 v36, v36, v32
    v_mfma_f32_32x32x16_bf16 v[112:127], a[192:195], a[176:179], v[112:127]
    ds_read_b64_tr_b16 a[240:241], v1 offset:1536
    v_mul_f32 v37, v37, v33
    v_mul_f32 v38, v38, v34
    v_mul_f32 v39, v39, v35
    v_exp_f32 v36, v36
    v_exp_f32 v37, v37
    v_mfma_f32_32x32x16_bf16 v[16:31], a[192:195], a[180:183], v[16:31]
    s_add_u32 m0, s59, 46720
    ds_read_b64_tr_b16 a[242:243], v1 offset:1792
    v_exp_f32 v38, v38
    v_exp_f32 v39, v39
    v_add_f32 v36, 1.0, v36
    v_mfma_f32_32x32x16_bf16 v[16:31], a[196:199], a[212:215], v[16:31]
    buffer_load_dwordx4 v2, s[20:23], s64 offen offset:512 lds
    v_add_f32 v37, 1.0, v37
    v_add_f32 v38, 1.0, v38
    v_add_f32 v39, 1.0, v39
    v_rcp_f32 v36, v36
    v_mfma_f32_32x32x16_bf16 v[112:127], a[196:199], a[208:211], v[112:127]
    s_waitcnt lgkmcnt(2)
    ds_read_b64_tr_b16 a[244:245], v1 offset:23104
    v_rcp_f32 v37, v37
    v_rcp_f32 v38, v38
    v_mfma_f32_32x32x16_bf16 v[128:143], a[204:207], a[208:211], v[128:143]
    ds_read_b64_tr_b16 a[246:247], v1 offset:23360
    buffer_load_dword v15, v14, s[48:51], 0 offen sc1
    v_rcp_f32 v39, v39
    v_mul_f32 v36, v36, v32
    v_mul_f32 v37, v37, v33
    v_mfma_f32_32x32x16_bf16 v[144:159], a[204:207], a[212:215], v[144:159]
    v_mul_f32 v38, v38, v34
    v_mul_f32 v39, v39, v35
    v_cvt_pk_bf16_f32 v42, v36, v37
    v_cvt_pk_bf16_f32 v43, v38, v39
    ds_write_b64 v3, v[42:43] offset:1280
    v_mfma_f32_32x32x16_bf16 v[160:175], a[204:207], a[216:219], v[160:175]
    s_waitcnt vmcnt(6)
    ds_add_u32 v11, v9
    v_add_u32 v1, 4294881024, v1
    v_add_u32 v10, 4294881024, v10
    s_add_u32 m0, s59, 47616
    v_mfma_f32_32x32x16_bf16 v[176:191], a[204:207], a[220:223], v[176:191]
    buffer_load_dwordx4 v2, s[20:23], s64 offen offset:640 lds
    v_accvgpr_read_b32 v32, a80
    v_accvgpr_read_b32 v33, a81
    v_accvgpr_read_b32 v34, a82
    v_accvgpr_read_b32 v35, a83
    v_mul_f32 v36, v32, v32
    v_mfma_f32_32x32x16_bf16 v[176:191], a[200:203], a[188:191], v[176:191]
    v_mul_f32 v37, v33, v33
    v_mul_f32 v38, v34, v34
    v_mul_f32 v39, v35, v35
    v_fma_f32 v36, v36, s70, v5
    v_fma_f32 v37, v37, s70, v5
    v_fma_f32 v38, v38, s70, v5
    v_mfma_f32_32x32x16_bf16 v[160:175], a[200:203], a[184:187], v[160:175]
    s_add_u32 m0, s59, 48512
    ds_read_b32 v6, v11
    v_fma_f32 v39, v39, s70, v5
    v_mul_f32 v36, v36, v32
    v_mul_f32 v37, v37, v33
    v_mul_f32 v38, v38, v34
    v_mul_f32 v39, v39, v35
    v_mfma_f32_32x32x16_bf16 v[144:159], a[200:203], a[180:183], v[144:159]
L_q6:
    s_cbranch_execz L_q10
    buffer_load_dwordx4 v2, s[20:23], s64 offen offset:768 lds
    v_exp_f32 v36, v36
    v_exp_f32 v37, v37
    v_exp_f32 v38, v38
    v_mfma_f32_32x32x16_bf16 v[128:143], a[200:203], a[176:179], v[128:143]
    s_waitcnt lgkmcnt(0)
    v_cmp_le_u32 vcc, 64, v6
    v_exp_f32 v39, v39
    v_add_f32 v36, 1.0, v36
    v_add_f32 v37, 1.0, v37
    v_add_f32 v38, 1.0, v38
    v_add_f32 v39, 1.0, v39
    v_mfma_f32_32x32x16_bf16 v[192:207], a[240:243], a[176:179], v[192:207]
    s_cbranch_vccz L_spin16
L_back16:
    ds_read_b128 a[176:179], v44 offset:0
    ds_read_b64_tr_b16 a[192:193], v1 offset:0
    v_rcp_f32 v36, v36
    v_rcp_f32 v37, v37
    v_mfma_f32_32x32x16_bf16 v[208:223], a[240:243], a[180:183], v[208:223]
    s_add_u32 m0, s59, 49408
    ds_read_b128 a[180:183], v44 offset:1024
    ds_read_b64_tr_b16 a[194:195], v1 offset:256
    v_rcp_f32 v38, v38
    v_rcp_f32 v39, v39
    v_mul_f32 v36, v36, v32
    v_mfma_f32_32x32x16_bf16 v[224:239], a[240:243], a[184:187], v[224:239]
    ds_read_b128 a[184:187], v4 offset:0
    buffer_load_dwordx4 v2, s[20:23], s64 offen offset:896 lds
    v_mul_f32 v37, v37, v33
    v_mul_f32 v38, v38, v34
    v_mul_f32 v39, v39, v35
    v_mfma_f32_32x32x16_bf16 v[240:255], a[240:243], a[188:191], v[240:255]
    ds_read_b128 a[188:191], v4 offset:1024
    ds_read_b64_tr_b16 a[196:197], v1 offset:21568
    v_cvt_pk_bf16_f32 v40, v36, v37
    v_cvt_pk_bf16_f32 v41, v38, v39
    ds_write_b64 v3, v[40:41] offset:8192
    v_mfma_f32_32x32x16_bf16 v[240:255], a[244:247], a[220:223], v[240:255]
    ds_read_b128 a[220:223], v4 offset:2048
    ds_read_b64_tr_b16 a[198:199], v1 offset:21824
    v_accvgpr_read_b32 v32, a84
    v_accvgpr_read_b32 v33, a85
    v_accvgpr_read_b32 v34, a86
    v_accvgpr_read_b32 v35, a87
    v_mfma_f32_32x32x16_bf16 v[224:239], a[244:247], a[216:219], v[224:239]
    s_add_u32 m0, s59, 50304
    ds_read_b128 a[216:219], v4 offset:3072
    v_mul_f32 v36, v32, v32
    v_mul_f32 v37, v33, v33
    v_mul_f32 v38, v34, v34
    v_mul_f32 v39, v35, v35
    v_fma_f32 v36, v36, s70, v5
    v_fma_f32 v37, v37, s70, v5
    v_mfma_f32_32x32x16_bf16 v[208:223], a[244:247], a[212:215], v[208:223]
    ds_read_b128 a[212:215], v44 offset:2048
    buffer_load_dwordx4 v2, s[20:23], s64 offen offset:1024 lds
    v_fma_f32 v38, v38, s70, v5
    v_fma_f32 v39, v39, s70, v5
    v_mul_f32 v36, v36, v32
    v_mul_f32 v37, v37, v33
    v_mfma_f32_32x32x16_bf16 v[192:207], a[244:247], a[208:211], v[192:207]
    s_waitcnt lgkmcnt(8)
    ds_read_b128 a[208:211], v44 offset:3072
    v_mul_f32 v38, v38, v34
    v_mul_f32 v39, v39, v35
    v_exp_f32 v36, v36
    v_exp_f32 v37, v37
    v_mfma_f32_32x32x16_bf16 v[48:63], a[192:195], a[176:179], v[48:63]
    s_mov_b32 s64, 0
    ds_read_b64_tr_b16 a[204:205], v1 offset:22080
    v_exp_f32 v38, v38
    v_exp_f32 v39, v39
    v_add_f32 v36, 1.0, v36
    v_mfma_f32_32x32x16_bf16 a[112:127], a[192:195], a[180:183], a[112:127]
    s_waitcnt lgkmcnt(8)
    ds_read_b64_tr_b16 a[206:207], v1 offset:22336
    s_add_u32 m0, s59, 86272
    v_add_u32 v2, s66, v2
    v_add_f32 v37, 1.0, v37
    v_add_f32 v38, 1.0, v38
    v_add_f32 v39, 1.0, v39
    v_mfma_f32_32x32x16_bf16 v[64:79], a[192:195], a[184:187], v[64:79]
    buffer_load_dwordx4 v2, s[20:23], s64 offen offset:0 lds
    v_rcp_f32 v36, v36
    v_rcp_f32 v37, v37
    v_mfma_f32_32x32x16_bf16 a[128:143], a[192:195], a[188:191], a[128:143]
    s_waitcnt lgkmcnt(4)
    ds_read_b64_tr_b16 a[200:201], v1 offset:512
    v_rcp_f32 v38, v38
    v_rcp_f32 v39, v39
    v_mul_f32 v36, v36, v32
    v_mul_f32 v37, v37, v33
    v_mfma_f32_32x32x16_bf16 a[128:143], a[196:199], a[220:223], a[128:143]
    s_add_u32 m0, s59, 87168
    ds_read_b64_tr_b16 a[202:203], v1 offset:768
    v_mul_f32 v38, v38, v34
    v_mul_f32 v39, v39, v35
    v_cvt_pk_bf16_f32 v42, v36, v37
    v_cvt_pk_bf16_f32 v43, v38, v39
    ds_write_b64 v3, v[42:43] offset:8448
    v_mfma_f32_32x32x16_bf16 v[64:79], a[196:199], a[216:219], v[64:79]
    s_waitcnt lgkmcnt(5)
    ds_read_b64_tr_b16 a[240:241], v10 offset:0
    v_accvgpr_read_b32 v32, a88
    v_accvgpr_read_b32 v33, a89
    v_accvgpr_read_b32 v34, a90
    v_accvgpr_read_b32 v35, a91
    v_mfma_f32_32x32x16_bf16 a[112:127], a[196:199], a[212:215], a[112:127]
    buffer_load_dwordx4 v2, s[20:23], s64 offen offset:128 lds
    v_mul_f32 v36, v32, v32
    v_mul_f32 v37, v33, v33
    v_mul_f32 v38, v34, v34
    v_mul_f32 v39, v35, v35
    v_fma_f32 v36, v36, s70, v5
    v_mfma_f32_32x32x16_bf16 v[48:63], a[196:199], a[208:211], v[48:63]
    s_waitcnt lgkmcnt(2)
    ds_read_b64_tr_b16 a[242:243], v10 offset:256
    v_fma_f32 v37, v37, s70, v5
    v_fma_f32 v38, v38, s70, v5
    v_fma_f32 v39, v39, s70, v5
    v_mul_f32 v36, v36, v32
    v_mul_f32 v37, v37, v33
    v_mfma_f32_32x32x16_bf16 v[80:95], a[204:207], a[208:211], v[80:95]
    ds_read_b64_tr_b16 a[244:245], v10 offset:21568
    v_mul_f32 v38, v38, v34
    v_mul_f32 v39, v39, v35
    v_exp_f32 v36, v36
    v_exp_f32 v37, v37
    v_mfma_f32_32x32x16_bf16 a[144:159], a[204:207], a[212:215], a[144:159]
    s_add_u32 m0, s59, 88064
    ds_read_b64_tr_b16 a[246:247], v10 offset:21824
    v_exp_f32 v38, v38
    v_exp_f32 v39, v39
    v_add_f32 v36, 1.0, v36
    v_mfma_f32_32x32x16_bf16 v[96:111], a[204:207], a[216:219], v[96:111]
    buffer_load_dwordx4 v2, s[20:23], s64 offen offset:256 lds
    v_add_f32 v37, 1.0, v37
    v_add_f32 v38, 1.0, v38
    v_add_f32 v39, 1.0, v39
    v_rcp_f32 v36, v36
    v_mfma_f32_32x32x16_bf16 a[160:175], a[204:207], a[220:223], a[160:175]
    ds_read_b64_tr_b16 a[196:197], v1 offset:22592
    v_rcp_f32 v37, v37
    v_rcp_f32 v38, v38
    v_rcp_f32 v39, v39
    v_mfma_f32_32x32x16_bf16 a[160:175], a[200:203], a[188:191], a[160:175]
    ds_read_b64_tr_b16 a[198:199], v1 offset:22848
    v_mul_f32 v36, v36, v32
    v_mul_f32 v37, v37, v33
    v_mul_f32 v38, v38, v34
    v_mul_f32 v39, v39, v35
    v_cvt_pk_bf16_f32 v40, v36, v37
    v_mfma_f32_32x32x16_bf16 v[96:111], a[200:203], a[184:187], v[96:111]
    s_add_u32 m0, s59, 88960
    ds_read_b64_tr_b16 a[192:193], v1 offset:1024
    v_cvt_pk_bf16_f32 v41, v38, v39
    ds_write_b64 v3, v[40:41] offset:9216
    v_accvgpr_read_b32 v32, a92
    v_accvgpr_read_b32 v33, a93
    v_mfma_f32_32x32x16_bf16 a[144:159], a[200:203], a[180:183], a[144:159]
    buffer_load_dwordx4 v2, s[20:23], s64 offen offset:384 lds
    v_accvgpr_read_b32 v34, a94
    v_accvgpr_read_b32 v35, a95
    v_mul_f32 v36, v32, v32
    v_mul_f32 v37, v33, v33
    v_mfma_f32_32x32x16_bf16 v[80:95], a[200:203], a[176:179], v[80:95]
    s_waitcnt lgkmcnt(4)
    ds_read_b64_tr_b16 a[194:195], v1 offset:1280
    v_mul_f32 v38, v34, v34
    v_mul_f32 v39, v35, v35
    v_fma_f32 v36, v36, s70, v5
    v_fma_f32 v37, v37, s70, v5
    v_fma_f32 v38, v38, s70, v5
    v_fma_f32 v39, v39, s70, v5
    v_mfma_f32_32x32x16_bf16 v[112:127], a[240:243], a[176:179], v[112:127]
    ds_read_b64_tr_b16 a[200:201], v1 offset:1536
    v_mul_f32 v36, v36, v32
    v_mul_f32 v37, v37, v33
    v_mul_f32 v38, v38, v34
    v_mul_f32 v39, v39, v35
    v_exp_f32 v36, v36
    v_mfma_f32_32x32x16_bf16 v[16:31], a[240:243], a[180:183], v[16:31]
    s_add_u32 m0, s59, 89856
    ds_read_b64_tr_b16 a[202:203], v1 offset:1792
    v_exp_f32 v37, v37
    v_exp_f32 v38, v38
    v_mfma_f32_32x32x16_bf16 v[16:31], a[244:247], a[212:215], v[16:31]
    buffer_load_dwordx4 v2, s[20:23], s64 offen offset:512 lds
    v_exp_f32 v39, v39
    v_add_f32 v36, 1.0, v36
    v_add_f32 v37, 1.0, v37
    v_add_f32 v38, 1.0, v38
    v_mfma_f32_32x32x16_bf16 v[112:127], a[244:247], a[208:211], v[112:127]
    s_waitcnt lgkmcnt(2)
    ds_read_b64_tr_b16 a[204:205], v1 offset:23104
    v_add_f32 v39, 1.0, v39
    v_rcp_f32 v36, v36
    v_rcp_f32 v37, v37
    v_mfma_f32_32x32x16_bf16 v[128:143], a[196:199], a[208:211], v[128:143]
    ds_read_b64_tr_b16 a[206:207], v1 offset:23360
    v_rcp_f32 v38, v38
    v_rcp_f32 v39, v39
    v_mul_f32 v36, v36, v32
    v_mul_f32 v37, v37, v33
    v_mfma_f32_32x32x16_bf16 v[144:159], a[196:199], a[212:215], v[144:159]
    v_mul_f32 v38, v38, v34
    v_mul_f32 v39, v39, v35
    v_cvt_pk_bf16_f32 v42, v36, v37
    v_cvt_pk_bf16_f32 v43, v38, v39
    ds_write_b64 v3, v[42:43] offset:9472
    v_mfma_f32_32x32x16_bf16 v[160:175], a[196:199], a[216:219], v[160:175]
    s_waitcnt vmcnt(5)
    ds_add_u32 v11, v9
    v_add_u32 v1, 43136, v1
    v_add_u32 v10, 43136, v10
    s_add_u32 m0, s59, 90752
    v_mfma_f32_32x32x16_bf16 v[176:191], a[196:199], a[220:223], v[176:191]
    buffer_load_dwordx4 v2, s[20:23], s64 offen offset:640 lds
    v_accvgpr_read_b32 v32, a96
    v_accvgpr_read_b32 v33, a97
    v_accvgpr_read_b32 v34, a98
    v_accvgpr_read_b32 v35, a99
    v_mul_f32 v36, v32, v32
    v_mfma_f32_32x32x16_bf16 v[176:191], a[192:195], a[188:191], v[176:191]
    v_mul_f32 v37, v33, v33
    v_mul_f32 v38, v34, v34
    v_mul_f32 v39, v35, v35
    v_fma_f32 v36, v36, s70, v5
    v_fma_f32 v37, v37, s70, v5
    v_fma_f32 v38, v38, s70, v5
    v_mfma_f32_32x32x16_bf16 v[160:175], a[192:195], a[184:187], v[160:175]
    s_add_u32 m0, s59, 91648
    ds_read_b32 v6, v11
    v_fma_f32 v39, v39, s70, v5
    v_mul_f32 v36, v36, v32
    v_mul_f32 v37, v37, v33
    v_mul_f32 v38, v38, v34
    v_mul_f32 v39, v39, v35
    v_exp_f32 v36, v36
    v_mfma_f32_32x32x16_bf16 v[144:159], a[192:195], a[180:183], v[144:159]
    buffer_load_dwordx4 v2, s[20:23], s64 offen offset:768 lds
    v_exp_f32 v37, v37
    v_exp_f32 v38, v38
    v_mfma_f32_32x32x16_bf16 v[128:143], a[192:195], a[176:179], v[128:143]
    s_waitcnt lgkmcnt(0)
    v_cmp_le_u32 vcc, 68, v6
    v_exp_f32 v39, v39
    v_add_f32 v36, 1.0, v36
    v_add_f32 v37, 1.0, v37
    v_add_f32 v38, 1.0, v38
    v_add_f32 v39, 1.0, v39
    v_mfma_f32_32x32x16_bf16 v[192:207], a[200:203], a[176:179], v[192:207]
    s_cbranch_vccz L_spin17
L_back17:
    ds_read_b128 a[176:179], v44 offset:8192
    ds_read_b64_tr_b16 a[240:241], v1 offset:0
    v_rcp_f32 v36, v36
    v_rcp_f32 v37, v37
    v_rcp_f32 v38, v38
    v_mfma_f32_32x32x16_bf16 v[208:223], a[200:203], a[180:183], v[208:223]
    v_cmp_gt_u32 vcc, 8, v15
    s_add_u32 m0, s59, 92544
    ds_read_b128 a[180:183], v44 offset:9216
    ds_read_b64_tr_b16 a[242:243], v1 offset:256
    v_rcp_f32 v39, v39
    v_mul_f32 v36, v36, v32
    v_mul_f32 v37, v37, v33
    v_mfma_f32_32x32x16_bf16 v[224:239], a[200:203], a[184:187], v[224:239]
    s_cbranch_vccnz L_spin10
L_back10:
    ds_read_b128 a[184:187], v4 offset:8192
    buffer_load_dwordx4 v2, s[20:23], s64 offen offset:896 lds
    v_mul_f32 v38, v38, v34
    v_mul_f32 v39, v39, v35
    v_cvt_pk_bf16_f32 v40, v36, v37
    v_cvt_pk_bf16_f32 v41, v38, v39
    v_mfma_f32_32x32x16_bf16 v[240:255], a[200:203], a[188:191], v[240:255]
    ds_read_b128 a[188:191], v4 offset:9216
    ds_read_b64_tr_b16 a[244:245], v1 offset:21568
    ds_write_b64 v3, v[40:41] offset:0
    v_accvgpr_read_b32 v32, a100
    v_mfma_f32_32x32x16_bf16 v[240:255], a[204:207], a[220:223], v[240:255]
    ds_read_b128 a[220:223], v4 offset:10240
    ds_read_b64_tr_b16 a[246:247], v1 offset:21824
    v_accvgpr_read_b32 v33, a101
    v_accvgpr_read_b32 v34, a102
    v_accvgpr_read_b32 v35, a103
    v_mul_f32 v36, v32, v32
    v_mul_f32 v37, v33, v33
    v_mfma_f32_32x32x16_bf16 v[224:239], a[204:207], a[216:219], v[224:239]
    s_add_u32 m0, s59, 93440
    ds_read_b128 a[216:219], v4 offset:11264
    v_mul_f32 v38, v34, v34
    v_mul_f32 v39, v35, v35
    v_fma_f32 v36, v36, s70, v5
    v_fma_f32 v37, v37, s70, v5
    v_fma_f32 v38, v38, s70, v5
    v_fma_f32 v39, v39, s70, v5
    v_mfma_f32_32x32x16_bf16 v[208:223], a[204:207], a[212:215], v[208:223]
    ds_read_b128 a[212:215], v44 offset:10240
    buffer_load_dwordx4 v2, s[20:23], s64 offen offset:1024 lds
    v_mul_f32 v36, v36, v32
    v_mul_f32 v37, v37, v33
    v_mul_f32 v38, v38, v34
    v_mfma_f32_32x32x16_bf16 v[192:207], a[204:207], a[208:211], v[192:207]
    s_waitcnt lgkmcnt(8)
    ds_read_b128 a[208:211], v44 offset:11264
    v_mul_f32 v39, v39, v35
    v_exp_f32 v36, v36
    v_exp_f32 v37, v37
    v_exp_f32 v38, v38
    v_mfma_f32_32x32x16_bf16 v[48:63], a[240:243], a[176:179], v[48:63]
    s_add_u32 s67, s72, 0
    ds_read_b64_tr_b16 a[196:197], v1 offset:22080
    v_exp_f32 v39, v39
    v_add_f32 v36, 1.0, v36
    v_add_f32 v37, 1.0, v37
    v_add_f32 v38, 1.0, v38
    v_mfma_f32_32x32x16_bf16 a[112:127], a[240:243], a[180:183], a[112:127]
    s_waitcnt lgkmcnt(8)
    ds_read_b64_tr_b16 a[198:199], v1 offset:22336
    s_add_u32 m0, s72, 0
    v_add_f32 v39, 1.0, v39
    v_rcp_f32 v36, v36
    v_rcp_f32 v37, v37
    v_mfma_f32_32x32x16_bf16 v[64:79], a[240:243], a[184:187], v[64:79]
    buffer_load_dwordx4 v7, s[28:31], s67 offen sc1 lds
    v_rcp_f32 v38, v38
    v_rcp_f32 v39, v39
    v_mfma_f32_32x32x16_bf16 a[128:143], a[240:243], a[188:191], a[128:143]
    s_waitcnt lgkmcnt(4)
    ds_read_b64_tr_b16 a[192:193], v1 offset:512
    v_mul_f32 v36, v36, v32
    v_mul_f32 v37, v37, v33
    v_mul_f32 v38, v38, v34
    v_mul_f32 v39, v39, v35
    v_cvt_pk_bf16_f32 v42, v36, v37
    v_cvt_pk_bf16_f32 v43, v38, v39
    v_mfma_f32_32x32x16_bf16 a[128:143], a[244:247], a[220:223], a[128:143]
    s_add_u32 s67, s72, 4096
    ds_read_b64_tr_b16 a[194:195], v1 offset:768
    ds_write_b64 v3, v[42:43] offset:256
    v_accvgpr_read_b32 v32, a104
    v_accvgpr_read_b32 v33, a105
    v_accvgpr_read_b32 v34, a106
    v_mfma_f32_32x32x16_bf16 v[64:79], a[244:247], a[216:219], v[64:79]
    s_waitcnt lgkmcnt(5)
    ds_read_b64_tr_b16 a[200:201], v10 offset:0
    s_add_u32 m0, s72, 4096
    v_accvgpr_read_b32 v35, a107
    v_mul_f32 v36, v32, v32
    v_mul_f32 v37, v33, v33
    v_mul_f32 v38, v34, v34
    v_mfma_f32_32x32x16_bf16 a[112:127], a[244:247], a[212:215], a[112:127]
    buffer_load_dwordx4 v7, s[28:31], s67 offen sc1 lds
    v_mul_f32 v39, v35, v35
    v_fma_f32 v36, v36, s70, v5
    v_fma_f32 v37, v37, s70, v5
    v_fma_f32 v38, v38, s70, v5
    v_fma_f32 v39, v39, s70, v5
    v_mfma_f32_32x32x16_bf16 v[48:63], a[244:247], a[208:211], v[48:63]
    s_waitcnt lgkmcnt(2)
    ds_read_b64_tr_b16 a[202:203], v10 offset:256
    v_mul_f32 v36, v36, v32
    v_mul_f32 v37, v37, v33
    v_mul_f32 v38, v38, v34
    v_mul_f32 v39, v39, v35
    v_exp_f32 v36, v36
    v_mfma_f32_32x32x16_bf16 v[80:95], a[196:199], a[208:211], v[80:95]
    s_add_u32 s67, s72, 8192
    ds_read_b64_tr_b16 a[204:205], v10 offset:21568
    v_exp_f32 v37, v37
    v_exp_f32 v38, v38
    v_exp_f32 v39, v39
    v_mfma_f32_32x32x16_bf16 a[144:159], a[196:199], a[212:215], a[144:159]
    s_add_u32 m0, s72, 8192
    ds_read_b64_tr_b16 a[206:207], v10 offset:21824
    v_add_f32 v36, 1.0, v36
    v_add_f32 v37, 1.0, v37
    v_add_f32 v38, 1.0, v38
    v_add_f32 v39, 1.0, v39
    v_rcp_f32 v36, v36
    v_mfma_f32_32x32x16_bf16 v[96:111], a[196:199], a[216:219], v[96:111]
    buffer_load_dwordx4 v7, s[28:31], s67 offen sc1 lds
    v_rcp_f32 v37, v37
    v_rcp_f32 v38, v38
    v_mfma_f32_32x32x16_bf16 a[160:175], a[196:199], a[220:223], a[160:175]
    ds_read_b64_tr_b16 a[244:245], v1 offset:22592
    v_rcp_f32 v39, v39
    v_mul_f32 v36, v36, v32
    v_mul_f32 v37, v37, v33
    v_mul_f32 v38, v38, v34
    v_mul_f32 v39, v39, v35
    v_mfma_f32_32x32x16_bf16 a[160:175], a[192:195], a[188:191], a[160:175]
    s_add_u32 s67, s72, 12288
    ds_read_b64_tr_b16 a[246:247], v1 offset:22848
    v_cvt_pk_bf16_f32 v40, v36, v37
    v_cvt_pk_bf16_f32 v41, v38, v39
    ds_write_b64 v3, v[40:41] offset:1024
    v_mfma_f32_32x32x16_bf16 v[96:111], a[192:195], a[184:187], v[96:111]
    s_add_u32 m0, s72, 12288
    ds_read_b64_tr_b16 a[240:241], v1 offset:1024
    v_accvgpr_read_b32 v32, a108
    v_accvgpr_read_b32 v33, a109
    v_accvgpr_read_b32 v34, a110
    v_accvgpr_read_b32 v35, a111
    v_mul_f32 v36, v32, v32
    v_mul_f32 v37, v33, v33
    v_mfma_f32_32x32x16_bf16 a[144:159], a[192:195], a[180:183], a[144:159]
    buffer_load_dwordx4 v7, s[28:31], s67 offen sc1 lds
    v_mul_f32 v38, v34, v34
    v_mul_f32 v39, v35, v35
    v_fma_f32 v36, v36, s70, v5
    v_fma_f32 v37, v37, s70, v5
    v_fma_f32 v38, v38, s70, v5
    v_mfma_f32_32x32x16_bf16 v[80:95], a[192:195], a[176:179], v[80:95]
    s_waitcnt lgkmcnt(4)
    ds_read_b64_tr_b16 a[242:243], v1 offset:1280
    v_fma_f32 v39, v39, s70, v5
    v_mul_f32 v36, v36, v32
    v_mul_f32 v37, v37, v33
    v_mul_f32 v38, v38, v34
    v_mul_f32 v39, v39, v35
    v_mfma_f32_32x32x16_bf16 v[112:127], a[200:203], a[176:179], v[112:127]
    s_add_u32 s67, s72, 16384
    ds_read_b64_tr_b16 a[192:193], v1 offset:1536
    v_exp_f32 v36, v36
    v_exp_f32 v37, v37
    v_exp_f32 v38, v38
    v_mfma_f32_32x32x16_bf16 v[16:31], a[200:203], a[180:183], v[16:31]
    s_add_u32 m0, s72, 16384
    ds_read_b64_tr_b16 a[194:195], v1 offset:1792
    v_exp_f32 v39, v39
    v_add_f32 v36, 1.0, v36
    v_add_f32 v37, 1.0, v37
    v_add_f32 v38, 1.0, v38
    v_add_f32 v39, 1.0, v39
    v_mfma_f32_32x32x16_bf16 v[16:31], a[204:207], a[212:215], v[16:31]
    buffer_load_dwordx4 v7, s[28:31], s67 offen sc1 lds
    v_rcp_f32 v36, v36
    v_rcp_f32 v37, v37
    v_mfma_f32_32x32x16_bf16 v[112:127], a[204:207], a[208:211], v[112:127]
    s_waitcnt lgkmcnt(2)
    ds_read_b64_tr_b16 a[196:197], v1 offset:23104
    v_rcp_f32 v38, v38
    v_rcp_f32 v39, v39
    v_mul_f32 v36, v36, v32
    v_mul_f32 v37, v37, v33
    v_mfma_f32_32x32x16_bf16 v[128:143], a[244:247], a[208:211], v[128:143]
    ds_read_b64_tr_b16 a[198:199], v1 offset:23360
    v_mul_f32 v38, v38, v34
    v_mul_f32 v39, v39, v35
    v_cvt_pk_bf16_f32 v42, v36, v37
    v_cvt_pk_bf16_f32 v43, v38, v39
    ds_write_b64 v3, v[42:43] offset:1280
    v_mfma_f32_32x32x16_bf16 v[144:159], a[244:247], a[212:215], v[144:159]
    s_cmp_eq_u32 s101, 0
    s_cbranch_scc1 L_noqt
    v_lshlrev_b32 v15, 3, v0
    s_mov_b32 exec_hi, 0
    buffer_load_dwordx2 a[224:225], v15, s[28:31], s19 offen sc1
    s_mov_b32 exec_hi, -1
L_noqt:
    v_mfma_f32_32x32x16_bf16 v[160:175], a[244:247], a[216:219], v[160:175]
    s_waitcnt vmcnt(5)
    ds_add_u32 v11, v9
    v_add_u32 v1, 43136, v1
    v_add_u32 v10, 43136, v10
    v_mfma_f32_32x32x16_bf16 v[176:191], a[244:247], a[220:223], v[176:191]
    v_lshlrev_b32 v2, 3, v0
    v_mov_b32 v3, v47
    v_mfma_f32_32x32x16_bf16 v[176:191], a[240:243], a[188:191], v[176:191]
    buffer_load_dword v8, v46, s[28:31], 0 offen sc1
    v_lshrrev_b32 v15, 5, v0
    v_mfma_f32_32x32x16_bf16 v[160:175], a[240:243], a[184:187], v[160:175]
    ds_read_b32 v6, v11
    v_lshl_add_u32 v5, v15, 9, v7
    v_mfma_f32_32x32x16_bf16 v[144:159], a[240:243], a[180:183], v[144:159]
    v_mov_b32 v15, 262144
    v_mfma_f32_32x32x16_bf16 v[128:143], a[240:243], a[176:179], v[128:143]
    s_waitcnt lgkmcnt(0)
    v_cmp_le_u32 vcc, 72, v6
    global_load_dword v8, v12, s[0:1]
    ds_read_b128 a[0:3], v15
    v_mfma_f32_32x32x16_bf16 v[192:207], a[192:195], a[176:179], v[192:207]
    s_cbranch_vccz L_spin18
L_back18:
    ds_read_b128 a[176:179], v44 offset:0
    ds_read_b64_tr_b16 a[200:201], v1 offset:0
    ds_read_b128 a[4:7], v15
    v_mfma_f32_32x32x16_bf16 v[192:207], a[196:199], a[208:211], v[192:207]
    ds_read_b128 a[208:211], v44 offset:3072
    ds_read_b64_tr_b16 a[202:203], v1 offset:256
    ds_read_b128 a[8:11], v15
    v_mfma_f32_32x32x16_bf16 v[208:223], a[196:199], a[212:215], v[208:223]
    ds_read_b128 a[212:215], v44 offset:2048
    ds_read_b128 a[12:15], v15
    ds_read_b128 a[16:19], v15
    v_mfma_f32_32x32x16_bf16 v[208:223], a[192:195], a[180:183], v[208:223]
    ds_read_b128 a[180:183], v44 offset:1024
    ds_read_b64_tr_b16 a[204:205], v1 offset:21568
    buffer_load_dword v8, v45, s[24:27], 0 offen
    v_mfma_f32_32x32x16_bf16 v[224:239], a[192:195], a[184:187], v[224:239]
    ds_read_b128 a[184:187], v4 offset:0
    ds_read_b64_tr_b16 a[206:207], v1 offset:21824
    ds_read_b128 a[20:23], v15
    v_mfma_f32_32x32x16_bf16 v[224:239], a[196:199], a[216:219], v[224:239]
    ds_read_b128 a[216:219], v4 offset:3072
    ds_read_b128 a[24:27], v15
    v_mfma_f32_32x32x16_bf16 v[240:255], a[196:199], a[220:223], v[240:255]
    s_add_u32 s67, s72, 18944
    ds_read_b128 a[220:223], v4 offset:2048
    ds_read_b128 a[28:31], v15
    s_mov_b32 s82, -1
    v_mfma_f32_32x32x16_bf16 v[240:255], a[192:195], a[188:191], v[240:255]
    s_waitcnt lgkmcnt(5)
    ds_read_b128 a[188:191], v4 offset:1024
    s_mov_b32 s83, 0
    v_mfma_f32_32x32x16_bf16 v[48:63], a[200:203], a[176:179], v[48:63]
    s_add_u32 m0, s72, 20480
    ds_read_b64_tr_b16 a[244:245], v1 offset:22080
    v_mfma_f32_32x32x16_bf16 v[48:63], a[204:207], a[208:211], v[48:63]
    s_waitcnt lgkmcnt(10)
    ds_read_b64_tr_b16 a[246:247], v1 offset:22336
    v_mfma_f32_32x32x16_bf16 a[112:127], a[204:207], a[212:215], a[112:127]
    buffer_load_dwordx4 v7, s[28:31], s67 offen sc1 lds
    v_sub_u32 v4, v5, v7
    v_mfma_f32_32x32x16_bf16 a[112:127], a[200:203], a[180:183], a[112:127]
    s_waitcnt lgkmcnt(6)
    ds_read_b64_tr_b16 a[240:241], v1 offset:512
    v_mfma_f32_32x32x16_bf16 v[64:79], a[200:203], a[184:187], v[64:79]
    s_add_u32 s67, s72, 23040
    ds_read_b64_tr_b16 a[242:243], v1 offset:768
    v_mfma_f32_32x32x16_bf16 v[64:79], a[204:207], a[216:219], v[64:79]
    s_waitcnt lgkmcnt(4)
    ds_read_b64_tr_b16 a[192:193], v10 offset:0
    s_add_u32 m0, s72, 24576
    v_cvt_pk_bf16_f32 v48, v48, v49
    v_cvt_pk_bf16_f32 v49, v50, v51
    v_cvt_pk_bf16_f32 v50, v52, v53
    v_cvt_pk_bf16_f32 v51, v54, v55
    v_cvt_pk_bf16_f32 v52, v56, v57
    v_mfma_f32_32x32x16_bf16 a[128:143], a[204:207], a[220:223], a[128:143]
    buffer_load_dwordx4 v7, s[28:31], s67 offen sc1 lds
    v_cvt_pk_bf16_f32 v53, v58, v59
    v_cvt_pk_bf16_f32 v54, v60, v61
    v_cvt_pk_bf16_f32 v55, v62, v63
    v_accvgpr_read_b32 v32, a112
    v_accvgpr_read_b32 v33, a113
    v_mfma_f32_32x32x16_bf16 a[128:143], a[200:203], a[188:191], a[128:143]
    s_waitcnt lgkmcnt(1)
    ds_read_b64_tr_b16 a[194:195], v10 offset:256
    v_accvgpr_read_b32 v34, a114
    v_accvgpr_read_b32 v35, a115
    v_accvgpr_read_b32 v36, a116
    v_accvgpr_read_b32 v37, a117
    v_accvgpr_read_b32 v38, a118
    v_accvgpr_read_b32 v39, a119
    v_mfma_f32_32x32x16_bf16 v[80:95], a[240:243], a[176:179], v[80:95]
    s_add_u32 s67, s72, 27136
    ds_read_b64_tr_b16 a[196:197], v10 offset:21568
    v_cvt_pk_bf16_f32 v56, v32, v33
    v_cvt_pk_bf16_f32 v57, v34, v35
    v_cvt_pk_bf16_f32 v58, v36, v37
    v_cvt_pk_bf16_f32 v59, v38, v39
    v_accvgpr_read_b32 v32, a120
    v_accvgpr_read_b32 v33, a121
    v_mfma_f32_32x32x16_bf16 v[80:95], a[244:247], a[208:211], v[80:95]
    s_add_u32 m0, s72, 28672
    ds_read_b64_tr_b16 a[198:199], v10 offset:21824
    v_accvgpr_read_b32 v34, a122
    v_accvgpr_read_b32 v35, a123
    v_accvgpr_read_b32 v36, a124
    v_accvgpr_read_b32 v37, a125
    v_accvgpr_read_b32 v38, a126
    v_accvgpr_read_b32 v39, a127
    v_mfma_f32_32x32x16_bf16 a[144:159], a[244:247], a[212:215], a[144:159]
    buffer_load_dwordx4 v7, s[28:31], s67 offen sc1 lds
    v_cvt_pk_bf16_f32 v60, v32, v33
    v_cvt_pk_bf16_f32 v61, v34, v35
    v_cvt_pk_bf16_f32 v62, v36, v37
    v_cvt_pk_bf16_f32 v63, v38, v39
    v_mfma_f32_32x32x16_bf16 a[144:159], a[240:243], a[180:183], a[144:159]
    ds_read_b64_tr_b16 a[204:205], v1 offset:22592
    v_cvt_pk_bf16_f32 v64, v64, v65
    v_cvt_pk_bf16_f32 v65, v66, v67
    v_cvt_pk_bf16_f32 v66, v68, v69
    v_cvt_pk_bf16_f32 v67, v70, v71
    v_cvt_pk_bf16_f32 v68, v72, v73
    v_cvt_pk_bf16_f32 v69, v74, v75
    v_mfma_f32_32x32x16_bf16 v[96:111], a[240:243], a[184:187], v[96:111]
    s_add_u32 s67, s72, 31232
    ds_read_b64_tr_b16 a[206:207], v1 offset:22848
    v_cvt_pk_bf16_f32 v70, v76, v77
    v_cvt_pk_bf16_f32 v71, v78, v79
    v_accvgpr_read_b32 v32, a128
    v_accvgpr_read_b32 v33, a129
    v_accvgpr_read_b32 v34, a130
    v_accvgpr_read_b32 v35, a131
    v_mfma_f32_32x32x16_bf16 v[96:111], a[244:247], a[216:219], v[96:111]
    s_add_u32 m0, s72, 32768
    ds_read_b64_tr_b16 a[200:201], v1 offset:1024
    v_accvgpr_read_b32 v36, a132
    v_accvgpr_read_b32 v37, a133
    v_accvgpr_read_b32 v38, a134
    v_accvgpr_read_b32 v39, a135
    v_cvt_pk_bf16_f32 v72, v32, v33
    v_cvt_pk_bf16_f32 v73, v34, v35
    v_mfma_f32_32x32x16_bf16 a[160:175], a[244:247], a[220:223], a[160:175]
    buffer_load_dwordx4 v7, s[28:31], s67 offen sc1 lds
    v_cvt_pk_bf16_f32 v74, v36, v37
    v_cvt_pk_bf16_f32 v75, v38, v39
    v_accvgpr_read_b32 v32, a136
    v_accvgpr_read_b32 v33, a137
    v_accvgpr_read_b32 v34, a138
    v_mfma_f32_32x32x16_bf16 a[160:175], a[240:243], a[188:191], a[160:175]
    s_waitcnt lgkmcnt(3)
    ds_read_b64_tr_b16 a[202:203], v1 offset:1280
    v_accvgpr_read_b32 v35, a139
    v_accvgpr_read_b32 v36, a140
    v_accvgpr_read_b32 v37, a141
    v_accvgpr_read_b32 v38, a142
    v_accvgpr_read_b32 v39, a143
    v_cvt_pk_bf16_f32 v76, v32, v33
    v_mfma_f32_32x32x16_bf16 v[112:127], a[192:195], a[176:179], v[112:127]
    s_add_u32 s67, s72, 35328
    ds_read_b64_tr_b16 a[240:241], v1 offset:1536
    v_cvt_pk_bf16_f32 v77, v34, v35
    v_cvt_pk_bf16_f32 v78, v36, v37
    v_cvt_pk_bf16_f32 v79, v38, v39
    v_cvt_pk_bf16_f32 v80, v80, v81
    v_cvt_pk_bf16_f32 v81, v82, v83
    v_cvt_pk_bf16_f32 v82, v84, v85
L_q7:
    s_cbranch_execz L_q11
    v_mfma_f32_32x32x16_bf16 v[112:127], a[196:199], a[208:211], v[112:127]
    s_add_u32 m0, s72, 36864
    ds_read_b64_tr_b16 a[242:243], v1 offset:1792
    v_cvt_pk_bf16_f32 v83, v86, v87
    v_cvt_pk_bf16_f32 v84, v88, v89
    v_cvt_pk_bf16_f32 v85, v90, v91
    v_cvt_pk_bf16_f32 v86, v92, v93
    v_cvt_pk_bf16_f32 v87, v94, v95
    v_accvgpr_read_b32 v32, a144
    v_mfma_f32_32x32x16_bf16 v[16:31], a[196:199], a[212:215], v[16:31]
    buffer_load_dwordx4 v7, s[28:31], s67 offen sc1 lds
    v_accvgpr_read_b32 v33, a145
    v_accvgpr_read_b32 v34, a146
    v_accvgpr_read_b32 v35, a147
    v_accvgpr_read_b32 v36, a148
    v_accvgpr_read_b32 v37, a149
    v_mfma_f32_32x32x16_bf16 v[16:31], a[192:195], a[180:183], v[16:31]
    s_waitcnt lgkmcnt(2)
    ds_read_b64_tr_b16 a[244:245], v1 offset:23104
    v_accvgpr_read_b32 v38, a150
    v_accvgpr_read_b32 v39, a151
    v_cvt_pk_bf16_f32 v88, v32, v33
    v_cvt_pk_bf16_f32 v89, v34, v35
    v_cvt_pk_bf16_f32 v90, v36, v37
    v_cvt_pk_bf16_f32 v91, v38, v39
    v_mfma_f32_32x32x16_bf16 v[128:143], a[200:203], a[176:179], v[128:143]
    ds_read_b64_tr_b16 a[246:247], v1 offset:23360
    v_accvgpr_read_b32 v32, a152
    v_accvgpr_read_b32 v33, a153
    v_accvgpr_read_b32 v34, a154
    v_accvgpr_read_b32 v35, a155
    v_accvgpr_read_b32 v36, a156
    v_mfma_f32_32x32x16_bf16 v[128:143], a[204:207], a[208:211], v[128:143]
    v_accvgpr_read_b32 v37, a157
    v_accvgpr_read_b32 v38, a158
    v_accvgpr_read_b32 v39, a159
    v_cvt_pk_bf16_f32 v92, v32, v33
    v_cvt_pk_bf16_f32 v93, v34, v35
    v_cvt_pk_bf16_f32 v94, v36, v37
    v_cvt_pk_bf16_f32 v95, v38, v39
    v_mfma_f32_32x32x16_bf16 v[144:159], a[204:207], a[212:215], v[144:159]
    s_waitcnt vmcnt(8)
    ds_add_u32 v11, v9
    v_cvt_pk_bf16_f32 v96, v96, v97
    v_cvt_pk_bf16_f32 v97, v98, v99
    v_cvt_pk_bf16_f32 v98, v100, v101
    v_cvt_pk_bf16_f32 v99, v102, v103
    v_cvt_pk_bf16_f32 v100, v104, v105
    v_cvt_pk_bf16_f32 v101, v106, v107
    v_mfma_f32_32x32x16_bf16 v[144:159], a[200:203], a[180:183], v[144:159]
    v_cvt_pk_bf16_f32 v102, v108, v109
    v_cvt_pk_bf16_f32 v103, v110, v111
    v_accvgpr_read_b32 v32, a160
    v_accvgpr_read_b32 v33, a161
    v_accvgpr_read_b32 v34, a162
    v_accvgpr_read_b32 v35, a163
    v_accvgpr_read_b32 v36, a164
    v_mfma_f32_32x32x16_bf16 v[160:175], a[200:203], a[184:187], v[160:175]
    v_accvgpr_read_b32 v37, a165
    v_accvgpr_read_b32 v38, a166
    v_accvgpr_read_b32 v39, a167
    v_cvt_pk_bf16_f32 v104, v32, v33
    v_cvt_pk_bf16_f32 v105, v34, v35
    v_cvt_pk_bf16_f32 v106, v36, v37
    v_cvt_pk_bf16_f32 v107, v38, v39
    v_mfma_f32_32x32x16_bf16 v[160:175], a[204:207], a[216:219], v[160:175]
    ds_read_b32 v6, v11
    v_accvgpr_read_b32 v32, a168
    v_accvgpr_read_b32 v33, a169
    v_accvgpr_read_b32 v34, a170
    v_accvgpr_read_b32 v35, a171
    v_accvgpr_read_b32 v36, a172
    v_accvgpr_read_b32 v37, a173
    v_mfma_f32_32x32x16_bf16 v[176:191], a[204:207], a[220:223], v[176:191]
    v_accvgpr_read_b32 v38, a174
    v_accvgpr_read_b32 v39, a175
    v_cvt_pk_bf16_f32 v108, v32, v33
    v_cvt_pk_bf16_f32 v109, v34, v35
    v_cvt_pk_bf16_f32 v110, v36, v37
    v_cvt_pk_bf16_f32 v111, v38, v39
    v_cvt_pk_bf16_f32 v112, v112, v113
    v_mfma_f32_32x32x16_bf16 v[176:191], a[200:203], a[188:191], v[176:191]
    s_waitcnt lgkmcnt(0)
    v_cmp_le_u32 vcc, 76, v6
    v_cvt_pk_bf16_f32 v113, v114, v115
    v_cvt_pk_bf16_f32 v114, v116, v117
    v_cvt_pk_bf16_f32 v115, v118, v119
    v_cvt_pk_bf16_f32 v116, v120, v121
    v_cvt_pk_bf16_f32 v117, v122, v123
    v_cvt_pk_bf16_f32 v118, v124, v125
    v_mfma_f32_32x32x16_bf16 v[192:207], a[240:243], a[176:179], v[192:207]
    s_cbranch_vccz L_spin19
L_back19:
    ds_read_b128 v[44:47], v4
    ds_read_b64 v[42:43], v4 offset:4096
    v_cvt_pk_bf16_f32 v119, v126, v127
    v_cvt_pk_bf16_f32 v120, v16, v17
    v_cvt_pk_bf16_f32 v121, v18, v19
    v_cvt_pk_bf16_f32 v122, v20, v21
    v_cvt_pk_bf16_f32 v123, v22, v23
    v_mfma_f32_32x32x16_bf16 v[192:207], a[244:247], a[208:211], v[192:207]
    ds_read_b128 a[32:35], v7 offset:0
    ds_read_b64 a[40:41], v2 offset:4096
    v_cvt_pk_bf16_f32 v124, v24, v25
    v_cvt_pk_bf16_f32 v125, v26, v27
    v_cvt_pk_bf16_f32 v126, v28, v29
    v_cvt_pk_bf16_f32 v127, v30, v31
    v_cvt_pk_bf16_f32 v128, v128, v129
    v_mfma_f32_32x32x16_bf16 v[208:223], a[244:247], a[212:215], v[208:223]
    ds_read_b128 a[44:47], v3 offset:4608
    ds_read_b128 a[48:51], v3 offset:5216
    v_cvt_pk_bf16_f32 v129, v130, v131
    v_cvt_pk_bf16_f32 v130, v132, v133
    v_cvt_pk_bf16_f32 v131, v134, v135
    v_cvt_pk_bf16_f32 v132, v136, v137
    v_mfma_f32_32x32x16_bf16 v[208:223], a[240:243], a[180:183], v[208:223]
    v_cvt_pk_bf16_f32 v133, v138, v139
    v_cvt_pk_bf16_f32 v134, v140, v141
    v_cvt_pk_bf16_f32 v135, v142, v143
    v_cvt_pk_bf16_f32 v136, v144, v145
    v_cvt_pk_bf16_f32 v137, v146, v147
    v_cvt_pk_bf16_f32 v138, v148, v149
    v_cvt_pk_bf16_f32 v139, v150, v151
    v_mfma_f32_32x32x16_bf16 v[224:239], a[240:243], a[184:187], v[224:239]
    v_cvt_pk_bf16_f32 v140, v152, v153
    v_cvt_pk_bf16_f32 v141, v154, v155
    v_cvt_pk_bf16_f32 v142, v156, v157
    v_cvt_pk_bf16_f32 v143, v158, v159
    v_cvt_pk_bf16_f32 v144, v160, v161
    v_cvt_pk_bf16_f32 v145, v162, v163
    v_cvt_pk_bf16_f32 v146, v164, v165
    v_mfma_f32_32x32x16_bf16 v[224:239], a[244:247], a[216:219], v[224:239]
    v_cvt_pk_bf16_f32 v147, v166, v167
    v_cvt_pk_bf16_f32 v148, v168, v169
    v_cvt_pk_bf16_f32 v149, v170, v171
    v_cvt_pk_bf16_f32 v150, v172, v173
    v_cvt_pk_bf16_f32 v151, v174, v175
    v_cvt_pk_bf16_f32 v152, v176, v177
    v_cvt_pk_bf16_f32 v153, v178, v179
    v_mfma_f32_32x32x16_bf16 v[240:255], a[244:247], a[220:223], v[240:255]
    v_cvt_pk_bf16_f32 v154, v180, v181
    v_cvt_pk_bf16_f32 v155, v182, v183
    v_cvt_pk_bf16_f32 v156, v184, v185
    v_cvt_pk_bf16_f32 v157, v186, v187
    v_cvt_pk_bf16_f32 v158, v188, v189
    v_cvt_pk_bf16_f32 v159, v190, v191
    v_cvt_pk_bf16_f32 v160, v192, v193
    v_mfma_f32_32x32x16_bf16 v[240:255], a[240:243], a[188:191], v[240:255]
    v_cvt_pk_bf16_f32 v161, v194, v195
    v_cvt_pk_bf16_f32 v162, v196, v197
    v_cvt_pk_bf16_f32 v163, v198, v199
    v_cvt_pk_bf16_f32 v164, v200, v201
    v_cvt_pk_bf16_f32 v165, v202, v203
    v_cvt_pk_bf16_f32 v166, v204, v205
    v_cvt_pk_bf16_f32 v167, v206, v207
    s_waitcnt lgkmcnt(0)
    v_xor_b32 v44, 0x80008000, v44
    v_xor_b32 v45, 0x80008000, v45
    v_xor_b32 v46, 0x80008000, v46
    v_xor_b32 v47, 0x80008000, v47
    v_xor_b32 v42, 0x80008000, v42
    v_mov_b32 v43, 0xc1d0
    v_accvgpr_read_b32 v15, a232
    v_mov_b32 v33, 0x3f80
    v_cndmask_b32 v32, 0, v15, s[82:83]
    v_mfma_f32_32x32x16_bf16 v[16:31], v[44:47], a[224:227], 0
    v_mov_b32 v34, 0
    v_mov_b32 v37, 0
    v_mov_b32 v38, 0
    v_cndmask_b32 v35, 0, v15, s[82:83]
    v_cndmask_b32 v36, v15, 0, s[82:83]
    v_cndmask_b32 v39, v15, 0, s[82:83]
    v_mfma_f32_32x32x8_bf16 v[16:31], v[42:43], v[32:33], v[16:31]
    v_mov_b32 v33, 0
    v_cvt_pk_bf16_f32 v168, v208, v209
    v_cvt_pk_bf16_f32 v169, v210, v211
    v_cvt_pk_bf16_f32 v170, v212, v213
    v_cvt_pk_bf16_f32 v171, v214, v215
    v_cvt_pk_bf16_f32 v172, v216, v217
    v_cvt_pk_bf16_f32 v173, v218, v219
    v_cvt_pk_bf16_f32 v174, v220, v221
    v_cvt_pk_bf16_f32 v175, v222, v223
    v_mfma_f32_32x32x16_bf16 v[192:207], a[32:35], a[224:227], v[16:31]
    v_cvt_pk_bf16_f32 v176, v224, v225
    v_cvt_pk_bf16_f32 v177, v226, v227
    v_cvt_pk_bf16_f32 v178, v228, v229
    v_cvt_pk_bf16_f32 v179, v230, v231
    v_cvt_pk_bf16_f32 v180, v232, v233
    v_cvt_pk_bf16_f32 v181, v234, v235
    v_cvt_pk_bf16_f32 v182, v236, v237
    v_cvt_pk_bf16_f32 v183, v238, v239
    v_mfma_f32_32x32x8_bf16 v[192:207], a[40:41], v[32:33], v[192:207]
    v_accvgpr_read_b32 v1, a233
    v_mov_b32 v41, 0x3f80
    v_cndmask_b32 v40, 0, v1, s[82:83]
    v_cvt_pk_bf16_f32 v184, v240, v241
    v_cvt_pk_bf16_f32 v185, v242, v243
    v_cvt_pk_bf16_f32 v186, v244, v245
    v_cvt_pk_bf16_f32 v187, v246, v247
    v_cvt_pk_bf16_f32 v188, v248, v249
    v_cvt_pk_bf16_f32 v189, v250, v251
    v_cvt_pk_bf16_f32 v190, v252, v253
    v_cvt_pk_bf16_f32 v191, v254, v255
    v_mfma_f32_32x32x16_bf16 v[240:255], v[44:47], a[228:231], 0
    v_mfma_f32_32x32x8_bf16 v[240:255], v[42:43], v[40:41], v[240:255]
    v_mov_b32 v41, 0
    v_mov_b32 v42, 0
    v_mov_b32 v45, 0
    v_mov_b32 v46, 0
    v_cndmask_b32 v43, 0, v1, s[82:83]
    v_cndmask_b32 v44, v1, 0, s[82:83]
    v_cndmask_b32 v47, v1, 0, s[82:83]
    v_mfma_f32_32x32x16_bf16 v[208:223], a[32:35], a[228:231], v[240:255]
    s_add_u32 s67, s72, 37888
    ds_read_b128 a[36:39], v7 offset:1024
    v_exp_f32 v192, v192
    v_exp_f32 v193, v193
    v_exp_f32 v194, v194
    v_exp_f32 v195, v195
    v_mfma_f32_32x32x8_bf16 v[208:223], a[40:41], v[40:41], v[208:223]
    v_exp_f32 v196, v196
    v_exp_f32 v197, v197
    v_exp_f32 v198, v198
    v_exp_f32 v199, v199
    ds_read_b128 a[52:55], v3 offset:5824
    ds_read_b128 a[56:59], v3 offset:6432
    v_exp_f32 v200, v200
    v_exp_f32 v201, v201
    v_exp_f32 v202, v202
    v_exp_f32 v203, v203
    v_smfmac_f32_32x32x32_bf16 a[0:15], a[44:47], v[192:199], v13
    s_waitcnt lgkmcnt(2)
    s_add_u32 s77, s36, 0
    v_exp_f32 v204, v204
    v_exp_f32 v205, v205
    v_exp_f32 v206, v206
    v_exp_f32 v207, v207
    v_mfma_f32_32x32x16_bf16 v[224:239], a[36:39], a[224:227], v[16:31]
    s_add_u32 m0, s72, 40960
    buffer_store_dwordx4 v[48:51], v5, s[28:31], s77 offen offset:0 sc1
    v_exp_f32 v208, v208
    v_exp_f32 v209, v209
    v_exp_f32 v210, v210
    v_exp_f32 v211, v211
    v_mfma_f32_32x32x8_bf16 v[224:239], a[40:41], v[34:35], v[224:239]
    v_exp_f32 v212, v212
    v_exp_f32 v213, v213
    v_exp_f32 v214, v214
    v_exp_f32 v215, v215
    v_smfmac_f32_32x32x32_bf16 a[0:15], a[48:51], v[200:207], v13
    buffer_load_dwordx4 v7, s[28:31], s67 offen sc1 lds
    v_exp_f32 v216, v216
    v_exp_f32 v217, v217
    v_exp_f32 v218, v218
    v_exp_f32 v219, v219
    v_smfmac_f32_32x32x32_bf16 a[16:31], a[44:47], v[208:215], v13
    s_waitcnt lgkmcnt(0)
    v_exp_f32 v220, v220
    v_exp_f32 v221, v221
    v_exp_f32 v222, v222
    v_exp_f32 v223, v223
    v_mfma_f32_32x32x16_bf16 v[192:207], a[36:39], a[228:231], v[240:255]
    ds_read_b128 a[32:35], v7 offset:2048
    v_exp_f32 v224, v224
    v_exp_f32 v225, v225
    v_exp_f32 v226, v226
    v_exp_f32 v227, v227
    v_mfma_f32_32x32x8_bf16 v[192:207], a[40:41], v[42:43], v[192:207]
    v_exp_f32 v228, v228
    v_exp_f32 v229, v229
    v_exp_f32 v230, v230
    v_exp_f32 v231, v231
    v_smfmac_f32_32x32x32_bf16 a[16:31], a[48:51], v[216:223], v13
    ds_read_b128 a[44:47], v3 offset:7040
    ds_read_b128 a[48:51], v3 offset:7648
    buffer_store_dwordx4 v[56:59], v5, s[28:31], s77 offen offset:512 sc1
    v_exp_f32 v232, v232
    v_exp_f32 v233, v233
    v_exp_f32 v234, v234
    v_exp_f32 v235, v235
    v_smfmac_f32_32x32x32_bf16 a[0:15], a[52:55], v[224:231], v13
    s_waitcnt lgkmcnt(2)
    s_add_u32 s67, s72, 41984
    v_exp_f32 v236, v236
    v_exp_f32 v237, v237
    v_exp_f32 v238, v238
    v_exp_f32 v239, v239
    v_mfma_f32_32x32x16_bf16 v[208:223], a[32:35], a[224:227], v[16:31]
    s_add_u32 m0, s72, 45056
    v_exp_f32 v192, v192
    v_exp_f32 v193, v193
    v_exp_f32 v194, v194
    v_exp_f32 v195, v195
    v_mfma_f32_32x32x8_bf16 v[208:223], a[40:41], v[36:37], v[208:223]
    v_exp_f32 v196, v196
    v_exp_f32 v197, v197
    v_exp_f32 v198, v198
    v_exp_f32 v199, v199
    v_smfmac_f32_32x32x32_bf16 a[0:15], a[56:59], v[232:239], v13
    buffer_load_dwordx4 v7, s[28:31], s67 offen sc1 lds
    v_exp_f32 v200, v200
    v_exp_f32 v201, v201
    v_exp_f32 v202, v202
    v_exp_f32 v203, v203
    v_smfmac_f32_32x32x32_bf16 a[16:31], a[52:55], v[192:199], v13
    s_waitcnt lgkmcnt(0)
    v_exp_f32 v204, v204
    v_exp_f32 v205, v205
    v_exp_f32 v206, v206
    v_exp_f32 v207, v207
    v_mfma_f32_32x32x16_bf16 v[224:239], a[32:35], a[228:231], v[240:255]
    ds_read_b128 a[36:39], v7 offset:3072
    v_exp_f32 v208, v208
    v_exp_f32 v209, v209
    v_exp_f32 v210, v210
    v_exp_f32 v211, v211
    v_mfma_f32_32x32x8_bf16 v[224:239], a[40:41], v[44:45], v[224:239]
    v_exp_f32 v212, v212
    v_exp_f32 v213, v213
    v_exp_f32 v214, v214
    v_exp_f32 v215, v215
    v_smfmac_f32_32x32x32_bf16 a[16:31], a[56:59], v[200:207], v13
    ds_read_b128 a[52:55], v3 offset:8256
    ds_read_b128 a[56:59], v3 offset:8864
    buffer_store_dwordx4 v[52:55], v5, s[28:31], s77 offen offset:2048 sc1
    v_exp_f32 v216, v216
    v_exp_f32 v217, v217
    v_exp_f32 v218, v218
    v_exp_f32 v219, v219
    v_smfmac_f32_32x32x32_bf16 a[0:15], a[44:47], v[208:215], v13
    s_waitcnt lgkmcnt(2)
    s_add_u32 s67, s72, 46080
    v_exp_f32 v220, v220
    v_exp_f32 v221, v221
    v_exp_f32 v222, v222
    v_exp_f32 v223, v223
    v_mfma_f32_32x32x16_bf16 v[192:207], a[36:39], a[224:227], v[16:31]
    s_add_u32 m0, s72, 49152
    v_exp_f32 v224, v224
    v_exp_f32 v225, v225
    v_exp_f32 v226, v226
    v_exp_f32 v227, v227
    v_mfma_f32_32x32x8_bf16 v[192:207], a[40:41], v[38:39], v[192:207]
    v_exp_f32 v228, v228
    v_exp_f32 v229, v229
    v_exp_f32 v230, v230
    v_exp_f32 v231, v231
    v_smfmac_f32_32x32x32_bf16 a[0:15], a[48:51], v[216:223], v13
    buffer_load_dwordx4 v7, s[28:31], s67 offen sc1 lds
    v_exp_f32 v232, v232
    v_exp_f32 v233, v233
    v_exp_f32 v234, v234
    v_exp_f32 v235, v235
    v_smfmac_f32_32x32x32_bf16 a[16:31], a[44:47], v[224:231], v13
    s_waitcnt lgkmcnt(0)
    v_exp_f32 v236, v236
    v_exp_f32 v237, v237
    v_exp_f32 v238, v238
    v_exp_f32 v239, v239
    v_mfma_f32_32x32x16_bf16 v[208:223], a[36:39], a[228:231], v[240:255]
    ds_read_b128 a[32:35], v7 offset:9472
    ds_read_b64 a[42:43], v2 offset:13568
    v_exp_f32 v192, v192
    v_exp_f32 v193, v193
    v_exp_f32 v194, v194
    v_exp_f32 v195, v195
    v_mfma_f32_32x32x8_bf16 v[208:223], a[40:41], v[46:47], v[208:223]
    v_exp_f32 v196, v196
    v_exp_f32 v197, v197
    v_exp_f32 v198, v198
    v_exp_f32 v199, v199
    v_smfmac_f32_32x32x32_bf16 a[16:31], a[48:51], v[232:239], v13
    ds_read_b128 a[44:47], v3 offset:14080
    ds_read_b128 a[48:51], v3 offset:14688
    buffer_store_dwordx4 v[60:63], v5, s[28:31], s77 offen offset:2560 sc1
    v_exp_f32 v200, v200
    v_exp_f32 v201, v201
    v_exp_f32 v202, v202
    v_exp_f32 v203, v203
    v_smfmac_f32_32x32x32_bf16 a[0:15], a[52:55], v[192:199], v13
    s_waitcnt lgkmcnt(2)
    s_add_u32 s67, s72, 50176
    v_exp_f32 v204, v204
    v_exp_f32 v205, v205
    v_exp_f32 v206, v206
    v_exp_f32 v207, v207
    v_mfma_f32_32x32x16_bf16 v[224:239], a[32:35], a[224:227], v[16:31]
    s_add_u32 m0, s72, 53248
    v_exp_f32 v208, v208
    v_exp_f32 v209, v209
    v_exp_f32 v210, v210
    v_exp_f32 v211, v211
    v_mfma_f32_32x32x8_bf16 v[224:239], a[42:43], v[32:33], v[224:239]
    v_exp_f32 v212, v212
    v_exp_f32 v213, v213
    v_exp_f32 v214, v214
    v_exp_f32 v215, v215
    v_smfmac_f32_32x32x32_bf16 a[0:15], a[56:59], v[200:207], v13
    buffer_load_dwordx4 v7, s[28:31], s67 offen sc1 lds
    v_exp_f32 v216, v216
    v_exp_f32 v217, v217
    v_exp_f32 v218, v218
    v_exp_f32 v219, v219
    v_smfmac_f32_32x32x32_bf16 a[16:31], a[52:55], v[208:215], v13
    s_waitcnt lgkmcnt(0)
    v_exp_f32 v220, v220
    v_exp_f32 v221, v221
    v_exp_f32 v222, v222
    v_exp_f32 v223, v223
    v_mfma_f32_32x32x16_bf16 v[192:207], a[32:35], a[228:231], v[240:255]
    s_add_u32 s77, s36, 8192
    ds_read_b128 a[36:39], v7 offset:10496
    v_exp_f32 v224, v224
    v_exp_f32 v225, v225
    v_exp_f32 v226, v226
    v_exp_f32 v227, v227
    v_mfma_f32_32x32x8_bf16 v[192:207], a[42:43], v[40:41], v[192:207]
    v_exp_f32 v228, v228
    v_exp_f32 v229, v229
    v_exp_f32 v230, v230
    v_exp_f32 v231, v231
    v_smfmac_f32_32x32x32_bf16 a[16:31], a[56:59], v[216:223], v13
    ds_read_b128 a[52:55], v3 offset:15296
    ds_read_b128 a[56:59], v3 offset:15904
    buffer_store_dwordx4 v[128:131], v5, s[28:31], s77 offen offset:0 sc1
    v_exp_f32 v232, v232
    v_exp_f32 v233, v233
    v_exp_f32 v234, v234
    v_exp_f32 v235, v235
    v_smfmac_f32_32x32x32_bf16 a[0:15], a[44:47], v[224:231], v13
    s_waitcnt lgkmcnt(2)
    s_add_u32 s67, s72, 54272
    v_exp_f32 v236, v236
    v_exp_f32 v237, v237
    v_exp_f32 v238, v238
    v_exp_f32 v239, v239
    v_mfma_f32_32x32x16_bf16 v[208:223], a[36:39], a[224:227], v[16:31]
    s_add_u32 m0, s72, 57344
    buffer_store_dwordx4 v[136:139], v5, s[28:31], s77 offen offset:512 sc1
    v_exp_f32 v192, v192
    v_exp_f32 v193, v193
    v_exp_f32 v194, v194
    v_exp_f32 v195, v195
    v_mfma_f32_32x32x8_bf16 v[208:223], a[42:43], v[34:35], v[208:223]
    v_exp_f32 v196, v196
    v_exp_f32 v197, v197
    v_exp_f32 v198, v198
    v_exp_f32 v199, v199
    v_smfmac_f32_32x32x32_bf16 a[0:15], a[48:51], v[232:239], v13
    buffer_load_dwordx4 v7, s[28:31], s67 offen sc1 lds
    v_exp_f32 v200, v200
    v_exp_f32 v201, v201
    v_exp_f32 v202, v202
    v_exp_f32 v203, v203
    v_smfmac_f32_32x32x32_bf16 a[16:31], a[44:47], v[192:199], v13
    s_waitcnt lgkmcnt(0)
    v_exp_f32 v204, v204
    v_exp_f32 v205, v205
    v_exp_f32 v206, v206
    v_exp_f32 v207, v207
    v_mfma_f32_32x32x16_bf16 v[224:239], a[36:39], a[228:231], v[240:255]
    ds_read_b128 a[32:35], v7 offset:11520
    v_exp_f32 v208, v208
    v_exp_f32 v209, v209
    v_exp_f32 v210, v210
    v_exp_f32 v211, v211
    v_mfma_f32_32x32x8_bf16 v[224:239], a[42:43], v[42:43], v[224:239]
    v_exp_f32 v212, v212
    v_exp_f32 v213, v213
    v_exp_f32 v214, v214
    v_exp_f32 v215, v215
    v_smfmac_f32_32x32x32_bf16 a[16:31], a[48:51], v[200:207], v13
    ds_read_b128 a[44:47], v3 offset:16512
    ds_read_b128 a[48:51], v3 offset:17120
    buffer_store_dwordx4 v[132:135], v5, s[28:31], s77 offen offset:2048 sc1
    v_exp_f32 v216, v216
    v_exp_f32 v217, v217
    v_exp_f32 v218, v218
    v_exp_f32 v219, v219
    v_smfmac_f32_32x32x32_bf16 a[0:15], a[52:55], v[208:215], v13
    s_waitcnt lgkmcnt(2)
    v_exp_f32 v220, v220
    v_exp_f32 v221, v221
    v_exp_f32 v222, v222
    v_exp_f32 v223, v223
    v_mfma_f32_32x32x16_bf16 v[192:207], a[32:35], a[224:227], v[16:31]
    v_exp_f32 v224, v224
    v_exp_f32 v225, v225
    v_exp_f32 v226, v226
    v_exp_f32 v227, v227
    v_mfma_f32_32x32x8_bf16 v[192:207], a[42:43], v[36:37], v[192:207]
    v_exp_f32 v228, v228
    v_exp_f32 v229, v229
    v_exp_f32 v230, v230
    v_exp_f32 v231, v231
    v_smfmac_f32_32x32x32_bf16 a[0:15], a[56:59], v[216:223], v13
    v_exp_f32 v232, v232
    v_exp_f32 v233, v233
    v_exp_f32 v234, v234
    v_exp_f32 v235, v235
    v_smfmac_f32_32x32x32_bf16 a[16:31], a[52:55], v[224:231], v13
    s_waitcnt lgkmcnt(0)
    v_exp_f32 v236, v236
    v_exp_f32 v237, v237
    v_exp_f32 v238, v238
    v_exp_f32 v239, v239
    v_mfma_f32_32x32x16_bf16 v[208:223], a[32:35], a[228:231], v[240:255]
    ds_read_b128 a[36:39], v7 offset:12544
    v_exp_f32 v192, v192
    v_exp_f32 v193, v193
    v_exp_f32 v194, v194
    v_exp_f32 v195, v195
    v_mfma_f32_32x32x8_bf16 v[208:223], a[42:43], v[44:45], v[208:223]
    v_exp_f32 v196, v196
    v_exp_f32 v197, v197
    v_exp_f32 v198, v198
    v_exp_f32 v199, v199
    v_smfmac_f32_32x32x32_bf16 a[16:31], a[56:59], v[232:239], v13
    ds_read_b128 a[52:55], v3 offset:17728
    ds_read_b128 a[56:59], v3 offset:18336
    buffer_store_dwordx4 v[140:143], v5, s[28:31], s77 offen offset:2560 sc1
    v_exp_f32 v200, v200
    v_exp_f32 v201, v201
    v_exp_f32 v202, v202
    v_exp_f32 v203, v203
    v_smfmac_f32_32x32x32_bf16 a[0:15], a[44:47], v[192:199], v13
    s_waitcnt vmcnt(13) lgkmcnt(2)
    ds_add_u32 v11, v9
    v_exp_f32 v204, v204
    v_exp_f32 v205, v205
    v_exp_f32 v206, v206
    v_exp_f32 v207, v207
    v_mfma_f32_32x32x16_bf16 v[224:239], a[36:39], a[224:227], v[16:31]
    v_exp_f32 v208, v208
    v_exp_f32 v209, v209
    v_exp_f32 v210, v210
    v_exp_f32 v211, v211
    v_mfma_f32_32x32x8_bf16 v[224:239], a[42:43], v[38:39], v[224:239]
    ds_read_b32 v6, v11
    v_exp_f32 v212, v212
    v_exp_f32 v213, v213
    v_exp_f32 v214, v214
    v_exp_f32 v215, v215
    v_smfmac_f32_32x32x32_bf16 a[0:15], a[48:51], v[200:207], v13
    v_exp_f32 v216, v216
    v_exp_f32 v217, v217
    v_exp_f32 v218, v218
    v_exp_f32 v219, v219
    v_smfmac_f32_32x32x32_bf16 a[16:31], a[44:47], v[208:215], v13
    s_waitcnt lgkmcnt(0)
    s_add_u32 s77, s36, 12288
    v_cmp_le_u32 vcc, 80, v6
    v_exp_f32 v220, v220
    v_exp_f32 v221, v221
    v_exp_f32 v222, v222
    v_exp_f32 v223, v223
    v_mfma_f32_32x32x16_bf16 v[192:207], a[36:39], a[228:231], v[240:255]
    s_cbranch_vccz L_spin22
L_back22:
    ds_read_b128 a[32:35], v7 offset:20480
    ds_read_b64 a[40:41], v2 offset:24576
    v_exp_f32 v224, v224
    v_exp_f32 v225, v225
    v_exp_f32 v226, v226
    v_exp_f32 v227, v227
    v_mfma_f32_32x32x8_bf16 v[192:207], a[42:43], v[46:47], v[192:207]
    v_exp_f32 v228, v228
    v_exp_f32 v229, v229
    v_exp_f32 v230, v230
    v_exp_f32 v231, v231
    v_smfmac_f32_32x32x32_bf16 a[16:31], a[48:51], v[216:223], v13
    ds_read_b128 a[44:47], v3 offset:25088
    ds_read_b128 a[48:51], v3 offset:25696
    buffer_store_dwordx4 v[160:163], v5, s[28:31], s77 offen offset:0 sc1
    v_exp_f32 v232, v232
    v_exp_f32 v233, v233
    v_exp_f32 v234, v234
    v_exp_f32 v235, v235
    v_smfmac_f32_32x32x32_bf16 a[0:15], a[52:55], v[224:231], v13
    s_waitcnt lgkmcnt(2)
    v_exp_f32 v236, v236
    v_exp_f32 v237, v237
    v_exp_f32 v238, v238
    v_exp_f32 v239, v239
    v_mfma_f32_32x32x16_bf16 v[208:223], a[32:35], a[224:227], v[16:31]
    v_exp_f32 v192, v192
    v_exp_f32 v193, v193
    v_exp_f32 v194, v194
    v_exp_f32 v195, v195
    v_mfma_f32_32x32x8_bf16 v[208:223], a[40:41], v[32:33], v[208:223]
    v_exp_f32 v196, v196
    v_exp_f32 v197, v197
    v_exp_f32 v198, v198
    v_exp_f32 v199, v199
    v_smfmac_f32_32x32x32_bf16 a[0:15], a[56:59], v[232:239], v13
    v_exp_f32 v200, v200
    v_exp_f32 v201, v201
    v_exp_f32 v202, v202
    v_exp_f32 v203, v203
    v_smfmac_f32_32x32x32_bf16 a[16:31], a[52:55], v[192:199], v13
    s_waitcnt lgkmcnt(0)
    v_exp_f32 v204, v204
    v_exp_f32 v205, v205
    v_exp_f32 v206, v206
    v_exp_f32 v207, v207
    v_mfma_f32_32x32x16_bf16 v[224:239], a[32:35], a[228:231], v[240:255]
    ds_read_b128 a[36:39], v7 offset:21504
    v_exp_f32 v208, v208
    v_exp_f32 v209, v209
    v_exp_f32 v210, v210
    v_exp_f32 v211, v211
    v_mfma_f32_32x32x8_bf16 v[224:239], a[40:41], v[40:41], v[224:239]
    v_exp_f32 v212, v212
    v_exp_f32 v213, v213
    v_exp_f32 v214, v214
    v_exp_f32 v215, v215
    v_smfmac_f32_32x32x32_bf16 a[16:31], a[56:59], v[200:207], v13
    ds_read_b128 a[52:55], v3 offset:26304
    ds_read_b128 a[56:59], v3 offset:26912
    buffer_store_dwordx4 v[168:171], v5, s[28:31], s77 offen offset:512 sc1
    v_exp_f32 v216, v216
    v_exp_f32 v217, v217
    v_exp_f32 v218, v218
    v_exp_f32 v219, v219
    v_smfmac_f32_32x32x32_bf16 a[0:15], a[44:47], v[208:215], v13
    s_waitcnt lgkmcnt(2)
    s_add_u32 s67, s72, 56832
    v_exp_f32 v220, v220
    v_exp_f32 v221, v221
    v_exp_f32 v222, v222
    v_exp_f32 v223, v223
    v_mfma_f32_32x32x16_bf16 v[192:207], a[36:39], a[224:227], v[16:31]
    s_add_u32 m0, s72, 0
    v_exp_f32 v224, v224
    v_exp_f32 v225, v225
    v_exp_f32 v226, v226
    v_exp_f32 v227, v227
    v_mfma_f32_32x32x8_bf16 v[192:207], a[40:41], v[34:35], v[192:207]
    v_exp_f32 v228, v228
    v_exp_f32 v229, v229
    v_exp_f32 v230, v230
    v_exp_f32 v231, v231
    v_smfmac_f32_32x32x32_bf16 a[0:15], a[48:51], v[216:223], v13
    buffer_load_dwordx4 v7, s[28:31], s67 offen sc1 lds
    v_exp_f32 v232, v232
    v_exp_f32 v233, v233
    v_exp_f32 v234, v234
    v_exp_f32 v235, v235
    v_smfmac_f32_32x32x32_bf16 a[16:31], a[44:47], v[224:231], v13
    s_waitcnt lgkmcnt(0)
    v_exp_f32 v236, v236
    v_exp_f32 v237, v237
    v_exp_f32 v238, v238
    v_exp_f32 v239, v239
    v_mfma_f32_32x32x16_bf16 v[208:223], a[36:39], a[228:231], v[240:255]
    ds_read_b128 a[32:35], v7 offset:22528
    v_exp_f32 v192, v192
    v_exp_f32 v193, v193
    v_exp_f32 v194, v194
    v_exp_f32 v195, v195
    v_mfma_f32_32x32x8_bf16 v[208:223], a[40:41], v[42:43], v[208:223]
    v_exp_f32 v196, v196
    v_exp_f32 v197, v197
    v_exp_f32 v198, v198
    v_exp_f32 v199, v199
    v_smfmac_f32_32x32x32_bf16 a[16:31], a[48:51], v[232:239], v13
    ds_read_b128 a[44:47], v3 offset:27520
    ds_read_b128 a[48:51], v3 offset:28128
    buffer_store_dwordx4 v[116:119], v5, s[28:31], s18 offen offset:2048 sc1
    v_exp_f32 v200, v200
    v_exp_f32 v201, v201
    v_exp_f32 v202, v202
    v_exp_f32 v203, v203
    v_smfmac_f32_32x32x32_bf16 a[0:15], a[52:55], v[192:199], v13
    s_waitcnt lgkmcnt(2)
    s_add_u32 s67, s72, 60928
    v_exp_f32 v204, v204
    v_exp_f32 v205, v205
    v_exp_f32 v206, v206
    v_exp_f32 v207, v207
    v_mfma_f32_32x32x16_bf16 v[224:239], a[32:35], a[224:227], v[16:31]
    s_add_u32 m0, s72, 4096
    v_exp_f32 v208, v208
    v_exp_f32 v209, v209
L_q8:
    s_cbranch_execz L_q12
    v_exp_f32 v210, v210
    v_exp_f32 v211, v211
    v_mfma_f32_32x32x8_bf16 v[224:239], a[40:41], v[36:37], v[224:239]
    v_exp_f32 v212, v212
    v_exp_f32 v213, v213
    v_exp_f32 v214, v214
    v_exp_f32 v215, v215
    v_smfmac_f32_32x32x32_bf16 a[0:15], a[56:59], v[200:207], v13
    buffer_load_dwordx4 v7, s[28:31], s67 offen sc1 lds
    v_exp_f32 v216, v216
    v_exp_f32 v217, v217
    v_exp_f32 v218, v218
    v_exp_f32 v219, v219
    v_smfmac_f32_32x32x32_bf16 a[16:31], a[52:55], v[208:215], v13
    s_waitcnt lgkmcnt(0)
    v_exp_f32 v220, v220
    v_exp_f32 v221, v221
    v_exp_f32 v222, v222
    v_exp_f32 v223, v223
    v_mfma_f32_32x32x16_bf16 v[192:207], a[32:35], a[228:231], v[240:255]
    ds_read_b128 a[36:39], v7 offset:23552
    v_exp_f32 v224, v224
    v_exp_f32 v225, v225
    v_exp_f32 v226, v226
    v_exp_f32 v227, v227
    v_mfma_f32_32x32x8_bf16 v[192:207], a[40:41], v[44:45], v[192:207]
    v_exp_f32 v228, v228
    v_exp_f32 v229, v229
    v_exp_f32 v230, v230
    v_exp_f32 v231, v231
    v_smfmac_f32_32x32x32_bf16 a[16:31], a[56:59], v[216:223], v13
    ds_read_b128 a[52:55], v3 offset:28736
    ds_read_b128 a[56:59], v3 offset:29344
    buffer_store_dwordx4 v[124:127], v5, s[28:31], s18 offen offset:2560 sc1
    v_exp_f32 v232, v232
    v_exp_f32 v233, v233
    v_exp_f32 v234, v234
    v_exp_f32 v235, v235
    v_smfmac_f32_32x32x32_bf16 a[0:15], a[44:47], v[224:231], v13
    s_waitcnt lgkmcnt(2)
    s_add_u32 s67, s72, 65024
    v_exp_f32 v236, v236
    v_exp_f32 v237, v237
    v_exp_f32 v238, v238
    v_exp_f32 v239, v239
    v_mfma_f32_32x32x16_bf16 v[208:223], a[36:39], a[224:227], v[16:31]
    s_add_u32 m0, s72, 8192
    v_exp_f32 v192, v192
    v_exp_f32 v193, v193
    v_exp_f32 v194, v194
    v_exp_f32 v195, v195
    v_mfma_f32_32x32x8_bf16 v[208:223], a[40:41], v[38:39], v[208:223]
    v_exp_f32 v196, v196
    v_exp_f32 v197, v197
    v_exp_f32 v198, v198
    v_exp_f32 v199, v199
    v_smfmac_f32_32x32x32_bf16 a[0:15], a[48:51], v[232:239], v13
    buffer_load_dwordx4 v7, s[28:31], s67 offen sc1 lds
    v_exp_f32 v200, v200
    v_exp_f32 v201, v201
    v_exp_f32 v202, v202
    v_exp_f32 v203, v203
    v_smfmac_f32_32x32x32_bf16 a[16:31], a[44:47], v[192:199], v13
    s_waitcnt lgkmcnt(0)
    v_exp_f32 v204, v204
    v_exp_f32 v205, v205
    v_exp_f32 v206, v206
    v_exp_f32 v207, v207
    v_mfma_f32_32x32x16_bf16 v[224:239], a[36:39], a[228:231], v[240:255]
    s_add_u32 s77, s37, 0
    ds_read_b128 a[32:35], v7 offset:29952
    ds_read_b64 a[42:43], v2 offset:34048
    v_exp_f32 v208, v208
    v_exp_f32 v209, v209
    v_exp_f32 v210, v210
    v_exp_f32 v211, v211
    v_mfma_f32_32x32x8_bf16 v[224:239], a[40:41], v[46:47], v[224:239]
    v_exp_f32 v212, v212
    v_exp_f32 v213, v213
    v_exp_f32 v214, v214
    v_exp_f32 v215, v215
    v_smfmac_f32_32x32x32_bf16 a[16:31], a[48:51], v[200:207], v13
    ds_read_b128 a[44:47], v3 offset:34560
    ds_read_b128 a[48:51], v3 offset:35168
    buffer_store_dwordx4 v[64:67], v5, s[28:31], s77 offen offset:0 sc1
    v_exp_f32 v216, v216
    v_exp_f32 v217, v217
    v_exp_f32 v218, v218
    v_exp_f32 v219, v219
    v_smfmac_f32_32x32x32_bf16 a[0:15], a[52:55], v[208:215], v13
    s_waitcnt lgkmcnt(2)
    s_add_u32 s67, s72, 69120
    v_exp_f32 v220, v220
    v_exp_f32 v221, v221
    v_exp_f32 v222, v222
    v_exp_f32 v223, v223
    v_mfma_f32_32x32x16_bf16 v[192:207], a[32:35], a[224:227], v[16:31]
    s_add_u32 m0, s72, 12288
    v_exp_f32 v224, v224
    v_exp_f32 v225, v225
    v_exp_f32 v226, v226
    v_exp_f32 v227, v227
    v_mfma_f32_32x32x8_bf16 v[192:207], a[42:43], v[32:33], v[192:207]
    v_exp_f32 v228, v228
    v_exp_f32 v229, v229
    v_exp_f32 v230, v230
    v_exp_f32 v231, v231
    v_smfmac_f32_32x32x32_bf16 a[0:15], a[56:59], v[216:223], v13
    buffer_load_dwordx4 v7, s[28:31], s67 offen sc1 lds
    v_exp_f32 v232, v232
    v_exp_f32 v233, v233
    v_exp_f32 v234, v234
    v_exp_f32 v235, v235
    v_smfmac_f32_32x32x32_bf16 a[16:31], a[52:55], v[224:231], v13
    s_waitcnt lgkmcnt(0)
    v_exp_f32 v236, v236
    v_exp_f32 v237, v237
    v_exp_f32 v238, v238
    v_exp_f32 v239, v239
    v_mfma_f32_32x32x16_bf16 v[208:223], a[32:35], a[228:231], v[240:255]
    ds_read_b128 a[36:39], v7 offset:30976
    v_exp_f32 v192, v192
    v_exp_f32 v193, v193
    v_exp_f32 v194, v194
    v_exp_f32 v195, v195
    v_mfma_f32_32x32x8_bf16 v[208:223], a[42:43], v[40:41], v[208:223]
    v_exp_f32 v196, v196
    v_exp_f32 v197, v197
    v_exp_f32 v198, v198
    v_exp_f32 v199, v199
    v_smfmac_f32_32x32x32_bf16 a[16:31], a[56:59], v[232:239], v13
    ds_read_b128 a[52:55], v3 offset:35776
    ds_read_b128 a[56:59], v3 offset:36384
    buffer_store_dwordx4 v[72:75], v5, s[28:31], s77 offen offset:512 sc1
    v_exp_f32 v200, v200
    v_exp_f32 v201, v201
    v_exp_f32 v202, v202
    v_exp_f32 v203, v203
    v_smfmac_f32_32x32x32_bf16 a[0:15], a[44:47], v[192:199], v13
    s_waitcnt lgkmcnt(2)
    s_add_u32 s67, s72, 73216
    v_exp_f32 v204, v204
    v_exp_f32 v205, v205
    v_exp_f32 v206, v206
    v_exp_f32 v207, v207
    v_mfma_f32_32x32x16_bf16 v[224:239], a[36:39], a[224:227], v[16:31]
    s_add_u32 m0, s72, 16384
    buffer_store_dwordx4 v[68:71], v5, s[28:31], s77 offen offset:2048 sc1
    v_exp_f32 v208, v208
    v_exp_f32 v209, v209
    v_exp_f32 v210, v210
    v_exp_f32 v211, v211
    v_mfma_f32_32x32x8_bf16 v[224:239], a[42:43], v[34:35], v[224:239]
    v_exp_f32 v212, v212
    v_exp_f32 v213, v213
    v_exp_f32 v214, v214
    v_exp_f32 v215, v215
    v_smfmac_f32_32x32x32_bf16 a[0:15], a[48:51], v[200:207], v13
    buffer_load_dwordx4 v7, s[28:31], s67 offen sc1 lds
    v_exp_f32 v216, v216
    v_exp_f32 v217, v217
    v_exp_f32 v218, v218
    v_exp_f32 v219, v219
    v_smfmac_f32_32x32x32_bf16 a[16:31], a[44:47], v[208:215], v13
    s_waitcnt lgkmcnt(0)
    v_exp_f32 v220, v220
    v_exp_f32 v221, v221
    v_exp_f32 v222, v222
    v_exp_f32 v223, v223
    v_mfma_f32_32x32x16_bf16 v[192:207], a[36:39], a[228:231], v[240:255]
    ds_read_b128 a[32:35], v7 offset:32000
    v_exp_f32 v224, v224
    v_exp_f32 v225, v225
    v_exp_f32 v226, v226
    v_exp_f32 v227, v227
    v_mfma_f32_32x32x8_bf16 v[192:207], a[42:43], v[42:43], v[192:207]
    v_exp_f32 v228, v228
    v_exp_f32 v229, v229
    v_exp_f32 v230, v230
    v_exp_f32 v231, v231
    v_smfmac_f32_32x32x32_bf16 a[16:31], a[48:51], v[216:223], v13
    ds_read_b128 a[44:47], v3 offset:36992
    ds_read_b128 a[48:51], v3 offset:37600
    buffer_store_dwordx4 v[76:79], v5, s[28:31], s77 offen offset:2560 sc1
    v_exp_f32 v232, v232
    v_exp_f32 v233, v233
    v_exp_f32 v234, v234
    v_exp_f32 v235, v235
    v_smfmac_f32_32x32x32_bf16 a[0:15], a[52:55], v[224:231], v13
    s_waitcnt lgkmcnt(2)
    v_exp_f32 v236, v236
    v_exp_f32 v237, v237
    v_exp_f32 v238, v238
    v_exp_f32 v239, v239
    v_mfma_f32_32x32x16_bf16 v[208:223], a[32:35], a[224:227], v[16:31]
    v_exp_f32 v192, v192
    v_exp_f32 v193, v193
    v_exp_f32 v194, v194
    v_exp_f32 v195, v195
    v_mfma_f32_32x32x8_bf16 v[208:223], a[42:43], v[36:37], v[208:223]
    v_exp_f32 v196, v196
    v_exp_f32 v197, v197
    v_exp_f32 v198, v198
    v_exp_f32 v199, v199
    v_smfmac_f32_32x32x32_bf16 a[0:15], a[56:59], v[232:239], v13
    v_exp_f32 v200, v200
    v_exp_f32 v201, v201
    v_exp_f32 v202, v202
    v_exp_f32 v203, v203
    v_smfmac_f32_32x32x32_bf16 a[16:31], a[52:55], v[192:199], v13
    s_waitcnt lgkmcnt(0)
    v_exp_f32 v204, v204
    v_exp_f32 v205, v205
    v_exp_f32 v206, v206
    v_exp_f32 v207, v207
    v_mfma_f32_32x32x16_bf16 v[224:239], a[32:35], a[228:231], v[240:255]
    s_add_u32 s77, s37, 8192
    ds_read_b128 a[36:39], v7 offset:33024
    v_exp_f32 v208, v208
    v_exp_f32 v209, v209
    v_exp_f32 v210, v210
    v_exp_f32 v211, v211
    v_mfma_f32_32x32x8_bf16 v[224:239], a[42:43], v[44:45], v[224:239]
    v_exp_f32 v212, v212
    v_exp_f32 v213, v213
    v_exp_f32 v214, v214
    v_exp_f32 v215, v215
    v_smfmac_f32_32x32x32_bf16 a[16:31], a[56:59], v[200:207], v13
    ds_read_b128 a[52:55], v3 offset:38208
    ds_read_b128 a[56:59], v3 offset:38816
    buffer_store_dwordx4 v[144:147], v5, s[28:31], s77 offen offset:0 sc1
    v_exp_f32 v216, v216
    v_exp_f32 v217, v217
    v_exp_f32 v218, v218
    v_exp_f32 v219, v219
    v_smfmac_f32_32x32x32_bf16 a[0:15], a[44:47], v[208:215], v13
    s_waitcnt vmcnt(16) lgkmcnt(2)
    ds_add_u32 v11, v9
    v_exp_f32 v220, v220
    v_exp_f32 v221, v221
    v_exp_f32 v222, v222
    v_exp_f32 v223, v223
    v_mfma_f32_32x32x16_bf16 v[192:207], a[36:39], a[224:227], v[16:31]
    v_exp_f32 v224, v224
    v_exp_f32 v225, v225
    v_exp_f32 v226, v226
    v_exp_f32 v227, v227
    v_mfma_f32_32x32x8_bf16 v[192:207], a[42:43], v[38:39], v[192:207]
    ds_read_b32 v6, v11
    v_exp_f32 v228, v228
    v_exp_f32 v229, v229
    v_exp_f32 v230, v230
    v_exp_f32 v231, v231
    v_smfmac_f32_32x32x32_bf16 a[0:15], a[48:51], v[216:223], v13
    v_exp_f32 v232, v232
    v_exp_f32 v233, v233
    v_exp_f32 v234, v234
    v_exp_f32 v235, v235
    v_smfmac_f32_32x32x32_bf16 a[16:31], a[44:47], v[224:231], v13
    s_waitcnt lgkmcnt(0)
    v_cmp_le_u32 vcc, 84, v6
    v_exp_f32 v236, v236
    v_exp_f32 v237, v237
    v_exp_f32 v238, v238
    v_exp_f32 v239, v239
    v_mfma_f32_32x32x16_bf16 v[208:223], a[36:39], a[228:231], v[240:255]
    s_cbranch_vccz L_spin23
L_back23:
    ds_read_b128 a[32:35], v7 offset:40960
    ds_read_b64 a[40:41], v2 offset:45056
    v_exp_f32 v192, v192
    v_exp_f32 v193, v193
    v_exp_f32 v194, v194
    v_exp_f32 v195, v195
    v_mfma_f32_32x32x8_bf16 v[208:223], a[42:43], v[46:47], v[208:223]
    v_exp_f32 v196, v196
    v_exp_f32 v197, v197
    v_exp_f32 v198, v198
    v_exp_f32 v199, v199
    v_smfmac_f32_32x32x32_bf16 a[16:31], a[48:51], v[232:239], v13
    ds_read_b128 a[44:47], v3 offset:45568
    ds_read_b128 a[48:51], v3 offset:46176
    buffer_store_dwordx4 v[152:155], v5, s[28:31], s77 offen offset:512 sc1
    v_exp_f32 v200, v200
    v_exp_f32 v201, v201
    v_exp_f32 v202, v202
    v_exp_f32 v203, v203
    v_smfmac_f32_32x32x32_bf16 a[0:15], a[52:55], v[192:199], v13
    s_waitcnt lgkmcnt(2)
    v_exp_f32 v204, v204
    v_exp_f32 v205, v205
    v_exp_f32 v206, v206
    v_exp_f32 v207, v207
    v_mfma_f32_32x32x16_bf16 v[224:239], a[32:35], a[224:227], v[16:31]
    v_exp_f32 v208, v208
    v_exp_f32 v209, v209
    v_exp_f32 v210, v210
    v_exp_f32 v211, v211
    v_mfma_f32_32x32x8_bf16 v[224:239], a[40:41], v[32:33], v[224:239]
    v_exp_f32 v212, v212
    v_exp_f32 v213, v213
    v_exp_f32 v214, v214
    v_exp_f32 v215, v215
    v_smfmac_f32_32x32x32_bf16 a[0:15], a[56:59], v[200:207], v13
    v_exp_f32 v216, v216
    v_exp_f32 v217, v217
    v_exp_f32 v218, v218
    v_exp_f32 v219, v219
    v_smfmac_f32_32x32x32_bf16 a[16:31], a[52:55], v[208:215], v13
    s_waitcnt lgkmcnt(0)
    v_exp_f32 v220, v220
    v_exp_f32 v221, v221
    v_exp_f32 v222, v222
    v_exp_f32 v223, v223
    v_mfma_f32_32x32x16_bf16 v[192:207], a[32:35], a[228:231], v[240:255]
    ds_read_b128 a[36:39], v7 offset:41984
    v_exp_f32 v224, v224
    v_exp_f32 v225, v225
    v_exp_f32 v226, v226
    v_exp_f32 v227, v227
    v_mfma_f32_32x32x8_bf16 v[192:207], a[40:41], v[40:41], v[192:207]
    v_exp_f32 v228, v228
    v_exp_f32 v229, v229
    v_exp_f32 v230, v230
    v_exp_f32 v231, v231
    v_smfmac_f32_32x32x32_bf16 a[16:31], a[56:59], v[216:223], v13
    ds_read_b128 a[52:55], v3 offset:46784
    ds_read_b128 a[56:59], v3 offset:47392
    buffer_store_dwordx4 v[148:151], v5, s[28:31], s77 offen offset:2048 sc1
    v_exp_f32 v232, v232
    v_exp_f32 v233, v233
    v_exp_f32 v234, v234
    v_exp_f32 v235, v235
    v_smfmac_f32_32x32x32_bf16 a[0:15], a[44:47], v[224:231], v13
    s_waitcnt lgkmcnt(2)
    s_add_u32 s67, s72, 75776
    v_exp_f32 v236, v236
    v_exp_f32 v237, v237
    v_exp_f32 v238, v238
    v_exp_f32 v239, v239
    v_mfma_f32_32x32x16_bf16 v[208:223], a[36:39], a[224:227], v[16:31]
    s_add_u32 m0, s72, 20480
    v_exp_f32 v192, v192
    v_exp_f32 v193, v193
    v_exp_f32 v194, v194
    v_exp_f32 v195, v195
    v_mfma_f32_32x32x8_bf16 v[208:223], a[40:41], v[34:35], v[208:223]
    v_exp_f32 v196, v196
    v_exp_f32 v197, v197
    v_exp_f32 v198, v198
    v_exp_f32 v199, v199
    v_smfmac_f32_32x32x32_bf16 a[0:15], a[48:51], v[232:239], v13
    buffer_load_dwordx4 v7, s[28:31], s67 offen sc1 lds
    v_exp_f32 v200, v200
    v_exp_f32 v201, v201
    v_exp_f32 v202, v202
    v_exp_f32 v203, v203
    v_smfmac_f32_32x32x32_bf16 a[16:31], a[44:47], v[192:199], v13
    s_waitcnt lgkmcnt(0)
    v_exp_f32 v204, v204
    v_exp_f32 v205, v205
    v_exp_f32 v206, v206
    v_exp_f32 v207, v207
    v_mfma_f32_32x32x16_bf16 v[224:239], a[36:39], a[228:231], v[240:255]
    ds_read_b128 a[32:35], v7 offset:43008
    v_exp_f32 v208, v208
    v_exp_f32 v209, v209
    v_exp_f32 v210, v210
    v_exp_f32 v211, v211
    v_mfma_f32_32x32x8_bf16 v[224:239], a[40:41], v[42:43], v[224:239]
    v_exp_f32 v212, v212
    v_exp_f32 v213, v213
    v_exp_f32 v214, v214
    v_exp_f32 v215, v215
    v_smfmac_f32_32x32x32_bf16 a[16:31], a[48:51], v[200:207], v13
    ds_read_b128 a[44:47], v3 offset:48000
    ds_read_b128 a[48:51], v3 offset:48608
    buffer_store_dwordx4 v[156:159], v5, s[28:31], s77 offen offset:2560 sc1
    v_exp_f32 v216, v216
    v_exp_f32 v217, v217
    v_exp_f32 v218, v218
    v_exp_f32 v219, v219
    v_smfmac_f32_32x32x32_bf16 a[0:15], a[52:55], v[208:215], v13
    s_waitcnt lgkmcnt(2)
    s_add_u32 s67, s72, 79872
    v_exp_f32 v220, v220
    v_exp_f32 v221, v221
    v_exp_f32 v222, v222
    v_exp_f32 v223, v223
    v_mfma_f32_32x32x16_bf16 v[192:207], a[32:35], a[224:227], v[16:31]
    s_add_u32 m0, s72, 24576
    v_exp_f32 v224, v224
    v_exp_f32 v225, v225
    v_exp_f32 v226, v226
    v_exp_f32 v227, v227
    v_mfma_f32_32x32x8_bf16 v[192:207], a[40:41], v[36:37], v[192:207]
    v_exp_f32 v228, v228
    v_exp_f32 v229, v229
    v_exp_f32 v230, v230
    v_exp_f32 v231, v231
    v_smfmac_f32_32x32x32_bf16 a[0:15], a[56:59], v[216:223], v13
    buffer_load_dwordx4 v7, s[28:31], s67 offen sc1 lds
    v_exp_f32 v232, v232
    v_exp_f32 v233, v233
    v_exp_f32 v234, v234
    v_exp_f32 v235, v235
    v_smfmac_f32_32x32x32_bf16 a[16:31], a[52:55], v[224:231], v13
    s_waitcnt lgkmcnt(0)
    v_exp_f32 v236, v236
    v_exp_f32 v237, v237
    v_exp_f32 v238, v238
    v_exp_f32 v239, v239
    v_mfma_f32_32x32x16_bf16 v[208:223], a[32:35], a[228:231], v[240:255]
    s_add_u32 s77, s37, 12288
    ds_read_b128 a[36:39], v7 offset:44032
    v_exp_f32 v192, v192
    v_exp_f32 v193, v193
    v_exp_f32 v194, v194
    v_exp_f32 v195, v195
    v_mfma_f32_32x32x8_bf16 v[208:223], a[40:41], v[44:45], v[208:223]
    v_exp_f32 v196, v196
    v_exp_f32 v197, v197
    v_exp_f32 v198, v198
    v_exp_f32 v199, v199
    v_smfmac_f32_32x32x32_bf16 a[16:31], a[56:59], v[232:239], v13
    ds_read_b128 a[52:55], v3 offset:49216
    ds_read_b128 a[56:59], v3 offset:49824
    buffer_store_dwordx4 v[176:179], v5, s[28:31], s77 offen offset:0 sc1
    v_exp_f32 v200, v200
    v_exp_f32 v201, v201
    v_exp_f32 v202, v202
    v_exp_f32 v203, v203
    v_smfmac_f32_32x32x32_bf16 a[0:15], a[44:47], v[192:199], v13
    s_waitcnt lgkmcnt(2)
    s_add_u32 s67, s72, 83968
    v_exp_f32 v204, v204
    v_exp_f32 v205, v205
    v_exp_f32 v206, v206
    v_exp_f32 v207, v207
    v_mfma_f32_32x32x16_bf16 v[224:239], a[36:39], a[224:227], v[16:31]
    s_add_u32 m0, s72, 28672
    v_exp_f32 v208, v208
    v_exp_f32 v209, v209
    v_exp_f32 v210, v210
    v_exp_f32 v211, v211
    v_mfma_f32_32x32x8_bf16 v[224:239], a[40:41], v[38:39], v[224:239]
    v_exp_f32 v212, v212
    v_exp_f32 v213, v213
    v_exp_f32 v214, v214
    v_exp_f32 v215, v215
    v_smfmac_f32_32x32x32_bf16 a[0:15], a[48:51], v[200:207], v13
    buffer_load_dwordx4 v7, s[28:31], s67 offen sc1 lds
    v_exp_f32 v216, v216
    v_exp_f32 v217, v217
    v_exp_f32 v218, v218
    v_exp_f32 v219, v219
    v_smfmac_f32_32x32x32_bf16 a[16:31], a[44:47], v[208:215], v13
    s_waitcnt lgkmcnt(0)
    v_exp_f32 v220, v220
    v_exp_f32 v221, v221
    v_exp_f32 v222, v222
    v_exp_f32 v223, v223
    v_mfma_f32_32x32x16_bf16 v[192:207], a[36:39], a[228:231], v[240:255]
    ds_read_b128 a[32:35], v7 offset:50432
    ds_read_b64 a[42:43], v2 offset:54528
    v_exp_f32 v224, v224
    v_exp_f32 v225, v225
    v_exp_f32 v226, v226
    v_exp_f32 v227, v227
    v_mfma_f32_32x32x8_bf16 v[192:207], a[40:41], v[46:47], v[192:207]
    v_exp_f32 v228, v228
    v_exp_f32 v229, v229
    v_exp_f32 v230, v230
    v_exp_f32 v231, v231
    v_smfmac_f32_32x32x32_bf16 a[16:31], a[48:51], v[216:223], v13
    ds_read_b128 a[44:47], v3 offset:55040
    ds_read_b128 a[48:51], v3 offset:55648
    buffer_store_dwordx4 v[184:187], v5, s[28:31], s77 offen offset:512 sc1
    v_exp_f32 v232, v232
    v_exp_f32 v233, v233
    v_exp_f32 v234, v234
    v_exp_f32 v235, v235
    v_smfmac_f32_32x32x32_bf16 a[0:15], a[52:55], v[224:231], v13
    s_waitcnt lgkmcnt(2)
    s_add_u32 s67, s72, 88064
    v_exp_f32 v236, v236
    v_exp_f32 v237, v237
    v_exp_f32 v238, v238
    v_exp_f32 v239, v239
    v_mfma_f32_32x32x16_bf16 v[208:223], a[32:35], a[224:227], v[16:31]
    s_add_u32 m0, s72, 32768
    v_exp_f32 v192, v192
    v_exp_f32 v193, v193
    v_exp_f32 v194, v194
    v_exp_f32 v195, v195
    v_mfma_f32_32x32x8_bf16 v[208:223], a[42:43], v[32:33], v[208:223]
    v_exp_f32 v196, v196
    v_exp_f32 v197, v197
    v_exp_f32 v198, v198
    v_exp_f32 v199, v199
    v_smfmac_f32_32x32x32_bf16 a[0:15], a[56:59], v[232:239], v13
    buffer_load_dwordx4 v7, s[28:31], s67 offen sc1 lds
    v_exp_f32 v200, v200
    v_exp_f32 v201, v201
    v_exp_f32 v202, v202
    v_exp_f32 v203, v203
    v_smfmac_f32_32x32x32_bf16 a[16:31], a[52:55], v[192:199], v13
    s_waitcnt lgkmcnt(0)
    v_exp_f32 v204, v204
    v_exp_f32 v205, v205
    v_exp_f32 v206, v206
    v_exp_f32 v207, v207
    v_mfma_f32_32x32x16_bf16 v[224:239], a[32:35], a[228:231], v[240:255]
    s_add_u32 s77, s36, 4096
    ds_read_b128 a[36:39], v7 offset:51456
    v_exp_f32 v208, v208
    v_exp_f32 v209, v209
    v_exp_f32 v210, v210
    v_exp_f32 v211, v211
    v_mfma_f32_32x32x8_bf16 v[224:239], a[42:43], v[40:41], v[224:239]
    v_exp_f32 v212, v212
    v_exp_f32 v213, v213
    v_exp_f32 v214, v214
    v_exp_f32 v215, v215
    v_smfmac_f32_32x32x32_bf16 a[16:31], a[56:59], v[200:207], v13
    ds_read_b128 a[52:55], v3 offset:56256
    ds_read_b128 a[56:59], v3 offset:56864
    buffer_store_dwordx4 v[80:83], v5, s[28:31], s77 offen offset:0 sc1
    v_exp_f32 v216, v216
    v_exp_f32 v217, v217
    v_exp_f32 v218, v218
    v_exp_f32 v219, v219
    v_smfmac_f32_32x32x32_bf16 a[0:15], a[44:47], v[208:215], v13
    s_waitcnt lgkmcnt(2)
    s_add_u32 s67, s72, 92160
    v_exp_f32 v220, v220
    v_exp_f32 v221, v221
    v_exp_f32 v222, v222
    v_exp_f32 v223, v223
    v_mfma_f32_32x32x16_bf16 v[192:207], a[36:39], a[224:227], v[16:31]
    s_add_u32 m0, s72, 36864
    buffer_store_dwordx4 v[88:91], v5, s[28:31], s77 offen offset:512 sc1
    v_exp_f32 v224, v224
    v_exp_f32 v225, v225
    v_exp_f32 v226, v226
    v_exp_f32 v227, v227
    v_mfma_f32_32x32x8_bf16 v[192:207], a[42:43], v[34:35], v[192:207]
    v_exp_f32 v228, v228
    v_exp_f32 v229, v229
    v_exp_f32 v230, v230
    v_exp_f32 v231, v231
    v_smfmac_f32_32x32x32_bf16 a[0:15], a[48:51], v[216:223], v13
    buffer_load_dwordx4 v7, s[28:31], s67 offen sc1 lds
    v_exp_f32 v232, v232
    v_exp_f32 v233, v233
    v_exp_f32 v234, v234
    v_exp_f32 v235, v235
    v_smfmac_f32_32x32x32_bf16 a[16:31], a[44:47], v[224:231], v13
    s_waitcnt lgkmcnt(0)
    v_exp_f32 v236, v236
    v_exp_f32 v237, v237
    v_exp_f32 v238, v238
    v_exp_f32 v239, v239
    v_mfma_f32_32x32x16_bf16 v[208:223], a[36:39], a[228:231], v[240:255]
    ds_read_b128 a[32:35], v7 offset:52480
    v_exp_f32 v192, v192
    v_exp_f32 v193, v193
    v_exp_f32 v194, v194
    v_exp_f32 v195, v195
    v_mfma_f32_32x32x8_bf16 v[208:223], a[42:43], v[42:43], v[208:223]
    v_exp_f32 v196, v196
    v_exp_f32 v197, v197
    v_exp_f32 v198, v198
    v_exp_f32 v199, v199
    v_smfmac_f32_32x32x32_bf16 a[16:31], a[48:51], v[232:239], v13
    ds_read_b128 a[44:47], v3 offset:57472
    ds_read_b128 a[48:51], v3 offset:58080
    buffer_store_dwordx4 v[84:87], v5, s[28:31], s77 offen offset:2048 sc1
    v_exp_f32 v200, v200
    v_exp_f32 v201, v201
    v_exp_f32 v202, v202
    v_exp_f32 v203, v203
    v_smfmac_f32_32x32x32_bf16 a[0:15], a[52:55], v[192:199], v13
    s_waitcnt lgkmcnt(2)
    v_exp_f32 v204, v204
    v_exp_f32 v205, v205
    v_exp_f32 v206, v206
    v_exp_f32 v207, v207
    v_mfma_f32_32x32x16_bf16 v[224:239], a[32:35], a[224:227], v[16:31]
    v_exp_f32 v208, v208
    v_exp_f32 v209, v209
    v_exp_f32 v210, v210
    v_exp_f32 v211, v211
    v_mfma_f32_32x32x8_bf16 v[224:239], a[42:43], v[36:37], v[224:239]
    v_exp_f32 v212, v212
    v_exp_f32 v213, v213
    v_exp_f32 v214, v214
    v_exp_f32 v215, v215
    v_smfmac_f32_32x32x32_bf16 a[0:15], a[56:59], v[200:207], v13
    v_exp_f32 v216, v216
    v_exp_f32 v217, v217
    v_exp_f32 v218, v218
    v_exp_f32 v219, v219
    v_smfmac_f32_32x32x32_bf16 a[16:31], a[52:55], v[208:215], v13
    s_waitcnt lgkmcnt(0)
    v_exp_f32 v220, v220
    v_exp_f32 v221, v221
    v_exp_f32 v222, v222
    v_exp_f32 v223, v223
    v_mfma_f32_32x32x16_bf16 v[192:207], a[32:35], a[228:231], v[240:255]
    ds_read_b128 a[36:39], v7 offset:53504
    v_exp_f32 v224, v224
    v_exp_f32 v225, v225
    v_exp_f32 v226, v226
    v_exp_f32 v227, v227
    v_mfma_f32_32x32x8_bf16 v[192:207], a[42:43], v[44:45], v[192:207]
    v_exp_f32 v228, v228
    v_exp_f32 v229, v229
    v_exp_f32 v230, v230
    v_exp_f32 v231, v231
    v_smfmac_f32_32x32x32_bf16 a[16:31], a[56:59], v[216:223], v13
    ds_read_b128 a[52:55], v3 offset:58688
    ds_read_b128 a[56:59], v3 offset:59296
    buffer_store_dwordx4 v[92:95], v5, s[28:31], s77 offen offset:2560 sc1
    v_exp_f32 v232, v232
    v_exp_f32 v233, v233
    v_exp_f32 v234, v234
    v_exp_f32 v235, v235
    v_smfmac_f32_32x32x32_bf16 a[0:15], a[44:47], v[224:231], v13
    s_waitcnt vmcnt(16) lgkmcnt(2)
    s_waitcnt vmcnt(6)
    ds_add_u32 v11, v9
    v_lshlrev_b32 v15, 2, v0
    s_mov_b32 exec_hi, 0
    buffer_store_dword v9, v15, s[28:31], s3 offen offset:0 sc1
    s_mov_b32 exec_hi, -1
    v_exp_f32 v236, v236
    v_exp_f32 v237, v237
    v_exp_f32 v238, v238
    v_exp_f32 v239, v239
    v_mfma_f32_32x32x16_bf16 v[208:223], a[36:39], a[224:227], v[16:31]
    v_exp_f32 v192, v192
    v_exp_f32 v193, v193
    v_exp_f32 v194, v194
    v_exp_f32 v195, v195
    v_mfma_f32_32x32x8_bf16 v[208:223], a[42:43], v[38:39], v[208:223]
    ds_read_b32 v6, v11
    v_exp_f32 v196, v196
    v_exp_f32 v197, v197
    v_exp_f32 v198, v198
    v_exp_f32 v199, v199
    v_smfmac_f32_32x32x32_bf16 a[0:15], a[48:51], v[232:239], v13
    v_exp_f32 v200, v200
    v_exp_f32 v201, v201
    v_exp_f32 v202, v202
    v_exp_f32 v203, v203
    v_smfmac_f32_32x32x32_bf16 a[16:31], a[44:47], v[192:199], v13
    s_waitcnt lgkmcnt(0)
    s_add_u32 s77, s36, 12288
    v_cmp_le_u32 vcc, 88, v6
    v_exp_f32 v204, v204
    v_exp_f32 v205, v205
    v_exp_f32 v206, v206
    v_exp_f32 v207, v207
    v_mfma_f32_32x32x16_bf16 v[224:239], a[36:39], a[228:231], v[240:255]
    s_cbranch_vccz L_spin24
L_back24:
    ds_read_b128 a[32:35], v7 offset:0
    ds_read_b64 a[40:41], v2 offset:4096
    v_exp_f32 v208, v208
    v_exp_f32 v209, v209
    v_exp_f32 v210, v210
    v_exp_f32 v211, v211
    v_mfma_f32_32x32x8_bf16 v[224:239], a[42:43], v[46:47], v[224:239]
    v_exp_f32 v212, v212
    v_exp_f32 v213, v213
    v_exp_f32 v214, v214
    v_exp_f32 v215, v215
    v_smfmac_f32_32x32x32_bf16 a[16:31], a[48:51], v[200:207], v13
    ds_read_b128 a[44:47], v3 offset:4608
    ds_read_b128 a[48:51], v3 offset:5216
    buffer_store_dwordx4 v[164:167], v5, s[28:31], s77 offen offset:2048 sc1
    v_exp_f32 v216, v216
    v_exp_f32 v217, v217
    v_exp_f32 v218, v218
    v_exp_f32 v219, v219
    v_smfmac_f32_32x32x32_bf16 a[0:15], a[52:55], v[208:215], v13
    s_waitcnt lgkmcnt(2)
    v_exp_f32 v220, v220
    v_exp_f32 v221, v221
    v_exp_f32 v222, v222
    v_exp_f32 v223, v223
    v_mfma_f32_32x32x16_bf16 v[192:207], a[32:35], a[224:227], v[16:31]
    v_exp_f32 v224, v224
    v_exp_f32 v225, v225
    v_exp_f32 v226, v226
    v_exp_f32 v227, v227
    v_mfma_f32_32x32x8_bf16 v[192:207], a[40:41], v[32:33], v[192:207]
    v_exp_f32 v228, v228
    v_exp_f32 v229, v229
    v_exp_f32 v230, v230
    v_exp_f32 v231, v231
    v_smfmac_f32_32x32x32_bf16 a[0:15], a[56:59], v[216:223], v13
    v_exp_f32 v232, v232
    v_exp_f32 v233, v233
    v_exp_f32 v234, v234
    v_exp_f32 v235, v235
    v_smfmac_f32_32x32x32_bf16 a[16:31], a[52:55], v[224:231], v13
    s_waitcnt lgkmcnt(0)
    v_exp_f32 v236, v236
    v_exp_f32 v237, v237
    v_exp_f32 v238, v238
    v_exp_f32 v239, v239
    v_mfma_f32_32x32x16_bf16 v[208:223], a[32:35], a[228:231], v[240:255]
    ds_read_b128 a[36:39], v7 offset:1024
    v_exp_f32 v192, v192
    v_exp_f32 v193, v193
    v_exp_f32 v194, v194
    v_exp_f32 v195, v195
    v_mfma_f32_32x32x8_bf16 v[208:223], a[40:41], v[40:41], v[208:223]
    v_exp_f32 v196, v196
    v_exp_f32 v197, v197
    v_exp_f32 v198, v198
    v_exp_f32 v199, v199
    v_smfmac_f32_32x32x32_bf16 a[16:31], a[56:59], v[232:239], v13
    ds_read_b128 a[52:55], v3 offset:5824
    ds_read_b128 a[56:59], v3 offset:6432
    buffer_store_dwordx4 v[172:175], v5, s[28:31], s77 offen offset:2560 sc1
    v_exp_f32 v200, v200
    v_exp_f32 v201, v201
    v_exp_f32 v202, v202
    v_exp_f32 v203, v203
    v_smfmac_f32_32x32x32_bf16 a[0:15], a[44:47], v[192:199], v13
    s_waitcnt lgkmcnt(2)
    s_add_u32 s67, s72, 94720
    v_exp_f32 v204, v204
    v_exp_f32 v205, v205
    v_exp_f32 v206, v206
    v_exp_f32 v207, v207
    v_mfma_f32_32x32x16_bf16 v[224:239], a[36:39], a[224:227], v[16:31]
    s_add_u32 m0, s72, 40960
    v_exp_f32 v208, v208
    v_exp_f32 v209, v209
    v_exp_f32 v210, v210
    v_exp_f32 v211, v211
    v_mfma_f32_32x32x8_bf16 v[224:239], a[40:41], v[34:35], v[224:239]
    v_exp_f32 v212, v212
    v_exp_f32 v213, v213
    v_exp_f32 v214, v214
    v_exp_f32 v215, v215
    v_smfmac_f32_32x32x32_bf16 a[0:15], a[48:51], v[200:207], v13
    buffer_load_dwordx4 v7, s[28:31], s67 offen sc1 lds
    v_exp_f32 v216, v216
    v_exp_f32 v217, v217
    v_exp_f32 v218, v218
    v_exp_f32 v219, v219
    v_smfmac_f32_32x32x32_bf16 a[16:31], a[44:47], v[208:215], v13
    s_waitcnt lgkmcnt(0)
    v_exp_f32 v220, v220
    v_exp_f32 v221, v221
    v_exp_f32 v222, v222
    v_exp_f32 v223, v223
    v_mfma_f32_32x32x16_bf16 v[192:207], a[36:39], a[228:231], v[240:255]
    ds_read_b128 a[32:35], v7 offset:2048
    v_exp_f32 v224, v224
    v_exp_f32 v225, v225
    v_exp_f32 v226, v226
    v_exp_f32 v227, v227
    v_mfma_f32_32x32x8_bf16 v[192:207], a[40:41], v[42:43], v[192:207]
    v_exp_f32 v228, v228
    v_exp_f32 v229, v229
    v_exp_f32 v230, v230
    v_exp_f32 v231, v231
    v_smfmac_f32_32x32x32_bf16 a[16:31], a[48:51], v[216:223], v13
    ds_read_b128 a[44:47], v3 offset:7040
    ds_read_b128 a[48:51], v3 offset:7648
    buffer_store_dwordx4 v[112:115], v5, s[28:31], s18 offen offset:0 sc1
    v_exp_f32 v232, v232
    v_exp_f32 v233, v233
    v_exp_f32 v234, v234
    v_exp_f32 v235, v235
    v_smfmac_f32_32x32x32_bf16 a[0:15], a[52:55], v[224:231], v13
    s_waitcnt lgkmcnt(2)
    s_add_u32 s67, s72, 98816
    v_exp_f32 v236, v236
    v_exp_f32 v237, v237
    v_exp_f32 v238, v238
    v_exp_f32 v239, v239
L_q9:
    s_cbranch_execz L_padx
    v_mfma_f32_32x32x16_bf16 v[208:223], a[32:35], a[224:227], v[16:31]
    s_add_u32 m0, s72, 45056
    v_exp_f32 v192, v192
    v_exp_f32 v193, v193
    v_exp_f32 v194, v194
    v_exp_f32 v195, v195
    v_mfma_f32_32x32x8_bf16 v[208:223], a[40:41], v[36:37], v[208:223]
    v_exp_f32 v196, v196
    v_exp_f32 v197, v197
    v_exp_f32 v198, v198
    v_exp_f32 v199, v199
    v_smfmac_f32_32x32x32_bf16 a[0:15], a[56:59], v[232:239], v13
    buffer_load_dwordx4 v7, s[28:31], s67 offen sc1 lds
    v_exp_f32 v200, v200
    v_exp_f32 v201, v201
    v_exp_f32 v202, v202
    v_exp_f32 v203, v203
    v_smfmac_f32_32x32x32_bf16 a[16:31], a[52:55], v[192:199], v13
    s_waitcnt lgkmcnt(0)
    v_exp_f32 v204, v204
    v_exp_f32 v205, v205
    v_exp_f32 v206, v206
    v_exp_f32 v207, v207
    v_mfma_f32_32x32x16_bf16 v[224:239], a[32:35], a[228:231], v[240:255]
    ds_read_b128 a[36:39], v7 offset:3072
    v_exp_f32 v208, v208
    v_exp_f32 v209, v209
    v_exp_f32 v210, v210
    v_exp_f32 v211, v211
    v_mfma_f32_32x32x8_bf16 v[224:239], a[40:41], v[44:45], v[224:239]
    v_exp_f32 v212, v212
    v_exp_f32 v213, v213
    v_exp_f32 v214, v214
    v_exp_f32 v215, v215
    v_smfmac_f32_32x32x32_bf16 a[16:31], a[56:59], v[200:207], v13
    ds_read_b128 a[52:55], v3 offset:8256
    ds_read_b128 a[56:59], v3 offset:8864
    buffer_store_dwordx4 v[120:123], v5, s[28:31], s18 offen offset:512 sc1
    v_exp_f32 v216, v216
    v_exp_f32 v217, v217
    v_exp_f32 v218, v218
    v_exp_f32 v219, v219
    v_smfmac_f32_32x32x32_bf16 a[0:15], a[44:47], v[208:215], v13
    s_waitcnt lgkmcnt(2)
    s_add_u32 s67, s72, 102912
    v_exp_f32 v220, v220
    v_exp_f32 v221, v221
    v_exp_f32 v222, v222
    v_exp_f32 v223, v223
    v_mfma_f32_32x32x16_bf16 v[192:207], a[36:39], a[224:227], v[16:31]
    s_add_u32 m0, s72, 49152
    v_exp_f32 v224, v224
    v_exp_f32 v225, v225
    v_exp_f32 v226, v226
    v_exp_f32 v227, v227
    v_mfma_f32_32x32x8_bf16 v[192:207], a[40:41], v[38:39], v[192:207]
    v_exp_f32 v228, v228
    v_exp_f32 v229, v229
    v_exp_f32 v230, v230
    v_exp_f32 v231, v231
    v_smfmac_f32_32x32x32_bf16 a[0:15], a[48:51], v[216:223], v13
    buffer_load_dwordx4 v7, s[28:31], s67 offen sc1 lds
    v_exp_f32 v232, v232
    v_exp_f32 v233, v233
    v_exp_f32 v234, v234
    v_exp_f32 v235, v235
    v_smfmac_f32_32x32x32_bf16 a[16:31], a[44:47], v[224:231], v13
    s_waitcnt lgkmcnt(0)
    v_exp_f32 v236, v236
    v_exp_f32 v237, v237
    v_exp_f32 v238, v238
    v_exp_f32 v239, v239
    v_mfma_f32_32x32x16_bf16 v[208:223], a[36:39], a[228:231], v[240:255]
    s_add_u32 s77, s37, 4096
    ds_read_b128 a[32:35], v7 offset:9472
    ds_read_b64 a[42:43], v2 offset:13568
    v_exp_f32 v192, v192
    v_exp_f32 v193, v193
    v_exp_f32 v194, v194
    v_exp_f32 v195, v195
    v_mfma_f32_32x32x8_bf16 v[208:223], a[40:41], v[46:47], v[208:223]
    v_exp_f32 v196, v196
    v_exp_f32 v197, v197
    v_exp_f32 v198, v198
    v_exp_f32 v199, v199
    v_smfmac_f32_32x32x32_bf16 a[16:31], a[48:51], v[232:239], v13
    ds_read_b128 a[44:47], v3 offset:14080
    ds_read_b128 a[48:51], v3 offset:14688
    buffer_store_dwordx4 v[96:99], v5, s[28:31], s77 offen offset:0 sc1
    v_exp_f32 v200, v200
    v_exp_f32 v201, v201
    v_exp_f32 v202, v202
    v_exp_f32 v203, v203
    v_smfmac_f32_32x32x32_bf16 a[0:15], a[52:55], v[192:199], v13
    s_waitcnt lgkmcnt(2)
    s_add_u32 s67, s72, 107008
    v_exp_f32 v204, v204
    v_exp_f32 v205, v205
    v_exp_f32 v206, v206
    v_exp_f32 v207, v207
    v_mfma_f32_32x32x16_bf16 v[224:239], a[32:35], a[224:227], v[16:31]
    s_add_u32 m0, s72, 53248
    v_exp_f32 v208, v208
    v_exp_f32 v209, v209
    v_exp_f32 v210, v210
    v_exp_f32 v211, v211
    v_mfma_f32_32x32x8_bf16 v[224:239], a[42:43], v[32:33], v[224:239]
    v_exp_f32 v212, v212
    v_exp_f32 v213, v213
    v_exp_f32 v214, v214
    v_exp_f32 v215, v215
    v_smfmac_f32_32x32x32_bf16 a[0:15], a[56:59], v[200:207], v13
    buffer_load_dwordx4 v7, s[28:31], s67 offen sc1 lds
    v_exp_f32 v216, v216
    v_exp_f32 v217, v217
    v_exp_f32 v218, v218
    v_exp_f32 v219, v219
    v_smfmac_f32_32x32x32_bf16 a[16:31], a[52:55], v[208:215], v13
    s_waitcnt lgkmcnt(0)
    v_exp_f32 v220, v220
    v_exp_f32 v221, v221
    v_exp_f32 v222, v222
    v_exp_f32 v223, v223
    v_mfma_f32_32x32x16_bf16 v[192:207], a[32:35], a[228:231], v[240:255]
    ds_read_b128 a[36:39], v7 offset:10496
    v_exp_f32 v224, v224
    v_exp_f32 v225, v225
    v_exp_f32 v226, v226
    v_exp_f32 v227, v227
    v_mfma_f32_32x32x8_bf16 v[192:207], a[42:43], v[40:41], v[192:207]
    v_exp_f32 v228, v228
    v_exp_f32 v229, v229
    v_exp_f32 v230, v230
    v_exp_f32 v231, v231
    v_smfmac_f32_32x32x32_bf16 a[16:31], a[56:59], v[216:223], v13
    ds_read_b128 a[52:55], v3 offset:15296
    ds_read_b128 a[56:59], v3 offset:15904
    buffer_store_dwordx4 v[104:107], v5, s[28:31], s77 offen offset:512 sc1
    v_exp_f32 v232, v232
    v_exp_f32 v233, v233
    v_exp_f32 v234, v234
    v_exp_f32 v235, v235
    v_smfmac_f32_32x32x32_bf16 a[0:15], a[44:47], v[224:231], v13
    s_waitcnt lgkmcnt(2)
    s_add_u32 s67, s72, 111104
    v_exp_f32 v236, v236
    v_exp_f32 v237, v237
    v_exp_f32 v238, v238
    v_exp_f32 v239, v239
    v_mfma_f32_32x32x16_bf16 v[208:223], a[36:39], a[224:227], v[16:31]
    s_add_u32 m0, s72, 57344
    buffer_store_dwordx4 v[100:103], v5, s[28:31], s77 offen offset:2048 sc1
    v_exp_f32 v192, v192
    v_exp_f32 v193, v193
    v_exp_f32 v194, v194
    v_exp_f32 v195, v195
    v_mfma_f32_32x32x8_bf16 v[208:223], a[42:43], v[34:35], v[208:223]
    v_exp_f32 v196, v196
    v_exp_f32 v197, v197
    v_exp_f32 v198, v198
    v_exp_f32 v199, v199
    v_smfmac_f32_32x32x32_bf16 a[0:15], a[48:51], v[232:239], v13
    buffer_load_dwordx4 v7, s[28:31], s67 offen sc1 lds
    v_exp_f32 v200, v200
    v_exp_f32 v201, v201
    v_exp_f32 v202, v202
    v_exp_f32 v203, v203
    v_smfmac_f32_32x32x32_bf16 a[16:31], a[44:47], v[192:199], v13
    s_waitcnt lgkmcnt(0)
    v_exp_f32 v204, v204
    v_exp_f32 v205, v205
    v_exp_f32 v206, v206
    v_exp_f32 v207, v207
    v_mfma_f32_32x32x16_bf16 v[224:239], a[36:39], a[228:231], v[240:255]
    ds_read_b128 a[32:35], v7 offset:11520
    v_exp_f32 v208, v208
    v_exp_f32 v209, v209
    v_exp_f32 v210, v210
    v_exp_f32 v211, v211
    v_mfma_f32_32x32x8_bf16 v[224:239], a[42:43], v[42:43], v[224:239]
    v_exp_f32 v212, v212
    v_exp_f32 v213, v213
    v_exp_f32 v214, v214
    v_exp_f32 v215, v215
    v_smfmac_f32_32x32x32_bf16 a[16:31], a[48:51], v[200:207], v13
    ds_read_b128 a[44:47], v3 offset:16512
    ds_read_b128 a[48:51], v3 offset:17120
    buffer_store_dwordx4 v[108:111], v5, s[28:31], s77 offen offset:2560 sc1
    v_exp_f32 v216, v216
    v_exp_f32 v217, v217
    v_exp_f32 v218, v218
    v_exp_f32 v219, v219
    v_smfmac_f32_32x32x32_bf16 a[0:15], a[52:55], v[208:215], v13
    s_waitcnt lgkmcnt(2)
    v_lshlrev_b32 v50, 5, v14
    v_lshrrev_b32 v48, 4, v0
    v_lshl_add_u32 v50, v48, 7, v50
    v_mul_u32_u24 v4, 73728, v48
    v_add_u32 v4, v4, v14
    v_mov_b32 v49, 1
    s_mov_b32 exec_hi, 0
    buffer_load_dword v49, v50, s[28:31], s44 offen sc1
    s_mov_b64 exec, -1
    v_exp_f32 v220, v220
    v_exp_f32 v221, v221
    v_exp_f32 v222, v222
    v_exp_f32 v223, v223
    v_mfma_f32_32x32x16_bf16 v[192:207], a[32:35], a[224:227], v[16:31]
    v_exp_f32 v224, v224
    v_exp_f32 v225, v225
    v_exp_f32 v226, v226
    v_exp_f32 v227, v227
    v_mfma_f32_32x32x8_bf16 v[192:207], a[42:43], v[36:37], v[192:207]
    v_exp_f32 v228, v228
    v_exp_f32 v229, v229
    v_exp_f32 v230, v230
    v_exp_f32 v231, v231
    v_smfmac_f32_32x32x32_bf16 a[0:15], a[56:59], v[216:223], v13
    v_exp_f32 v232, v232
    v_exp_f32 v233, v233
    v_exp_f32 v234, v234
    v_exp_f32 v235, v235
    v_smfmac_f32_32x32x32_bf16 a[16:31], a[52:55], v[224:231], v13
    s_waitcnt lgkmcnt(0)
    v_exp_f32 v236, v236
    v_exp_f32 v237, v237
    v_exp_f32 v238, v238
    v_exp_f32 v239, v239
    v_mfma_f32_32x32x16_bf16 v[208:223], a[32:35], a[228:231], v[240:255]
    s_add_u32 s77, s37, 12288
    ds_read_b128 a[36:39], v7 offset:12544
    v_exp_f32 v192, v192
    v_exp_f32 v193, v193
    v_exp_f32 v194, v194
    v_exp_f32 v195, v195
    v_mfma_f32_32x32x8_bf16 v[208:223], a[42:43], v[44:45], v[208:223]
    v_exp_f32 v196, v196
    v_exp_f32 v197, v197
    v_exp_f32 v198, v198
    v_exp_f32 v199, v199
    v_smfmac_f32_32x32x32_bf16 a[16:31], a[56:59], v[232:239], v13
    ds_read_b128 a[52:55], v3 offset:17728
    ds_read_b128 a[56:59], v3 offset:18336
    buffer_store_dwordx4 v[180:183], v5, s[28:31], s77 offen offset:2048 sc1
    v_exp_f32 v200, v200
    v_exp_f32 v201, v201
    v_exp_f32 v202, v202
    v_exp_f32 v203, v203
    v_smfmac_f32_32x32x32_bf16 a[0:15], a[44:47], v[192:199], v13
    s_waitcnt vmcnt(18) lgkmcnt(2)
    ds_add_u32 v11, v9
    v_exp_f32 v204, v204
    v_exp_f32 v205, v205
    v_exp_f32 v206, v206
    v_exp_f32 v207, v207
    v_mfma_f32_32x32x16_bf16 v[224:239], a[36:39], a[224:227], v[16:31]
    v_exp_f32 v208, v208
    v_exp_f32 v209, v209
    v_exp_f32 v210, v210
    v_exp_f32 v211, v211
    v_mfma_f32_32x32x8_bf16 v[224:239], a[42:43], v[38:39], v[224:239]
    ds_read_b32 v6, v11
    v_exp_f32 v212, v212
    v_exp_f32 v213, v213
    v_exp_f32 v214, v214
    v_exp_f32 v215, v215
    v_smfmac_f32_32x32x32_bf16 a[0:15], a[48:51], v[200:207], v13
    v_exp_f32 v216, v216
    v_exp_f32 v217, v217
    v_exp_f32 v218, v218
    v_exp_f32 v219, v219
    v_smfmac_f32_32x32x32_bf16 a[16:31], a[44:47], v[208:215], v13
    s_waitcnt lgkmcnt(0)
    v_cmp_le_u32 vcc, 92, v6
    v_exp_f32 v220, v220
    v_exp_f32 v221, v221
    v_exp_f32 v222, v222
    v_exp_f32 v223, v223
    v_mfma_f32_32x32x16_bf16 v[192:207], a[36:39], a[228:231], v[240:255]
    s_cbranch_vccz L_spin25
L_back25:
    ds_read_b128 a[32:35], v7 offset:20480
    ds_read_b64 a[40:41], v2 offset:24576
    v_exp_f32 v224, v224
    v_exp_f32 v225, v225
    v_exp_f32 v226, v226
    v_exp_f32 v227, v227
    v_mfma_f32_32x32x8_bf16 v[192:207], a[42:43], v[46:47], v[192:207]
    v_exp_f32 v228, v228
    v_exp_f32 v229, v229
    v_exp_f32 v230, v230
    v_exp_f32 v231, v231
    v_smfmac_f32_32x32x32_bf16 a[16:31], a[48:51], v[216:223], v13
    ds_read_b128 a[44:47], v3 offset:25088
    ds_read_b128 a[48:51], v3 offset:25696
    buffer_store_dwordx4 v[188:191], v5, s[28:31], s77 offen offset:2560 sc1
    v_exp_f32 v232, v232
    v_exp_f32 v233, v233
    v_exp_f32 v234, v234
    v_exp_f32 v235, v235
    v_smfmac_f32_32x32x32_bf16 a[0:15], a[52:55], v[224:231], v13
    s_waitcnt lgkmcnt(2)
    v_exp_f32 v236, v236
    v_exp_f32 v237, v237
    v_exp_f32 v238, v238
    v_exp_f32 v239, v239
    v_mfma_f32_32x32x16_bf16 v[208:223], a[32:35], a[224:227], v[16:31]
    s_waitcnt vmcnt(2)
    v_cmp_gt_u32 vcc, 1, v49
    v_exp_f32 v192, v192
    v_exp_f32 v193, v193
    v_exp_f32 v194, v194
    v_exp_f32 v195, v195
    v_mfma_f32_32x32x8_bf16 v[208:223], a[40:41], v[32:33], v[208:223]
    v_exp_f32 v196, v196
    v_exp_f32 v197, v197
    v_exp_f32 v198, v198
    v_exp_f32 v199, v199
    v_smfmac_f32_32x32x32_bf16 a[0:15], a[56:59], v[232:239], v13
    s_cbranch_vccnz L_spin20
L_back20:
    v_exp_f32 v200, v200
    v_exp_f32 v201, v201
    v_exp_f32 v202, v202
    v_exp_f32 v203, v203
    v_smfmac_f32_32x32x32_bf16 a[16:31], a[52:55], v[192:199], v13
    s_waitcnt lgkmcnt(0)
    v_exp_f32 v204, v204
    v_exp_f32 v205, v205
    v_exp_f32 v206, v206
    v_exp_f32 v207, v207
    v_mfma_f32_32x32x16_bf16 v[224:239], a[32:35], a[228:231], v[240:255]
    s_add_u32 s78, s38, 0
    ds_read_b128 a[36:39], v7 offset:21504
    v_exp_f32 v208, v208
    v_exp_f32 v209, v209
    v_exp_f32 v210, v210
    v_exp_f32 v211, v211
    v_mfma_f32_32x32x8_bf16 v[224:239], a[40:41], v[40:41], v[224:239]
    v_exp_f32 v212, v212
    v_exp_f32 v213, v213
    v_exp_f32 v214, v214
    v_exp_f32 v215, v215
    v_smfmac_f32_32x32x32_bf16 a[16:31], a[56:59], v[200:207], v13
    s_add_u32 s67, s72, 113664
    ds_read_b128 a[52:55], v3 offset:26304
    ds_read_b128 a[56:59], v3 offset:26912
    buffer_load_dwordx4 a[64:67], v4, s[28:31], s78 offen offset:0 sc1
    v_exp_f32 v216, v216
    v_exp_f32 v217, v217
    v_exp_f32 v218, v218
    v_exp_f32 v219, v219
    v_smfmac_f32_32x32x32_bf16 a[0:15], a[44:47], v[208:215], v13
    s_waitcnt lgkmcnt(2)
    s_add_u32 m0, s72, 0
    v_exp_f32 v220, v220
    v_exp_f32 v221, v221
    v_exp_f32 v222, v222
    v_exp_f32 v223, v223
    v_mfma_f32_32x32x16_bf16 v[192:207], a[36:39], a[224:227], v[16:31]
    buffer_load_dwordx4 v7, s[28:31], s67 offen sc1 lds
    v_exp_f32 v224, v224
    v_exp_f32 v225, v225
    v_exp_f32 v226, v226
    v_exp_f32 v227, v227
    v_mfma_f32_32x32x8_bf16 v[192:207], a[40:41], v[34:35], v[192:207]
    v_exp_f32 v228, v228
    v_exp_f32 v229, v229
    v_exp_f32 v230, v230
    v_exp_f32 v231, v231
    v_smfmac_f32_32x32x32_bf16 a[0:15], a[48:51], v[216:223], v13
    v_exp_f32 v232, v232
    v_exp_f32 v233, v233
    v_exp_f32 v234, v234
    v_exp_f32 v235, v235
    v_smfmac_f32_32x32x32_bf16 a[16:31], a[44:47], v[224:231], v13
    s_waitcnt lgkmcnt(0)
    buffer_load_dwordx4 a[68:71], v4, s[28:31], s78 offen offset:1024 sc1
    v_exp_f32 v236, v236
    v_exp_f32 v237, v237
    v_exp_f32 v238, v238
    v_exp_f32 v239, v239
    v_mfma_f32_32x32x16_bf16 v[208:223], a[36:39], a[228:231], v[240:255]
    s_xor_b32 s66, s76, 0
    ds_read_b128 a[32:35], v7 offset:22528
    v_accvgpr_read_b32 v1, a234
    v_accvgpr_read_b32 v10, a235
    v_exp_f32 v192, v192
    v_exp_f32 v193, v193
    v_exp_f32 v194, v194
    v_exp_f32 v195, v195
    v_mfma_f32_32x32x8_bf16 v[208:223], a[40:41], v[42:43], v[208:223]
    v_exp_f32 v196, v196
    v_exp_f32 v197, v197
    v_exp_f32 v198, v198
    v_exp_f32 v199, v199
    v_smfmac_f32_32x32x32_bf16 a[16:31], a[48:51], v[232:239], v13
    s_add_u32 s67, s72, 117760
    s_mul_i32 s66, s66, 165888
    ds_read_b128 a[44:47], v3 offset:27520
    ds_read_b128 a[48:51], v3 offset:28128
    buffer_load_dwordx4 a[72:75], v4, s[28:31], s78 offen offset:2048 sc1
    v_exp_f32 v200, v200
    v_exp_f32 v201, v201
    v_exp_f32 v202, v202
    v_exp_f32 v203, v203
    v_smfmac_f32_32x32x32_bf16 a[0:15], a[52:55], v[192:199], v13
    s_waitcnt lgkmcnt(2)
    s_add_u32 m0, s72, 4096
    v_exp_f32 v204, v204
    v_exp_f32 v205, v205
    v_exp_f32 v206, v206
    v_exp_f32 v207, v207
    v_mfma_f32_32x32x16_bf16 v[224:239], a[32:35], a[224:227], v[16:31]
    s_add_u32 s65, s66, s60
    buffer_load_dwordx4 v7, s[28:31], s67 offen sc1 lds
    v_exp_f32 v208, v208
    v_exp_f32 v209, v209
    v_exp_f32 v210, v210
    v_exp_f32 v211, v211
    v_mfma_f32_32x32x8_bf16 v[224:239], a[40:41], v[36:37], v[224:239]
    v_exp_f32 v212, v212
    v_exp_f32 v213, v213
    v_exp_f32 v214, v214
    v_exp_f32 v215, v215
    v_smfmac_f32_32x32x32_bf16 a[0:15], a[56:59], v[200:207], v13
    s_add_u32 m0, s73, 0
    v_exp_f32 v216, v216
    v_exp_f32 v217, v217
    v_exp_f32 v218, v218
    v_exp_f32 v219, v219
    v_smfmac_f32_32x32x32_bf16 a[16:31], a[52:55], v[208:215], v13
    s_waitcnt lgkmcnt(0)
    buffer_load_dwordx4 v1, s[24:27], s65 offen lds
    v_exp_f32 v220, v220
    v_exp_f32 v221, v221
    v_exp_f32 v222, v222
    v_exp_f32 v223, v223
    v_mfma_f32_32x32x16_bf16 v[192:207], a[32:35], a[228:231], v[240:255]
    ds_read_b128 a[36:39], v7 offset:23552
    v_exp_f32 v224, v224
    v_exp_f32 v225, v225
    v_exp_f32 v226, v226
    v_exp_f32 v227, v227
    v_mfma_f32_32x32x8_bf16 v[192:207], a[40:41], v[44:45], v[192:207]
    v_exp_f32 v228, v228
    v_exp_f32 v229, v229
    v_exp_f32 v230, v230
    v_exp_f32 v231, v231
    v_smfmac_f32_32x32x32_bf16 a[16:31], a[56:59], v[216:223], v13
    s_add_u32 s67, s72, 121856
    ds_read_b128 a[52:55], v3 offset:28736
    ds_read_b128 a[56:59], v3 offset:29344
    buffer_load_dwordx4 a[76:79], v4, s[28:31], s78 offen offset:3072 sc1
    v_exp_f32 v232, v232
    v_exp_f32 v233, v233
    v_exp_f32 v234, v234
    v_exp_f32 v235, v235
    v_smfmac_f32_32x32x32_bf16 a[0:15], a[44:47], v[224:231], v13
    s_waitcnt lgkmcnt(2)
    s_add_u32 m0, s72, 8192
    v_exp_f32 v236, v236
    v_exp_f32 v237, v237
    v_exp_f32 v238, v238
    v_exp_f32 v239, v239
    v_mfma_f32_32x32x16_bf16 v[208:223], a[36:39], a[224:227], v[16:31]
    s_add_u32 s66, s66, s61
    buffer_load_dwordx4 v7, s[28:31], s67 offen sc1 lds
    v_exp_f32 v192, v192
    v_exp_f32 v193, v193
    v_exp_f32 v194, v194
    v_exp_f32 v195, v195
    v_mfma_f32_32x32x8_bf16 v[208:223], a[40:41], v[38:39], v[208:223]
    v_exp_f32 v196, v196
    v_exp_f32 v197, v197
    v_exp_f32 v198, v198
    v_exp_f32 v199, v199
    v_smfmac_f32_32x32x32_bf16 a[0:15], a[48:51], v[232:239], v13
    s_add_u32 m0, s73, 960
    v_exp_f32 v200, v200
    v_exp_f32 v201, v201
    v_exp_f32 v202, v202
    v_exp_f32 v203, v203
    v_smfmac_f32_32x32x32_bf16 a[16:31], a[44:47], v[192:199], v13
    s_waitcnt lgkmcnt(0)
    buffer_load_dwordx4 v1, s[24:27], s65 offen offset:64 lds
    v_exp_f32 v204, v204
    v_exp_f32 v205, v205
    v_exp_f32 v206, v206
    v_exp_f32 v207, v207
    v_mfma_f32_32x32x16_bf16 v[224:239], a[36:39], a[228:231], v[240:255]
    s_add_u32 s78, s38, 294912
    ds_read_b128 a[32:35], v7 offset:29952
    ds_read_b64 a[42:43], v2 offset:34048
    v_exp_f32 v208, v208
    v_exp_f32 v209, v209
    v_exp_f32 v210, v210
    v_exp_f32 v211, v211
    v_mfma_f32_32x32x8_bf16 v[224:239], a[40:41], v[46:47], v[224:239]
    v_exp_f32 v212, v212
    v_exp_f32 v213, v213
    v_exp_f32 v214, v214
    v_exp_f32 v215, v215
    v_smfmac_f32_32x32x32_bf16 a[16:31], a[48:51], v[200:207], v13
    ds_read_b128 a[44:47], v3 offset:34560
    ds_read_b128 a[48:51], v3 offset:35168
    buffer_load_dwordx4 a[100:103], v4, s[28:31], s78 offen offset:0 sc1
    v_exp_f32 v216, v216
    v_exp_f32 v217, v217
    v_exp_f32 v218, v218
    v_exp_f32 v219, v219
    v_smfmac_f32_32x32x32_bf16 a[0:15], a[52:55], v[208:215], v13
    s_waitcnt lgkmcnt(2)
    s_add_u32 s3, s3, 262144
    v_exp_f32 v220, v220
    v_exp_f32 v221, v221
    v_exp_f32 v222, v222
    v_exp_f32 v223, v223
    v_mfma_f32_32x32x16_bf16 v[192:207], a[32:35], a[224:227], v[16:31]
    s_waitcnt vmcnt(10)
    v_lshlrev_b32 v15, 2, v0
    s_mov_b32 exec_hi, 0
    buffer_store_dword v9, v15, s[28:31], s3 offen offset:0 sc1
    s_mov_b32 exec_hi, -1
    v_exp_f32 v224, v224
    v_exp_f32 v225, v225
    v_exp_f32 v226, v226
    v_exp_f32 v227, v227
    v_mfma_f32_32x32x8_bf16 v[192:207], a[42:43], v[32:33], v[192:207]
    v_exp_f32 v228, v228
    v_exp_f32 v229, v229
    v_exp_f32 v230, v230
    v_exp_f32 v231, v231
    v_smfmac_f32_32x32x32_bf16 a[0:15], a[56:59], v[216:223], v13
    s_add_u32 m0, s73, 2048
    v_exp_f32 v232, v232
    v_exp_f32 v233, v233
    v_exp_f32 v234, v234
    v_exp_f32 v235, v235
    v_smfmac_f32_32x32x32_bf16 a[16:31], a[52:55], v[224:231], v13
    s_waitcnt lgkmcnt(0)
    s_add_u32 s67, s72, 125952
    buffer_load_dword v10, s[24:27], s66 offen lds
    v_exp_f32 v236, v236
    v_exp_f32 v237, v237
    v_exp_f32 v238, v238
    v_exp_f32 v239, v239
    v_mfma_f32_32x32x16_bf16 v[208:223], a[32:35], a[228:231], v[240:255]
    s_add_u32 m0, s72, 12288
    ds_read_b128 a[36:39], v7 offset:30976
    v_exp_f32 v192, v192
    v_exp_f32 v193, v193
    v_exp_f32 v194, v194
    v_exp_f32 v195, v195
    v_mfma_f32_32x32x8_bf16 v[208:223], a[42:43], v[40:41], v[208:223]
    v_exp_f32 v196, v196
    v_exp_f32 v197, v197
    v_exp_f32 v198, v198
    v_exp_f32 v199, v199
    v_smfmac_f32_32x32x32_bf16 a[16:31], a[56:59], v[232:239], v13
    s_xor_b32 s66, s76, 1
    ds_read_b128 a[52:55], v3 offset:35776
    ds_read_b128 a[56:59], v3 offset:36384
    buffer_load_dwordx4 v7, s[28:31], s67 offen sc1 lds
    v_exp_f32 v200, v200
    v_exp_f32 v201, v201
    v_exp_f32 v202, v202
    v_exp_f32 v203, v203
    v_smfmac_f32_32x32x32_bf16 a[0:15], a[44:47], v[192:199], v13
    s_waitcnt lgkmcnt(2)
    s_mul_i32 s66, s66, 165888
    v_exp_f32 v204, v204
    v_exp_f32 v205, v205
    v_exp_f32 v206, v206
    v_exp_f32 v207, v207
    v_mfma_f32_32x32x16_bf16 v[224:239], a[36:39], a[224:227], v[16:31]
    s_add_u32 s65, s66, s60
    buffer_load_dwordx4 a[104:107], v4, s[28:31], s78 offen offset:1024 sc1
    v_exp_f32 v208, v208
    v_exp_f32 v209, v209
    v_exp_f32 v210, v210
    v_exp_f32 v211, v211
    v_mfma_f32_32x32x8_bf16 v[224:239], a[42:43], v[34:35], v[224:239]
    v_exp_f32 v212, v212
    v_exp_f32 v213, v213
    v_exp_f32 v214, v214
    v_exp_f32 v215, v215
    v_smfmac_f32_32x32x32_bf16 a[0:15], a[48:51], v[200:207], v13
    s_add_u32 m0, s73, 2304
    v_exp_f32 v216, v216
    v_exp_f32 v217, v217
    v_exp_f32 v218, v218
    v_exp_f32 v219, v219
    v_smfmac_f32_32x32x32_bf16 a[16:31], a[44:47], v[208:215], v13
    s_waitcnt lgkmcnt(0)
    buffer_load_dwordx4 v1, s[24:27], s65 offen lds
    v_exp_f32 v220, v220
    v_exp_f32 v221, v221
    v_exp_f32 v222, v222
    v_exp_f32 v223, v223
    v_mfma_f32_32x32x16_bf16 v[192:207], a[36:39], a[228:231], v[240:255]
    ds_read_b128 a[32:35], v7 offset:32000
    v_exp_f32 v224, v224
    v_exp_f32 v225, v225
    v_exp_f32 v226, v226
    v_exp_f32 v227, v227
    v_mfma_f32_32x32x8_bf16 v[192:207], a[42:43], v[42:43], v[192:207]
    v_exp_f32 v228, v228
    v_exp_f32 v229, v229
    v_exp_f32 v230, v230
    v_exp_f32 v231, v231
    v_smfmac_f32_32x32x32_bf16 a[16:31], a[48:51], v[216:223], v13
    s_add_u32 s67, s72, 130048
    ds_read_b128 a[44:47], v3 offset:36992
    ds_read_b128 a[48:51], v3 offset:37600
    buffer_load_dwordx4 a[108:111], v4, s[28:31], s78 offen offset:2048 sc1
    v_exp_f32 v232, v232
    v_exp_f32 v233, v233
    v_exp_f32 v234, v234
    v_exp_f32 v235, v235
    v_smfmac_f32_32x32x32_bf16 a[0:15], a[52:55], v[224:231], v13
    s_waitcnt lgkmcnt(2)
    s_add_u32 m0, s72, 16384
    v_exp_f32 v236, v236
    v_exp_f32 v237, v237
    v_exp_f32 v238, v238
    v_exp_f32 v239, v239
    v_mfma_f32_32x32x16_bf16 v[208:223], a[32:35], a[224:227], v[16:31]
    s_add_u32 s66, s66, s61
    buffer_load_dwordx4 v7, s[28:31], s67 offen sc1 lds
    v_exp_f32 v192, v192
    v_exp_f32 v193, v193
    v_exp_f32 v194, v194
    v_exp_f32 v195, v195
    v_mfma_f32_32x32x8_bf16 v[208:223], a[42:43], v[36:37], v[208:223]
    v_exp_f32 v196, v196
    v_exp_f32 v197, v197
    v_exp_f32 v198, v198
    v_exp_f32 v199, v199
    v_smfmac_f32_32x32x32_bf16 a[0:15], a[56:59], v[232:239], v13
    s_add_u32 m0, s73, 3264
    v_exp_f32 v200, v200
    v_exp_f32 v201, v201
    v_exp_f32 v202, v202
    v_exp_f32 v203, v203
    v_smfmac_f32_32x32x32_bf16 a[16:31], a[52:55], v[192:199], v13
    s_waitcnt lgkmcnt(0)
    buffer_load_dwordx4 v1, s[24:27], s65 offen offset:64 lds
    v_exp_f32 v204, v204
    v_exp_f32 v205, v205
    v_exp_f32 v206, v206
    v_exp_f32 v207, v207
    v_mfma_f32_32x32x16_bf16 v[224:239], a[32:35], a[228:231], v[240:255]
    ds_read_b128 a[36:39], v7 offset:33024
    v_exp_f32 v208, v208
    v_exp_f32 v209, v209
    v_exp_f32 v210, v210
    v_exp_f32 v211, v211
    v_mfma_f32_32x32x8_bf16 v[224:239], a[42:43], v[44:45], v[224:239]
    v_exp_f32 v212, v212
    v_exp_f32 v213, v213
    v_exp_f32 v214, v214
    v_exp_f32 v215, v215
    v_smfmac_f32_32x32x32_bf16 a[16:31], a[56:59], v[200:207], v13
    ds_read_b128 a[52:55], v3 offset:38208
    ds_read_b128 a[56:59], v3 offset:38816
    buffer_load_dwordx4 a[112:115], v4, s[28:31], s78 offen offset:3072 sc1
    v_exp_f32 v216, v216
    v_exp_f32 v217, v217
    v_exp_f32 v218, v218
    v_exp_f32 v219, v219
    v_smfmac_f32_32x32x32_bf16 a[0:15], a[44:47], v[208:215], v13
    s_waitcnt vmcnt(23) lgkmcnt(2)
    s_add_u32 m0, s73, 4352
    ds_add_u32 v11, v9
    v_exp_f32 v220, v220
    v_exp_f32 v221, v221
    v_exp_f32 v222, v222
    v_exp_f32 v223, v223
    v_mfma_f32_32x32x16_bf16 v[192:207], a[36:39], a[224:227], v[16:31]
    buffer_load_dword v10, s[24:27], s66 offen lds
    v_exp_f32 v224, v224
    v_exp_f32 v225, v225
    v_exp_f32 v226, v226
    v_exp_f32 v227, v227
    v_mfma_f32_32x32x8_bf16 v[192:207], a[42:43], v[38:39], v[192:207]
    ds_read_b32 v6, v11
    v_exp_f32 v228, v228
    v_exp_f32 v229, v229
    v_exp_f32 v230, v230
    v_exp_f32 v231, v231
    v_smfmac_f32_32x32x32_bf16 a[0:15], a[48:51], v[216:223], v13
    s_add_u32 s78, s38, 589824
    s_xor_b32 s66, s76, 2
    v_exp_f32 v232, v232
    v_exp_f32 v233, v233
    v_exp_f32 v234, v234
    v_exp_f32 v235, v235
    v_smfmac_f32_32x32x32_bf16 a[16:31], a[44:47], v[224:231], v13
    s_waitcnt lgkmcnt(0)
    s_mul_i32 s66, s66, 165888
    v_cmp_le_u32 vcc, 96, v6
    buffer_load_dwordx4 a[136:139], v4, s[28:31], s78 offen offset:0 sc1
    v_exp_f32 v236, v236
    v_exp_f32 v237, v237
    v_exp_f32 v238, v238
    v_exp_f32 v239, v239
    v_mfma_f32_32x32x16_bf16 v[208:223], a[36:39], a[228:231], v[240:255]
    s_cbranch_vccz L_spin26
L_back26:
    ds_read_b128 a[32:35], v7 offset:40960
    ds_read_b64 a[40:41], v2 offset:45056
    v_exp_f32 v192, v192
    v_exp_f32 v193, v193
    v_exp_f32 v194, v194
    v_exp_f32 v195, v195
    v_mfma_f32_32x32x8_bf16 v[208:223], a[42:43], v[46:47], v[208:223]
    v_exp_f32 v196, v196
    v_exp_f32 v197, v197
    v_exp_f32 v198, v198
    v_exp_f32 v199, v199
    v_smfmac_f32_32x32x32_bf16 a[16:31], a[48:51], v[232:239], v13
    s_add_u32 s65, s66, s60
    s_add_u32 m0, s73, 4608
    ds_read_b128 a[44:47], v3 offset:45568
    ds_read_b128 a[48:51], v3 offset:46176
    buffer_load_dwordx4 v1, s[24:27], s65 offen lds
    v_exp_f32 v200, v200
    v_exp_f32 v201, v201
    v_exp_f32 v202, v202
    v_exp_f32 v203, v203
    v_smfmac_f32_32x32x32_bf16 a[0:15], a[52:55], v[192:199], v13
    s_waitcnt lgkmcnt(2)
    v_exp_f32 v204, v204
    v_exp_f32 v205, v205
    v_exp_f32 v206, v206
    v_exp_f32 v207, v207
    v_mfma_f32_32x32x16_bf16 v[224:239], a[32:35], a[224:227], v[16:31]
    s_add_u32 s66, s66, s61
    buffer_load_dwordx4 a[140:143], v4, s[28:31], s78 offen offset:1024 sc1
    v_exp_f32 v208, v208
    v_exp_f32 v209, v209
    v_exp_f32 v210, v210
    v_exp_f32 v211, v211
    v_mfma_f32_32x32x8_bf16 v[224:239], a[40:41], v[32:33], v[224:239]
    v_exp_f32 v212, v212
    v_exp_f32 v213, v213
    v_exp_f32 v214, v214
    v_exp_f32 v215, v215
    v_smfmac_f32_32x32x32_bf16 a[0:15], a[56:59], v[200:207], v13
    s_add_u32 m0, s73, 5568
    v_exp_f32 v216, v216
    v_exp_f32 v217, v217
    v_exp_f32 v218, v218
    v_exp_f32 v219, v219
    v_smfmac_f32_32x32x32_bf16 a[16:31], a[52:55], v[208:215], v13
    s_waitcnt lgkmcnt(0)
    buffer_load_dwordx4 v1, s[24:27], s65 offen offset:64 lds
    v_exp_f32 v220, v220
    v_exp_f32 v221, v221
    v_exp_f32 v222, v222
    v_exp_f32 v223, v223
    v_mfma_f32_32x32x16_bf16 v[192:207], a[32:35], a[228:231], v[240:255]
    ds_read_b128 a[36:39], v7 offset:41984
    v_exp_f32 v224, v224
    v_exp_f32 v225, v225
    v_exp_f32 v226, v226
    v_exp_f32 v227, v227
    v_mfma_f32_32x32x8_bf16 v[192:207], a[40:41], v[40:41], v[192:207]
    v_exp_f32 v228, v228
    v_exp_f32 v229, v229
    v_exp_f32 v230, v230
    v_exp_f32 v231, v231
    v_smfmac_f32_32x32x32_bf16 a[16:31], a[56:59], v[216:223], v13
L_q10:
    s_cbranch_execz L_wret
    ds_read_b128 a[52:55], v3 offset:46784
    ds_read_b128 a[56:59], v3 offset:47392
    buffer_load_dwordx4 a[144:147], v4, s[28:31], s78 offen offset:2048 sc1
    v_exp_f32 v232, v232
    v_exp_f32 v233, v233
    v_exp_f32 v234, v234
    v_exp_f32 v235, v235
    v_smfmac_f32_32x32x32_bf16 a[0:15], a[44:47], v[224:231], v13
    s_waitcnt lgkmcnt(2)
    s_add_u32 m0, s73, 6656
    v_exp_f32 v236, v236
    v_exp_f32 v237, v237
    v_exp_f32 v238, v238
    v_exp_f32 v239, v239
    v_mfma_f32_32x32x16_bf16 v[208:223], a[36:39], a[224:227], v[16:31]
    buffer_load_dword v10, s[24:27], s66 offen lds
    v_exp_f32 v192, v192
    v_exp_f32 v193, v193
    v_exp_f32 v194, v194
    v_exp_f32 v195, v195
    v_mfma_f32_32x32x8_bf16 v[208:223], a[40:41], v[34:35], v[208:223]
    v_exp_f32 v196, v196
    v_exp_f32 v197, v197
    v_exp_f32 v198, v198
    v_exp_f32 v199, v199
    v_smfmac_f32_32x32x32_bf16 a[0:15], a[48:51], v[232:239], v13
    s_xor_b32 s66, s76, 3
    s_mul_i32 s66, s66, 165888
    v_exp_f32 v200, v200
    v_exp_f32 v201, v201
    v_exp_f32 v202, v202
    v_exp_f32 v203, v203
    v_smfmac_f32_32x32x32_bf16 a[16:31], a[44:47], v[192:199], v13
    s_waitcnt lgkmcnt(0)
    s_add_u32 s67, s72, 132608
    buffer_load_dwordx4 a[148:151], v4, s[28:31], s78 offen offset:3072 sc1
    v_exp_f32 v204, v204
    v_exp_f32 v205, v205
    v_exp_f32 v206, v206
    v_exp_f32 v207, v207
    v_mfma_f32_32x32x16_bf16 v[224:239], a[36:39], a[228:231], v[240:255]
    s_add_u32 m0, s72, 20480
    ds_read_b128 a[32:35], v7 offset:43008
    v_exp_f32 v208, v208
    v_exp_f32 v209, v209
    v_exp_f32 v210, v210
    v_exp_f32 v211, v211
    v_mfma_f32_32x32x8_bf16 v[224:239], a[40:41], v[42:43], v[224:239]
    v_exp_f32 v212, v212
    v_exp_f32 v213, v213
    v_exp_f32 v214, v214
    v_exp_f32 v215, v215
    v_smfmac_f32_32x32x32_bf16 a[16:31], a[48:51], v[200:207], v13
    s_add_u32 s65, s66, s60
    ds_read_b128 a[44:47], v3 offset:48000
    ds_read_b128 a[48:51], v3 offset:48608
    buffer_load_dwordx4 v7, s[28:31], s67 offen sc1 lds
    v_exp_f32 v216, v216
    v_exp_f32 v217, v217
    v_exp_f32 v218, v218
    v_exp_f32 v219, v219
    v_smfmac_f32_32x32x32_bf16 a[0:15], a[52:55], v[208:215], v13
    s_waitcnt lgkmcnt(2)
    s_add_u32 m0, s73, 6912
    v_exp_f32 v220, v220
    v_exp_f32 v221, v221
    v_exp_f32 v222, v222
    v_exp_f32 v223, v223
    v_mfma_f32_32x32x16_bf16 v[192:207], a[32:35], a[224:227], v[16:31]
    buffer_load_dwordx4 v1, s[24:27], s65 offen lds
    v_exp_f32 v224, v224
    v_exp_f32 v225, v225
    v_exp_f32 v226, v226
    v_exp_f32 v227, v227
    v_mfma_f32_32x32x8_bf16 v[192:207], a[40:41], v[36:37], v[192:207]
    v_exp_f32 v228, v228
    v_exp_f32 v229, v229
    v_exp_f32 v230, v230
    v_exp_f32 v231, v231
    v_smfmac_f32_32x32x32_bf16 a[0:15], a[56:59], v[216:223], v13
    s_add_u32 s44, s44, 262144
    v_exp_f32 v232, v232
    v_exp_f32 v233, v233
    v_exp_f32 v234, v234
    v_exp_f32 v235, v235
    v_smfmac_f32_32x32x32_bf16 a[16:31], a[52:55], v[224:231], v13
    s_waitcnt lgkmcnt(0)
    v_mov_b32 v49, 1
    s_mov_b32 exec_hi, 0
    buffer_load_dword v49, v50, s[28:31], s44 offen sc1
    s_mov_b64 exec, -1
    v_exp_f32 v236, v236
    v_exp_f32 v237, v237
    v_exp_f32 v238, v238
    v_exp_f32 v239, v239
    v_mfma_f32_32x32x16_bf16 v[208:223], a[32:35], a[228:231], v[240:255]
    s_add_u32 s78, s38, 884736
    ds_read_b128 a[36:39], v7 offset:44032
    v_exp_f32 v192, v192
    v_exp_f32 v193, v193
    v_exp_f32 v194, v194
    v_exp_f32 v195, v195
    v_mfma_f32_32x32x8_bf16 v[208:223], a[40:41], v[44:45], v[208:223]
    v_exp_f32 v196, v196
    v_exp_f32 v197, v197
    v_exp_f32 v198, v198
    v_exp_f32 v199, v199
    v_smfmac_f32_32x32x32_bf16 a[16:31], a[56:59], v[232:239], v13
    s_add_u32 s66, s66, s61
    ds_read_b128 a[52:55], v3 offset:49216
    ds_read_b128 a[56:59], v3 offset:49824
    buffer_load_dwordx4 a[172:175], v4, s[28:31], s78 offen offset:0 sc1
    v_exp_f32 v200, v200
    v_exp_f32 v201, v201
    v_exp_f32 v202, v202
    v_exp_f32 v203, v203
    v_smfmac_f32_32x32x32_bf16 a[0:15], a[44:47], v[192:199], v13
    s_waitcnt lgkmcnt(2)
    s_add_u32 m0, s73, 7872
    v_exp_f32 v204, v204
    v_exp_f32 v205, v205
    v_exp_f32 v206, v206
    v_exp_f32 v207, v207
    v_mfma_f32_32x32x16_bf16 v[224:239], a[36:39], a[224:227], v[16:31]
    buffer_load_dwordx4 v1, s[24:27], s65 offen offset:64 lds
    v_exp_f32 v208, v208
    v_exp_f32 v209, v209
    v_exp_f32 v210, v210
    v_exp_f32 v211, v211
    v_mfma_f32_32x32x8_bf16 v[224:239], a[40:41], v[38:39], v[224:239]
    v_exp_f32 v212, v212
    v_exp_f32 v213, v213
    v_exp_f32 v214, v214
    v_exp_f32 v215, v215
    v_smfmac_f32_32x32x32_bf16 a[0:15], a[48:51], v[200:207], v13
    v_exp_f32 v216, v216
    v_exp_f32 v217, v217
    v_exp_f32 v218, v218
    v_exp_f32 v219, v219
    v_smfmac_f32_32x32x32_bf16 a[16:31], a[44:47], v[208:215], v13
    s_waitcnt lgkmcnt(0)
    s_add_u32 s67, s72, 136704
    buffer_load_dwordx4 a[176:179], v4, s[28:31], s78 offen offset:1024 sc1
    v_exp_f32 v220, v220
    v_exp_f32 v221, v221
    v_exp_f32 v222, v222
    v_exp_f32 v223, v223
    v_mfma_f32_32x32x16_bf16 v[192:207], a[36:39], a[228:231], v[240:255]
    s_add_u32 m0, s72, 24576
    ds_read_b128 a[32:35], v7 offset:50432
    ds_read_b64 a[42:43], v2 offset:54528
    v_exp_f32 v224, v224
    v_exp_f32 v225, v225
    v_exp_f32 v226, v226
    v_exp_f32 v227, v227
    v_mfma_f32_32x32x8_bf16 v[192:207], a[40:41], v[46:47], v[192:207]
    v_exp_f32 v228, v228
    v_exp_f32 v229, v229
    v_exp_f32 v230, v230
    v_exp_f32 v231, v231
    v_smfmac_f32_32x32x32_bf16 a[16:31], a[48:51], v[216:223], v13
    ds_read_b128 a[44:47], v3 offset:55040
    ds_read_b128 a[48:51], v3 offset:55648
    buffer_load_dwordx4 v7, s[28:31], s67 offen sc1 lds
    v_exp_f32 v232, v232
    v_exp_f32 v233, v233
    v_exp_f32 v234, v234
    v_exp_f32 v235, v235
    v_smfmac_f32_32x32x32_bf16 a[0:15], a[52:55], v[224:231], v13
    s_waitcnt lgkmcnt(2)
    s_add_u32 m0, s73, 8960
    v_exp_f32 v236, v236
    v_exp_f32 v237, v237
    v_exp_f32 v238, v238
    v_exp_f32 v239, v239
    v_mfma_f32_32x32x16_bf16 v[208:223], a[32:35], a[224:227], v[16:31]
    buffer_load_dword v10, s[24:27], s66 offen lds
    v_exp_f32 v192, v192
    v_exp_f32 v193, v193
    v_exp_f32 v194, v194
    v_exp_f32 v195, v195
    v_mfma_f32_32x32x8_bf16 v[208:223], a[42:43], v[32:33], v[208:223]
    v_exp_f32 v196, v196
    v_exp_f32 v197, v197
    v_exp_f32 v198, v198
    v_exp_f32 v199, v199
    v_smfmac_f32_32x32x32_bf16 a[0:15], a[56:59], v[232:239], v13
    v_exp_f32 v200, v200
    v_exp_f32 v201, v201
    v_exp_f32 v202, v202
    v_exp_f32 v203, v203
    v_smfmac_f32_32x32x32_bf16 a[16:31], a[52:55], v[192:199], v13
    s_waitcnt lgkmcnt(0)
    s_add_u32 s67, s72, 140800
    buffer_load_dwordx4 a[180:183], v4, s[28:31], s78 offen offset:2048 sc1
    v_exp_f32 v204, v204
    v_exp_f32 v205, v205
    v_exp_f32 v206, v206
    v_exp_f32 v207, v207
    v_mfma_f32_32x32x16_bf16 v[224:239], a[32:35], a[228:231], v[240:255]
    s_add_u32 m0, s72, 28672
    ds_read_b128 a[36:39], v7 offset:51456
    v_exp_f32 v208, v208
    v_exp_f32 v209, v209
    v_exp_f32 v210, v210
    v_exp_f32 v211, v211
    v_mfma_f32_32x32x8_bf16 v[224:239], a[42:43], v[40:41], v[224:239]
    v_exp_f32 v212, v212
    v_exp_f32 v213, v213
    v_exp_f32 v214, v214
    v_exp_f32 v215, v215
    v_smfmac_f32_32x32x32_bf16 a[16:31], a[56:59], v[200:207], v13
    ds_read_b128 a[52:55], v3 offset:56256
    ds_read_b128 a[56:59], v3 offset:56864
    buffer_load_dwordx4 v7, s[28:31], s67 offen sc1 lds
    v_exp_f32 v216, v216
    v_exp_f32 v217, v217
    v_exp_f32 v218, v218
    v_exp_f32 v219, v219
    v_smfmac_f32_32x32x32_bf16 a[0:15], a[44:47], v[208:215], v13
    s_waitcnt lgkmcnt(2)
    s_xor_b32 s66, s76, 0
    v_add_u32 v10, 20736, v10
    v_add_u32 v1, 20736, v1
    v_exp_f32 v220, v220
    v_exp_f32 v221, v221
    v_exp_f32 v222, v222
    v_exp_f32 v223, v223
    v_mfma_f32_32x32x16_bf16 v[192:207], a[36:39], a[224:227], v[16:31]
    s_mul_i32 s66, s66, 165888
    buffer_load_dwordx4 a[184:187], v4, s[28:31], s78 offen offset:3072 sc1
    v_exp_f32 v224, v224
    v_exp_f32 v225, v225
    v_exp_f32 v226, v226
    v_exp_f32 v227, v227
    v_mfma_f32_32x32x8_bf16 v[192:207], a[42:43], v[34:35], v[192:207]
    v_exp_f32 v228, v228
    v_exp_f32 v229, v229
    v_exp_f32 v230, v230
    v_exp_f32 v231, v231
    v_smfmac_f32_32x32x32_bf16 a[0:15], a[48:51], v[216:223], v13
    s_waitcnt vmcnt(8)
    s_add_u32 s67, s72, 144896
    v_cmp_gt_u32 vcc, 1, v49
    v_exp_f32 v232, v232
    v_exp_f32 v233, v233
    v_exp_f32 v234, v234
    v_exp_f32 v235, v235
    v_smfmac_f32_32x32x32_bf16 a[16:31], a[44:47], v[224:231], v13
    s_waitcnt lgkmcnt(0)
    s_cbranch_vccnz L_spin21
L_back21:
    v_exp_f32 v236, v236
    v_exp_f32 v237, v237
    v_exp_f32 v238, v238
    v_exp_f32 v239, v239
    v_mfma_f32_32x32x16_bf16 v[208:223], a[36:39], a[228:231], v[240:255]
    s_add_u32 m0, s72, 32768
    ds_read_b128 a[32:35], v7 offset:52480
    v_exp_f32 v192, v192
    v_exp_f32 v193, v193
    v_exp_f32 v194, v194
    v_exp_f32 v195, v195
    v_mfma_f32_32x32x8_bf16 v[208:223], a[42:43], v[42:43], v[208:223]
    v_exp_f32 v196, v196
    v_exp_f32 v197, v197
    v_exp_f32 v198, v198
    v_exp_f32 v199, v199
    v_smfmac_f32_32x32x32_bf16 a[16:31], a[48:51], v[232:239], v13
    s_add_u32 s65, s66, s60
    ds_read_b128 a[44:47], v3 offset:57472
    ds_read_b128 a[48:51], v3 offset:58080
    buffer_load_dwordx4 v7, s[28:31], s67 offen sc1 lds
    v_exp_f32 v200, v200
    v_exp_f32 v201, v201
    v_exp_f32 v202, v202
    v_exp_f32 v203, v203
    v_smfmac_f32_32x32x32_bf16 a[0:15], a[52:55], v[192:199], v13
    s_waitcnt lgkmcnt(2)
    s_add_u32 m0, s73, 9216
    v_exp_f32 v204, v204
    v_exp_f32 v205, v205
    v_exp_f32 v206, v206
    v_exp_f32 v207, v207
    v_mfma_f32_32x32x16_bf16 v[224:239], a[32:35], a[224:227], v[16:31]
    buffer_load_dwordx4 v1, s[24:27], s65 offen lds
    v_exp_f32 v208, v208
    v_exp_f32 v209, v209
    v_exp_f32 v210, v210
    v_exp_f32 v211, v211
    v_mfma_f32_32x32x8_bf16 v[224:239], a[42:43], v[36:37], v[224:239]
    v_exp_f32 v212, v212
    v_exp_f32 v213, v213
    v_exp_f32 v214, v214
    v_exp_f32 v215, v215
    v_smfmac_f32_32x32x32_bf16 a[0:15], a[56:59], v[200:207], v13
    s_add_u32 s78, s38, 4096
    v_exp_f32 v216, v216
    v_exp_f32 v217, v217
    v_exp_f32 v218, v218
    v_exp_f32 v219, v219
    v_smfmac_f32_32x32x32_bf16 a[16:31], a[52:55], v[208:215], v13
    s_waitcnt lgkmcnt(0)
    buffer_load_dwordx4 a[80:83], v4, s[28:31], s78 offen offset:0 sc1
    v_exp_f32 v220, v220
    v_exp_f32 v221, v221
    v_exp_f32 v222, v222
    v_exp_f32 v223, v223
    v_mfma_f32_32x32x16_bf16 v[192:207], a[32:35], a[228:231], v[240:255]
    ds_read_b128 a[36:39], v7 offset:53504
    v_exp_f32 v224, v224
    v_exp_f32 v225, v225
    v_exp_f32 v226, v226
    v_exp_f32 v227, v227
    v_mfma_f32_32x32x8_bf16 v[192:207], a[42:43], v[44:45], v[192:207]
    v_exp_f32 v228, v228
    v_exp_f32 v229, v229
    v_exp_f32 v230, v230
    v_exp_f32 v231, v231
    v_smfmac_f32_32x32x32_bf16 a[16:31], a[56:59], v[216:223], v13
    s_add_u32 s67, s72, 148992
    ds_read_b128 a[52:55], v3 offset:58688
    ds_read_b128 a[56:59], v3 offset:59296
    buffer_load_dwordx4 a[84:87], v4, s[28:31], s78 offen offset:1024 sc1
    v_exp_f32 v232, v232
    v_exp_f32 v233, v233
    v_exp_f32 v234, v234
    v_exp_f32 v235, v235
    v_smfmac_f32_32x32x32_bf16 a[0:15], a[44:47], v[224:231], v13
    s_waitcnt vmcnt(25) lgkmcnt(2)
    s_add_u32 m0, s72, 36864
    ds_add_u32 v11, v9
    v_exp_f32 v236, v236
    v_exp_f32 v237, v237
    v_exp_f32 v238, v238
    v_exp_f32 v239, v239
    v_mfma_f32_32x32x16_bf16 v[208:223], a[36:39], a[224:227], v[16:31]
    s_add_u32 s66, s66, s61
    buffer_load_dwordx4 v7, s[28:31], s67 offen sc1 lds
    v_exp_f32 v192, v192
    v_exp_f32 v193, v193
    v_exp_f32 v194, v194
    v_exp_f32 v195, v195
    v_mfma_f32_32x32x8_bf16 v[208:223], a[42:43], v[38:39], v[208:223]
    ds_read_b32 v6, v11
    v_exp_f32 v196, v196
    v_exp_f32 v197, v197
    v_exp_f32 v198, v198
    v_exp_f32 v199, v199
    v_smfmac_f32_32x32x32_bf16 a[0:15], a[48:51], v[232:239], v13
    s_add_u32 m0, s73, 10176
    v_exp_f32 v200, v200
    v_exp_f32 v201, v201
    v_exp_f32 v202, v202
    v_exp_f32 v203, v203
    v_smfmac_f32_32x32x32_bf16 a[16:31], a[44:47], v[192:199], v13
    s_waitcnt lgkmcnt(0)
    v_cmp_le_u32 vcc, 100, v6
    buffer_load_dwordx4 v1, s[24:27], s65 offen offset:64 lds
    v_exp_f32 v204, v204
    v_exp_f32 v205, v205
    v_exp_f32 v206, v206
    v_exp_f32 v207, v207
    v_mfma_f32_32x32x16_bf16 v[224:239], a[36:39], a[228:231], v[240:255]
    s_cbranch_vccz L_spin27
L_back27:
    ds_read_b128 a[32:35], v7 offset:0
    ds_read_b64 a[40:41], v2 offset:4096
    v_exp_f32 v208, v208
    v_exp_f32 v209, v209
    v_exp_f32 v210, v210
    v_exp_f32 v211, v211
    v_mfma_f32_32x32x8_bf16 v[224:239], a[42:43], v[46:47], v[224:239]
    v_exp_f32 v212, v212
    v_exp_f32 v213, v213
    v_exp_f32 v214, v214
    v_exp_f32 v215, v215
    v_smfmac_f32_32x32x32_bf16 a[16:31], a[48:51], v[200:207], v13
    s_add_u32 m0, s73, 11264
    ds_read_b128 a[44:47], v3 offset:4608
    ds_read_b128 a[48:51], v3 offset:5216
    buffer_load_dword v10, s[24:27], s66 offen lds
    v_exp_f32 v216, v216
    v_exp_f32 v217, v217
    v_exp_f32 v218, v218
    v_exp_f32 v219, v219
    v_smfmac_f32_32x32x32_bf16 a[0:15], a[52:55], v[208:215], v13
    s_waitcnt lgkmcnt(2)
    v_exp_f32 v220, v220
    v_exp_f32 v221, v221
    v_exp_f32 v222, v222
    v_exp_f32 v223, v223
    v_mfma_f32_32x32x16_bf16 v[192:207], a[32:35], a[224:227], v[16:31]
    s_xor_b32 s66, s76, 1
    buffer_load_dwordx4 a[88:91], v4, s[28:31], s78 offen offset:2048 sc1
    v_exp_f32 v224, v224
    v_exp_f32 v225, v225
    v_exp_f32 v226, v226
    v_exp_f32 v227, v227
    v_mfma_f32_32x32x8_bf16 v[192:207], a[40:41], v[32:33], v[192:207]
    v_exp_f32 v228, v228
    v_exp_f32 v229, v229
    v_exp_f32 v230, v230
    v_exp_f32 v231, v231
    v_smfmac_f32_32x32x32_bf16 a[0:15], a[56:59], v[216:223], v13
    s_mul_i32 s66, s66, 165888
    v_exp_f32 v232, v232
    v_exp_f32 v233, v233
    v_exp_f32 v234, v234
    v_exp_f32 v235, v235
    v_smfmac_f32_32x32x32_bf16 a[16:31], a[52:55], v[224:231], v13
    s_waitcnt lgkmcnt(0)
    s_add_u32 s65, s66, s60
    buffer_load_dwordx4 a[92:95], v4, s[28:31], s78 offen offset:3072 sc1
    v_exp_f32 v236, v236
    v_exp_f32 v237, v237
    v_exp_f32 v238, v238
    v_exp_f32 v239, v239
    v_mfma_f32_32x32x16_bf16 v[208:223], a[32:35], a[228:231], v[240:255]
    s_add_u32 m0, s73, 11520
    ds_read_b128 a[36:39], v7 offset:1024
    v_exp_f32 v192, v192
    v_exp_f32 v193, v193
    v_exp_f32 v194, v194
    v_exp_f32 v195, v195
    v_mfma_f32_32x32x8_bf16 v[208:223], a[40:41], v[40:41], v[208:223]
    v_exp_f32 v196, v196
    v_exp_f32 v197, v197
    v_exp_f32 v198, v198
    v_exp_f32 v199, v199
    v_smfmac_f32_32x32x32_bf16 a[16:31], a[56:59], v[232:239], v13
    s_add_u32 s66, s66, s61
    ds_read_b128 a[52:55], v3 offset:5824
    ds_read_b128 a[56:59], v3 offset:6432
    buffer_load_dwordx4 v1, s[24:27], s65 offen lds
    v_exp_f32 v200, v200
    v_exp_f32 v201, v201
    v_exp_f32 v202, v202
    v_exp_f32 v203, v203
    v_smfmac_f32_32x32x32_bf16 a[0:15], a[44:47], v[192:199], v13
    s_waitcnt lgkmcnt(2)
    s_add_u32 m0, s73, 12480
    v_exp_f32 v204, v204
    v_exp_f32 v205, v205
    v_exp_f32 v206, v206
    v_exp_f32 v207, v207
    v_mfma_f32_32x32x16_bf16 v[224:239], a[36:39], a[224:227], v[16:31]
    buffer_load_dwordx4 v1, s[24:27], s65 offen offset:64 lds
    v_exp_f32 v208, v208
    v_exp_f32 v209, v209
    v_exp_f32 v210, v210
    v_exp_f32 v211, v211
    v_mfma_f32_32x32x8_bf16 v[224:239], a[40:41], v[34:35], v[224:239]
    v_exp_f32 v212, v212
    v_exp_f32 v213, v213
    v_exp_f32 v214, v214
    v_exp_f32 v215, v215
    v_smfmac_f32_32x32x32_bf16 a[0:15], a[48:51], v[200:207], v13
    s_add_u32 s78, s39, 0
    v_exp_f32 v216, v216
    v_exp_f32 v217, v217
    v_exp_f32 v218, v218
    v_exp_f32 v219, v219
    v_smfmac_f32_32x32x32_bf16 a[16:31], a[44:47], v[208:215], v13
    s_waitcnt lgkmcnt(0)
    buffer_load_dwordx4 a[96:99], v4, s[28:31], s78 offen offset:0 sc1
    v_exp_f32 v220, v220
    v_exp_f32 v221, v221
    v_exp_f32 v222, v222
    v_exp_f32 v223, v223
    v_mfma_f32_32x32x16_bf16 v[192:207], a[36:39], a[228:231], v[240:255]
    s_add_u32 m0, s73, 13568
    ds_read_b128 a[32:35], v7 offset:2048
    v_exp_f32 v224, v224
    v_exp_f32 v225, v225
    v_exp_f32 v226, v226
    v_exp_f32 v227, v227
    v_mfma_f32_32x32x8_bf16 v[192:207], a[40:41], v[42:43], v[192:207]
    v_exp_f32 v228, v228
    v_exp_f32 v229, v229
    v_exp_f32 v230, v230
    v_exp_f32 v231, v231
    v_smfmac_f32_32x32x32_bf16 a[16:31], a[48:51], v[216:223], v13
    ds_read_b128 a[44:47], v3 offset:7040
    ds_read_b128 a[48:51], v3 offset:7648
    buffer_load_dword v10, s[24:27], s66 offen lds
    v_exp_f32 v232, v232
    v_exp_f32 v233, v233
    v_exp_f32 v234, v234
    v_exp_f32 v235, v235
    v_smfmac_f32_32x32x32_bf16 a[0:15], a[52:55], v[224:231], v13
    s_waitcnt lgkmcnt(2)
    s_add_u32 s78, s38, 299008
    v_exp_f32 v236, v236
    v_exp_f32 v237, v237
    v_exp_f32 v238, v238
    v_exp_f32 v239, v239
    v_mfma_f32_32x32x16_bf16 v[208:223], a[32:35], a[224:227], v[16:31]
    s_xor_b32 s66, s76, 2
    buffer_load_dwordx4 a[116:119], v4, s[28:31], s78 offen offset:0 sc1
    v_exp_f32 v192, v192
    v_exp_f32 v193, v193
    v_exp_f32 v194, v194
    v_exp_f32 v195, v195
    v_mfma_f32_32x32x8_bf16 v[208:223], a[40:41], v[36:37], v[208:223]
    v_exp_f32 v196, v196
    v_exp_f32 v197, v197
    v_exp_f32 v198, v198
    v_exp_f32 v199, v199
    v_smfmac_f32_32x32x32_bf16 a[0:15], a[56:59], v[232:239], v13
    s_mul_i32 s66, s66, 165888
    s_add_u32 s65, s66, s60
    v_exp_f32 v200, v200
    v_exp_f32 v201, v201
    v_exp_f32 v202, v202
    v_exp_f32 v203, v203
    v_smfmac_f32_32x32x32_bf16 a[16:31], a[52:55], v[192:199], v13
    s_waitcnt lgkmcnt(0)
    s_add_u32 m0, s73, 13824
    s_nop 0
    buffer_load_dwordx4 v1, s[24:27], s65 offen lds
    v_exp_f32 v204, v204
    v_exp_f32 v205, v205
    v_exp_f32 v206, v206
    v_exp_f32 v207, v207
    v_mfma_f32_32x32x16_bf16 v[224:239], a[32:35], a[228:231], v[240:255]
    ds_read_b128 a[36:39], v7 offset:3072
    v_exp_f32 v208, v208
    v_exp_f32 v209, v209
    v_exp_f32 v210, v210
    v_exp_f32 v211, v211
    v_mfma_f32_32x32x8_bf16 v[224:239], a[40:41], v[44:45], v[224:239]
    v_exp_f32 v212, v212
    v_exp_f32 v213, v213
    v_exp_f32 v214, v214
    v_exp_f32 v215, v215
    v_smfmac_f32_32x32x32_bf16 a[16:31], a[56:59], v[200:207], v13
    ds_read_b128 a[52:55], v3 offset:8256
    ds_read_b128 a[56:59], v3 offset:8864
    buffer_load_dwordx4 a[120:123], v4, s[28:31], s78 offen offset:1024 sc1
    v_exp_f32 v216, v216
    v_exp_f32 v217, v217
    v_exp_f32 v218, v218
    v_exp_f32 v219, v219
    v_smfmac_f32_32x32x32_bf16 a[0:15], a[44:47], v[208:215], v13
    s_waitcnt lgkmcnt(2)
    v_exp_f32 v220, v220
    v_exp_f32 v221, v221
    v_exp_f32 v222, v222
    v_exp_f32 v223, v223
    v_mfma_f32_32x32x16_bf16 v[192:207], a[36:39], a[224:227], v[16:31]
    s_add_u32 s66, s66, s61
    v_and_b32 v58, 31, v0
    v_lshlrev_b32 v58, 7, v58
    buffer_load_dword v51, v58, s[28:31], s46 offen sc1
    v_exp_f32 v224, v224
    v_exp_f32 v225, v225
    v_exp_f32 v226, v226
    v_exp_f32 v227, v227
    v_mfma_f32_32x32x8_bf16 v[192:207], a[40:41], v[38:39], v[192:207]
    v_exp_f32 v228, v228
    v_exp_f32 v229, v229
    v_exp_f32 v230, v230
    v_exp_f32 v231, v231
    v_smfmac_f32_32x32x32_bf16 a[0:15], a[48:51], v[216:223], v13
    s_add_u32 m0, s73, 14784
    v_exp_f32 v232, v232
    v_exp_f32 v233, v233
    v_exp_f32 v234, v234
    v_exp_f32 v235, v235
    v_smfmac_f32_32x32x32_bf16 a[16:31], a[44:47], v[224:231], v13
    s_waitcnt lgkmcnt(0)
    buffer_load_dwordx4 v1, s[24:27], s65 offen offset:64 lds
    v_exp_f32 v236, v236
    v_exp_f32 v237, v237
    v_exp_f32 v238, v238
    v_exp_f32 v239, v239
    v_mfma_f32_32x32x16_bf16 v[208:223], a[36:39], a[228:231], v[240:255]
    ds_read_b128 a[32:35], v7 offset:9472
    ds_read_b64 a[42:43], v2 offset:13568
    v_exp_f32 v192, v192
    v_exp_f32 v193, v193
    v_exp_f32 v194, v194
    v_exp_f32 v195, v195
    v_mfma_f32_32x32x8_bf16 v[208:223], a[40:41], v[46:47], v[208:223]
    v_exp_f32 v196, v196
    v_exp_f32 v197, v197
    v_exp_f32 v198, v198
    v_exp_f32 v199, v199
    v_smfmac_f32_32x32x32_bf16 a[16:31], a[48:51], v[232:239], v13
    ds_read_b128 a[44:47], v3 offset:14080
    ds_read_b128 a[48:51], v3 offset:14688
    buffer_load_dwordx4 a[124:127], v4, s[28:31], s78 offen offset:2048 sc1
    v_exp_f32 v200, v200
    v_exp_f32 v201, v201
    v_exp_f32 v202, v202
    v_exp_f32 v203, v203
    v_smfmac_f32_32x32x32_bf16 a[0:15], a[52:55], v[192:199], v13
    s_waitcnt lgkmcnt(2)
    v_exp_f32 v204, v204
    v_exp_f32 v205, v205
    v_exp_f32 v206, v206
    v_exp_f32 v207, v207
    v_mfma_f32_32x32x16_bf16 v[224:239], a[32:35], a[224:227], v[16:31]
    v_lshlrev_b32 v58, 3, v14
    buffer_load_dword v52, v58, s[28:31], s47 offen sc1
    v_exp_f32 v208, v208
    v_exp_f32 v209, v209
    v_exp_f32 v210, v210
    v_exp_f32 v211, v211
    v_mfma_f32_32x32x8_bf16 v[224:239], a[42:43], v[32:33], v[224:239]
    v_exp_f32 v212, v212
    v_exp_f32 v213, v213
    v_exp_f32 v214, v214
    v_exp_f32 v215, v215
    v_smfmac_f32_32x32x32_bf16 a[0:15], a[56:59], v[200:207], v13
    s_add_u32 m0, s73, 15872
    v_exp_f32 v216, v216
    v_exp_f32 v217, v217
    v_exp_f32 v218, v218
    v_exp_f32 v219, v219
    v_smfmac_f32_32x32x32_bf16 a[16:31], a[52:55], v[208:215], v13
    s_waitcnt lgkmcnt(0)
    buffer_load_dword v10, s[24:27], s66 offen lds
    v_exp_f32 v220, v220
    v_exp_f32 v221, v221
    v_exp_f32 v222, v222
    v_exp_f32 v223, v223
    v_mfma_f32_32x32x16_bf16 v[192:207], a[32:35], a[228:231], v[240:255]
    ds_read_b128 a[36:39], v7 offset:10496
    v_exp_f32 v224, v224
    v_exp_f32 v225, v225
    v_exp_f32 v226, v226
    v_exp_f32 v227, v227
    v_mfma_f32_32x32x8_bf16 v[192:207], a[42:43], v[40:41], v[192:207]
    v_exp_f32 v228, v228
    v_exp_f32 v229, v229
    v_exp_f32 v230, v230
    v_exp_f32 v231, v231
    v_smfmac_f32_32x32x32_bf16 a[16:31], a[56:59], v[216:223], v13
    s_xor_b32 s66, s76, 3
    ds_read_b128 a[52:55], v3 offset:15296
    ds_read_b128 a[56:59], v3 offset:15904
    buffer_load_dwordx4 a[128:131], v4, s[28:31], s78 offen offset:3072 sc1
    v_exp_f32 v232, v232
    v_exp_f32 v233, v233
    v_exp_f32 v234, v234
    v_exp_f32 v235, v235
    v_smfmac_f32_32x32x32_bf16 a[0:15], a[44:47], v[224:231], v13
    s_waitcnt lgkmcnt(2)
    s_mul_i32 s66, s66, 165888
    v_exp_f32 v236, v236
    v_exp_f32 v237, v237
    v_exp_f32 v238, v238
    v_exp_f32 v239, v239
    v_mfma_f32_32x32x16_bf16 v[208:223], a[36:39], a[224:227], v[16:31]
    s_add_u32 s65, s66, s60
    v_lshlrev_b32 v58, 3, v48
    buffer_load_dwordx2 v[172:173], v58, s[40:43], s60 offen offset:0
    v_exp_f32 v192, v192
    v_exp_f32 v193, v193
    v_exp_f32 v194, v194
    v_exp_f32 v195, v195
    v_mfma_f32_32x32x8_bf16 v[208:223], a[42:43], v[34:35], v[208:223]
    v_exp_f32 v196, v196
    v_exp_f32 v197, v197
    v_exp_f32 v198, v198
    v_exp_f32 v199, v199
    v_smfmac_f32_32x32x32_bf16 a[0:15], a[48:51], v[232:239], v13
    s_add_u32 m0, s73, 16128
    v_exp_f32 v200, v200
    v_exp_f32 v201, v201
    v_exp_f32 v202, v202
    v_exp_f32 v203, v203
    v_smfmac_f32_32x32x32_bf16 a[16:31], a[44:47], v[192:199], v13
    s_waitcnt lgkmcnt(0)
    buffer_load_dwordx4 v1, s[24:27], s65 offen lds
    v_exp_f32 v204, v204
    v_exp_f32 v205, v205
    v_exp_f32 v206, v206
    v_exp_f32 v207, v207
    v_mfma_f32_32x32x16_bf16 v[224:239], a[36:39], a[228:231], v[240:255]
    s_add_u32 s78, s39, 294912
    ds_read_b128 a[32:35], v7 offset:11520
    v_exp_f32 v208, v208
    v_exp_f32 v209, v209
    v_exp_f32 v210, v210
    v_exp_f32 v211, v211
    v_mfma_f32_32x32x8_bf16 v[224:239], a[42:43], v[42:43], v[224:239]
    v_exp_f32 v212, v212
    v_exp_f32 v213, v213
    v_exp_f32 v214, v214
    v_exp_f32 v215, v215
    v_smfmac_f32_32x32x32_bf16 a[16:31], a[48:51], v[200:207], v13
    s_add_u32 s66, s66, s61
    ds_read_b128 a[44:47], v3 offset:16512
    ds_read_b128 a[48:51], v3 offset:17120
    buffer_load_dwordx4 a[132:135], v4, s[28:31], s78 offen offset:0 sc1
    v_exp_f32 v216, v216
    v_exp_f32 v217, v217
    v_exp_f32 v218, v218
    v_exp_f32 v219, v219
    v_smfmac_f32_32x32x32_bf16 a[0:15], a[52:55], v[208:215], v13
    s_waitcnt lgkmcnt(2)
    s_add_u32 m0, s73, 17088
    v_exp_f32 v220, v220
    v_exp_f32 v221, v221
    v_exp_f32 v222, v222
    v_exp_f32 v223, v223
    v_mfma_f32_32x32x16_bf16 v[192:207], a[32:35], a[224:227], v[16:31]
    buffer_load_dwordx4 v1, s[24:27], s65 offen offset:64 lds
    v_exp_f32 v224, v224
    v_exp_f32 v225, v225
    v_exp_f32 v226, v226
    v_exp_f32 v227, v227
    v_mfma_f32_32x32x8_bf16 v[192:207], a[42:43], v[36:37], v[192:207]
    v_exp_f32 v228, v228
    v_exp_f32 v229, v229
    v_exp_f32 v230, v230
    v_exp_f32 v231, v231
    v_smfmac_f32_32x32x32_bf16 a[0:15], a[56:59], v[216:223], v13
    v_exp_f32 v232, v232
    v_exp_f32 v233, v233
    v_exp_f32 v234, v234
    v_exp_f32 v235, v235
    v_smfmac_f32_32x32x32_bf16 a[16:31], a[52:55], v[224:231], v13
    s_waitcnt lgkmcnt(0)
    buffer_load_dwordx2 v[174:175], v58, s[40:43], s60 offen offset:32
    v_exp_f32 v236, v236
    v_exp_f32 v237, v237
    v_exp_f32 v238, v238
    v_exp_f32 v239, v239
    v_mfma_f32_32x32x16_bf16 v[208:223], a[32:35], a[228:231], v[240:255]
    s_add_u32 s78, s38, 593920
    ds_read_b128 a[36:39], v7 offset:12544
    v_exp_f32 v192, v192
    v_exp_f32 v193, v193
    v_exp_f32 v194, v194
    v_exp_f32 v195, v195
    v_mfma_f32_32x32x8_bf16 v[208:223], a[42:43], v[44:45], v[208:223]
    v_exp_f32 v196, v196
    v_exp_f32 v197, v197
    v_exp_f32 v198, v198
    v_exp_f32 v199, v199
    v_smfmac_f32_32x32x32_bf16 a[16:31], a[56:59], v[232:239], v13
    ds_read_b128 a[52:55], v3 offset:17728
    ds_read_b128 a[56:59], v3 offset:18336
    buffer_load_dwordx4 a[152:155], v4, s[28:31], s78 offen offset:0 sc1
    v_exp_f32 v200, v200
    v_exp_f32 v201, v201
    v_exp_f32 v202, v202
    v_exp_f32 v203, v203
    v_smfmac_f32_32x32x32_bf16 a[0:15], a[44:47], v[192:199], v13
    s_waitcnt vmcnt(23) lgkmcnt(2)
    s_add_u32 m0, s73, 18176
    ds_add_u32 v11, v9
    v_exp_f32 v204, v204
    v_exp_f32 v205, v205
    v_exp_f32 v206, v206
    v_exp_f32 v207, v207
    v_mfma_f32_32x32x16_bf16 v[224:239], a[36:39], a[224:227], v[16:31]
    buffer_load_dword v10, s[24:27], s66 offen lds
    v_exp_f32 v208, v208
    v_exp_f32 v209, v209
    v_exp_f32 v210, v210
    v_exp_f32 v211, v211
    v_mfma_f32_32x32x8_bf16 v[224:239], a[42:43], v[38:39], v[224:239]
    ds_read_b32 v6, v11
    v_exp_f32 v212, v212
    v_exp_f32 v213, v213
    v_exp_f32 v214, v214
    v_exp_f32 v215, v215
    v_smfmac_f32_32x32x32_bf16 a[0:15], a[48:51], v[200:207], v13
L_q11:
    s_cbranch_execz L_wret
    v_exp_f32 v216, v216
    v_exp_f32 v217, v217
    v_exp_f32 v218, v218
    v_exp_f32 v219, v219
    v_smfmac_f32_32x32x32_bf16 a[16:31], a[44:47], v[208:215], v13
    s_waitcnt lgkmcnt(0)
    v_cmp_le_u32 vcc, 104, v6
    buffer_load_dwordx4 a[156:159], v4, s[28:31], s78 offen offset:1024 sc1
    v_exp_f32 v220, v220
    v_exp_f32 v221, v221
    v_exp_f32 v222, v222
    v_exp_f32 v223, v223
    v_mfma_f32_32x32x16_bf16 v[192:207], a[36:39], a[228:231], v[240:255]
    s_cbranch_vccz L_spin28
L_back28:
    ds_read_b128 a[32:35], v7 offset:20480
    ds_read_b64 a[40:41], v2 offset:24576
    v_exp_f32 v224, v224
    v_exp_f32 v225, v225
    v_exp_f32 v226, v226
    v_exp_f32 v227, v227
    v_mfma_f32_32x32x8_bf16 v[192:207], a[42:43], v[46:47], v[192:207]
    v_exp_f32 v228, v228
    v_exp_f32 v229, v229
    v_exp_f32 v230, v230
    v_exp_f32 v231, v231
    v_smfmac_f32_32x32x32_bf16 a[16:31], a[48:51], v[216:223], v13
    ds_read_b128 a[44:47], v3 offset:25088
    ds_read_b128 a[48:51], v3 offset:25696
    buffer_load_dwordx2 v[176:177], v58, s[40:43], s60 offen offset:64
    v_exp_f32 v232, v232
    v_exp_f32 v233, v233
    v_exp_f32 v234, v234
    v_exp_f32 v235, v235
    v_smfmac_f32_32x32x32_bf16 a[0:15], a[52:55], v[224:231], v13
    s_waitcnt lgkmcnt(2)
    v_accvgpr_read_b32 v1, a236
    v_accvgpr_read_b32 v10, a237
    v_exp_f32 v236, v236
    v_exp_f32 v237, v237
    v_exp_f32 v238, v238
    v_exp_f32 v239, v239
    v_mfma_f32_32x32x16_bf16 v[208:223], a[32:35], a[224:227], v[16:31]
    ds_read_b128 a[36:39], v7 offset:21504
    buffer_load_dwordx4 a[160:163], v4, s[28:31], s78 offen offset:2048 sc1
    v_exp_f32 v192, v192
    v_exp_f32 v193, v193
    v_exp_f32 v194, v194
    v_exp_f32 v195, v195
    v_mfma_f32_32x32x8_bf16 v[208:223], a[40:41], v[32:33], v[208:223]
    v_exp_f32 v196, v196
    v_exp_f32 v197, v197
    v_exp_f32 v198, v198
    v_exp_f32 v199, v199
    v_smfmac_f32_32x32x32_bf16 a[0:15], a[56:59], v[232:239], v13
    v_exp_f32 v200, v200
    v_exp_f32 v201, v201
    v_exp_f32 v202, v202
    v_exp_f32 v203, v203
    v_smfmac_f32_32x32x32_bf16 a[16:31], a[52:55], v[192:199], v13
    s_waitcnt lgkmcnt(0)
    buffer_load_dwordx2 v[178:179], v58, s[40:43], s60 offen offset:96
    v_exp_f32 v204, v204
    v_exp_f32 v205, v205
    v_exp_f32 v206, v206
    v_exp_f32 v207, v207
    v_mfma_f32_32x32x16_bf16 v[224:239], a[36:39], a[224:227], v[16:31]
    s_add_u32 m0, s73, 18432
    ds_read_b128 a[32:35], v7 offset:22528
    v_exp_f32 v208, v208
    v_exp_f32 v209, v209
    v_exp_f32 v210, v210
    v_exp_f32 v211, v211
    v_mfma_f32_32x32x8_bf16 v[224:239], a[40:41], v[34:35], v[224:239]
    v_exp_f32 v212, v212
    v_exp_f32 v213, v213
    v_exp_f32 v214, v214
    v_exp_f32 v215, v215
    v_smfmac_f32_32x32x32_bf16 a[16:31], a[56:59], v[200:207], v13
    ds_read_b128 a[52:55], v3 offset:26304
    ds_read_b128 a[56:59], v3 offset:26912
    buffer_load_dwordx4 v1, s[24:27], s60 offen lds
    v_exp_f32 v216, v216
    v_exp_f32 v217, v217
    v_exp_f32 v218, v218
    v_exp_f32 v219, v219
    v_smfmac_f32_32x32x32_bf16 a[0:15], a[44:47], v[208:215], v13
    s_waitcnt lgkmcnt(2)
    v_exp_f32 v220, v220
    v_exp_f32 v221, v221
    v_exp_f32 v222, v222
    v_exp_f32 v223, v223
    v_mfma_f32_32x32x16_bf16 v[192:207], a[32:35], a[224:227], v[16:31]
    ds_read_b128 a[36:39], v7 offset:23552
    buffer_load_dwordx4 a[164:167], v4, s[28:31], s78 offen offset:3072 sc1
    v_exp_f32 v224, v224
    v_exp_f32 v225, v225
    v_exp_f32 v226, v226
    v_exp_f32 v227, v227
    v_mfma_f32_32x32x8_bf16 v[192:207], a[40:41], v[36:37], v[192:207]
    v_exp_f32 v228, v228
    v_exp_f32 v229, v229
    v_exp_f32 v230, v230
    v_exp_f32 v231, v231
    v_smfmac_f32_32x32x32_bf16 a[0:15], a[48:51], v[216:223], v13
    s_waitcnt lgkmcnt(1)
    s_add_u32 m0, s73, 19392
    ds_read_b128 a[44:47], v3 offset:27520
    ds_read_b128 a[48:51], v3 offset:28128
    v_exp_f32 v232, v232
    v_exp_f32 v233, v233
    v_exp_f32 v234, v234
    v_exp_f32 v235, v235
    v_smfmac_f32_32x32x32_bf16 a[0:15], a[52:55], v[224:231], v13
    s_waitcnt lgkmcnt(2)
    buffer_load_dwordx4 v1, s[24:27], s60 offen offset:64 lds
    v_exp_f32 v236, v236
    v_exp_f32 v237, v237
    v_exp_f32 v238, v238
    v_exp_f32 v239, v239
    v_mfma_f32_32x32x16_bf16 v[208:223], a[36:39], a[224:227], v[16:31]
    ds_read_b128 a[32:35], v7 offset:29952
    ds_read_b64 a[42:43], v2 offset:34048
    v_exp_f32 v192, v192
    v_exp_f32 v193, v193
    v_exp_f32 v194, v194
    v_exp_f32 v195, v195
    v_mfma_f32_32x32x8_bf16 v[208:223], a[40:41], v[38:39], v[208:223]
    v_exp_f32 v196, v196
    v_exp_f32 v197, v197
    v_exp_f32 v198, v198
    v_exp_f32 v199, v199
    v_smfmac_f32_32x32x32_bf16 a[0:15], a[56:59], v[232:239], v13
    s_waitcnt lgkmcnt(2)
    ds_read_b128 a[52:55], v3 offset:28736
    ds_read_b128 a[56:59], v3 offset:29344
    buffer_load_dwordx2 v[180:181], v58, s[40:43], s61 offen offset:0
    v_exp_f32 v200, v200
    v_exp_f32 v201, v201
    v_exp_f32 v202, v202
    v_exp_f32 v203, v203
    v_smfmac_f32_32x32x32_bf16 a[0:15], a[44:47], v[192:199], v13
    s_waitcnt lgkmcnt(2)
    s_add_u32 s78, s39, 589824
    v_exp_f32 v204, v204
    v_exp_f32 v205, v205
    v_exp_f32 v206, v206
    v_exp_f32 v207, v207
    v_mfma_f32_32x32x16_bf16 v[224:239], a[32:35], a[224:227], v[16:31]
    ds_read_b128 a[36:39], v7 offset:30976
    buffer_load_dwordx4 a[168:171], v4, s[28:31], s78 offen offset:0 sc1
    v_exp_f32 v208, v208
    v_exp_f32 v209, v209
    v_exp_f32 v210, v210
    v_exp_f32 v211, v211
    v_mfma_f32_32x32x8_bf16 v[224:239], a[42:43], v[32:33], v[224:239]
    v_exp_f32 v212, v212
    v_exp_f32 v213, v213
    v_exp_f32 v214, v214
    v_exp_f32 v215, v215
    v_smfmac_f32_32x32x32_bf16 a[0:15], a[48:51], v[200:207], v13
    s_waitcnt lgkmcnt(1)
    s_add_u32 m0, s73, 20480
    ds_read_b128 a[44:47], v3 offset:34560
    ds_read_b128 a[48:51], v3 offset:35168
    v_exp_f32 v216, v216
    v_exp_f32 v217, v217
    v_exp_f32 v218, v218
    v_exp_f32 v219, v219
    v_smfmac_f32_32x32x32_bf16 a[0:15], a[52:55], v[208:215], v13
    s_waitcnt lgkmcnt(2)
    buffer_load_dword v10, s[24:27], s61 offen lds
    v_exp_f32 v220, v220
    v_exp_f32 v221, v221
    v_exp_f32 v222, v222
    v_exp_f32 v223, v223
    v_mfma_f32_32x32x16_bf16 v[192:207], a[36:39], a[224:227], v[16:31]
    ds_read_b128 a[32:35], v7 offset:32000
    v_exp_f32 v224, v224
    v_exp_f32 v225, v225
    v_exp_f32 v226, v226
    v_exp_f32 v227, v227
    v_mfma_f32_32x32x8_bf16 v[192:207], a[42:43], v[34:35], v[192:207]
    v_exp_f32 v228, v228
    v_exp_f32 v229, v229
    v_exp_f32 v230, v230
    v_exp_f32 v231, v231
    v_smfmac_f32_32x32x32_bf16 a[0:15], a[56:59], v[216:223], v13
    s_waitcnt lgkmcnt(1)
    ds_read_b128 a[52:55], v3 offset:35776
    ds_read_b128 a[56:59], v3 offset:36384
    global_load_dword v8, v12, s[0:1]
    v_exp_f32 v232, v232
    v_exp_f32 v233, v233
    v_exp_f32 v234, v234
    v_exp_f32 v235, v235
    v_smfmac_f32_32x32x32_bf16 a[0:15], a[44:47], v[224:231], v13
    s_waitcnt lgkmcnt(2)
    s_add_u32 s78, s38, 888832
    v_exp_f32 v236, v236
    v_exp_f32 v237, v237
    v_exp_f32 v238, v238
    v_exp_f32 v239, v239
    v_mfma_f32_32x32x16_bf16 v[208:223], a[32:35], a[224:227], v[16:31]
    ds_read_b128 a[36:39], v7 offset:33024
    buffer_load_dwordx4 a[188:191], v4, s[28:31], s78 offen offset:0 sc1
    v_exp_f32 v192, v192
    v_exp_f32 v193, v193
    v_exp_f32 v194, v194
    v_exp_f32 v195, v195
    v_mfma_f32_32x32x8_bf16 v[208:223], a[42:43], v[36:37], v[208:223]
    v_exp_f32 v196, v196
    v_exp_f32 v197, v197
    v_exp_f32 v198, v198
    v_exp_f32 v199, v199
    v_smfmac_f32_32x32x32_bf16 a[0:15], a[48:51], v[232:239], v13
    s_waitcnt lgkmcnt(1)
    ds_read_b128 a[44:47], v3 offset:36992
    ds_read_b128 a[48:51], v3 offset:37600
    buffer_load_dwordx4 a[192:195], v4, s[28:31], s78 offen offset:1024 sc1
    v_exp_f32 v200, v200
    v_exp_f32 v201, v201
    v_exp_f32 v202, v202
    v_exp_f32 v203, v203
    v_smfmac_f32_32x32x32_bf16 a[0:15], a[52:55], v[192:199], v13
    s_waitcnt lgkmcnt(2)
    buffer_load_dwordx4 a[196:199], v4, s[28:31], s78 offen offset:2048 sc1
    v_exp_f32 v204, v204
    v_exp_f32 v205, v205
    v_exp_f32 v206, v206
    v_exp_f32 v207, v207
    v_mfma_f32_32x32x16_bf16 v[224:239], a[36:39], a[224:227], v[16:31]
    ds_read_b128 a[32:35], v7 offset:20480
    ds_read_b64 a[40:41], v2 offset:24576
    buffer_load_dwordx4 a[200:203], v4, s[28:31], s78 offen offset:3072 sc1
    v_exp_f32 v208, v208
    v_exp_f32 v209, v209
    v_exp_f32 v210, v210
    v_exp_f32 v211, v211
    v_mfma_f32_32x32x8_bf16 v[224:239], a[42:43], v[38:39], v[224:239]
    v_exp_f32 v212, v212
    v_exp_f32 v213, v213
    v_exp_f32 v214, v214
    v_exp_f32 v215, v215
    v_smfmac_f32_32x32x32_bf16 a[0:15], a[56:59], v[200:207], v13
    s_waitcnt lgkmcnt(2)
    s_add_u32 s78, s39, 884736
    ds_read_b128 a[52:55], v3 offset:38208
    ds_read_b128 a[56:59], v3 offset:38816
    buffer_load_dwordx4 a[204:207], v4, s[28:31], s78 offen offset:0 sc1
    v_exp_f32 v216, v216
    v_exp_f32 v217, v217
    v_exp_f32 v218, v218
    v_exp_f32 v219, v219
    v_smfmac_f32_32x32x32_bf16 a[0:15], a[44:47], v[208:215], v13
    s_waitcnt lgkmcnt(2)
    v_exp_f32 v220, v220
    v_exp_f32 v221, v221
    v_exp_f32 v222, v222
    v_exp_f32 v223, v223
    v_mfma_f32_32x32x16_bf16 v[192:207], a[32:35], a[228:231], v[240:255]
    ds_read_b128 a[36:39], v7 offset:21504
    v_exp_f32 v224, v224
    v_exp_f32 v225, v225
    v_exp_f32 v226, v226
    v_exp_f32 v227, v227
    v_mfma_f32_32x32x8_bf16 v[192:207], a[40:41], v[40:41], v[192:207]
    v_exp_f32 v228, v228
    v_exp_f32 v229, v229
    v_exp_f32 v230, v230
    v_exp_f32 v231, v231
    v_smfmac_f32_32x32x32_bf16 a[0:15], a[48:51], v[216:223], v13
    s_waitcnt lgkmcnt(1)
    ds_read_b128 a[44:47], v3 offset:25088
    ds_read_b128 a[48:51], v3 offset:25696
    v_exp_f32 v232, v232
    v_exp_f32 v233, v233
    v_exp_f32 v234, v234
    v_exp_f32 v235, v235
    v_smfmac_f32_32x32x32_bf16 a[0:15], a[52:55], v[224:231], v13
    s_waitcnt lgkmcnt(2)
    v_exp_f32 v236, v236
    v_exp_f32 v237, v237
    v_exp_f32 v238, v238
    v_exp_f32 v239, v239
    v_mfma_f32_32x32x16_bf16 v[208:223], a[36:39], a[228:231], v[240:255]
    ds_read_b128 a[32:35], v7 offset:22528
    v_exp_f32 v192, v192
    v_exp_f32 v193, v193
    v_exp_f32 v194, v194
    v_exp_f32 v195, v195
    v_mfma_f32_32x32x8_bf16 v[208:223], a[40:41], v[42:43], v[208:223]
    v_exp_f32 v196, v196
    v_exp_f32 v197, v197
    v_exp_f32 v198, v198
    v_exp_f32 v199, v199
    v_smfmac_f32_32x32x32_bf16 a[0:15], a[56:59], v[232:239], v13
    s_waitcnt lgkmcnt(1)
    ds_read_b128 a[52:55], v3 offset:26304
    ds_read_b128 a[56:59], v3 offset:26912
    v_exp_f32 v200, v200
    v_exp_f32 v201, v201
    v_exp_f32 v202, v202
    v_exp_f32 v203, v203
    v_smfmac_f32_32x32x32_bf16 a[16:31], a[44:47], v[192:199], v13
    s_waitcnt lgkmcnt(2)
    v_exp_f32 v204, v204
    v_exp_f32 v205, v205
    v_exp_f32 v206, v206
    v_exp_f32 v207, v207
    v_mfma_f32_32x32x16_bf16 v[224:239], a[32:35], a[228:231], v[240:255]
    s_waitcnt vmcnt(28)
    ds_read_b128 a[36:39], v7 offset:23552
    v_accvgpr_read_b32 v110, a10
    v_accvgpr_read_b32 v100, a0
    v_rcp_f32 v111, v110
    v_cmp_ngt_f32 s[82:83], s10, v110
    v_mul_f32 v111, v111, v51
    v_accvgpr_read_b32 v101, a1
    v_accvgpr_read_b32 v102, a2
    v_accvgpr_read_b32 v103, a3
    v_accvgpr_read_b32 v104, a4
    v_accvgpr_read_b32 v105, a5
    v_accvgpr_read_b32 v106, a6
    v_accvgpr_read_b32 v107, a7
    v_accvgpr_read_b32 v108, a8
    v_accvgpr_read_b32 v109, a9
    v_mul_f32 v100, v100, v111
    v_mul_f32 v101, v101, v111
    v_mul_f32 v102, v102, v111
    v_mul_f32 v103, v103, v111
    v_mul_f32 v104, v104, v111
    v_mul_f32 v105, v105, v111
    v_mul_f32 v106, v106, v111
    v_mul_f32 v107, v107, v111
    v_cvt_pk_bf16_f32 v112, v100, v101
    v_cvt_pk_bf16_f32 v113, v102, v103
    v_cvt_pk_bf16_f32 v114, v104, v105
    v_cvt_pk_bf16_f32 v115, v106, v107
    v_exp_f32 v208, v208
    v_exp_f32 v209, v209
    v_exp_f32 v210, v210
    v_exp_f32 v211, v211
    v_mfma_f32_32x32x8_bf16 v[224:239], a[40:41], v[44:45], v[224:239]
    v_exp_f32 v212, v212
    v_exp_f32 v213, v213
    v_exp_f32 v214, v214
    v_exp_f32 v215, v215
    v_smfmac_f32_32x32x32_bf16 a[16:31], a[48:51], v[200:207], v13
    s_waitcnt lgkmcnt(1)
    ds_read_b128 a[44:47], v3 offset:27520
    ds_read_b128 a[48:51], v3 offset:28128
    buffer_store_dwordx4 v[112:115], v7, s[28:31], s4 offen sc1
    v_exp_f32 v216, v216
    v_exp_f32 v217, v217
    v_exp_f32 v218, v218
    v_exp_f32 v219, v219
    v_smfmac_f32_32x32x32_bf16 a[16:31], a[52:55], v[208:215], v13
    s_waitcnt lgkmcnt(2)
    v_mul_f32 v108, v108, v111
    v_mul_f32 v109, v109, v111
    v_cvt_pk_bf16_f32 v111, v108, v109
    v_lshlrev_b32 v15, 2, v0
    s_mov_b32 exec_hi, 0
    buffer_store_dword v111, v15, s[28:31], s5 offen offset:0 sc1
    s_mov_b32 exec_hi, -1
    v_exp_f32 v220, v220
    v_exp_f32 v221, v221
    v_exp_f32 v222, v222
    v_exp_f32 v223, v223
    v_mfma_f32_32x32x16_bf16 v[192:207], a[36:39], a[228:231], v[240:255]
    ds_read_b128 a[32:35], v7 offset:29952
    ds_read_b64 a[42:43], v2 offset:34048
    v_exp_f32 v224, v224
    v_exp_f32 v225, v225
    v_exp_f32 v226, v226
    v_exp_f32 v227, v227
    v_mfma_f32_32x32x8_bf16 v[192:207], a[40:41], v[46:47], v[192:207]
    v_exp_f32 v228, v228
    v_exp_f32 v229, v229
    v_exp_f32 v230, v230
    v_exp_f32 v231, v231
    v_smfmac_f32_32x32x32_bf16 a[16:31], a[56:59], v[216:223], v13
    s_waitcnt lgkmcnt(2)
    ds_read_b128 a[52:55], v3 offset:28736
    ds_read_b128 a[56:59], v3 offset:29344
    v_exp_f32 v232, v232
    v_exp_f32 v233, v233
    v_exp_f32 v234, v234
    v_exp_f32 v235, v235
    v_smfmac_f32_32x32x32_bf16 a[16:31], a[44:47], v[224:231], v13
    s_waitcnt vmcnt(8) lgkmcnt(2)
    ds_add_u32 v11, v9
    v_exp_f32 v236, v236
    v_exp_f32 v237, v237
    v_exp_f32 v238, v238
    v_exp_f32 v239, v239
    v_mfma_f32_32x32x16_bf16 v[208:223], a[32:35], a[228:231], v[240:255]
    ds_read_b128 a[36:39], v7 offset:30976
    v_exp_f32 v192, v192
    v_exp_f32 v193, v193
    v_exp_f32 v194, v194
    v_exp_f32 v195, v195
    v_mfma_f32_32x32x8_bf16 v[208:223], a[42:43], v[40:41], v[208:223]
    v_exp_f32 v196, v196
    v_exp_f32 v197, v197
    v_exp_f32 v198, v198
    v_exp_f32 v199, v199
    v_smfmac_f32_32x32x32_bf16 a[16:31], a[48:51], v[232:239], v13
    s_waitcnt lgkmcnt(2)
    ds_read_b128 a[44:47], v3 offset:34560
    ds_read_b128 a[48:51], v3 offset:35168
    v_exp_f32 v200, v200
    v_exp_f32 v201, v201
    v_exp_f32 v202, v202
    v_exp_f32 v203, v203
    v_smfmac_f32_32x32x32_bf16 a[16:31], a[52:55], v[192:199], v13
    s_waitcnt lgkmcnt(2)
    v_exp_f32 v204, v204
    v_exp_f32 v205, v205
    v_exp_f32 v206, v206
    v_exp_f32 v207, v207
    v_mfma_f32_32x32x16_bf16 v[224:239], a[36:39], a[228:231], v[240:255]
    ds_read_b128 a[32:35], v7 offset:32000
    s_cmp_eq_u64 s[82:83], 0
    s_cselect_b32 s12, s6, 1073741824
    v_exp_f32 v208, v208
    v_exp_f32 v209, v209
    v_exp_f32 v210, v210
    v_exp_f32 v211, v211
    v_mfma_f32_32x32x8_bf16 v[224:239], a[42:43], v[42:43], v[224:239]
    v_exp_f32 v212, v212
    v_exp_f32 v213, v213
    v_exp_f32 v214, v214
    v_exp_f32 v215, v215
    v_smfmac_f32_32x32x32_bf16 a[16:31], a[56:59], v[200:207], v13
    s_waitcnt lgkmcnt(1)
    ds_read_b128 a[52:55], v3 offset:35776
    ds_read_b128 a[56:59], v3 offset:36384
    v_exp_f32 v216, v216
    v_exp_f32 v217, v217
    v_exp_f32 v218, v218
    v_exp_f32 v219, v219
    v_smfmac_f32_32x32x32_bf16 a[16:31], a[44:47], v[208:215], v13
    s_waitcnt lgkmcnt(2)
    v_exp_f32 v220, v220
    v_exp_f32 v221, v221
    v_exp_f32 v222, v222
    v_exp_f32 v223, v223
    v_mfma_f32_32x32x16_bf16 v[192:207], a[32:35], a[228:231], v[240:255]
    ds_read_b128 a[36:39], v7 offset:33024
    s_waitcnt vmcnt(0)
    v_mov_b32 v100, 2
    s_mov_b32 exec_hi, 0
    buffer_store_dword v100, v15, s[28:31], s12 offen offset:0 sc1
    s_mov_b32 exec_hi, -1
    v_exp_f32 v224, v224
    v_exp_f32 v225, v225
    v_exp_f32 v226, v226
    v_exp_f32 v227, v227
    v_mfma_f32_32x32x8_bf16 v[192:207], a[42:43], v[44:45], v[192:207]
    v_exp_f32 v228, v228
    v_exp_f32 v229, v229
    v_exp_f32 v230, v230
    v_exp_f32 v231, v231
    v_smfmac_f32_32x32x32_bf16 a[16:31], a[48:51], v[216:223], v13
    s_waitcnt lgkmcnt(1)
    ds_read_b128 a[44:47], v3 offset:36992
    ds_read_b128 a[48:51], v3 offset:37600
    v_exp_f32 v232, v232
    v_exp_f32 v233, v233
    v_exp_f32 v234, v234
    v_exp_f32 v235, v235
    v_smfmac_f32_32x32x32_bf16 a[16:31], a[52:55], v[224:231], v13
    s_waitcnt lgkmcnt(2)
    v_exp_f32 v236, v236
    v_exp_f32 v237, v237
    v_exp_f32 v238, v238
    v_exp_f32 v239, v239
    v_mfma_f32_32x32x16_bf16 v[208:223], a[36:39], a[228:231], v[240:255]
    ds_read_b32 v6, v11
    v_exp_f32 v192, v192
    v_exp_f32 v193, v193
    v_exp_f32 v194, v194
    v_exp_f32 v195, v195
    v_mfma_f32_32x32x8_bf16 v[208:223], a[42:43], v[46:47], v[208:223]
    v_exp_f32 v196, v196
    v_exp_f32 v197, v197
    v_exp_f32 v198, v198
    v_exp_f32 v199, v199
    v_smfmac_f32_32x32x32_bf16 a[16:31], a[56:59], v[232:239], v13
    s_waitcnt lgkmcnt(1)
    ds_read_b128 a[52:55], v3 offset:38208
    ds_read_b128 a[56:59], v3 offset:38816
    v_exp_f32 v200, v200
    v_exp_f32 v201, v201
    v_exp_f32 v202, v202
    v_exp_f32 v203, v203
    v_smfmac_f32_32x32x32_bf16 a[16:31], a[44:47], v[192:199], v13
    s_waitcnt lgkmcnt(2)
    v_cmp_le_u32 vcc, 108, v6
    v_exp_f32 v204, v204
    v_exp_f32 v205, v205
    v_exp_f32 v206, v206
    v_exp_f32 v207, v207
    v_exp_f32 v208, v208
    v_exp_f32 v209, v209
    v_exp_f32 v210, v210
    v_exp_f32 v211, v211
    v_exp_f32 v212, v212
    v_exp_f32 v213, v213
    v_exp_f32 v214, v214
    v_exp_f32 v215, v215
    v_smfmac_f32_32x32x32_bf16 a[16:31], a[48:51], v[200:207], v13
    s_waitcnt lgkmcnt(0)
    s_cbranch_vccz L_spin29
L_back29:
    v_exp_f32 v216, v216
    v_exp_f32 v217, v217
    v_exp_f32 v218, v218
    v_exp_f32 v219, v219
    v_smfmac_f32_32x32x32_bf16 a[16:31], a[52:55], v[208:215], v13
    v_exp_f32 v220, v220
    v_exp_f32 v221, v221
    v_exp_f32 v222, v222
    v_exp_f32 v223, v223
    s_sub_u32 s3, s3, 131072
    s_lshl_b32 s62, s75, 8
    v_smfmac_f32_32x32x32_bf16 a[16:31], a[56:59], v[216:223], v13
    v_add_u32 v53, s62, v14
    v_lshrrev_b32 v54, 2, v53
    v_lshl_add_u32 v54, v48, 9, v54
    v_lshl_add_u32 v53, v48, 9, v53
    v_and_b32 v60, 16, v7
    v_mov_b32 v61, 0x3f80
    v_lshlrev_b32 v61, v60, v61
    v_lshrrev_b32 v60, 5, v14
    s_waitcnt vmcnt(11)
    v_lshlrev_b32 v68, 16, v172
    v_and_b32 v69, 0xffff0000, v172
    v_lshlrev_b32 v70, 16, v173
    v_accvgpr_read_b32 v202, a26
    v_accvgpr_read_b32 v192, a16
    v_rcp_f32 v203, v202
    v_cmp_ngt_f32 vcc, s11, v202
    v_mul_f32 v203, v203, v51
    v_accvgpr_read_b32 v193, a17
    v_accvgpr_read_b32 v194, a18
    v_accvgpr_read_b32 v195, a19
    v_accvgpr_read_b32 v196, a20
    v_accvgpr_read_b32 v197, a21
    v_accvgpr_read_b32 v198, a22
    v_accvgpr_read_b32 v199, a23
    v_accvgpr_read_b32 v200, a24
    v_accvgpr_read_b32 v201, a25
    s_or_b64 vcc, vcc, s[82:83]
    s_cbranch_scc1 L_fb
L_fbdone:
    v_mul_f32 v192, v192, v203
    v_mul_f32 v193, v193, v203
    v_mul_f32 v194, v194, v203
    v_mul_f32 v195, v195, v203
    v_mul_f32 v196, v196, v203
    v_mul_f32 v197, v197, v203
    v_mul_f32 v198, v198, v203
    v_mul_f32 v199, v199, v203
    v_cvt_pk_bf16_f32 v204, v192, v193
    v_cvt_pk_bf16_f32 v205, v194, v195
    v_cvt_pk_bf16_f32 v206, v196, v197
    v_cvt_pk_bf16_f32 v207, v198, v199
    buffer_store_dwordx4 v[204:207], v7, s[28:31], s7 offen sc1
    v_mul_f32 v200, v200, v203
    v_mul_f32 v201, v201, v203
    v_cvt_pk_bf16_f32 v203, v200, v201
    s_mov_b32 exec_hi, 0
    buffer_store_dword v203, v15, s[28:31], s8 offen offset:0 sc1
    s_mov_b32 exec_hi, -1
    v_cmp_eq_u32 vcc, 0, v60
    v_and_b32 v71, 0xffff0000, v173
    v_lshlrev_b32 v72, 16, v174
    v_cndmask_b32 v88, 0, v61, vcc
    v_cmp_eq_u32 vcc, 1, v60
    v_and_b32 v73, 0xffff0000, v174
    v_lshlrev_b32 v74, 16, v175
    v_cndmask_b32 v89, 0, v61, vcc
    v_cmp_eq_u32 vcc, 2, v60
    v_and_b32 v75, 0xffff0000, v175
    v_lshlrev_b32 v76, 16, v176
    v_cndmask_b32 v90, 0, v61, vcc
    v_cmp_eq_u32 vcc, 3, v60
    v_and_b32 v77, 0xffff0000, v176
    v_lshlrev_b32 v78, 16, v177
    v_cndmask_b32 v91, 0, v61, vcc
    v_cmp_eq_u32 vcc, 4, v60
    v_and_b32 v79, 0xffff0000, v177
    v_lshlrev_b32 v80, 16, v178
    v_cndmask_b32 v92, 0, v61, vcc
    v_cmp_eq_u32 vcc, 5, v60
    v_and_b32 v81, 0xffff0000, v178
    v_lshlrev_b32 v82, 16, v179
    v_cndmask_b32 v93, 0, v61, vcc
    v_cmp_eq_u32 vcc, 6, v60
    v_and_b32 v83, 0xffff0000, v179
    v_lshlrev_b32 v84, 16, v180
    v_cndmask_b32 v94, 0, v61, vcc
    v_cmp_eq_u32 vcc, 7, v60
    v_and_b32 v85, 0xffff0000, v180
    v_lshlrev_b32 v86, 16, v181
    v_cndmask_b32 v95, 0, v61, vcc
    v_and_b32 v87, 0xffff0000, v181
    s_waitcnt vmcnt(5)
    v_mfma_f32_16x16x32_bf16 v[68:71], v[88:91], a[64:67], v[68:71]
    v_accvgpr_read_b32 v60, a238
    v_accvgpr_read_b32 v61, a239
    v_mfma_f32_16x16x32_bf16 v[68:71], v[92:95], a[68:71], v[68:71]
    v_sub_f32 v52, 1.0, v52
    v_mfma_f32_16x16x32_bf16 v[68:71], v[88:91], a[100:103], v[68:71]
    ds_read_b64_tr_b16 a[0:1], v60 offset:0
    ds_read_b64_tr_b16 a[2:3], v60 offset:256
    v_mfma_f32_16x16x32_bf16 v[68:71], v[92:95], a[104:107], v[68:71]
    ds_read_b64_tr_b16 a[4:5], v60 offset:512
    ds_read_b64_tr_b16 a[6:7], v60 offset:768
    v_mfma_f32_16x16x32_bf16 v[68:71], v[88:91], a[136:139], v[68:71]
    ds_read_b64_tr_b16 a[8:9], v60 offset:32
    ds_read_b64_tr_b16 a[10:11], v60 offset:288
    v_mfma_f32_16x16x32_bf16 v[68:71], v[92:95], a[140:143], v[68:71]
    ds_read_b64_tr_b16 a[12:13], v60 offset:544
    ds_read_b64_tr_b16 a[14:15], v60 offset:800
    v_mfma_f32_16x16x32_bf16 v[68:71], v[88:91], a[172:175], v[68:71]
    ds_read_b64_tr_b16 a[16:17], v60 offset:1024
    ds_read_b64_tr_b16 a[18:19], v60 offset:1280
    v_mfma_f32_16x16x32_bf16 v[68:71], v[92:95], a[176:179], v[68:71]
    ds_read_b64_tr_b16 a[20:21], v60 offset:1536
    ds_read_b64_tr_b16 a[22:23], v60 offset:1792
    v_mfma_f32_16x16x32_bf16 v[72:75], v[88:91], a[72:75], v[72:75]
    s_waitcnt lgkmcnt(8)
    ds_read_b64_tr_b16 a[24:25], v60 offset:1056
    ds_read_b64_tr_b16 a[26:27], v60 offset:1312
    v_mfma_f32_16x16x32_bf16 v[72:75], v[92:95], a[76:79], v[72:75]
    ds_read_b64_tr_b16 a[28:29], v60 offset:1568
    ds_read_b64_tr_b16 a[30:31], v60 offset:1824
    v_mfma_f32_16x16x32_bf16 v[72:75], v[88:91], a[108:111], v[72:75]
    s_waitcnt lgkmcnt(8)
    ds_read_b64_tr_b16 a[32:33], v61 offset:2048
    ds_read_b64_tr_b16 a[34:35], v61 offset:2112
    v_mfma_f32_16x16x32_bf16 v[72:75], v[92:95], a[112:115], v[72:75]
    ds_read_b64_tr_b16 a[36:37], v61 offset:2176
    ds_read_b64_tr_b16 a[38:39], v61 offset:2240
    v_mfma_f32_16x16x32_bf16 v[72:75], v[88:91], a[144:147], v[72:75]
    s_waitcnt lgkmcnt(8)
    ds_read_b64_tr_b16 a[40:41], v60 offset:2304
    ds_read_b64_tr_b16 a[42:43], v60 offset:2560
    v_mfma_f32_16x16x32_bf16 v[72:75], v[92:95], a[148:151], v[72:75]
    ds_read_b64_tr_b16 a[44:45], v60 offset:2816
    ds_read_b64_tr_b16 a[46:47], v60 offset:3072
    v_mfma_f32_16x16x32_bf16 v[72:75], v[88:91], a[180:183], v[72:75]
    s_waitcnt lgkmcnt(8)
    ds_read_b64_tr_b16 a[48:49], v60 offset:2336
    ds_read_b64_tr_b16 a[50:51], v60 offset:2592
    v_mfma_f32_16x16x32_bf16 v[72:75], v[92:95], a[184:187], v[72:75]
    ds_read_b64_tr_b16 a[52:53], v60 offset:2848
    ds_read_b64_tr_b16 a[54:55], v60 offset:3104
    v_mfma_f32_16x16x32_bf16 v[76:79], v[88:91], a[80:83], v[76:79]
    s_waitcnt lgkmcnt(8)
    ds_read_b64_tr_b16 a[56:57], v60 offset:3328
    ds_read_b64_tr_b16 a[58:59], v60 offset:3584
    v_mfma_f32_16x16x32_bf16 v[76:79], v[92:95], a[84:87], v[76:79]
    ds_read_b64_tr_b16 a[60:61], v60 offset:3840
    ds_read_b64_tr_b16 a[62:63], v60 offset:4096
    v_mfma_f32_16x16x32_bf16 v[76:79], v[88:91], a[116:119], v[76:79]
    s_waitcnt lgkmcnt(8)
    ds_read_b64_tr_b16 a[208:209], v60 offset:3360
    ds_read_b64_tr_b16 a[210:211], v60 offset:3616
    v_mfma_f32_16x16x32_bf16 v[76:79], v[92:95], a[120:123], v[76:79]
    ds_read_b64_tr_b16 a[212:213], v60 offset:3872
    ds_read_b64_tr_b16 a[214:215], v60 offset:4128
    v_mfma_f32_16x16x32_bf16 v[76:79], v[88:91], a[152:155], v[76:79]
    v_mov_b32 v49, 2
    s_mov_b64 exec, 0xffff
    buffer_load_dword v49, v50, s[28:31], s9 offen sc1
    s_mov_b64 exec, -1
    v_mfma_f32_16x16x32_bf16 v[76:79], v[92:95], a[156:159], v[76:79]
    s_waitcnt lgkmcnt(8)
    ds_read_b64_tr_b16 a[216:217], v61 offset:4352
    ds_read_b64_tr_b16 a[218:219], v61 offset:4416
    v_mfma_f32_16x16x32_bf16 v[76:79], v[88:91], a[188:191], v[76:79]
    ds_read_b64_tr_b16 a[220:221], v61 offset:4480
    ds_read_b64_tr_b16 a[222:223], v61 offset:4544
    v_mfma_f32_16x16x32_bf16 v[76:79], v[92:95], a[192:195], v[76:79]
    s_waitcnt lgkmcnt(8)
    ds_read_b64_tr_b16 a[224:225], v60 offset:4608
    ds_read_b64_tr_b16 a[226:227], v60 offset:4864
    v_mfma_f32_16x16x32_bf16 v[80:83], v[88:91], a[88:91], v[80:83]
    ds_read_b64_tr_b16 a[228:229], v60 offset:5120
    ds_read_b64_tr_b16 a[230:231], v60 offset:5376
    v_mfma_f32_16x16x32_bf16 v[80:83], v[92:95], a[92:95], v[80:83]
    s_waitcnt lgkmcnt(8)
    ds_read_b64_tr_b16 a[232:233], v60 offset:4640
    ds_read_b64_tr_b16 a[234:235], v60 offset:4896
    v_mfma_f32_16x16x32_bf16 v[80:83], v[88:91], a[124:127], v[80:83]
    ds_read_b64_tr_b16 a[236:237], v60 offset:5152
    ds_read_b64_tr_b16 a[238:239], v60 offset:5408
    v_mfma_f32_16x16x32_bf16 v[80:83], v[92:95], a[128:131], v[80:83]
    s_waitcnt lgkmcnt(8)
    ds_read_b64_tr_b16 a[240:241], v60 offset:5632
    ds_read_b64_tr_b16 a[242:243], v60 offset:5888
    v_mfma_f32_16x16x32_bf16 v[80:83], v[88:91], a[160:163], v[80:83]
    ds_read_b64_tr_b16 a[244:245], v60 offset:6144
    ds_read_b64_tr_b16 a[246:247], v60 offset:6400
    v_mfma_f32_16x16x32_bf16 v[80:83], v[92:95], a[164:167], v[80:83]
    s_waitcnt lgkmcnt(8)
    ds_read_b64_tr_b16 a[248:249], v60 offset:5664
    ds_read_b64_tr_b16 a[250:251], v60 offset:5920
    v_mfma_f32_16x16x32_bf16 v[80:83], v[88:91], a[196:199], v[80:83]
    ds_read_b64_tr_b16 a[252:253], v60 offset:6176
    ds_read_b64_tr_b16 a[254:255], v60 offset:6432
    v_mfma_f32_16x16x32_bf16 v[80:83], v[92:95], a[200:203], v[80:83]
    v_mfma_f32_16x16x32_bf16 v[84:87], v[88:91], a[96:99], v[84:87]
    v_mfma_f32_16x16x32_bf16 v[84:87], v[88:91], a[132:135], v[84:87]
    v_mfma_f32_16x16x32_bf16 v[84:87], v[88:91], a[168:171], v[84:87]
    v_mfma_f32_16x16x32_bf16 v[84:87], v[88:91], a[204:207], v[84:87]
    v_mul_f32 v68, v68, v52
    v_mul_f32 v69, v69, v52
    v_mul_f32 v70, v70, v52
    v_mul_f32 v71, v71, v52
    v_mul_f32 v72, v72, v52
    v_mul_f32 v73, v73, v52
    v_mul_f32 v74, v74, v52
    v_mul_f32 v75, v75, v52
    v_mul_f32 v76, v76, v52
    v_mul_f32 v77, v77, v52
    v_mul_f32 v78, v78, v52
    v_mul_f32 v79, v79, v52
    v_mul_f32 v80, v80, v52
    v_mul_f32 v81, v81, v52
    v_mul_f32 v82, v82, v52
    v_mul_f32 v83, v83, v52
L_q12:
    s_cbranch_execz L_wret
    s_waitcnt vmcnt(0)
    v_cmp_gt_u32 vcc, 2, v49
    v_mul_f32 v84, v84, v52
    v_mul_f32 v85, v85, v52
    v_mul_f32 v86, v86, v52
    v_mul_f32 v87, v87, v52
    s_cbranch_vccnz L_spin30
L_back30:
    buffer_load_dwordx4 v[100:103], v53, s[28:31], s13 offen offset:0 sc1
    buffer_load_dwordx4 v[104:107], v53, s[28:31], s13 offen offset:2048 sc1
    buffer_load_dwordx4 v[108:111], v53, s[28:31], s14 offen offset:0 sc1
    buffer_load_dwordx4 v[112:115], v53, s[28:31], s14 offen offset:2048 sc1
    buffer_load_dwordx4 v[116:119], v53, s[28:31], s15 offen offset:0 sc1
    buffer_load_dwordx4 v[120:123], v53, s[28:31], s15 offen offset:2048 sc1
    buffer_load_dwordx4 v[124:127], v53, s[28:31], s16 offen offset:0 sc1
    buffer_load_dwordx4 v[128:131], v53, s[28:31], s16 offen offset:2048 sc1
    buffer_load_dword v132, v54, s[28:31], s17 offen offset:0 sc1
    buffer_load_dword v133, v54, s[28:31], s17 offen offset:128 sc1
    buffer_load_dword v134, v54, s[28:31], s17 offen offset:256 sc1
    buffer_load_dword v135, v54, s[28:31], s17 offen offset:384 sc1
    v_add_u32 v53, 18432, v53
    v_add_u32 v54, 18432, v54
    s_waitcnt lgkmcnt(8)
    ds_read_b64_tr_b16 a[64:65], v61 offset:6656
    ds_read_b64_tr_b16 a[66:67], v61 offset:6720
    ds_read_b64_tr_b16 a[68:69], v61 offset:6784
    ds_read_b64_tr_b16 a[70:71], v61 offset:6848
    s_waitcnt lgkmcnt(8)
    ds_read_b64_tr_b16 a[72:73], v60 offset:6912
    ds_read_b64_tr_b16 a[74:75], v60 offset:7168
    ds_read_b64_tr_b16 a[76:77], v60 offset:7424
    ds_read_b64_tr_b16 a[78:79], v60 offset:7680
    s_waitcnt lgkmcnt(8)
    ds_read_b64_tr_b16 a[80:81], v60 offset:6944
    ds_read_b64_tr_b16 a[82:83], v60 offset:7200
    ds_read_b64_tr_b16 a[84:85], v60 offset:7456
    ds_read_b64_tr_b16 a[86:87], v60 offset:7712
    s_waitcnt lgkmcnt(8)
    ds_read_b64_tr_b16 a[88:89], v60 offset:7936
    ds_read_b64_tr_b16 a[90:91], v60 offset:8192
    ds_read_b64_tr_b16 a[92:93], v60 offset:8448
    ds_read_b64_tr_b16 a[94:95], v60 offset:8704
    s_waitcnt lgkmcnt(8)
    ds_read_b64_tr_b16 a[96:97], v60 offset:7968
    ds_read_b64_tr_b16 a[98:99], v60 offset:8224
    ds_read_b64_tr_b16 a[100:101], v60 offset:8480
    ds_read_b64_tr_b16 a[102:103], v60 offset:8736
    s_waitcnt lgkmcnt(8)
    ds_read_b64_tr_b16 a[104:105], v61 offset:8960
    ds_read_b64_tr_b16 a[106:107], v61 offset:9024
    ds_read_b64_tr_b16 a[108:109], v61 offset:9088
    ds_read_b64_tr_b16 a[110:111], v61 offset:9152
    s_waitcnt lgkmcnt(8)
    ds_read_b64_tr_b16 a[112:113], v60 offset:18432
    ds_read_b64_tr_b16 a[114:115], v60 offset:18688
    ds_read_b64_tr_b16 a[116:117], v60 offset:18464
    ds_read_b64_tr_b16 a[118:119], v60 offset:18720
    s_waitcnt lgkmcnt(8)
    ds_read_b64_tr_b16 a[120:121], v60 offset:19456
    ds_read_b64_tr_b16 a[122:123], v60 offset:19712
    ds_read_b64_tr_b16 a[124:125], v60 offset:19488
    ds_read_b64_tr_b16 a[126:127], v60 offset:19744
    s_waitcnt vmcnt(10) lgkmcnt(15)
    v_mfma_f32_16x16x32_bf16 v[68:71], a[0:3], v[100:103], v[68:71]
    buffer_load_dwordx4 v[136:139], v53, s[28:31], s13 offen offset:0 sc1
    v_mfma_f32_16x16x32_bf16 v[68:71], a[4:7], v[104:107], v[68:71]
    buffer_load_dwordx4 v[140:143], v53, s[28:31], s13 offen offset:2048 sc1
    v_mfma_f32_16x16x32_bf16 v[72:75], a[8:11], v[100:103], v[72:75]
    s_waitcnt lgkmcnt(6)
    ds_read_b64_tr_b16 a[128:129], v61 offset:20480
    ds_read_b64_tr_b16 a[130:131], v61 offset:20544
    v_mfma_f32_16x16x32_bf16 v[72:75], a[12:15], v[104:107], v[72:75]
    buffer_load_dwordx4 v[144:147], v53, s[28:31], s14 offen offset:0 sc1
    v_mfma_f32_16x16x32_bf16 v[76:79], a[16:19], v[100:103], v[76:79]
    buffer_load_dwordx4 v[148:151], v53, s[28:31], s14 offen offset:2048 sc1
    v_mfma_f32_16x16x32_bf16 v[76:79], a[20:23], v[104:107], v[76:79]
    ds_read_b64_tr_b16 a[132:133], v60 offset:9216
    ds_read_b64_tr_b16 a[134:135], v60 offset:9472
    v_mfma_f32_16x16x32_bf16 v[80:83], a[24:27], v[100:103], v[80:83]
    buffer_load_dwordx4 v[152:155], v53, s[28:31], s15 offen offset:0 sc1
    v_mfma_f32_16x16x32_bf16 v[80:83], a[28:31], v[104:107], v[80:83]
    buffer_load_dwordx4 v[156:159], v53, s[28:31], s15 offen offset:2048 sc1
    v_mfma_f32_16x16x32_bf16 v[84:87], a[32:35], v[100:103], v[84:87]
    ds_read_b64_tr_b16 a[136:137], v60 offset:9728
    ds_read_b64_tr_b16 a[138:139], v60 offset:9984
    v_mfma_f32_16x16x32_bf16 v[84:87], a[36:39], v[104:107], v[84:87]
    s_waitcnt vmcnt(14) lgkmcnt(15)
    buffer_load_dwordx4 v[160:163], v53, s[28:31], s16 offen offset:0 sc1
    v_mfma_f32_16x16x32_bf16 v[68:71], a[40:43], v[108:111], v[68:71]
    buffer_load_dwordx4 v[164:167], v53, s[28:31], s16 offen offset:2048 sc1
    v_mfma_f32_16x16x32_bf16 v[68:71], a[44:47], v[112:115], v[68:71]
    s_waitcnt lgkmcnt(6)
    ds_read_b64_tr_b16 a[140:141], v60 offset:9248
    ds_read_b64_tr_b16 a[142:143], v60 offset:9504
    v_mfma_f32_16x16x32_bf16 v[72:75], a[48:51], v[108:111], v[72:75]
    buffer_load_dword v168, v54, s[28:31], s17 offen offset:0 sc1
    v_mfma_f32_16x16x32_bf16 v[72:75], a[52:55], v[112:115], v[72:75]
    buffer_load_dword v169, v54, s[28:31], s17 offen offset:128 sc1
    v_mfma_f32_16x16x32_bf16 v[76:79], a[56:59], v[108:111], v[76:79]
    ds_read_b64_tr_b16 a[144:145], v60 offset:9760
    ds_read_b64_tr_b16 a[146:147], v60 offset:10016
    v_mfma_f32_16x16x32_bf16 v[76:79], a[60:63], v[112:115], v[76:79]
    buffer_load_dword v170, v54, s[28:31], s17 offen offset:256 sc1
    v_mfma_f32_16x16x32_bf16 v[80:83], a[208:211], v[108:111], v[80:83]
    buffer_load_dword v171, v54, s[28:31], s17 offen offset:384 sc1
    v_mfma_f32_16x16x32_bf16 v[80:83], a[212:215], v[112:115], v[80:83]
    ds_read_b64_tr_b16 a[148:149], v60 offset:10240
    ds_read_b64_tr_b16 a[150:151], v60 offset:10496
    v_mfma_f32_16x16x32_bf16 v[84:87], a[216:219], v[108:111], v[84:87]
    s_waitcnt lgkmcnt(6)
    ds_read_b64_tr_b16 a[152:153], v60 offset:10752
    ds_read_b64_tr_b16 a[154:155], v60 offset:11008
    v_mfma_f32_16x16x32_bf16 v[84:87], a[220:223], v[112:115], v[84:87]
    s_waitcnt vmcnt(18) lgkmcnt(15)
    ds_read_b64_tr_b16 a[156:157], v60 offset:10272
    ds_read_b64_tr_b16 a[158:159], v60 offset:10528
    v_mfma_f32_16x16x32_bf16 v[68:71], a[224:227], v[116:119], v[68:71]
    ds_read_b64_tr_b16 a[160:161], v60 offset:10784
    ds_read_b64_tr_b16 a[162:163], v60 offset:11040
    v_mfma_f32_16x16x32_bf16 v[68:71], a[228:231], v[120:123], v[68:71]
    s_waitcnt lgkmcnt(6)
    ds_read_b64_tr_b16 a[164:165], v61 offset:11264
    ds_read_b64_tr_b16 a[166:167], v61 offset:11328
    v_mfma_f32_16x16x32_bf16 v[72:75], a[232:235], v[116:119], v[72:75]
    ds_read_b64_tr_b16 a[168:169], v61 offset:11392
    ds_read_b64_tr_b16 a[170:171], v61 offset:11456
    v_mfma_f32_16x16x32_bf16 v[72:75], a[236:239], v[120:123], v[72:75]
    ds_read_b64_tr_b16 a[172:173], v60 offset:11520
    ds_read_b64_tr_b16 a[174:175], v60 offset:11776
    v_mfma_f32_16x16x32_bf16 v[76:79], a[240:243], v[116:119], v[76:79]
    s_waitcnt lgkmcnt(6)
    ds_read_b64_tr_b16 a[176:177], v60 offset:12032
    ds_read_b64_tr_b16 a[178:179], v60 offset:12288
    v_mfma_f32_16x16x32_bf16 v[76:79], a[244:247], v[120:123], v[76:79]
    ds_read_b64_tr_b16 a[180:181], v60 offset:11552
    ds_read_b64_tr_b16 a[182:183], v60 offset:11808
    v_mfma_f32_16x16x32_bf16 v[80:83], a[248:251], v[116:119], v[80:83]
    ds_read_b64_tr_b16 a[184:185], v60 offset:12064
    ds_read_b64_tr_b16 a[186:187], v60 offset:12320
    v_mfma_f32_16x16x32_bf16 v[80:83], a[252:255], v[120:123], v[80:83]
    s_waitcnt lgkmcnt(6)
    ds_read_b64_tr_b16 a[188:189], v60 offset:12544
    ds_read_b64_tr_b16 a[190:191], v60 offset:12800
    v_mfma_f32_16x16x32_bf16 v[84:87], a[64:67], v[116:119], v[84:87]
    ds_read_b64_tr_b16 a[192:193], v60 offset:13056
    ds_read_b64_tr_b16 a[194:195], v60 offset:13312
    v_mfma_f32_16x16x32_bf16 v[84:87], a[68:71], v[120:123], v[84:87]
    s_waitcnt vmcnt(16) lgkmcnt(15)
    ds_read_b64_tr_b16 a[196:197], v60 offset:12576
    ds_read_b64_tr_b16 a[198:199], v60 offset:12832
    v_mfma_f32_16x16x32_bf16 v[68:71], a[72:75], v[124:127], v[68:71]
    s_waitcnt lgkmcnt(6)
    ds_read_b64_tr_b16 a[200:201], v60 offset:13088
    ds_read_b64_tr_b16 a[202:203], v60 offset:13344
    v_mfma_f32_16x16x32_bf16 v[68:71], a[76:79], v[128:131], v[68:71]
    ds_read_b64_tr_b16 a[204:205], v61 offset:13568
    ds_read_b64_tr_b16 a[206:207], v61 offset:13632
    v_mfma_f32_16x16x32_bf16 v[72:75], a[80:83], v[124:127], v[72:75]
    ds_read_b64_tr_b16 v[172:173], v61 offset:13696
    ds_read_b64_tr_b16 v[174:175], v61 offset:13760
    v_mfma_f32_16x16x32_bf16 v[72:75], a[84:87], v[128:131], v[72:75]
    s_waitcnt lgkmcnt(6)
    ds_read_b64_tr_b16 v[176:177], v60 offset:13824
    ds_read_b64_tr_b16 v[178:179], v60 offset:14080
    v_mfma_f32_16x16x32_bf16 v[76:79], a[88:91], v[124:127], v[76:79]
    ds_read_b64_tr_b16 v[180:181], v60 offset:14336
    ds_read_b64_tr_b16 v[182:183], v60 offset:14592
    v_mfma_f32_16x16x32_bf16 v[76:79], a[92:95], v[128:131], v[76:79]
    ds_read_b64_tr_b16 v[184:185], v60 offset:13856
    ds_read_b64_tr_b16 v[186:187], v60 offset:14112
    v_mfma_f32_16x16x32_bf16 v[80:83], a[96:99], v[124:127], v[80:83]
    s_waitcnt lgkmcnt(6)
    ds_read_b64_tr_b16 v[188:189], v60 offset:14368
    ds_read_b64_tr_b16 v[190:191], v60 offset:14624
    v_mfma_f32_16x16x32_bf16 v[80:83], a[100:103], v[128:131], v[80:83]
    ds_read_b64_tr_b16 v[192:193], v60 offset:14848
    ds_read_b64_tr_b16 v[194:195], v60 offset:15104
    v_mfma_f32_16x16x32_bf16 v[84:87], a[104:107], v[124:127], v[84:87]
    ds_read_b64_tr_b16 v[196:197], v60 offset:15360
    ds_read_b64_tr_b16 v[198:199], v60 offset:15616
    v_mfma_f32_16x16x32_bf16 v[84:87], a[108:111], v[128:131], v[84:87]
    s_waitcnt vmcnt(12) lgkmcnt(15)
    ds_read_b64_tr_b16 v[200:201], v60 offset:14880
    ds_read_b64_tr_b16 v[202:203], v60 offset:15136
    v_mfma_f32_16x16x32_bf16 v[68:71], a[112:115], v[132:135], v[68:71]
    ds_read_b64_tr_b16 v[204:205], v60 offset:15392
    ds_read_b64_tr_b16 v[206:207], v60 offset:15648
    v_mfma_f32_16x16x32_bf16 v[72:75], a[116:119], v[132:135], v[72:75]
    ds_read_b64_tr_b16 v[208:209], v61 offset:15872
    ds_read_b64_tr_b16 v[210:211], v61 offset:15936
    v_mfma_f32_16x16x32_bf16 v[76:79], a[120:123], v[132:135], v[76:79]
    s_waitcnt lgkmcnt(6)
    ds_read_b64_tr_b16 v[212:213], v61 offset:16000
    ds_read_b64_tr_b16 v[214:215], v61 offset:16064
    v_mfma_f32_16x16x32_bf16 v[80:83], a[124:127], v[132:135], v[80:83]
    ds_read_b64_tr_b16 v[216:217], v60 offset:16128
    ds_read_b64_tr_b16 v[218:219], v60 offset:16384
    v_mfma_f32_16x16x32_bf16 v[84:87], a[128:131], v[132:135], v[84:87]
    ds_read_b64_tr_b16 v[220:221], v60 offset:16640
    ds_read_b64_tr_b16 v[222:223], v60 offset:16896
    s_waitcnt vmcnt(8)
    v_max3_u32 v55, v136, v137, 0
    v_max3_u32 v56, v138, v139, 0
    v_max3_u32 v55, v140, v141, v55
    v_max3_u32 v56, v142, v143, v56
    v_max3_u32 v55, v144, v145, v55
    v_max3_u32 v56, v146, v147, v56
    v_max3_u32 v55, v148, v149, v55
    v_max3_u32 v56, v150, v151, v56
    s_waitcnt vmcnt(0)
    v_max3_u32 v55, v152, v153, v55
    v_max3_u32 v56, v154, v155, v56
    v_max3_u32 v55, v156, v157, v55
    v_max3_u32 v56, v158, v159, v56
    v_max3_u32 v55, v160, v161, v55
    v_max3_u32 v56, v162, v163, v56
    v_max3_u32 v55, v164, v165, v55
    v_max3_u32 v56, v166, v167, v56
    v_max3_u32 v55, v168, v169, v55
    v_max3_u32 v56, v170, v171, v56
    v_max_u32 v55, v55, v56
    v_cmp_eq_u32 vcc, -1, v55
    s_mul_i32 s62, s58, 2304
    s_add_u32 s62, s62, 40960
    v_mul_u32_u24 v58, 9, v14
    v_lshl_add_u32 v58, v48, 3, v58
    v_add_u32 v58, s62, v58
    s_and_b32 s63, s57, 1
    s_xor_b32 s63, s63, 1
    s_lshl_b32 s63, s63, 7
    v_lshrrev_b32 v15, 5, v0
    v_lshl_add_u32 v59, v15, 18, v58
    v_add_u32 v59, s63, v59
    s_and_b32 s63, s57, 1
    s_lshl_b32 s63, s63, 4
    v_add_u32 v58, s63, v58
    v_add_u32 v2, s62, v7
    s_cbranch_vccnz L_retry
L_verified:
    s_waitcnt vmcnt(10) lgkmcnt(15)
    v_mfma_f32_16x16x32_bf16 v[68:71], a[132:135], v[136:139], v[68:71]
    ds_read_b64_tr_b16 v[224:225], v60 offset:16160
    ds_read_b64_tr_b16 v[226:227], v60 offset:16416
    v_mfma_f32_16x16x32_bf16 v[68:71], a[136:139], v[140:143], v[68:71]
    ds_read_b64_tr_b16 v[228:229], v60 offset:16672
    ds_read_b64_tr_b16 v[230:231], v60 offset:16928
    v_mfma_f32_16x16x32_bf16 v[72:75], a[140:143], v[136:139], v[72:75]
    ds_read_b64_tr_b16 v[232:233], v60 offset:17152
    ds_read_b64_tr_b16 v[234:235], v60 offset:17408
    v_mfma_f32_16x16x32_bf16 v[72:75], a[144:147], v[140:143], v[72:75]
    ds_read_b64_tr_b16 v[236:237], v60 offset:17664
    ds_read_b64_tr_b16 v[238:239], v60 offset:17920
    v_mfma_f32_16x16x32_bf16 v[76:79], a[148:151], v[136:139], v[76:79]
    ds_read_b64_tr_b16 v[240:241], v60 offset:17184
    ds_read_b64_tr_b16 v[242:243], v60 offset:17440
    v_mfma_f32_16x16x32_bf16 v[76:79], a[152:155], v[140:143], v[76:79]
    ds_read_b64_tr_b16 v[244:245], v60 offset:17696
    ds_read_b64_tr_b16 v[246:247], v60 offset:17952
    v_mfma_f32_16x16x32_bf16 v[80:83], a[156:159], v[136:139], v[80:83]
    ds_read_b64_tr_b16 v[248:249], v61 offset:18176
    ds_read_b64_tr_b16 v[250:251], v61 offset:18240
    v_mfma_f32_16x16x32_bf16 v[80:83], a[160:163], v[140:143], v[80:83]
    ds_read_b64_tr_b16 a[0:1], v61 offset:18304
    ds_read_b64_tr_b16 a[2:3], v61 offset:18368
    v_mfma_f32_16x16x32_bf16 v[84:87], a[164:167], v[136:139], v[84:87]
    ds_read_b64_tr_b16 a[4:5], v60 offset:18944
    ds_read_b64_tr_b16 a[6:7], v60 offset:19200
    v_mfma_f32_16x16x32_bf16 v[84:87], a[168:171], v[140:143], v[84:87]
    s_waitcnt vmcnt(8) lgkmcnt(15)
    ds_read_b64_tr_b16 a[8:9], v60 offset:18976
    ds_read_b64_tr_b16 a[10:11], v60 offset:19232
    v_mfma_f32_16x16x32_bf16 v[68:71], a[172:175], v[144:147], v[68:71]
    ds_read_b64_tr_b16 a[12:13], v60 offset:19968
    ds_read_b64_tr_b16 a[14:15], v60 offset:20224
    v_mfma_f32_16x16x32_bf16 v[68:71], a[176:179], v[148:151], v[68:71]
    ds_read_b64_tr_b16 a[16:17], v60 offset:20000
    ds_read_b64_tr_b16 a[18:19], v60 offset:20256
    v_mfma_f32_16x16x32_bf16 v[72:75], a[180:183], v[144:147], v[72:75]
    ds_read_b64_tr_b16 a[20:21], v61 offset:20608
    ds_read_b64_tr_b16 a[22:23], v61 offset:20672
    v_mfma_f32_16x16x32_bf16 v[72:75], a[184:187], v[148:151], v[72:75]
    v_add_u32 v15, 0, v0
    v_mul_u32_u24 v55, 7282, v15
    v_mfma_f32_16x16x32_bf16 v[76:79], a[188:191], v[144:147], v[76:79]
    v_lshrrev_b32 v55, 16, v55
    v_mul_u32_u24 v55, 1008, v55
    v_mfma_f32_16x16x32_bf16 v[76:79], a[192:195], v[148:151], v[76:79]
    v_lshl_add_u32 v55, v15, 4, v55
    v_add_u32 v15, 64, v0
    v_mfma_f32_16x16x32_bf16 v[80:83], a[196:199], v[144:147], v[80:83]
    v_mul_u32_u24 v56, 7282, v15
    v_lshrrev_b32 v56, 16, v56
    v_mfma_f32_16x16x32_bf16 v[80:83], a[200:203], v[148:151], v[80:83]
    v_mul_u32_u24 v56, 1008, v56
    v_lshl_add_u32 v56, v15, 4, v56
    v_mfma_f32_16x16x32_bf16 v[84:87], a[204:207], v[144:147], v[84:87]
    v_add_u32 v15, 128, v0
    v_mul_u32_u24 v57, 7282, v15
    v_mfma_f32_16x16x32_bf16 v[84:87], v[172:175], v[148:151], v[84:87]
    s_waitcnt vmcnt(6) lgkmcnt(15)
    v_lshrrev_b32 v57, 16, v57
    v_mul_u32_u24 v57, 1008, v57
    v_mfma_f32_16x16x32_bf16 v[68:71], v[176:179], v[152:155], v[68:71]
    v_lshl_add_u32 v57, v15, 4, v57
    v_lshl_add_u32 v57, v48, 28, v57
    v_mfma_f32_16x16x32_bf16 v[68:71], v[180:183], v[156:159], v[68:71]
    v_mfma_f32_16x16x32_bf16 v[72:75], v[184:187], v[152:155], v[72:75]
    v_mfma_f32_16x16x32_bf16 v[72:75], v[188:191], v[156:159], v[72:75]
    v_mfma_f32_16x16x32_bf16 v[76:79], v[192:195], v[152:155], v[76:79]
    v_mfma_f32_16x16x32_bf16 v[76:79], v[196:199], v[156:159], v[76:79]
    v_mfma_f32_16x16x32_bf16 v[80:83], v[200:203], v[152:155], v[80:83]
    v_mfma_f32_16x16x32_bf16 v[80:83], v[204:207], v[156:159], v[80:83]
    v_mfma_f32_16x16x32_bf16 v[84:87], v[208:211], v[152:155], v[84:87]
    v_mfma_f32_16x16x32_bf16 v[84:87], v[212:215], v[156:159], v[84:87]
    s_waitcnt vmcnt(4) lgkmcnt(10)
    v_mfma_f32_16x16x32_bf16 v[68:71], v[216:219], v[160:163], v[68:71]
    v_mfma_f32_16x16x32_bf16 v[68:71], v[220:223], v[164:167], v[68:71]
    v_mfma_f32_16x16x32_bf16 v[72:75], v[224:227], v[160:163], v[72:75]
    v_mfma_f32_16x16x32_bf16 v[72:75], v[228:231], v[164:167], v[72:75]
    v_mfma_f32_16x16x32_bf16 v[76:79], v[232:235], v[160:163], v[76:79]
    v_mfma_f32_16x16x32_bf16 v[76:79], v[236:239], v[164:167], v[76:79]
    v_mfma_f32_16x16x32_bf16 v[80:83], v[240:243], v[160:163], v[80:83]
    v_mfma_f32_16x16x32_bf16 v[80:83], v[244:247], v[164:167], v[80:83]
    v_mfma_f32_16x16x32_bf16 v[84:87], v[248:251], v[160:163], v[84:87]
    v_mfma_f32_16x16x32_bf16 v[84:87], a[0:3], v[164:167], v[84:87]
    s_waitcnt vmcnt(0) lgkmcnt(0)
    v_mfma_f32_16x16x32_bf16 v[68:71], a[4:7], v[168:171], v[68:71]
    v_mfma_f32_16x16x32_bf16 v[72:75], a[8:11], v[168:171], v[72:75]
    v_mfma_f32_16x16x32_bf16 v[76:79], a[12:15], v[168:171], v[76:79]
    v_mfma_f32_16x16x32_bf16 v[80:83], a[16:19], v[168:171], v[80:83]
    v_mfma_f32_16x16x32_bf16 v[84:87], a[20:23], v[168:171], v[84:87]
    s_nop 3
    v_cvt_pk_bf16_f32 v68, v68, v69
    v_cvt_pk_bf16_f32 v69, v70, v71
    ds_write_b64 v58, v[68:69] offset:0
    v_cvt_pk_bf16_f32 v72, v72, v73
    v_cvt_pk_bf16_f32 v73, v74, v75
    ds_write_b64 v58, v[72:73] offset:32
    v_cvt_pk_bf16_f32 v76, v76, v77
    v_cvt_pk_bf16_f32 v77, v78, v79
    ds_write_b64 v58, v[76:77] offset:64
    v_cvt_pk_bf16_f32 v80, v80, v81
    v_cvt_pk_bf16_f32 v81, v82, v83
    ds_write_b64 v58, v[80:81] offset:96
    v_cvt_pk_bf16_f32 v84, v84, v85
    v_cvt_pk_bf16_f32 v85, v86, v87
    ds_write_b64 v59, v[84:85] offset:0
    ds_read_b128 v[100:103], v2 offset:0
    ds_read_b128 v[104:107], v2 offset:1024
    ds_read_b128 v[108:111], v2 offset:2048
    s_waitcnt lgkmcnt(2)
    buffer_store_dwordx4 v[100:103], v55, s[32:35], s54 offen
    s_waitcnt lgkmcnt(1)
    buffer_store_dwordx4 v[104:107], v56, s[32:35], s54 offen
    s_waitcnt lgkmcnt(0)
    buffer_store_dwordx4 v[108:111], v57, s[32:35], s54 offen
L_end:
    s_endpgm
L_padx:
    s_branch L_wret
L_spin30:
    s_mov_b32 s74, 262144
L_spin30_l:
    s_mov_b64 exec, vcc
    buffer_load_dword v49, v50, s[28:31], s9 offen sc1
    s_sub_u32 s74, s74, 1
    s_waitcnt vmcnt(0)
    s_mov_b64 exec, -1
    s_cbranch_scc1 L_back30
    v_cmp_gt_u32 vcc, 2, v49
    s_nop 1
    s_cbranch_vccnz L_spin30_l
    s_branch L_back30
L_retry:
    s_mov_b32 s74, 262144
L_retry_l:
    buffer_load_dwordx4 v[136:139], v53, s[28:31], s13 offen offset:0 sc1
    buffer_load_dwordx4 v[140:143], v53, s[28:31], s13 offen offset:2048 sc1
    buffer_load_dwordx4 v[144:147], v53, s[28:31], s14 offen offset:0 sc1
    buffer_load_dwordx4 v[148:151], v53, s[28:31], s14 offen offset:2048 sc1
    buffer_load_dwordx4 v[152:155], v53, s[28:31], s15 offen offset:0 sc1
    buffer_load_dwordx4 v[156:159], v53, s[28:31], s15 offen offset:2048 sc1
    buffer_load_dwordx4 v[160:163], v53, s[28:31], s16 offen offset:0 sc1
    buffer_load_dwordx4 v[164:167], v53, s[28:31], s16 offen offset:2048 sc1
    buffer_load_dword v168, v54, s[28:31], s17 offen offset:0 sc1
    buffer_load_dword v169, v54, s[28:31], s17 offen offset:128 sc1
    buffer_load_dword v170, v54, s[28:31], s17 offen offset:256 sc1
    buffer_load_dword v171, v54, s[28:31], s17 offen offset:384 sc1
    s_sub_u32 s74, s74, 1
    s_waitcnt vmcnt(0)
    s_cbranch_scc1 L_verified
    v_max3_u32 v55, v136, v137, 0
    v_max3_u32 v56, v138, v139, 0
    v_max3_u32 v55, v140, v141, v55
    v_max3_u32 v56, v142, v143, v56
    v_max3_u32 v55, v144, v145, v55
    v_max3_u32 v56, v146, v147, v56
    v_max3_u32 v55, v148, v149, v55
    v_max3_u32 v56, v150, v151, v56
    v_max3_u32 v55, v152, v153, v55
    v_max3_u32 v56, v154, v155, v56
    v_max3_u32 v55, v156, v157, v55
    v_max3_u32 v56, v158, v159, v56
    v_max3_u32 v55, v160, v161, v55
    v_max3_u32 v56, v162, v163, v56
    v_max3_u32 v55, v164, v165, v55
    v_max3_u32 v56, v166, v167, v56
    v_max3_u32 v55, v168, v169, v55
    v_max3_u32 v56, v170, v171, v56
    v_max_u32 v55, v55, v56
    v_cmp_eq_u32 vcc, -1, v55
    s_nop 1
    s_cbranch_vccnz L_retry_l
    s_branch L_verified
L_spin0:
    s_mov_b32 s74, 4194304
L_spin0_l:
    ds_read_b32 v6, v11
    s_sub_u32 s74, s74, 1
    s_waitcnt lgkmcnt(0)
    s_cbranch_scc1 L_back0
    v_cmp_le_u32 vcc, 4, v6
    s_nop 1
    s_cbranch_vccz L_spin0_l
    s_branch L_back0
L_spin1:
    s_mov_b32 s74, 4194304
L_spin1_l:
    ds_read_b32 v6, v11
    s_sub_u32 s74, s74, 1
    s_waitcnt lgkmcnt(0)
    s_cbranch_scc1 L_back1
    v_cmp_le_u32 vcc, 8, v6
    s_nop 1
    s_cbranch_vccz L_spin1_l
    s_branch L_back1
L_spin2:
    s_mov_b32 s74, 4194304
L_spin2_l:
    ds_read_b32 v6, v11
    s_sub_u32 s74, s74, 1
    s_waitcnt lgkmcnt(0)
    s_cbranch_scc1 L_back2
    v_cmp_le_u32 vcc, 12, v6
    s_nop 1
    s_cbranch_vccz L_spin2_l
    s_branch L_back2
L_spin3:
    s_mov_b32 s74, 4194304
L_spin3_l:
    ds_read_b32 v6, v11
    s_sub_u32 s74, s74, 1
    s_waitcnt lgkmcnt(0)
    s_cbranch_scc1 L_back3
    v_cmp_le_u32 vcc, 16, v6
    s_nop 1
    s_cbranch_vccz L_spin3_l
    s_branch L_back3
L_spin4:
    s_mov_b32 s74, 4194304
L_spin4_l:
    ds_read_b32 v6, v11
    s_sub_u32 s74, s74, 1
    s_waitcnt lgkmcnt(0)
    s_cbranch_scc1 L_back4
    v_cmp_le_u32 vcc, 20, v6
    s_nop 1
    s_cbranch_vccz L_spin4_l
    s_branch L_back4
L_spin5:
    s_mov_b32 s74, 4194304
L_spin5_l:
    ds_read_b32 v6, v11
    s_sub_u32 s74, s74, 1
    s_waitcnt lgkmcnt(0)
    s_cbranch_scc1 L_back5
    v_cmp_le_u32 vcc, 24, v6
    s_nop 1
    s_cbranch_vccz L_spin5_l
    s_branch L_back5
L_spin6:
    s_mov_b32 s74, 4194304
L_spin6_l:
    ds_read_b32 v6, v11
    s_sub_u32 s74, s74, 1
    s_waitcnt lgkmcnt(0)
    s_cbranch_scc1 L_back6
    v_cmp_le_u32 vcc, 28, v6
    s_nop 1
    s_cbranch_vccz L_spin6_l
    s_branch L_back6
L_spin7:
    s_mov_b32 s74, 4194304
L_spin7_l:
    ds_read_b32 v6, v11
    s_sub_u32 s74, s74, 1
    s_waitcnt lgkmcnt(0)
    s_cbranch_scc1 L_back7
    v_cmp_le_u32 vcc, 32, v6
    s_nop 1
    s_cbranch_vccz L_spin7_l
    s_branch L_back7
L_spin8:
    s_mov_b32 s74, 4194304
L_spin8_l:
    ds_read_b32 v6, v11
    s_sub_u32 s74, s74, 1
    s_waitcnt lgkmcnt(0)
    s_cbranch_scc1 L_back8
    v_cmp_le_u32 vcc, 36, v6
    s_nop 1
    s_cbranch_vccz L_spin8_l
    s_branch L_back8
L_spin9:
    s_mov_b32 s74, 4194304
L_spin9_l:
    ds_read_b32 v6, v11
    s_sub_u32 s74, s74, 1
    s_waitcnt lgkmcnt(0)
    s_cbranch_scc1 L_back9
    v_cmp_le_u32 vcc, 40, v6
    s_nop 1
    s_cbranch_vccz L_spin9_l
    s_branch L_back9
L_spin10:
    s_mov_b32 s74, 262144
L_spin10_l:
    s_sleep 2
    s_mov_b64 exec, vcc
    buffer_load_dword v15, v14, s[48:51], 0 offen sc1
    s_sub_u32 s74, s74, 1
    s_waitcnt vmcnt(0)
    s_mov_b64 exec, -1
    s_cbranch_scc1 L_back10
    v_cmp_gt_u32 vcc, 8, v15
    s_nop 1
    s_cbranch_vccnz L_spin10_l
    s_branch L_back10
L_spin11:
    s_mov_b32 s74, 4194304
L_spin11_l:
    ds_read_b32 v6, v11
    s_sub_u32 s74, s74, 1
    s_waitcnt lgkmcnt(0)
    s_cbranch_scc1 L_back11
    v_cmp_le_u32 vcc, 44, v6
    s_nop 1
    s_cbranch_vccz L_spin11_l
    s_branch L_back11
L_spin12:
    s_mov_b32 s74, 4194304
L_spin12_l:
    ds_read_b32 v6, v11
    s_sub_u32 s74, s74, 1
    s_waitcnt lgkmcnt(0)
    s_cbranch_scc1 L_back12
    v_cmp_le_u32 vcc, 48, v6
    s_nop 1
    s_cbranch_vccz L_spin12_l
    s_branch L_back12
L_spin13:
    s_mov_b32 s74, 4194304
L_spin13_l:
    ds_read_b32 v6, v11
    s_sub_u32 s74, s74, 1
    s_waitcnt lgkmcnt(0)
    s_cbranch_scc1 L_back13
    v_cmp_le_u32 vcc, 52, v6
    s_nop 1
    s_cbranch_vccz L_spin13_l
    s_branch L_back13
L_spin14:
    s_mov_b32 s74, 4194304
L_spin14_l:
    ds_read_b32 v6, v11
    s_sub_u32 s74, s74, 1
    s_waitcnt lgkmcnt(0)
    s_cbranch_scc1 L_back14
    v_cmp_le_u32 vcc, 56, v6
    s_nop 1
    s_cbranch_vccz L_spin14_l
    s_branch L_back14
L_spin15:
    s_mov_b32 s74, 4194304
L_spin15_l:
    ds_read_b32 v6, v11
    s_sub_u32 s74, s74, 1
    s_waitcnt lgkmcnt(0)
    s_cbranch_scc1 L_back15
    v_cmp_le_u32 vcc, 60, v6
    s_nop 1
    s_cbranch_vccz L_spin15_l
    s_branch L_back15
L_spin16:
    s_mov_b32 s74, 4194304
L_spin16_l:
    ds_read_b32 v6, v11
    s_sub_u32 s74, s74, 1
    s_waitcnt lgkmcnt(0)
    s_cbranch_scc1 L_back16
    v_cmp_le_u32 vcc, 64, v6
    s_nop 1
    s_cbranch_vccz L_spin16_l
    s_branch L_back16
L_spin17:
    s_mov_b32 s74, 4194304
L_spin17_l:
    ds_read_b32 v6, v11
    s_sub_u32 s74, s74, 1
    s_waitcnt lgkmcnt(0)
    s_cbranch_scc1 L_back17
    v_cmp_le_u32 vcc, 68, v6
    s_nop 1
    s_cbranch_vccz L_spin17_l
    s_branch L_back17
L_spin18:
    s_mov_b32 s74, 4194304
L_spin18_l:
    ds_read_b32 v6, v11
    s_sub_u32 s74, s74, 1
    s_waitcnt lgkmcnt(0)
    s_cbranch_scc1 L_back18
    v_cmp_le_u32 vcc, 72, v6
    s_nop 1
    s_cbranch_vccz L_spin18_l
    s_branch L_back18
L_spin19:
    s_mov_b32 s74, 4194304
L_spin19_l:
    ds_read_b32 v6, v11
    s_sub_u32 s74, s74, 1
    s_waitcnt lgkmcnt(0)
    s_cbranch_scc1 L_back19
    v_cmp_le_u32 vcc, 76, v6
    s_nop 1
    s_cbranch_vccz L_spin19_l
    s_branch L_back19
L_spin20:
    s_mov_b32 s74, 262144
L_spin20_l:
    s_sleep 2
    s_mov_b64 exec, vcc
    buffer_load_dword v49, v50, s[28:31], s44 offen sc1
    s_sub_u32 s74, s74, 1
    s_waitcnt vmcnt(0)
    s_mov_b64 exec, -1
    s_cbranch_scc1 L_back20
    v_cmp_gt_u32 vcc, 1, v49
    s_nop 1
    s_cbranch_vccnz L_spin20_l
    s_branch L_back20
L_spin21:
    s_mov_b32 s74, 262144
L_spin21_l:
    s_sleep 2
    s_mov_b64 exec, vcc
    buffer_load_dword v49, v50, s[28:31], s44 offen sc1
    s_sub_u32 s74, s74, 1
    s_waitcnt vmcnt(0)
    s_mov_b64 exec, -1
    s_cbranch_scc1 L_back21
    v_cmp_gt_u32 vcc, 1, v49
    s_nop 1
    s_cbranch_vccnz L_spin21_l
    s_branch L_back21
L_spin22:
    s_mov_b32 s74, 4194304
L_spin22_l:
    ds_read_b32 v6, v11
    s_sub_u32 s74, s74, 1
    s_waitcnt lgkmcnt(0)
    s_cbranch_scc1 L_back22
    v_cmp_le_u32 vcc, 80, v6
    s_nop 1
    s_cbranch_vccz L_spin22_l
    s_branch L_back22
L_spin23:
    s_mov_b32 s74, 4194304
L_spin23_l:
    ds_read_b32 v6, v11
    s_sub_u32 s74, s74, 1
    s_waitcnt lgkmcnt(0)
    s_cbranch_scc1 L_back23
    v_cmp_le_u32 vcc, 84, v6
    s_nop 1
    s_cbranch_vccz L_spin23_l
    s_branch L_back23
L_spin24:
    s_mov_b32 s74, 4194304
L_spin24_l:
    ds_read_b32 v6, v11
    s_sub_u32 s74, s74, 1
    s_waitcnt lgkmcnt(0)
    s_cbranch_scc1 L_back24
    v_cmp_le_u32 vcc, 88, v6
    s_nop 1
    s_cbranch_vccz L_spin24_l
    s_branch L_back24
L_spin25:
    s_mov_b32 s74, 4194304
L_spin25_l:
    ds_read_b32 v6, v11
    s_sub_u32 s74, s74, 1
    s_waitcnt lgkmcnt(0)
    s_cbranch_scc1 L_back25
    v_cmp_le_u32 vcc, 92, v6
    s_nop 1
    s_cbranch_vccz L_spin25_l
    s_branch L_back25
L_spin26:
    s_mov_b32 s74, 4194304
L_spin26_l:
    ds_read_b32 v6, v11
    s_sub_u32 s74, s74, 1
    s_waitcnt lgkmcnt(0)
    s_cbranch_scc1 L_back26
    v_cmp_le_u32 vcc, 96, v6
    s_nop 1
    s_cbranch_vccz L_spin26_l
    s_branch L_back26
L_spin27:
    s_mov_b32 s74, 4194304
L_spin27_l:
    ds_read_b32 v6, v11
    s_sub_u32 s74, s74, 1
    s_waitcnt lgkmcnt(0)
    s_cbranch_scc1 L_back27
    v_cmp_le_u32 vcc, 100, v6
    s_nop 1
    s_cbranch_vccz L_spin27_l
    s_branch L_back27
L_spin28:
    s_mov_b32 s74, 4194304
L_spin28_l:
    ds_read_b32 v6, v11
    s_sub_u32 s74, s74, 1
    s_waitcnt lgkmcnt(0)
    s_cbranch_scc1 L_back28
    v_cmp_le_u32 vcc, 104, v6
    s_nop 1
    s_cbranch_vccz L_spin28_l
    s_branch L_back28
L_spin29:
    s_mov_b32 s74, 4194304
L_spin29_l:
    ds_read_b32 v6, v11
    s_sub_u32 s74, s74, 1
    s_waitcnt lgkmcnt(0)
    s_cbranch_scc1 L_back29
    v_cmp_le_u32 vcc, 108, v6
    s_nop 1
    s_cbranch_vccz L_spin29_l
    s_branch L_back29
L_fb:
    v_cmp_gt_u32 vcc, 262144, v3
    v_mov_b32 v152, 1073741824
    s_mov_b32 s62, 0
    v_cndmask_b32 v3, v152, v3, vcc
    v_mov_b32 v152, 0xff7fffff
    v_mov_b32 v153, 0xff7fffff
L_fb1:
    s_add_u32 s63, s62, 4096
    buffer_load_dwordx4 v[100:103], v7, s[28:31], s62 offen offset:0 sc1
    buffer_load_dwordx4 v[104:107], v7, s[28:31], s62 offen offset:1024 sc1
    buffer_load_dwordx4 v[108:111], v7, s[28:31], s62 offen offset:2048 sc1
    buffer_load_dwordx4 v[112:115], v7, s[28:31], s62 offen offset:3072 sc1
    buffer_load_dwordx2 v[116:117], v2, s[28:31], s63 offen sc1
    s_waitcnt vmcnt(0)
    v_mfma_f32_32x32x16_bf16 v[192:207], v[100:103], a[224:227], 0
    v_mfma_f32_32x32x8_bf16 v[192:207], v[116:117], v[32:33], v[192:207]
    v_mfma_f32_32x32x16_bf16 v[208:223], v[100:103], a[228:231], 0
    v_mfma_f32_32x32x8_bf16 v[208:223], v[116:117], v[40:41], v[208:223]
    s_nop 15
    v_max3_f32 v152, v192, v193, v152
    v_max3_f32 v152, v194, v195, v152
    v_max3_f32 v152, v196, v197, v152
    v_max3_f32 v152, v198, v199, v152
    v_max3_f32 v152, v200, v201, v152
    v_max3_f32 v152, v202, v203, v152
    v_max3_f32 v152, v204, v205, v152
    v_max3_f32 v152, v206, v207, v152
    v_max3_f32 v153, v208, v209, v153
    v_max3_f32 v153, v210, v211, v153
    v_max3_f32 v153, v212, v213, v153
    v_max3_f32 v153, v214, v215, v153
    v_max3_f32 v153, v216, v217, v153
    v_max3_f32 v153, v218, v219, v153
    v_max3_f32 v153, v220, v221, v153
    v_max3_f32 v153, v222, v223, v153
    v_mfma_f32_32x32x16_bf16 v[192:207], v[104:107], a[224:227], 0
    v_mfma_f32_32x32x8_bf16 v[192:207], v[116:117], v[34:35], v[192:207]
    v_mfma_f32_32x32x16_bf16 v[208:223], v[104:107], a[228:231], 0
    v_mfma_f32_32x32x8_bf16 v[208:223], v[116:117], v[42:43], v[208:223]
    s_nop 15
    v_max3_f32 v152, v192, v193, v152
    v_max3_f32 v152, v194, v195, v152
    v_max3_f32 v152, v196, v197, v152
    v_max3_f32 v152, v198, v199, v152
    v_max3_f32 v152, v200, v201, v152
    v_max3_f32 v152, v202, v203, v152
    v_max3_f32 v152, v204, v205, v152
    v_max3_f32 v152, v206, v207, v152
    v_max3_f32 v153, v208, v209, v153
    v_max3_f32 v153, v210, v211, v153
    v_max3_f32 v153, v212, v213, v153
    v_max3_f32 v153, v214, v215, v153
    v_max3_f32 v153, v216, v217, v153
    v_max3_f32 v153, v218, v219, v153
    v_max3_f32 v153, v220, v221, v153
    v_max3_f32 v153, v222, v223, v153
    v_mfma_f32_32x32x16_bf16 v[192:207], v[108:111], a[224:227], 0
    v_mfma_f32_32x32x8_bf16 v[192:207], v[116:117], v[36:37], v[192:207]
    v_mfma_f32_32x32x16_bf16 v[208:223], v[108:111], a[228:231], 0
    v_mfma_f32_32x32x8_bf16 v[208:223], v[116:117], v[44:45], v[208:223]
    s_nop 15
    v_max3_f32 v152, v192, v193, v152
    v_max3_f32 v152, v194, v195, v152
    v_max3_f32 v152, v196, v197, v152
    v_max3_f32 v152, v198, v199, v152
    v_max3_f32 v152, v200, v201, v152
    v_max3_f32 v152, v202, v203, v152
    v_max3_f32 v152, v204, v205, v152
    v_max3_f32 v152, v206, v207, v152
    v_max3_f32 v153, v208, v209, v153
    v_max3_f32 v153, v210, v211, v153
    v_max3_f32 v153, v212, v213, v153
    v_max3_f32 v153, v214, v215, v153
    v_max3_f32 v153, v216, v217, v153
    v_max3_f32 v153, v218, v219, v153
    v_max3_f32 v153, v220, v221, v153
    v_max3_f32 v153, v222, v223, v153
    v_mfma_f32_32x32x16_bf16 v[192:207], v[112:115], a[224:227], 0
    v_mfma_f32_32x32x8_bf16 v[192:207], v[116:117], v[38:39], v[192:207]
    v_mfma_f32_32x32x16_bf16 v[208:223], v[112:115], a[228:231], 0
    v_mfma_f32_32x32x8_bf16 v[208:223], v[116:117], v[46:47], v[208:223]
    s_nop 15
    v_max3_f32 v152, v192, v193, v152
    v_max3_f32 v152, v194, v195, v152
    v_max3_f32 v152, v196, v197, v152
    v_max3_f32 v152, v198, v199, v152
    v_max3_f32 v152, v200, v201, v152
    v_max3_f32 v152, v202, v203, v152
    v_max3_f32 v152, v204, v205, v152
    v_max3_f32 v152, v206, v207, v152
    v_max3_f32 v153, v208, v209, v153
    v_max3_f32 v153, v210, v211, v153
    v_max3_f32 v153, v212, v213, v153
    v_max3_f32 v153, v214, v215, v153
    v_max3_f32 v153, v216, v217, v153
    v_max3_f32 v153, v218, v219, v153
    v_max3_f32 v153, v220, v221, v153
    v_max3_f32 v153, v222, v223, v153
    s_add_u32 s62, s62, 9472
    s_cmp_lt_u32 s62, 151552
    s_cbranch_scc1 L_fb1
    v_mov_b32 v154, v152
    s_nop 1
    v_permlane32_swap_b32 v152, v154
    v_max_f32 v152, v152, v154
    v_sub_f32 v16, 0, v152
    v_sub_f32 v17, 0, v152
    v_sub_f32 v18, 0, v152
    v_sub_f32 v19, 0, v152
    v_sub_f32 v20, 0, v152
    v_sub_f32 v21, 0, v152
    v_sub_f32 v22, 0, v152
    v_sub_f32 v23, 0, v152
    v_sub_f32 v24, 0, v152
    v_sub_f32 v25, 0, v152
    v_sub_f32 v26, 0, v152
    v_sub_f32 v27, 0, v152
    v_sub_f32 v28, 0, v152
    v_sub_f32 v29, 0, v152
    v_sub_f32 v30, 0, v152
    v_sub_f32 v31, 0, v152
    v_mov_b32 v154, v153
    s_nop 1
    v_permlane32_swap_b32 v153, v154
    v_max_f32 v153, v153, v154
    v_sub_f32 v240, 0, v153
    v_sub_f32 v241, 0, v153
    v_sub_f32 v242, 0, v153
    v_sub_f32 v243, 0, v153
    v_sub_f32 v244, 0, v153
    v_sub_f32 v245, 0, v153
    v_sub_f32 v246, 0, v153
    v_sub_f32 v247, 0, v153
    v_sub_f32 v248, 0, v153
    v_sub_f32 v249, 0, v153
    v_sub_f32 v250, 0, v153
    v_sub_f32 v251, 0, v153
    v_sub_f32 v252, 0, v153
    v_sub_f32 v253, 0, v153
    v_sub_f32 v254, 0, v153
    v_sub_f32 v255, 0, v153
    v_accvgpr_write_b32 a0, 0
    v_accvgpr_write_b32 a1, 0
    v_accvgpr_write_b32 a2, 0
    v_accvgpr_write_b32 a3, 0
    v_accvgpr_write_b32 a4, 0
    v_accvgpr_write_b32 a5, 0
    v_accvgpr_write_b32 a6, 0
    v_accvgpr_write_b32 a7, 0
    v_accvgpr_write_b32 a8, 0
    v_accvgpr_write_b32 a9, 0
    v_accvgpr_write_b32 a10, 0
    v_accvgpr_write_b32 a11, 0
    v_accvgpr_write_b32 a12, 0
    v_accvgpr_write_b32 a13, 0
    v_accvgpr_write_b32 a14, 0
    v_accvgpr_write_b32 a15, 0
    v_accvgpr_write_b32 a16, 0
    v_accvgpr_write_b32 a17, 0
    v_accvgpr_write_b32 a18, 0
    v_accvgpr_write_b32 a19, 0
    v_accvgpr_write_b32 a20, 0
    v_accvgpr_write_b32 a21, 0
    v_accvgpr_write_b32 a22, 0
    v_accvgpr_write_b32 a23, 0
    v_accvgpr_write_b32 a24, 0
    v_accvgpr_write_b32 a25, 0
    v_accvgpr_write_b32 a26, 0
    v_accvgpr_write_b32 a27, 0
    v_accvgpr_write_b32 a28, 0
    v_accvgpr_write_b32 a29, 0
    v_accvgpr_write_b32 a30, 0
    v_accvgpr_write_b32 a31, 0
    s_mov_b32 s62, 0
L_fb2:
    s_add_u32 s63, s62, 4096
    buffer_load_dwordx4 v[100:103], v7, s[28:31], s62 offen offset:0 sc1
    buffer_load_dwordx4 v[104:107], v7, s[28:31], s62 offen offset:1024 sc1
    buffer_load_dwordx4 v[108:111], v7, s[28:31], s62 offen offset:2048 sc1
    buffer_load_dwordx4 v[112:115], v7, s[28:31], s62 offen offset:3072 sc1
    buffer_load_dwordx2 v[116:117], v2, s[28:31], s63 offen sc1
    s_add_u32 s63, s62, 4608
    buffer_load_dwordx4 v[120:123], v3, s[28:31], s63 offen offset:0 sc1
    buffer_load_dwordx4 v[124:127], v3, s[28:31], s63 offen offset:608 sc1
    buffer_load_dwordx4 v[128:131], v3, s[28:31], s63 offen offset:1216 sc1
    buffer_load_dwordx4 v[132:135], v3, s[28:31], s63 offen offset:1824 sc1
    s_add_u32 s63, s63, 2432
    buffer_load_dwordx4 v[136:139], v3, s[28:31], s63 offen offset:0 sc1
    buffer_load_dwordx4 v[140:143], v3, s[28:31], s63 offen offset:608 sc1
    buffer_load_dwordx4 v[144:147], v3, s[28:31], s63 offen offset:1216 sc1
    buffer_load_dwordx4 v[148:151], v3, s[28:31], s63 offen offset:1824 sc1
    s_waitcnt vmcnt(0)
    v_mfma_f32_32x32x16_bf16 v[192:207], v[100:103], a[224:227], v[16:31]
    v_mfma_f32_32x32x8_bf16 v[192:207], v[116:117], v[32:33], v[192:207]
    v_mfma_f32_32x32x16_bf16 v[208:223], v[100:103], a[228:231], v[240:255]
    v_mfma_f32_32x32x8_bf16 v[208:223], v[116:117], v[40:41], v[208:223]
    s_nop 15
    v_exp_f32 v192, v192
    v_exp_f32 v193, v193
    v_exp_f32 v194, v194
    v_exp_f32 v195, v195
    v_exp_f32 v196, v196
    v_exp_f32 v197, v197
    v_exp_f32 v198, v198
    v_exp_f32 v199, v199
    v_exp_f32 v200, v200
    v_exp_f32 v201, v201
    v_exp_f32 v202, v202
    v_exp_f32 v203, v203
    v_exp_f32 v204, v204
    v_exp_f32 v205, v205
    v_exp_f32 v206, v206
    v_exp_f32 v207, v207
    s_nop 1
    v_smfmac_f32_32x32x32_bf16 a[0:15], v[120:123], v[192:199], v13
    v_smfmac_f32_32x32x32_bf16 a[0:15], v[124:127], v[200:207], v13
    v_exp_f32 v208, v208
    v_exp_f32 v209, v209
    v_exp_f32 v210, v210
    v_exp_f32 v211, v211
    v_exp_f32 v212, v212
    v_exp_f32 v213, v213
    v_exp_f32 v214, v214
    v_exp_f32 v215, v215
    v_exp_f32 v216, v216
    v_exp_f32 v217, v217
    v_exp_f32 v218, v218
    v_exp_f32 v219, v219
    v_exp_f32 v220, v220
    v_exp_f32 v221, v221
    v_exp_f32 v222, v222
    v_exp_f32 v223, v223
    s_nop 1
    v_smfmac_f32_32x32x32_bf16 a[16:31], v[120:123], v[208:215], v13
    v_smfmac_f32_32x32x32_bf16 a[16:31], v[124:127], v[216:223], v13
    v_mfma_f32_32x32x16_bf16 v[192:207], v[104:107], a[224:227], v[16:31]
    v_mfma_f32_32x32x8_bf16 v[192:207], v[116:117], v[34:35], v[192:207]
    v_mfma_f32_32x32x16_bf16 v[208:223], v[104:107], a[228:231], v[240:255]
    v_mfma_f32_32x32x8_bf16 v[208:223], v[116:117], v[42:43], v[208:223]
    s_nop 15
    v_exp_f32 v192, v192
    v_exp_f32 v193, v193
    v_exp_f32 v194, v194
    v_exp_f32 v195, v195
    v_exp_f32 v196, v196
    v_exp_f32 v197, v197
    v_exp_f32 v198, v198
    v_exp_f32 v199, v199
    v_exp_f32 v200, v200
    v_exp_f32 v201, v201
    v_exp_f32 v202, v202
    v_exp_f32 v203, v203
    v_exp_f32 v204, v204
    v_exp_f32 v205, v205
    v_exp_f32 v206, v206
    v_exp_f32 v207, v207
    s_nop 1
    v_smfmac_f32_32x32x32_bf16 a[0:15], v[128:131], v[192:199], v13
    v_smfmac_f32_32x32x32_bf16 a[0:15], v[132:135], v[200:207], v13
    v_exp_f32 v208, v208
    v_exp_f32 v209, v209
    v_exp_f32 v210, v210
    v_exp_f32 v211, v211
    v_exp_f32 v212, v212
    v_exp_f32 v213, v213
    v_exp_f32 v214, v214
    v_exp_f32 v215, v215
    v_exp_f32 v216, v216
    v_exp_f32 v217, v217
    v_exp_f32 v218, v218
    v_exp_f32 v219, v219
    v_exp_f32 v220, v220
    v_exp_f32 v221, v221
    v_exp_f32 v222, v222
    v_exp_f32 v223, v223
    s_nop 1
    v_smfmac_f32_32x32x32_bf16 a[16:31], v[128:131], v[208:215], v13
    v_smfmac_f32_32x32x32_bf16 a[16:31], v[132:135], v[216:223], v13
    v_mfma_f32_32x32x16_bf16 v[192:207], v[108:111], a[224:227], v[16:31]
    v_mfma_f32_32x32x8_bf16 v[192:207], v[116:117], v[36:37], v[192:207]
    v_mfma_f32_32x32x16_bf16 v[208:223], v[108:111], a[228:231], v[240:255]
    v_mfma_f32_32x32x8_bf16 v[208:223], v[116:117], v[44:45], v[208:223]
    s_nop 15
    v_exp_f32 v192, v192
    v_exp_f32 v193, v193
    v_exp_f32 v194, v194
    v_exp_f32 v195, v195
    v_exp_f32 v196, v196
    v_exp_f32 v197, v197
    v_exp_f32 v198, v198
    v_exp_f32 v199, v199
    v_exp_f32 v200, v200
    v_exp_f32 v201, v201
    v_exp_f32 v202, v202
    v_exp_f32 v203, v203
    v_exp_f32 v204, v204
    v_exp_f32 v205, v205
    v_exp_f32 v206, v206
    v_exp_f32 v207, v207
    s_nop 1
    v_smfmac_f32_32x32x32_bf16 a[0:15], v[136:139], v[192:199], v13
    v_smfmac_f32_32x32x32_bf16 a[0:15], v[140:143], v[200:207], v13
    v_exp_f32 v208, v208
    v_exp_f32 v209, v209
    v_exp_f32 v210, v210
    v_exp_f32 v211, v211
    v_exp_f32 v212, v212
    v_exp_f32 v213, v213
    v_exp_f32 v214, v214
    v_exp_f32 v215, v215
    v_exp_f32 v216, v216
    v_exp_f32 v217, v217
    v_exp_f32 v218, v218
    v_exp_f32 v219, v219
    v_exp_f32 v220, v220
    v_exp_f32 v221, v221
    v_exp_f32 v222, v222
    v_exp_f32 v223, v223
    s_nop 1
    v_smfmac_f32_32x32x32_bf16 a[16:31], v[136:139], v[208:215], v13
    v_smfmac_f32_32x32x32_bf16 a[16:31], v[140:143], v[216:223], v13
    v_mfma_f32_32x32x16_bf16 v[192:207], v[112:115], a[224:227], v[16:31]
    v_mfma_f32_32x32x8_bf16 v[192:207], v[116:117], v[38:39], v[192:207]
    v_mfma_f32_32x32x16_bf16 v[208:223], v[112:115], a[228:231], v[240:255]
    v_mfma_f32_32x32x8_bf16 v[208:223], v[116:117], v[46:47], v[208:223]
    s_nop 15
    v_exp_f32 v192, v192
    v_exp_f32 v193, v193
    v_exp_f32 v194, v194
    v_exp_f32 v195, v195
    v_exp_f32 v196, v196
    v_exp_f32 v197, v197
    v_exp_f32 v198, v198
    v_exp_f32 v199, v199
    v_exp_f32 v200, v200
    v_exp_f32 v201, v201
    v_exp_f32 v202, v202
    v_exp_f32 v203, v203
    v_exp_f32 v204, v204
    v_exp_f32 v205, v205
    v_exp_f32 v206, v206
    v_exp_f32 v207, v207
    s_nop 1
    v_smfmac_f32_32x32x32_bf16 a[0:15], v[144:147], v[192:199], v13
    v_smfmac_f32_32x32x32_bf16 a[0:15], v[148:151], v[200:207], v13
    v_exp_f32 v208, v208
    v_exp_f32 v209, v209
    v_exp_f32 v210, v210
    v_exp_f32 v211, v211
    v_exp_f32 v212, v212
    v_exp_f32 v213, v213
    v_exp_f32 v214, v214
    v_exp_f32 v215, v215
    v_exp_f32 v216, v216
    v_exp_f32 v217, v217
    v_exp_f32 v218, v218
    v_exp_f32 v219, v219
    v_exp_f32 v220, v220
    v_exp_f32 v221, v221
    v_exp_f32 v222, v222
    v_exp_f32 v223, v223
    s_nop 1
    v_smfmac_f32_32x32x32_bf16 a[16:31], v[144:147], v[208:215], v13
    v_smfmac_f32_32x32x32_bf16 a[16:31], v[148:151], v[216:223], v13
    s_add_u32 s62, s62, 9472
    s_cmp_lt_u32 s62, 151552
    s_cbranch_scc1 L_fb2
    s_nop 15
    s_cmp_eq_u64 s[82:83], 0
    s_cbranch_scc1 L_fb3
    v_accvgpr_read_b32 v110, a10
    v_accvgpr_read_b32 v100, a0
    v_rcp_f32 v111, v110
    v_accvgpr_read_b32 v101, a1
    v_mul_f32 v111, v111, v51
    v_accvgpr_read_b32 v101, a1
    v_accvgpr_read_b32 v102, a2
    v_accvgpr_read_b32 v103, a3
    v_accvgpr_read_b32 v104, a4
    v_accvgpr_read_b32 v105, a5
    v_accvgpr_read_b32 v106, a6
    v_accvgpr_read_b32 v107, a7
    v_accvgpr_read_b32 v108, a8
    v_accvgpr_read_b32 v109, a9
    v_mul_f32 v100, v100, v111
    v_mul_f32 v101, v101, v111
    v_mul_f32 v102, v102, v111
    v_mul_f32 v103, v103, v111
    v_mul_f32 v104, v104, v111
    v_mul_f32 v105, v105, v111
    v_mul_f32 v106, v106, v111
    v_mul_f32 v107, v107, v111
    v_cvt_pk_bf16_f32 v112, v100, v101
    v_cvt_pk_bf16_f32 v113, v102, v103
    v_cvt_pk_bf16_f32 v114, v104, v105
    v_cvt_pk_bf16_f32 v115, v106, v107
    buffer_store_dwordx4 v[112:115], v7, s[28:31], s4 offen sc1
    v_mul_f32 v108, v108, v111
    v_mul_f32 v109, v109, v111
    v_cvt_pk_bf16_f32 v111, v108, v109
    v_lshlrev_b32 v15, 2, v0
    s_mov_b32 exec_hi, 0
    buffer_store_dword v111, v15, s[28:31], s5 offen offset:0 sc1
    s_mov_b32 exec_hi, -1
    s_waitcnt vmcnt(0)
    v_mov_b32 v100, 2
    v_lshlrev_b32 v15, 2, v0
    s_mov_b32 exec_hi, 0
    buffer_store_dword v100, v15, s[28:31], s6 offen offset:0 sc1
    s_mov_b32 exec_hi, -1
L_fb3:
    v_accvgpr_read_b32 v202, a26
    v_accvgpr_read_b32 v192, a16
    v_rcp_f32 v203, v202
    v_accvgpr_read_b32 v193, a17
    v_mul_f32 v203, v203, v51
    v_accvgpr_read_b32 v193, a17
    v_accvgpr_read_b32 v194, a18
    v_accvgpr_read_b32 v195, a19
    v_accvgpr_read_b32 v196, a20
    v_accvgpr_read_b32 v197, a21
    v_accvgpr_read_b32 v198, a22
    v_accvgpr_read_b32 v199, a23
    v_accvgpr_read_b32 v200, a24
    v_accvgpr_read_b32 v201, a25
    s_branch L_fbdone
L_espin0:
    s_mov_b32 s74, 4194304
L_espin0_l:
    ds_read_b32 v6, v11
    s_sub_u32 s74, s74, 1
    s_waitcnt lgkmcnt(0)
    s_cbranch_scc1 L_eback0
    v_cmp_le_u32 vcc, 4, v6
    s_nop 1
    s_cbranch_vccz L_espin0_l
    s_branch L_eback0
L_espin1:
    s_mov_b32 s74, 4194304
L_espin1_l:
    ds_read_b32 v6, v11
    s_sub_u32 s74, s74, 1
    s_waitcnt lgkmcnt(0)
    s_cbranch_scc1 L_eback1
    v_cmp_le_u32 vcc, 8, v6
    s_nop 1
    s_cbranch_vccz L_espin1_l
    s_branch L_eback1
L_espin2:
    s_mov_b32 s74, 4194304
L_espin2_l:
    ds_read_b32 v6, v11
    s_sub_u32 s74, s74, 1
    s_waitcnt lgkmcnt(0)
    s_cbranch_scc1 L_eback2
    v_cmp_le_u32 vcc, 12, v6
    s_nop 1
    s_cbranch_vccz L_espin2_l
    s_branch L_eback2
L_espin3:
    s_mov_b32 s74, 4194304
L_espin3_l:
    ds_read_b32 v6, v11
    s_sub_u32 s74, s74, 1
    s_waitcnt lgkmcnt(0)
    s_cbranch_scc1 L_eback3
    v_cmp_le_u32 vcc, 16, v6
    s_nop 1
    s_cbranch_vccz L_espin3_l
    s_branch L_eback3
L_espin4:
    s_mov_b32 s74, 4194304
L_espin4_l:
    ds_read_b32 v6, v11
    s_sub_u32 s74, s74, 1
    s_waitcnt lgkmcnt(0)
    s_cbranch_scc1 L_eback4
    v_cmp_le_u32 vcc, 20, v6
    s_nop 1
    s_cbranch_vccz L_espin4_l
    s_branch L_eback4
L_espin5:
    s_mov_b32 s74, 4194304
L_espin5_l:
    ds_read_b32 v6, v11
    s_sub_u32 s74, s74, 1
    s_waitcnt lgkmcnt(0)
    s_cbranch_scc1 L_eback5
    v_cmp_le_u32 vcc, 24, v6
    s_nop 1
    s_cbranch_vccz L_espin5_l
    s_branch L_eback5
L_espin6:
    s_mov_b32 s74, 4194304
L_espin6_l:
    ds_read_b32 v6, v11
    s_sub_u32 s74, s74, 1
    s_waitcnt lgkmcnt(0)
    s_cbranch_scc1 L_eback6
    v_cmp_le_u32 vcc, 28, v6
    s_nop 1
    s_cbranch_vccz L_espin6_l
    s_branch L_eback6
L_espin7:
    s_mov_b32 s74, 4194304
L_espin7_l:
    ds_read_b32 v6, v11
    s_sub_u32 s74, s74, 1
    s_waitcnt lgkmcnt(0)
    s_cbranch_scc1 L_eback7
    v_cmp_le_u32 vcc, 32, v6
    s_nop 1
    s_cbranch_vccz L_espin7_l
    s_branch L_eback7
L_espin8:
    s_mov_b32 s74, 4194304
L_espin8_l:
    ds_read_b32 v6, v11
    s_sub_u32 s74, s74, 1
    s_waitcnt lgkmcnt(0)
    s_cbranch_scc1 L_eback8
    v_cmp_le_u32 vcc, 36, v6
    s_nop 1
    s_cbranch_vccz L_espin8_l
    s_branch L_eback8
.p2align 12
L_p1e:
    s_waitcnt vmcnt(10) lgkmcnt(0)
    s_barrier
    ds_read_b64_tr_b16 v[136:137], v199 offset:0
    ds_read_b64_tr_b16 v[138:139], v199 offset:64
    ds_read_b64_tr_b16 v[140:141], v199 offset:128
    ds_read_b64_tr_b16 v[142:143], v199 offset:192
    ds_read_b128 v[80:83], v202 offset:2048
    ds_read_b128 v[84:87], v203 offset:2048
    ds_read_b128 v[72:75], v202 offset:0
    ds_read_b128 v[76:79], v203 offset:0
    ds_read_b64_tr_b16 v[144:145], v197 offset:9216
    ds_read_b64_tr_b16 v[146:147], v197 offset:9472
    ds_read_b64_tr_b16 v[148:149], v197 offset:9728
    ds_read_b64_tr_b16 v[150:151], v197 offset:9984
    ds_read_b32 v174, v222 offset:0
    ds_read_b128 v[224:227], v221 offset:0
    s_waitcnt lgkmcnt(6)
    v_mfma_f32_16x16x32_bf16 v[68:71], v[140:143], v[84:87], 0
    s_add_u32 m0, s59, 52352
    ds_read_b128 v[96:99], v204 offset:2048
    v_mfma_f32_16x16x32_bf16 v[68:71], v[136:139], v[80:83], v[68:71]
    ds_read_b128 v[100:103], v205 offset:2048
    buffer_load_dwordx4 v192, s[12:15], s65 offen lds
    v_mfma_f32_16x16x32_bf16 v[64:67], v[136:139], v[72:75], 0
    ds_read_b128 v[88:91], v204 offset:0
    v_mfma_f32_16x16x32_bf16 v[64:67], v[140:143], v[76:79], v[64:67]
    s_waitcnt lgkmcnt(4)
    ds_read_b128 v[92:95], v205 offset:0
    v_mfma_f32_16x16x32_bf16 v[52:55], v[148:151], v[84:87], 0
    s_add_u32 m0, s59, 53376
    ds_read_b64_tr_b16 v[152:153], v197 offset:0
    ds_read_b64_tr_b16 v[154:155], v197 offset:256
    v_mfma_f32_16x16x32_bf16 v[52:55], v[144:147], v[80:83], v[52:55]
    ds_read_b64_tr_b16 v[156:157], v197 offset:1024
    buffer_load_dword v193, s[12:15], s65 offen lds
    v_mfma_f32_16x16x32_bf16 v[48:51], v[144:147], v[72:75], 0
    ds_read_b64_tr_b16 v[158:159], v197 offset:1280
    v_mfma_f32_16x16x32_bf16 v[48:51], v[148:151], v[76:79], v[48:51]
    s_waitcnt lgkmcnt(4)
    ds_read_b128 v[240:243], v221 offset:128
    v_mfma_f32_16x16x32_bf16 v[60:63], v[148:151], v[100:103], 0
    s_add_u32 m0, s59, 53632
    ds_read_b64_tr_b16 v[160:161], v197 offset:512
    v_mfma_f32_16x16x32_bf16 v[60:63], v[144:147], v[96:99], v[60:63]
    ds_read_b64_tr_b16 v[162:163], v197 offset:768
    buffer_load_dword v194, s[16:19], s66 offen lds
    v_mfma_f32_16x16x32_bf16 v[56:59], v[144:147], v[88:91], 0
    ds_read_b64_tr_b16 v[164:165], v197 offset:1536
    v_mfma_f32_16x16x32_bf16 v[56:59], v[148:151], v[92:95], v[56:59]
    s_waitcnt lgkmcnt(4)
    ds_read_b64_tr_b16 v[166:167], v197 offset:1792
    v_mfma_f32_16x16x32_bf16 v[236:239], v[156:159], v[100:103], v[224:227]
    s_add_u32 m0, s59, 46208
    ds_read_b128 a[0:3], v221 offset:256
    v_lshlrev_b32 v178, 16, v174
    v_mfma_f32_16x16x32_bf16 v[236:239], v[152:155], v[96:99], v[236:239]
    buffer_load_dwordx4 v208, s[8:11], s67 offen lds
    v_mfma_f32_16x16x32_bf16 v[232:235], v[152:155], v[88:91], v[224:227]
    ds_read_b64_tr_b16 v[136:137], v197 offset:2048
    v_lshlrev_b32 v179, 16, v172
    v_mfma_f32_16x16x32_bf16 v[232:235], v[156:159], v[92:95], v[232:235]
    s_xor_b32 s67, s67, 384
    ds_read_b64_tr_b16 v[138:139], v197 offset:2304
    v_and_b32 v180, 0xffff0000, v174
    v_mfma_f32_16x16x32_bf16 v[228:231], v[156:159], v[84:87], v[224:227]
    s_add_u32 m0, s59, 47232
    ds_read_b64_tr_b16 v[140:141], v197 offset:3072
    v_and_b32 v181, 0xffff0000, v172
    v_mfma_f32_16x16x32_bf16 v[228:231], v[152:155], v[80:83], v[228:231]
    ds_read_b64_tr_b16 v[142:143], v197 offset:3328
    buffer_load_dwordx4 v191, s[8:11], s67 offen lds
    v_mfma_f32_16x16x32_bf16 v[224:227], v[152:155], v[72:75], v[224:227]
    ds_read_b128 a[16:19], v221 offset:384
    v_fmac_f32 v177, v178, v179
    v_mfma_f32_16x16x32_bf16 v[224:227], v[156:159], v[76:79], v[224:227]
    s_waitcnt lgkmcnt(6)
    v_fmac_f32 v177, v180, v181
    v_mfma_f32_16x16x32_bf16 v[252:255], v[164:167], v[100:103], v[240:243]
    ds_read_b64_tr_b16 v[144:145], v197 offset:2560
    v_mfma_f32_16x16x32_bf16 v[252:255], v[160:163], v[96:99], v[252:255]
    ds_read_b64_tr_b16 v[146:147], v197 offset:2816
    v_mfma_f32_16x16x32_bf16 v[248:251], v[160:163], v[88:91], v[240:243]
    s_add_u32 m0, s59, 48256
    ds_read_b64_tr_b16 v[148:149], v197 offset:3584
    v_mfma_f32_16x16x32_bf16 v[248:251], v[164:167], v[92:95], v[248:251]
    ds_read_b64_tr_b16 v[150:151], v197 offset:3840
    buffer_load_dwordx4 v208, s[8:11], s67 offen lds
    v_mfma_f32_16x16x32_bf16 v[244:247], v[164:167], v[84:87], v[240:243]
    ds_read_b128 a[32:35], v221 offset:512
    v_mfma_f32_16x16x32_bf16 v[244:247], v[160:163], v[80:83], v[244:247]
    s_xor_b32 s67, s67, 128
    v_mfma_f32_16x16x32_bf16 v[240:243], v[160:163], v[72:75], v[240:243]
    s_add_u32 m0, s59, 49280
    ds_read_b64_tr_b16 v[152:153], v197 offset:4096
    v_mfma_f32_16x16x32_bf16 v[240:243], v[164:167], v[76:79], v[240:243]
    s_waitcnt lgkmcnt(7)
    ds_read_b64_tr_b16 v[154:155], v197 offset:4352
    buffer_load_dwordx4 v191, s[8:11], s67 offen lds
    v_mfma_f32_16x16x32_bf16 a[12:15], v[140:143], v[100:103], a[0:3]
    ds_read_b64_tr_b16 v[156:157], v197 offset:5120
    v_mfma_f32_16x16x32_bf16 a[12:15], v[136:139], v[96:99], a[12:15]
    ds_read_b64_tr_b16 v[158:159], v197 offset:5376
    v_mfma_f32_16x16x32_bf16 a[8:11], v[136:139], v[88:91], a[0:3]
    s_add_u32 m0, s59, 50304
    ds_read_b128 a[48:51], v221 offset:640
    v_mfma_f32_16x16x32_bf16 a[8:11], v[140:143], v[92:95], a[8:11]
    buffer_load_dwordx4 v208, s[8:11], s67 offen lds
    v_mfma_f32_16x16x32_bf16 a[4:7], v[140:143], v[84:87], a[0:3]
    s_bfe_u32 s66, s77, 0x40004
    ds_read_b64_tr_b16 v[160:161], v197 offset:4608
    v_mfma_f32_16x16x32_bf16 a[4:7], v[136:139], v[80:83], a[4:7]
    s_mul_i32 s64, s66, 589824
    ds_read_b64_tr_b16 v[162:163], v197 offset:4864
    v_mfma_f32_16x16x32_bf16 a[0:3], v[136:139], v[72:75], a[0:3]
    s_mul_i32 s65, s66, 73728
    ds_read_b64_tr_b16 v[164:165], v197 offset:5632
    s_add_u32 m0, s59, 94464
    v_mfma_f32_16x16x32_bf16 a[0:3], v[140:143], v[76:79], a[0:3]
    s_waitcnt lgkmcnt(9)
    ds_read_b64_tr_b16 v[166:167], v197 offset:5888
    buffer_load_dwordx4 v206, s[8:11], s64 offen lds
    v_mfma_f32_16x16x32_bf16 a[28:31], v[148:151], v[100:103], a[16:19]
    s_lshl_b32 s78, s66, 7
    ds_read_b128 a[64:67], v221 offset:768
    v_mfma_f32_16x16x32_bf16 a[28:31], v[144:147], v[96:99], a[28:31]
    s_add_u32 s68, s78, 18432
    v_mfma_f32_16x16x32_bf16 a[24:27], v[144:147], v[88:91], a[16:19]
    s_add_u32 s67, s64, s71
    ds_read_b64_tr_b16 v[136:137], v197 offset:6144
    s_add_u32 m0, s59, 86272
    v_mfma_f32_16x16x32_bf16 a[24:27], v[148:151], v[92:95], a[24:27]
    ds_read_b64_tr_b16 v[138:139], v197 offset:6400
    buffer_load_dwordx4 v191, s[8:11], s67 offen lds
    v_mfma_f32_16x16x32_bf16 a[20:23], v[148:151], v[84:87], a[16:19]
    ds_read_b64_tr_b16 v[140:141], v197 offset:7168
    v_mfma_f32_16x16x32_bf16 a[20:23], v[144:147], v[80:83], a[20:23]
    ds_read_b64_tr_b16 v[142:143], v197 offset:7424
    v_mfma_f32_16x16x32_bf16 a[16:19], v[144:147], v[72:75], a[16:19]
    s_mul_i32 s66, s66, 2304
    ds_read_b128 a[80:83], v221 offset:896
    v_mfma_f32_16x16x32_bf16 a[16:19], v[148:151], v[76:79], a[16:19]
    s_waitcnt lgkmcnt(11)
    v_mfma_f32_16x16x32_bf16 a[44:47], v[156:159], v[100:103], a[32:35]
    s_add_u32 m0, s59, 87296
    ds_read_b64_tr_b16 v[144:145], v197 offset:6656
    v_mfma_f32_16x16x32_bf16 a[44:47], v[152:155], v[96:99], a[44:47]
    ds_read_b64_tr_b16 v[146:147], v197 offset:6912
    buffer_load_dwordx4 v208, s[8:11], s67 offen lds
    v_mfma_f32_16x16x32_bf16 a[40:43], v[152:155], v[88:91], a[32:35]
    ds_read_b64_tr_b16 v[148:149], v197 offset:7680
    v_mfma_f32_16x16x32_bf16 a[40:43], v[156:159], v[92:95], a[40:43]
    s_xor_b32 s67, s67, 128
    ds_read_b64_tr_b16 v[150:151], v197 offset:7936
    v_mfma_f32_16x16x32_bf16 a[36:39], v[156:159], v[84:87], a[32:35]
    s_add_u32 m0, s59, 88320
    ds_read_b128 a[96:99], v221 offset:1024
    v_mfma_f32_16x16x32_bf16 a[36:39], v[152:155], v[80:83], a[36:39]
    buffer_load_dwordx4 v191, s[8:11], s67 offen lds
    v_mfma_f32_16x16x32_bf16 a[32:35], v[152:155], v[72:75], a[32:35]
    ds_read_b64_tr_b16 v[152:153], v197 offset:8192
    v_mfma_f32_16x16x32_bf16 a[32:35], v[156:159], v[76:79], a[32:35]
    s_waitcnt lgkmcnt(12)
    ds_read_b64_tr_b16 v[154:155], v197 offset:8448
    v_mfma_f32_16x16x32_bf16 a[60:63], v[164:167], v[100:103], a[48:51]
    s_add_u32 m0, s59, 95488
    ds_read_b64_tr_b16 v[156:157], v197 offset:8704
    v_mfma_f32_16x16x32_bf16 a[60:63], v[160:163], v[96:99], a[60:63]
    ds_read_b64_tr_b16 v[158:159], v197 offset:8960
    buffer_load_dwordx4 v192, s[12:15], s65 offen lds
    v_mfma_f32_16x16x32_bf16 a[56:59], v[160:163], v[88:91], a[48:51]
    v_mfma_f32_16x16x32_bf16 a[56:59], v[164:167], v[92:95], a[56:59]
    s_add_u32 m0, s59, 96512
    v_mfma_f32_16x16x32_bf16 a[52:55], v[164:167], v[84:87], a[48:51]
    s_waitcnt vmcnt(5)
    ds_add_u32 v11, v9
    v_mfma_f32_16x16x32_bf16 a[52:55], v[160:163], v[80:83], a[52:55]
    buffer_load_dword v193, s[12:15], s65 offen lds
    v_mfma_f32_16x16x32_bf16 a[48:51], v[160:163], v[72:75], a[48:51]
    v_mfma_f32_16x16x32_bf16 a[48:51], v[164:167], v[76:79], a[48:51]
    s_waitcnt lgkmcnt(11)
    v_mfma_f32_16x16x32_bf16 a[76:79], v[140:143], v[100:103], a[64:67]
    s_add_u32 m0, s59, 96768
    v_mfma_f32_16x16x32_bf16 a[76:79], v[136:139], v[96:99], a[76:79]
    ds_read_b32 v6, v11
    buffer_load_dword v194, s[16:19], s66 offen lds
    v_mfma_f32_16x16x32_bf16 a[72:75], v[136:139], v[88:91], a[64:67]
    v_mfma_f32_16x16x32_bf16 a[72:75], v[140:143], v[92:95], a[72:75]
    v_mfma_f32_16x16x32_bf16 a[68:71], v[140:143], v[84:87], a[64:67]
    v_mfma_f32_16x16x32_bf16 a[68:71], v[136:139], v[80:83], a[68:71]
    s_add_u32 m0, s72, 129408
    v_mfma_f32_16x16x32_bf16 a[64:67], v[136:139], v[72:75], a[64:67]
    s_waitcnt lgkmcnt(0)
    v_cmp_le_u32 vcc, 4, v6
    v_mfma_f32_16x16x32_bf16 a[64:67], v[140:143], v[76:79], a[64:67]
    s_waitcnt lgkmcnt(7)
    v_mfma_f32_16x16x32_bf16 a[92:95], v[148:151], v[100:103], a[80:83]
    s_cbranch_vccz L_espin0
L_eback0:
    ds_read_b128 v[112:115], v202 offset:18432
    v_mfma_f32_16x16x32_bf16 a[92:95], v[144:147], v[96:99], a[92:95]
    buffer_load_dwordx4 v195, s[4:7], s78 offen lds
    v_mfma_f32_16x16x32_bf16 a[88:91], v[144:147], v[88:91], a[80:83]
    ds_read_b128 v[116:119], v203 offset:18432
    v_mfma_f32_16x16x32_bf16 a[88:91], v[148:151], v[92:95], a[88:91]
    ds_read_b128 v[104:107], v202 offset:16384
    v_mfma_f32_16x16x32_bf16 a[84:87], v[148:151], v[84:87], a[80:83]
    s_add_u32 m0, s72, 131456
    ds_read_b128 v[108:111], v203 offset:16384
    v_mfma_f32_16x16x32_bf16 a[84:87], v[144:147], v[80:83], a[84:87]
    buffer_load_dwordx4 v195, s[4:7], s68 offen lds
    v_mfma_f32_16x16x32_bf16 a[80:83], v[144:147], v[72:75], a[80:83]
    ds_read_b64_tr_b16 v[160:161], v199 offset:43136
    ds_read_b64_tr_b16 v[162:163], v199 offset:43200
    v_mfma_f32_16x16x32_bf16 a[80:83], v[148:151], v[76:79], a[80:83]
    s_waitcnt lgkmcnt(8)
    ds_read_b64_tr_b16 v[164:165], v199 offset:43264
    v_mfma_f32_16x16x32_bf16 a[108:111], v[156:159], v[100:103], a[96:99]
    s_add_u32 m0, s73, 129408
    ds_read_b64_tr_b16 v[166:167], v199 offset:43328
    v_mfma_f32_16x16x32_bf16 a[108:111], v[152:155], v[96:99], a[108:111]
    buffer_load_dwordx4 v196, s[4:7], s78 offen lds
    v_mfma_f32_16x16x32_bf16 a[104:107], v[152:155], v[88:91], a[96:99]
    ds_read_b64_tr_b16 v[136:137], v197 offset:52352
    v_mfma_f32_16x16x32_bf16 a[104:107], v[156:159], v[92:95], a[104:107]
    ds_read_b64_tr_b16 v[138:139], v197 offset:52608
    v_mfma_f32_16x16x32_bf16 a[100:103], v[156:159], v[84:87], a[96:99]
    s_add_u32 m0, s73, 131456
    ds_read_b64_tr_b16 v[140:141], v197 offset:52864
    v_mfma_f32_16x16x32_bf16 a[100:103], v[152:155], v[80:83], a[100:103]
    buffer_load_dwordx4 v196, s[4:7], s68 offen lds
    v_mfma_f32_16x16x32_bf16 a[96:99], v[152:155], v[72:75], a[96:99]
    ds_read_b64_tr_b16 v[142:143], v197 offset:53120
    ds_read_b32 v174, v222 offset:16384
    v_mfma_f32_16x16x32_bf16 a[96:99], v[156:159], v[76:79], a[96:99]
    s_waitcnt lgkmcnt(5)
    buffer_load_dword v172, v207, s[44:47], s78 offen
    v_mfma_f32_16x16x32_bf16 v[68:71], v[164:167], v[116:119], v[68:71]
    s_add_u32 m0, s59, 89344
    ds_read_b128 v[128:131], v204 offset:18432
    v_mfma_f32_16x16x32_bf16 v[68:71], v[160:163], v[112:115], v[68:71]
    ds_read_b128 v[132:135], v205 offset:18432
    buffer_load_dwordx4 v208, s[8:11], s67 offen lds
    v_mfma_f32_16x16x32_bf16 v[64:67], v[160:163], v[104:107], v[64:67]
    s_xor_b32 s67, s67, 384
    ds_read_b128 v[120:123], v204 offset:16384
    v_mfma_f32_16x16x32_bf16 v[64:67], v[164:167], v[108:111], v[64:67]
    s_waitcnt lgkmcnt(3)
    ds_read_b128 v[124:127], v205 offset:16384
    s_add_u32 m0, s59, 90368
    v_mfma_f32_16x16x32_bf16 v[52:55], v[140:143], v[116:119], v[52:55]
    ds_read_b64_tr_b16 v[144:145], v197 offset:43136
    ds_read_b64_tr_b16 v[146:147], v197 offset:43392
    buffer_load_dwordx4 v191, s[8:11], s67 offen lds
    v_mfma_f32_16x16x32_bf16 v[52:55], v[136:139], v[112:115], v[52:55]
    s_lshl_b32 s62, s56, 4
    ds_read_b64_tr_b16 v[148:149], v197 offset:44160
    v_mfma_f32_16x16x32_bf16 v[48:51], v[136:139], v[104:107], v[48:51]
    s_add_u32 m0, s59, 91392
    ds_read_b64_tr_b16 v[150:151], v197 offset:44416
    v_mfma_f32_16x16x32_bf16 v[48:51], v[140:143], v[108:111], v[48:51]
    s_waitcnt lgkmcnt(4)
    buffer_load_dwordx4 v208, s[8:11], s67 offen lds
    v_mfma_f32_16x16x32_bf16 v[60:63], v[140:143], v[132:135], v[60:63]
    s_add_u32 s62, s62, s57
    ds_read_b64_tr_b16 v[152:153], v197 offset:43648
    v_lshlrev_b32 v178, 16, v174
    v_mfma_f32_16x16x32_bf16 v[60:63], v[136:139], v[128:131], v[60:63]
    s_lshl_b32 s63, s62, 10
    ds_read_b64_tr_b16 v[154:155], v197 offset:43904
    v_lshlrev_b32 v179, 16, v173
    v_mfma_f32_16x16x32_bf16 v[56:59], v[136:139], v[120:123], v[56:59]
    s_xor_b32 s67, s67, 128
    v_and_b32 v180, 0xffff0000, v174
    v_and_b32 v181, 0xffff0000, v173
    v_mfma_f32_16x16x32_bf16 v[56:59], v[140:143], v[124:127], v[56:59]
    s_waitcnt lgkmcnt(2)
    ds_read_b64_tr_b16 v[156:157], v197 offset:44672
    v_fmac_f32 v177, v178, v179
    v_mfma_f32_16x16x32_bf16 v[236:239], v[148:151], v[132:135], v[236:239]
    s_add_u32 m0, s59, 92416
    ds_read_b64_tr_b16 v[158:159], v197 offset:44928
    v_fmac_f32 v177, v180, v181
    v_mfma_f32_16x16x32_bf16 v[236:239], v[144:147], v[128:131], v[236:239]
    s_add_u32 s63, s63, 3145728
    buffer_load_dwordx4 v191, s[8:11], s67 offen lds
    v_mfma_f32_16x16x32_bf16 v[232:235], v[144:147], v[120:123], v[232:235]
    ds_read_b64_tr_b16 v[160:161], v197 offset:45184
    v_lshl_add_u32 v220, v201, 2, s63
    v_mfma_f32_16x16x32_bf16 v[232:235], v[148:151], v[124:127], v[232:235]
    s_add_u32 m0, s59, 93440
    ds_read_b64_tr_b16 v[162:163], v197 offset:45440
    v_mfma_f32_16x16x32_bf16 v[228:231], v[148:151], v[116:119], v[228:231]
    s_lshl_b32 s62, s62, 2
    buffer_load_dwordx4 v208, s[8:11], s67 offen lds
    v_mfma_f32_16x16x32_bf16 v[228:231], v[144:147], v[112:115], v[228:231]
    s_add_u32 s62, s62, s58
    ds_read_b64_tr_b16 v[164:165], v197 offset:46208
    v_mfma_f32_16x16x32_bf16 v[224:227], v[144:147], v[104:107], v[224:227]
    s_bfe_u32 s66, s77, 0x40008
    ds_read_b64_tr_b16 v[166:167], v197 offset:46464
    v_mfma_f32_16x16x32_bf16 v[224:227], v[148:151], v[108:111], v[224:227]
    s_waitcnt lgkmcnt(4)
    v_mfma_f32_16x16x32_bf16 v[252:255], v[156:159], v[132:135], v[252:255]
    s_mul_i32 s64, s66, 589824
    ds_read_b64_tr_b16 v[136:137], v197 offset:45696
    v_mfma_f32_16x16x32_bf16 v[252:255], v[152:155], v[128:131], v[252:255]
    s_mul_i32 s65, s66, 73728
    ds_read_b64_tr_b16 v[138:139], v197 offset:45952
    s_add_u32 m0, s59, 8192
    v_mfma_f32_16x16x32_bf16 v[248:251], v[152:155], v[120:123], v[248:251]
    s_lshl_b32 s62, s62, 7
    buffer_load_dwordx4 v206, s[8:11], s64 offen lds
    v_mfma_f32_16x16x32_bf16 v[248:251], v[156:159], v[124:127], v[248:251]
    s_lshl_b32 s78, s66, 7
    ds_read_b64_tr_b16 v[140:141], v197 offset:46720
    v_mfma_f32_16x16x32_bf16 v[244:247], v[156:159], v[116:119], v[244:247]
    s_add_u32 s68, s78, 18432
    ds_read_b64_tr_b16 v[142:143], v197 offset:46976
    s_add_u32 s67, s64, s71
    s_add_u32 m0, s59, 0
    v_mfma_f32_16x16x32_bf16 v[244:247], v[152:155], v[112:115], v[244:247]
    s_add_u32 s3, s62, 196608
    buffer_load_dwordx4 v191, s[8:11], s67 offen lds
    v_mfma_f32_16x16x32_bf16 v[240:243], v[152:155], v[104:107], v[240:243]
    s_lshl_b32 s62, s56, 13
    ds_read_b64_tr_b16 v[144:145], v197 offset:47232
    v_mfma_f32_16x16x32_bf16 v[240:243], v[156:159], v[108:111], v[240:243]
    s_waitcnt lgkmcnt(5)
    ds_read_b64_tr_b16 v[146:147], v197 offset:47488
    v_mfma_f32_16x16x32_bf16 a[12:15], v[164:167], v[132:135], a[12:15]
    s_add_u32 s62, s62, 196608
    v_mfma_f32_16x16x32_bf16 a[12:15], v[160:163], v[128:131], a[12:15]
    s_mul_i32 s66, s66, 2304
    ds_read_b64_tr_b16 v[148:149], v197 offset:48256
    v_mfma_f32_16x16x32_bf16 a[8:11], v[160:163], v[120:123], a[8:11]
    s_add_u32 m0, s59, 1024
    ds_read_b64_tr_b16 v[150:151], v197 offset:48512
    v_mfma_f32_16x16x32_bf16 a[8:11], v[164:167], v[124:127], a[8:11]
    s_lshr_b32 s63, s53, 1
    buffer_load_dwordx4 v208, s[8:11], s67 offen lds
    v_mfma_f32_16x16x32_bf16 a[4:7], v[164:167], v[116:119], a[4:7]
    s_xor_b32 s67, s67, 128
    ds_read_b64_tr_b16 v[152:153], v197 offset:47744
    v_mfma_f32_16x16x32_bf16 a[4:7], v[160:163], v[112:115], a[4:7]
    s_add_u32 m0, s59, 2048
    ds_read_b64_tr_b16 v[154:155], v197 offset:48000
    v_mfma_f32_16x16x32_bf16 a[0:3], v[160:163], v[104:107], a[0:3]
    s_mul_i32 s63, s63, 131072
    buffer_load_dwordx4 v191, s[8:11], s67 offen lds
    v_mfma_f32_16x16x32_bf16 a[0:3], v[164:167], v[108:111], a[0:3]
    s_waitcnt lgkmcnt(6)
    ds_read_b64_tr_b16 v[156:157], v197 offset:48768
    v_mfma_f32_16x16x32_bf16 a[28:31], v[140:143], v[132:135], a[28:31]
    s_add_u32 m0, s59, 9216
    ds_read_b64_tr_b16 v[158:159], v197 offset:49024
    v_mfma_f32_16x16x32_bf16 a[28:31], v[136:139], v[128:131], a[28:31]
    s_add_u32 s62, s62, s63
    buffer_load_dwordx4 v192, s[12:15], s65 offen lds
    v_mfma_f32_16x16x32_bf16 a[24:27], v[136:139], v[120:123], a[24:27]
    s_and_b32 s63, s57, 1
    ds_read_b64_tr_b16 v[160:161], v197 offset:49280
    v_mfma_f32_16x16x32_bf16 a[24:27], v[140:143], v[124:127], a[24:27]
    s_lshl_b32 s63, s63, 12
    ds_read_b64_tr_b16 v[162:163], v197 offset:49536
    v_mfma_f32_16x16x32_bf16 a[20:23], v[140:143], v[116:119], a[20:23]
    s_add_u32 s62, s62, s63
    v_mfma_f32_16x16x32_bf16 a[20:23], v[136:139], v[112:115], a[20:23]
    s_cmp_lt_u32 s53, 6
    s_cselect_b32 s62, s62, 1073741824
    ds_read_b64_tr_b16 v[164:165], v197 offset:50304
    v_mfma_f32_16x16x32_bf16 a[16:19], v[136:139], v[104:107], a[16:19]
    s_add_u32 m0, s59, 10240
    ds_read_b64_tr_b16 v[166:167], v197 offset:50560
    v_lshl_add_u32 v175, v201, 4, s62
    v_mfma_f32_16x16x32_bf16 a[16:19], v[140:143], v[108:111], a[16:19]
    s_waitcnt lgkmcnt(8)
    buffer_load_dword v193, s[12:15], s65 offen lds
    v_mfma_f32_16x16x32_bf16 a[44:47], v[148:151], v[132:135], a[44:47]
    ds_read_b64_tr_b16 v[136:137], v197 offset:49792
    v_mov_b32 v5, 0xc0135761
    v_mfma_f32_16x16x32_bf16 a[44:47], v[144:147], v[128:131], a[44:47]
    s_add_u32 m0, s59, 10496
    ds_read_b64_tr_b16 v[138:139], v197 offset:50048
    v_mov_b32 v13, 0xdddddddd
    v_mfma_f32_16x16x32_bf16 a[40:43], v[144:147], v[120:123], a[40:43]
    buffer_load_dword v194, s[16:19], s66 offen lds
    v_mfma_f32_16x16x32_bf16 a[40:43], v[148:151], v[124:127], a[40:43]
    ds_read_b64_tr_b16 v[140:141], v197 offset:50816
    v_lshlrev_b32 v7, 4, v0
    v_mfma_f32_16x16x32_bf16 a[36:39], v[148:151], v[116:119], a[36:39]
    ds_read_b64_tr_b16 v[142:143], v197 offset:51072
    v_and_b32 v14, 0xf0, v7
    v_mfma_f32_16x16x32_bf16 a[36:39], v[144:147], v[112:115], a[36:39]
    s_mov_b32 s70, 0xbdd2d3e8
    v_mov_b32 v168, 0
    v_mov_b32 v169, 0
    v_mfma_f32_16x16x32_bf16 a[32:35], v[144:147], v[104:107], a[32:35]
    s_add_u32 m0, s59, 3072
    ds_read_b64_tr_b16 v[144:145], v197 offset:51328
    v_mov_b32 v170, 0
    v_mfma_f32_16x16x32_bf16 a[32:35], v[148:151], v[108:111], a[32:35]
    s_waitcnt lgkmcnt(9)
    ds_read_b64_tr_b16 v[146:147], v197 offset:51584
    v_mov_b32 v171, 0
    v_mfma_f32_16x16x32_bf16 a[60:63], v[156:159], v[132:135], a[60:63]
    s_lshl_b32 s62, s56, 2
    buffer_load_dwordx4 v208, s[8:11], s67 offen lds
    v_mfma_f32_16x16x32_bf16 a[60:63], v[152:155], v[128:131], a[60:63]
    s_xor_b32 s67, s67, 384
    ds_read_b64_tr_b16 v[148:149], v197 offset:51840
    v_mfma_f32_16x16x32_bf16 a[56:59], v[152:155], v[120:123], a[56:59]
    s_add_u32 m0, s59, 4096
    ds_read_b64_tr_b16 v[150:151], v197 offset:52096
    v_mfma_f32_16x16x32_bf16 a[56:59], v[156:159], v[124:127], a[56:59]
    s_add_u32 s62, s62, s58
    buffer_load_dwordx4 v191, s[8:11], s67 offen lds
    v_mfma_f32_16x16x32_bf16 a[52:55], v[156:159], v[116:119], a[52:55]
    s_waitcnt vmcnt(9)
    ds_add_u32 v11, v9
    v_mfma_f32_16x16x32_bf16 a[52:55], v[152:155], v[112:115], a[52:55]
    s_mul_i32 s62, s62, 36864
    v_mfma_f32_16x16x32_bf16 a[48:51], v[152:155], v[104:107], a[48:51]
    s_add_u32 m0, s59, 5120
    v_mfma_f32_16x16x32_bf16 a[48:51], v[156:159], v[108:111], a[48:51]
    s_waitcnt lgkmcnt(9)
    v_mfma_f32_16x16x32_bf16 a[76:79], v[164:167], v[132:135], a[76:79]
    s_add_u32 s62, s62, 673792
    buffer_load_dwordx4 v208, s[8:11], s67 offen lds
    v_mfma_f32_16x16x32_bf16 a[76:79], v[160:163], v[128:131], a[76:79]
    s_xor_b32 s67, s67, 128
    ds_read_b32 v6, v11
    v_mfma_f32_16x16x32_bf16 a[72:75], v[160:163], v[120:123], a[72:75]
    s_add_u32 m0, s59, 6144
    v_mfma_f32_16x16x32_bf16 a[72:75], v[164:167], v[124:127], a[72:75]
    s_lshl_b32 s63, s100, 10
    buffer_load_dwordx4 v191, s[8:11], s67 offen lds
    v_mfma_f32_16x16x32_bf16 a[68:71], v[164:167], v[116:119], a[68:71]
    s_add_u32 s63, s63, s62
    v_lshl_add_u32 v182, v0, 4, s63
    v_mfma_f32_16x16x32_bf16 a[68:71], v[160:163], v[112:115], a[68:71]
    s_add_u32 m0, s72, 145792
    v_mfma_f32_16x16x32_bf16 a[64:67], v[160:163], v[104:107], a[64:67]
    s_waitcnt lgkmcnt(0)
    v_cmp_le_u32 vcc, 8, v6
    v_mfma_f32_16x16x32_bf16 a[64:67], v[164:167], v[108:111], a[64:67]
    s_waitcnt lgkmcnt(6)
    v_mfma_f32_16x16x32_bf16 a[92:95], v[140:143], v[132:135], a[92:95]
    s_cbranch_vccz L_espin1
L_eback1:
    ds_read_b128 v[80:83], v202 offset:2048
    v_mfma_f32_16x16x32_bf16 a[92:95], v[136:139], v[128:131], a[92:95]
    buffer_load_dwordx4 v195, s[4:7], s78 offen lds
    v_mfma_f32_16x16x32_bf16 a[88:91], v[136:139], v[120:123], a[88:91]
    ds_read_b128 v[84:87], v203 offset:2048
    v_mfma_f32_16x16x32_bf16 a[88:91], v[140:143], v[124:127], a[88:91]
    ds_read_b128 v[72:75], v202 offset:0
    v_mfma_f32_16x16x32_bf16 a[84:87], v[140:143], v[116:119], a[84:87]
    s_add_u32 m0, s72, 147840
    ds_read_b128 v[76:79], v203 offset:0
    v_mfma_f32_16x16x32_bf16 a[84:87], v[136:139], v[112:115], a[84:87]
    buffer_load_dwordx4 v195, s[4:7], s68 offen lds
    v_mfma_f32_16x16x32_bf16 a[80:83], v[136:139], v[104:107], a[80:83]
    ds_read_b64_tr_b16 v[152:153], v200 offset:0
    ds_read_b64_tr_b16 v[154:155], v200 offset:64
    v_mfma_f32_16x16x32_bf16 a[80:83], v[140:143], v[108:111], a[80:83]
    s_waitcnt lgkmcnt(8)
    ds_read_b64_tr_b16 v[156:157], v200 offset:128
    v_mfma_f32_16x16x32_bf16 a[108:111], v[148:151], v[132:135], a[108:111]
    s_add_u32 m0, s73, 145792
    ds_read_b64_tr_b16 v[158:159], v200 offset:192
    v_mfma_f32_16x16x32_bf16 a[108:111], v[144:147], v[128:131], a[108:111]
    buffer_load_dwordx4 v196, s[4:7], s78 offen lds
    v_mfma_f32_16x16x32_bf16 a[104:107], v[144:147], v[120:123], a[104:107]
    ds_read_b64_tr_b16 v[160:161], v198 offset:9216
    v_mfma_f32_16x16x32_bf16 a[104:107], v[148:151], v[124:127], a[104:107]
    ds_read_b64_tr_b16 v[162:163], v198 offset:9472
    v_mfma_f32_16x16x32_bf16 a[100:103], v[148:151], v[116:119], a[100:103]
    s_add_u32 m0, s73, 147840
    ds_read_b64_tr_b16 v[164:165], v198 offset:9728
    v_mfma_f32_16x16x32_bf16 a[100:103], v[144:147], v[112:115], a[100:103]
    buffer_load_dwordx4 v196, s[4:7], s68 offen lds
    v_mfma_f32_16x16x32_bf16 a[96:99], v[144:147], v[104:107], a[96:99]
    ds_read_b64_tr_b16 v[166:167], v198 offset:9984
    ds_read_b32 v174, v222 offset:0
    v_mfma_f32_16x16x32_bf16 a[96:99], v[148:151], v[108:111], a[96:99]
    s_waitcnt lgkmcnt(5)
    buffer_load_dword v173, v207, s[44:47], s78 offen
    v_mfma_f32_16x16x32_bf16 v[68:71], v[156:159], v[84:87], v[68:71]
    ds_read_b128 v[96:99], v204 offset:2048
    v_mfma_f32_16x16x32_bf16 v[68:71], v[152:155], v[80:83], v[68:71]
    ds_read_b128 v[100:103], v205 offset:2048
    v_mfma_f32_16x16x32_bf16 v[64:67], v[152:155], v[72:75], v[64:67]
    s_lshl_b32 s63, s100, 7
    ds_read_b128 v[88:91], v204 offset:0
    v_mfma_f32_16x16x32_bf16 v[64:67], v[156:159], v[76:79], v[64:67]
    s_waitcnt lgkmcnt(3)
    ds_read_b128 v[92:95], v205 offset:0
    v_mfma_f32_16x16x32_bf16 v[52:55], v[164:167], v[84:87], v[52:55]
    s_add_u32 s63, s63, s62
    ds_read_b64_tr_b16 v[136:137], v198 offset:0
    ds_read_b64_tr_b16 v[138:139], v198 offset:256
    v_mfma_f32_16x16x32_bf16 v[52:55], v[160:163], v[80:83], v[52:55]
    s_add_u32 s63, s63, 16384
    ds_read_b64_tr_b16 v[140:141], v198 offset:1024
    v_add_u32 v183, s63, v207
    v_mfma_f32_16x16x32_bf16 v[48:51], v[160:163], v[72:75], v[48:51]
    s_add_u32 m0, s59, 7168
    ds_read_b64_tr_b16 v[142:143], v198 offset:1280
    v_mov_b32 v184, -1
    v_mfma_f32_16x16x32_bf16 v[48:51], v[164:167], v[76:79], v[48:51]
    s_waitcnt lgkmcnt(4)
    buffer_load_dwordx4 v208, s[8:11], s67 offen lds
    v_mfma_f32_16x16x32_bf16 v[60:63], v[164:167], v[100:103], v[60:63]
    s_bfe_u32 s66, s77, 0x4000c
    ds_read_b64_tr_b16 v[144:145], v198 offset:512
    v_lshlrev_b32 v178, 16, v174
    v_mfma_f32_16x16x32_bf16 v[60:63], v[160:163], v[96:99], v[60:63]
    s_mul_i32 s64, s66, 589824
    ds_read_b64_tr_b16 v[146:147], v198 offset:768
    s_mul_i32 s65, s66, 73728
    s_add_u32 m0, s59, 51328
    v_mfma_f32_16x16x32_bf16 v[56:59], v[160:163], v[88:91], v[56:59]
    buffer_load_dwordx4 v206, s[8:11], s64 offen lds
    v_mfma_f32_16x16x32_bf16 v[56:59], v[164:167], v[92:95], v[56:59]
    s_waitcnt lgkmcnt(2)
    ds_read_b64_tr_b16 v[148:149], v198 offset:1536
    v_lshlrev_b32 v179, 16, v172
    v_mfma_f32_16x16x32_bf16 v[236:239], v[140:143], v[100:103], v[236:239]
    s_lshl_b32 s78, s66, 7
    ds_read_b64_tr_b16 v[150:151], v198 offset:1792
    v_and_b32 v180, 0xffff0000, v174
    v_mfma_f32_16x16x32_bf16 v[236:239], v[136:139], v[96:99], v[236:239]
    s_add_u32 s68, s78, 18432
    v_and_b32 v181, 0xffff0000, v172
    v_fmac_f32 v177, v178, v179
    v_mfma_f32_16x16x32_bf16 v[232:235], v[136:139], v[88:91], v[232:235]
    s_add_u32 s67, s64, s71
    ds_read_b64_tr_b16 v[152:153], v198 offset:2048
    v_fmac_f32 v177, v180, v181
    v_mfma_f32_16x16x32_bf16 v[232:235], v[140:143], v[92:95], v[232:235]
    s_add_u32 m0, s59, 43136
    ds_read_b64_tr_b16 v[154:155], v198 offset:2304
    v_mov_b32 v185, -1
    v_mfma_f32_16x16x32_bf16 v[228:231], v[140:143], v[84:87], v[228:231]
    buffer_load_dwordx4 v191, s[8:11], s67 offen lds
    v_mfma_f32_16x16x32_bf16 v[228:231], v[136:139], v[80:83], v[228:231]
    s_mul_i32 s66, s66, 2304
    ds_read_b64_tr_b16 v[156:157], v198 offset:3072
    v_mov_b32 v186, -1
    v_mfma_f32_16x16x32_bf16 v[224:227], v[136:139], v[72:75], v[224:227]
    s_add_u32 m0, s59, 44160
    ds_read_b64_tr_b16 v[158:159], v198 offset:3328
    v_mov_b32 v187, -1
    v_mfma_f32_16x16x32_bf16 v[224:227], v[140:143], v[76:79], v[224:227]
    s_waitcnt lgkmcnt(4)
    buffer_load_dwordx4 v208, s[8:11], s67 offen lds
    v_mfma_f32_16x16x32_bf16 v[252:255], v[148:151], v[100:103], v[252:255]
    s_mul_i32 s62, s57, 288
    ds_read_b64_tr_b16 v[160:161], v198 offset:2560
    v_mfma_f32_16x16x32_bf16 v[252:255], v[144:147], v[96:99], v[252:255]
    s_lshl_b32 s63, s58, 3
    ds_read_b64_tr_b16 v[162:163], v198 offset:2816
    v_mfma_f32_16x16x32_bf16 v[248:251], v[144:147], v[88:91], v[248:251]
    s_add_u32 s62, s62, s63
    v_mfma_f32_16x16x32_bf16 v[248:251], v[148:151], v[92:95], v[248:251]
L_pe2:
L_r0:
    s_cbranch_execz L_q3
    s_xor_b32 s67, s67, 128
    ds_read_b64_tr_b16 v[164:165], v198 offset:3584
    v_mfma_f32_16x16x32_bf16 v[244:247], v[148:151], v[84:87], v[244:247]
    s_add_u32 m0, s59, 45184
    ds_read_b64_tr_b16 v[166:167], v198 offset:3840
    v_mfma_f32_16x16x32_bf16 v[244:247], v[144:147], v[80:83], v[244:247]
    s_and_b32 s63, s57, 1
    buffer_load_dwordx4 v191, s[8:11], s67 offen lds
    v_mfma_f32_16x16x32_bf16 v[240:243], v[144:147], v[72:75], v[240:243]
    s_lshl_b32 s63, s63, 5
    ds_read_b64_tr_b16 v[136:137], v198 offset:4096
    v_mfma_f32_16x16x32_bf16 v[240:243], v[148:151], v[76:79], v[240:243]
    s_waitcnt lgkmcnt(5)
    ds_read_b64_tr_b16 v[138:139], v198 offset:4352
    v_mfma_f32_16x16x32_bf16 a[12:15], v[156:159], v[100:103], a[12:15]
    s_add_u32 s62, s62, s63
    v_bfe_u32 v214, v0, 2, 3
    v_add_u32 v214, s62, v214
    v_mfma_f32_16x16x32_bf16 a[12:15], v[152:155], v[96:99], a[12:15]
    ds_read_b64_tr_b16 v[140:141], v198 offset:5120
    v_mul_u32_u24 v2, 1152, v214
    v_mfma_f32_16x16x32_bf16 a[8:11], v[152:155], v[88:91], a[8:11]
    s_add_u32 m0, s59, 52352
    ds_read_b64_tr_b16 v[142:143], v198 offset:5376
    v_lshrrev_b32 v215, 5, v0
    v_mfma_f32_16x16x32_bf16 a[8:11], v[156:159], v[92:95], a[8:11]
    buffer_load_dwordx4 v192, s[12:15], s65 offen lds
    v_mfma_f32_16x16x32_bf16 a[4:7], v[156:159], v[84:87], a[4:7]
    ds_read_b64_tr_b16 v[144:145], v198 offset:4608
    v_lshl_add_u32 v2, v215, 6, v2
    v_mfma_f32_16x16x32_bf16 a[4:7], v[152:155], v[80:83], a[4:7]
    s_add_u32 m0, s59, 53376
    ds_read_b64_tr_b16 v[146:147], v198 offset:4864
    v_and_b32 v214, 3, v0
    v_mfma_f32_16x16x32_bf16 a[0:3], v[152:155], v[72:75], a[0:3]
    buffer_load_dword v193, s[12:15], s65 offen lds
    v_mfma_f32_16x16x32_bf16 a[0:3], v[156:159], v[76:79], a[0:3]
    s_waitcnt lgkmcnt(6)
    ds_read_b64_tr_b16 v[148:149], v198 offset:5632
    v_lshl_add_u32 v2, v214, 4, v2
    v_mfma_f32_16x16x32_bf16 a[28:31], v[164:167], v[100:103], a[28:31]
    ds_read_b64_tr_b16 v[150:151], v198 offset:5888
    v_mul_u32_u24 v1, 10784, v215
    v_mfma_f32_16x16x32_bf16 a[28:31], v[160:163], v[96:99], a[28:31]
    v_bfe_u32 v214, v0, 2, 2
    v_lshl_add_u32 v1, v214, 6, v1
    v_mfma_f32_16x16x32_bf16 a[24:27], v[160:163], v[88:91], a[24:27]
    ds_read_b64_tr_b16 v[152:153], v198 offset:6144
    v_bfe_u32 v214, v0, 4, 1
    v_mfma_f32_16x16x32_bf16 a[24:27], v[164:167], v[92:95], a[24:27]
    s_add_u32 m0, s59, 53632
    ds_read_b64_tr_b16 v[154:155], v198 offset:6400
    v_lshl_add_u32 v1, v214, 5, v1
    v_mfma_f32_16x16x32_bf16 a[20:23], v[164:167], v[84:87], a[20:23]
    buffer_load_dword v194, s[16:19], s66 offen lds
    v_mfma_f32_16x16x32_bf16 a[20:23], v[160:163], v[80:83], a[20:23]
    ds_read_b64_tr_b16 v[156:157], v198 offset:7168
    v_and_b32 v214, 1, v0
    v_mfma_f32_16x16x32_bf16 a[16:19], v[160:163], v[72:75], a[16:19]
    s_add_u32 m0, s59, 46208
    ds_read_b64_tr_b16 v[158:159], v198 offset:7424
    v_lshl_add_u32 v1, v214, 4, v1
    v_mfma_f32_16x16x32_bf16 a[16:19], v[164:167], v[76:79], a[16:19]
    s_waitcnt lgkmcnt(8)
    buffer_load_dwordx4 v208, s[8:11], s67 offen lds
    v_mfma_f32_16x16x32_bf16 a[44:47], v[140:143], v[100:103], a[44:47]
    ds_read_b64_tr_b16 v[160:161], v198 offset:6656
    v_bfe_u32 v214, v0, 1, 1
    v_mfma_f32_16x16x32_bf16 a[44:47], v[136:139], v[96:99], a[44:47]
    ds_read_b64_tr_b16 v[162:163], v198 offset:6912
    v_lshl_add_u32 v1, v214, 3, v1
    v_mfma_f32_16x16x32_bf16 a[40:43], v[136:139], v[88:91], a[40:43]
    s_lshr_b32 s62, s58, 1
    v_mfma_f32_16x16x32_bf16 a[40:43], v[140:143], v[92:95], a[40:43]
    s_xor_b32 s67, s67, 384
    ds_read_b64_tr_b16 v[164:165], v198 offset:7680
    v_mfma_f32_16x16x32_bf16 a[36:39], v[140:143], v[84:87], a[36:39]
    s_add_u32 m0, s59, 47232
    ds_read_b64_tr_b16 v[166:167], v198 offset:7936
    v_mfma_f32_16x16x32_bf16 a[36:39], v[136:139], v[80:83], a[36:39]
    s_mul_i32 s62, s62, 4608
    buffer_load_dwordx4 v191, s[8:11], s67 offen lds
    v_mfma_f32_16x16x32_bf16 a[32:35], v[136:139], v[72:75], a[32:35]
    s_add_u32 s63, s62, 2048
    ds_read_b64_tr_b16 v[136:137], v198 offset:8192
    v_add_u32 v10, s63, v1
    v_mfma_f32_16x16x32_bf16 a[32:35], v[140:143], v[76:79], a[32:35]
    s_waitcnt lgkmcnt(9)
    ds_read_b64_tr_b16 v[138:139], v198 offset:8448
    v_mfma_f32_16x16x32_bf16 a[60:63], v[148:151], v[100:103], a[60:63]
    s_mul_i32 s63, s75, 2560
    v_mfma_f32_16x16x32_bf16 a[60:63], v[144:147], v[96:99], a[60:63]
    s_add_u32 s62, s62, s63
    ds_read_b64_tr_b16 v[140:141], v198 offset:8704
    v_add_u32 v1, s62, v1
    v_mfma_f32_16x16x32_bf16 a[56:59], v[144:147], v[88:91], a[56:59]
    s_add_u32 m0, s59, 48256
    ds_read_b64_tr_b16 v[142:143], v198 offset:8960
    v_mfma_f32_16x16x32_bf16 a[56:59], v[148:151], v[92:95], a[56:59]
    s_lshl_b32 s62, s58, 11
    buffer_load_dwordx4 v208, s[8:11], s67 offen lds
    v_mfma_f32_16x16x32_bf16 a[52:55], v[148:151], v[84:87], a[52:55]
    s_waitcnt vmcnt(10)
    ds_add_u32 v11, v9
    v_mfma_f32_16x16x32_bf16 a[52:55], v[144:147], v[80:83], a[52:55]
    s_xor_b32 s67, s67, 128
    s_add_u32 m0, s59, 49280
    v_mfma_f32_16x16x32_bf16 a[48:51], v[144:147], v[72:75], a[48:51]
    s_add_u32 s63, s62, 129408
    buffer_load_dwordx4 v191, s[8:11], s67 offen lds
    v_mfma_f32_16x16x32_bf16 a[48:51], v[148:151], v[76:79], a[48:51]
    s_waitcnt lgkmcnt(9)
    v_and_b32 v214, 0x2f, v0
    v_lshl_add_u32 v3, v214, 4, s63
    v_mfma_f32_16x16x32_bf16 a[76:79], v[156:159], v[100:103], a[76:79]
    v_bfe_u32 v214, v0, 4, 1
    v_lshl_add_u32 v3, v214, 3, v3
    v_mfma_f32_16x16x32_bf16 a[76:79], v[152:155], v[96:99], a[76:79]
    s_lshl_b32 s62, s75, 12
    ds_read_b32 v6, v11
    v_mfma_f32_16x16x32_bf16 a[72:75], v[152:155], v[88:91], a[72:75]
    s_add_u32 m0, s59, 50304
    v_mfma_f32_16x16x32_bf16 a[72:75], v[156:159], v[92:95], a[72:75]
    s_add_u32 s63, s62, 129408
    buffer_load_dwordx4 v208, s[8:11], s67 offen lds
    v_mfma_f32_16x16x32_bf16 a[68:71], v[156:159], v[84:87], a[68:71]
    v_lshl_add_u32 v44, v0, 4, s63
    v_mfma_f32_16x16x32_bf16 a[68:71], v[152:155], v[80:83], a[68:71]
    s_add_u32 m0, s72, 129408
    v_mfma_f32_16x16x32_bf16 a[64:67], v[152:155], v[72:75], a[64:67]
    s_waitcnt lgkmcnt(0)
    v_cmp_le_u32 vcc, 12, v6
    v_mfma_f32_16x16x32_bf16 a[64:67], v[156:159], v[76:79], a[64:67]
    s_waitcnt lgkmcnt(6)
    v_mfma_f32_16x16x32_bf16 a[92:95], v[164:167], v[100:103], a[92:95]
    s_cbranch_vccz L_espin2
L_eback2:
    ds_read_b128 v[112:115], v202 offset:18432
    v_mfma_f32_16x16x32_bf16 a[92:95], v[160:163], v[96:99], a[92:95]
    buffer_load_dwordx4 v195, s[4:7], s78 offen lds
    v_mfma_f32_16x16x32_bf16 a[88:91], v[160:163], v[88:91], a[88:91]
    ds_read_b128 v[116:119], v203 offset:18432
    v_mfma_f32_16x16x32_bf16 a[88:91], v[164:167], v[92:95], a[88:91]
    ds_read_b128 v[104:107], v202 offset:16384
    v_mfma_f32_16x16x32_bf16 a[84:87], v[164:167], v[84:87], a[84:87]
    s_add_u32 m0, s72, 131456
    ds_read_b128 v[108:111], v203 offset:16384
    v_mfma_f32_16x16x32_bf16 a[84:87], v[160:163], v[80:83], a[84:87]
    buffer_load_dwordx4 v195, s[4:7], s68 offen lds
    v_mfma_f32_16x16x32_bf16 a[80:83], v[160:163], v[72:75], a[80:83]
    ds_read_b64_tr_b16 v[144:145], v199 offset:0
    ds_read_b64_tr_b16 v[146:147], v199 offset:64
    v_mfma_f32_16x16x32_bf16 a[80:83], v[164:167], v[76:79], a[80:83]
    s_waitcnt lgkmcnt(8)
    ds_read_b64_tr_b16 v[148:149], v199 offset:128
    v_mfma_f32_16x16x32_bf16 a[108:111], v[140:143], v[100:103], a[108:111]
    s_add_u32 m0, s73, 129408
    ds_read_b64_tr_b16 v[150:151], v199 offset:192
    v_mfma_f32_16x16x32_bf16 a[108:111], v[136:139], v[96:99], a[108:111]
    buffer_load_dwordx4 v196, s[4:7], s78 offen lds
    v_mfma_f32_16x16x32_bf16 a[104:107], v[136:139], v[88:91], a[104:107]
    ds_read_b64_tr_b16 v[152:153], v197 offset:9216
    v_mfma_f32_16x16x32_bf16 a[104:107], v[140:143], v[92:95], a[104:107]
    ds_read_b64_tr_b16 v[154:155], v197 offset:9472
    v_mfma_f32_16x16x32_bf16 a[100:103], v[140:143], v[84:87], a[100:103]
    s_add_u32 m0, s73, 131456
    ds_read_b64_tr_b16 v[156:157], v197 offset:9728
    v_mfma_f32_16x16x32_bf16 a[100:103], v[136:139], v[80:83], a[100:103]
    buffer_load_dwordx4 v196, s[4:7], s68 offen lds
    v_mfma_f32_16x16x32_bf16 a[96:99], v[136:139], v[72:75], a[96:99]
    ds_read_b64_tr_b16 v[158:159], v197 offset:9984
    ds_read_b32 v174, v222 offset:16384
    v_mfma_f32_16x16x32_bf16 a[96:99], v[140:143], v[76:79], a[96:99]
    s_waitcnt lgkmcnt(5)
    buffer_load_dword v172, v207, s[44:47], s78 offen
    v_mfma_f32_16x16x32_bf16 v[68:71], v[148:151], v[116:119], v[68:71]
    ds_read_b128 v[128:131], v204 offset:18432
    v_mfma_f32_16x16x32_bf16 v[68:71], v[144:147], v[112:115], v[68:71]
    ds_read_b128 v[132:135], v205 offset:18432
    v_mfma_f32_16x16x32_bf16 v[64:67], v[144:147], v[104:107], v[64:67]
    s_xor_b32 s62, s62, 4096
    ds_read_b128 v[120:123], v204 offset:16384
    v_mfma_f32_16x16x32_bf16 v[64:67], v[148:151], v[108:111], v[64:67]
    s_waitcnt lgkmcnt(3)
    ds_read_b128 v[124:127], v205 offset:16384
    v_mfma_f32_16x16x32_bf16 v[52:55], v[156:159], v[116:119], v[52:55]
    s_bfe_u32 s66, s77, 0x40010
    ds_read_b64_tr_b16 v[160:161], v197 offset:0
    ds_read_b64_tr_b16 v[162:163], v197 offset:256
    v_mfma_f32_16x16x32_bf16 v[52:55], v[152:155], v[112:115], v[52:55]
    s_mul_i32 s64, s66, 589824
    ds_read_b64_tr_b16 v[164:165], v197 offset:1024
    v_mfma_f32_16x16x32_bf16 v[48:51], v[152:155], v[104:107], v[48:51]
    s_mul_i32 s65, s66, 73728
    ds_read_b64_tr_b16 v[166:167], v197 offset:1280
    s_add_u32 m0, s59, 94464
    v_mfma_f32_16x16x32_bf16 v[48:51], v[156:159], v[108:111], v[48:51]
    s_waitcnt lgkmcnt(4)
    buffer_load_dwordx4 v206, s[8:11], s64 offen lds
    v_mfma_f32_16x16x32_bf16 v[60:63], v[156:159], v[132:135], v[60:63]
    s_lshl_b32 s78, s66, 7
    ds_read_b64_tr_b16 v[136:137], v197 offset:512
    v_lshlrev_b32 v178, 16, v174
    v_mfma_f32_16x16x32_bf16 v[60:63], v[152:155], v[128:131], v[60:63]
    s_add_u32 s68, s78, 18432
    ds_read_b64_tr_b16 v[138:139], v197 offset:768
    s_add_u32 s67, s64, s71
    s_add_u32 m0, s59, 86272
    v_mfma_f32_16x16x32_bf16 v[56:59], v[152:155], v[120:123], v[56:59]
    s_add_u32 s63, s62, 129408
    buffer_load_dwordx4 v191, s[8:11], s67 offen lds
    v_mfma_f32_16x16x32_bf16 v[56:59], v[156:159], v[124:127], v[56:59]
    s_waitcnt lgkmcnt(2)
    ds_read_b64_tr_b16 v[140:141], v197 offset:1536
    v_lshlrev_b32 v179, 16, v173
    v_mfma_f32_16x16x32_bf16 v[236:239], v[164:167], v[132:135], v[236:239]
    ds_read_b64_tr_b16 v[142:143], v197 offset:1792
    v_and_b32 v180, 0xffff0000, v174
    v_mfma_f32_16x16x32_bf16 v[236:239], v[160:163], v[128:131], v[236:239]
    v_and_b32 v181, 0xffff0000, v173
    v_fmac_f32 v177, v178, v179
    v_mfma_f32_16x16x32_bf16 v[232:235], v[160:163], v[120:123], v[232:235]
    s_mul_i32 s66, s66, 2304
    ds_read_b64_tr_b16 v[144:145], v197 offset:2048
    v_fmac_f32 v177, v180, v181
    v_mfma_f32_16x16x32_bf16 v[232:235], v[164:167], v[124:127], v[232:235]
    s_add_u32 m0, s59, 87296
    ds_read_b64_tr_b16 v[146:147], v197 offset:2304
    v_lshl_add_u32 v4, v0, 4, s63
    v_mfma_f32_16x16x32_bf16 v[228:231], v[164:167], v[116:119], v[228:231]
    s_mul_i32 s62, s69, 18
    buffer_load_dwordx4 v208, s[8:11], s67 offen lds
    v_mfma_f32_16x16x32_bf16 v[228:231], v[160:163], v[112:115], v[228:231]
    s_mul_i32 s63, s58, 9
    ds_read_b64_tr_b16 v[148:149], v197 offset:3072
    v_mfma_f32_16x16x32_bf16 v[224:227], v[160:163], v[104:107], v[224:227]
    s_lshr_b32 s63, s63, 1
    ds_read_b64_tr_b16 v[150:151], v197 offset:3328
    v_mfma_f32_16x16x32_bf16 v[224:227], v[164:167], v[108:111], v[224:227]
    s_waitcnt lgkmcnt(4)
    v_mfma_f32_16x16x32_bf16 v[252:255], v[140:143], v[132:135], v[252:255]
    s_xor_b32 s67, s67, 128
    ds_read_b64_tr_b16 v[152:153], v197 offset:2560
    v_mfma_f32_16x16x32_bf16 v[252:255], v[136:139], v[128:131], v[252:255]
    s_add_u32 m0, s59, 88320
    ds_read_b64_tr_b16 v[154:155], v197 offset:2816
    v_mfma_f32_16x16x32_bf16 v[248:251], v[136:139], v[120:123], v[248:251]
    s_add_u32 s62, s62, s63
    buffer_load_dwordx4 v191, s[8:11], s67 offen lds
    v_mfma_f32_16x16x32_bf16 v[248:251], v[140:143], v[124:127], v[248:251]
    s_lshl_b32 s62, s62, 1
    ds_read_b64_tr_b16 v[156:157], v197 offset:3584
    v_mfma_f32_16x16x32_bf16 v[244:247], v[140:143], v[116:119], v[244:247]
    s_bfe_u32 s63, s57, 0x10002
    ds_read_b64_tr_b16 v[158:159], v197 offset:3840
    v_mfma_f32_16x16x32_bf16 v[244:247], v[136:139], v[112:115], v[244:247]
    s_add_u32 s62, s62, s63
    v_mfma_f32_16x16x32_bf16 v[240:243], v[136:139], v[104:107], v[240:243]
    s_add_u32 m0, s59, 95488
    ds_read_b64_tr_b16 v[160:161], v197 offset:4096
    v_mfma_f32_16x16x32_bf16 v[240:243], v[140:143], v[108:111], v[240:243]
    s_waitcnt lgkmcnt(5)
    ds_read_b64_tr_b16 v[162:163], v197 offset:4352
    v_mfma_f32_16x16x32_bf16 a[12:15], v[148:151], v[132:135], a[12:15]
    s_mul_i32 s62, s62, 576
    buffer_load_dwordx4 v192, s[12:15], s65 offen lds
    v_mfma_f32_16x16x32_bf16 a[12:15], v[144:147], v[128:131], a[12:15]
    ds_read_b64_tr_b16 v[164:165], v197 offset:5120
    v_lshrrev_b32 v45, 3, v0
    v_mfma_f32_16x16x32_bf16 a[8:11], v[144:147], v[120:123], a[8:11]
    s_add_u32 m0, s59, 96512
    ds_read_b64_tr_b16 v[166:167], v197 offset:5376
    v_min_u32 v45, 4, v45
    v_mfma_f32_16x16x32_bf16 a[8:11], v[148:151], v[124:127], a[8:11]
    buffer_load_dword v193, s[12:15], s65 offen lds
    v_mfma_f32_16x16x32_bf16 a[4:7], v[148:151], v[116:119], a[4:7]
    ds_read_b64_tr_b16 v[136:137], v197 offset:4608
    v_and_b32 v46, 7, v0
    v_mfma_f32_16x16x32_bf16 a[4:7], v[144:147], v[112:115], a[4:7]
    ds_read_b64_tr_b16 v[138:139], v197 offset:4864
    v_lshlrev_b32 v46, 7, v46
    v_mfma_f32_16x16x32_bf16 a[0:3], v[144:147], v[104:107], a[0:3]
    v_min_u32 v46, 572, v46
    v_mul_u32_u24 v45, 1152, v45
    v_mfma_f32_16x16x32_bf16 a[0:3], v[148:151], v[108:111], a[0:3]
    s_waitcnt lgkmcnt(6)
    ds_read_b64_tr_b16 v[140:141], v197 offset:5632
    v_add3_u32 v45, v45, v46, s62
    v_mfma_f32_16x16x32_bf16 a[28:31], v[156:159], v[132:135], a[28:31]
    s_add_u32 m0, s59, 96768
    ds_read_b64_tr_b16 v[142:143], v197 offset:5888
    v_mfma_f32_16x16x32_bf16 a[28:31], v[152:155], v[128:131], a[28:31]
    s_lshl_b32 s62, s69, 2
    buffer_load_dword v194, s[16:19], s66 offen lds
    v_mfma_f32_16x16x32_bf16 a[24:27], v[152:155], v[120:123], a[24:27]
    s_add_u32 s62, s62, s58
    ds_read_b64_tr_b16 v[144:145], v197 offset:6144
    v_mfma_f32_16x16x32_bf16 a[24:27], v[156:159], v[124:127], a[24:27]
    s_mul_i32 s63, s62, 1280
    ds_read_b64_tr_b16 v[146:147], v197 offset:6400
    v_mul_u32_u24 v46, 10, v0
    v_mfma_f32_16x16x32_bf16 a[20:23], v[156:159], v[116:119], a[20:23]
    v_lshrrev_b32 v46, 6, v46
    v_lshl_add_u32 v46, v46, 7, s63
    v_mfma_f32_16x16x32_bf16 a[20:23], v[152:155], v[112:115], a[20:23]
    s_mul_i32 s62, s62, 640
    ds_read_b64_tr_b16 v[148:149], v197 offset:7168
    v_mul_u32_u24 v12, 5, v0
    v_mfma_f32_16x16x32_bf16 a[16:19], v[152:155], v[104:107], a[16:19]
    s_add_u32 m0, s59, 89344
    ds_read_b64_tr_b16 v[150:151], v197 offset:7424
    v_lshrrev_b32 v12, 6, v12
    v_mfma_f32_16x16x32_bf16 a[16:19], v[156:159], v[108:111], a[16:19]
    s_waitcnt lgkmcnt(8)
    buffer_load_dwordx4 v208, s[8:11], s67 offen lds
    v_mfma_f32_16x16x32_bf16 a[44:47], v[164:167], v[132:135], a[44:47]
    ds_read_b64_tr_b16 v[152:153], v197 offset:6656
    v_lshl_add_u32 v12, v12, 7, s62
    v_mfma_f32_16x16x32_bf16 a[44:47], v[160:163], v[128:131], a[44:47]
    ds_read_b64_tr_b16 v[154:155], v197 offset:6912
    v_min_u32 v12, L_codeend-L_pc-4, v12
    v_mfma_f32_16x16x32_bf16 a[40:43], v[160:163], v[120:123], a[40:43]
    v_bfe_u32 v214, v0, 3, 2
    v_and_b32 v215, 3, v0
    v_mfma_f32_16x16x32_bf16 a[40:43], v[164:167], v[124:127], a[40:43]
    s_xor_b32 s67, s67, 384
    ds_read_b64_tr_b16 v[156:157], v197 offset:7680
    v_lshl_add_u32 v214, v214, 2, v215
    v_mfma_f32_16x16x32_bf16 a[36:39], v[164:167], v[116:119], a[36:39]
    s_add_u32 m0, s59, 90368
    ds_read_b64_tr_b16 v[158:159], v197 offset:7936
    v_lshrrev_b32 v215, 2, v0
    v_mfma_f32_16x16x32_bf16 a[36:39], v[160:163], v[112:115], a[36:39]
    buffer_load_dwordx4 v191, s[8:11], s67 offen lds
    v_mfma_f32_16x16x32_bf16 a[32:35], v[160:163], v[104:107], a[32:35]
    s_add_u32 m0, s59, 91392
    ds_read_b64_tr_b16 v[160:161], v197 offset:8192
    v_or_b32 v215, v215, v0
    v_mfma_f32_16x16x32_bf16 a[32:35], v[164:167], v[108:111], a[32:35]
    s_waitcnt lgkmcnt(9)
    ds_read_b64_tr_b16 v[162:163], v197 offset:8448
    v_and_b32 v215, 4, v215
    v_mfma_f32_16x16x32_bf16 a[60:63], v[140:143], v[132:135], a[60:63]
    buffer_load_dwordx4 v208, s[8:11], s67 offen lds
    v_mfma_f32_16x16x32_bf16 a[60:63], v[136:139], v[128:131], a[60:63]
    ds_read_b64_tr_b16 v[164:165], v197 offset:8704
    v_lshl_add_u32 v214, v215, 1, v214
    v_mfma_f32_16x16x32_bf16 a[56:59], v[136:139], v[120:123], a[56:59]
    ds_read_b64_tr_b16 v[166:167], v197 offset:8960
    v_lshrrev_b32 v215, 5, v0
    v_mfma_f32_16x16x32_bf16 a[56:59], v[140:143], v[124:127], a[56:59]
    s_xor_b32 s67, s67, 128
    v_mad_u32_u24 v214, v215, 19, v214
    v_lshlrev_b32 v214, 4, v214
    v_mfma_f32_16x16x32_bf16 a[52:55], v[140:143], v[116:119], a[52:55]
    s_waitcnt vmcnt(10)
    ds_add_u32 v11, v9
    v_mfma_f32_16x16x32_bf16 a[52:55], v[136:139], v[112:115], a[52:55]
    s_add_u32 m0, s59, 92416
    v_mfma_f32_16x16x32_bf16 a[48:51], v[136:139], v[104:107], a[48:51]
    s_mov_b32 s82, 0x47ffff
    buffer_load_dwordx4 v191, s[8:11], s67 offen lds
    v_mfma_f32_16x16x32_bf16 a[48:51], v[140:143], v[108:111], a[48:51]
    s_waitcnt lgkmcnt(9)
    v_mfma_f32_16x16x32_bf16 a[76:79], v[148:151], v[132:135], a[76:79]
    s_mov_b32 s83, 0x47ffff
    v_mov_b32 v215, 262144
    v_cndmask_b32 v47, v215, v214, s[82:83]
    v_mfma_f32_16x16x32_bf16 a[76:79], v[144:147], v[128:131], a[76:79]
    s_lshr_b32 s62, s58, 1
    ds_read_b32 v6, v11
    v_mfma_f32_16x16x32_bf16 a[72:75], v[144:147], v[120:123], a[72:75]
    s_add_u32 m0, s59, 93440
    v_mfma_f32_16x16x32_bf16 a[72:75], v[148:151], v[124:127], a[72:75]
    s_mul_i32 s62, s62, 36
    buffer_load_dwordx4 v208, s[8:11], s67 offen lds
    v_mfma_f32_16x16x32_bf16 a[68:71], v[148:151], v[116:119], a[68:71]
    s_lshl3_add_u32 s62, s75, s62
    v_lshrrev_b32 v214, 5, v0
    v_mul_u32_u24 v214, 72, v214
    v_mfma_f32_16x16x32_bf16 a[68:71], v[144:147], v[112:115], a[68:71]
    s_add_u32 m0, s72, 145792
    v_mfma_f32_16x16x32_bf16 a[64:67], v[144:147], v[104:107], a[64:67]
    s_waitcnt lgkmcnt(0)
    v_cmp_le_u32 vcc, 16, v6
    v_mfma_f32_16x16x32_bf16 a[64:67], v[148:151], v[108:111], a[64:67]
    s_waitcnt lgkmcnt(6)
    v_mfma_f32_16x16x32_bf16 a[92:95], v[156:159], v[132:135], a[92:95]
    s_cbranch_vccz L_espin3
L_eback3:
    ds_read_b128 v[80:83], v202 offset:2048
    v_mfma_f32_16x16x32_bf16 a[92:95], v[152:155], v[128:131], a[92:95]
    buffer_load_dwordx4 v195, s[4:7], s78 offen lds
    v_mfma_f32_16x16x32_bf16 a[88:91], v[152:155], v[120:123], a[88:91]
    ds_read_b128 v[84:87], v203 offset:2048
    v_mfma_f32_16x16x32_bf16 a[88:91], v[156:159], v[124:127], a[88:91]
    ds_read_b128 v[72:75], v202 offset:0
    v_mfma_f32_16x16x32_bf16 a[84:87], v[156:159], v[116:119], a[84:87]
    s_add_u32 m0, s72, 147840
    ds_read_b128 v[76:79], v203 offset:0
    v_mfma_f32_16x16x32_bf16 a[84:87], v[152:155], v[112:115], a[84:87]
    buffer_load_dwordx4 v195, s[4:7], s68 offen lds
    v_mfma_f32_16x16x32_bf16 a[80:83], v[152:155], v[104:107], a[80:83]
    ds_read_b64_tr_b16 v[136:137], v199 offset:43136
    ds_read_b64_tr_b16 v[138:139], v199 offset:43200
    v_mfma_f32_16x16x32_bf16 a[80:83], v[156:159], v[108:111], a[80:83]
    s_waitcnt lgkmcnt(8)
    ds_read_b64_tr_b16 v[140:141], v199 offset:43264
    v_mfma_f32_16x16x32_bf16 a[108:111], v[164:167], v[132:135], a[108:111]
    s_add_u32 m0, s73, 145792
    ds_read_b64_tr_b16 v[142:143], v199 offset:43328
    v_mfma_f32_16x16x32_bf16 a[108:111], v[160:163], v[128:131], a[108:111]
    buffer_load_dwordx4 v196, s[4:7], s78 offen lds
    v_mfma_f32_16x16x32_bf16 a[104:107], v[160:163], v[120:123], a[104:107]
    ds_read_b64_tr_b16 v[144:145], v197 offset:52352
    v_mfma_f32_16x16x32_bf16 a[104:107], v[164:167], v[124:127], a[104:107]
    ds_read_b64_tr_b16 v[146:147], v197 offset:52608
    v_mfma_f32_16x16x32_bf16 a[100:103], v[164:167], v[116:119], a[100:103]
    s_add_u32 m0, s73, 147840
    ds_read_b64_tr_b16 v[148:149], v197 offset:52864
    v_mfma_f32_16x16x32_bf16 a[100:103], v[160:163], v[112:115], a[100:103]
    buffer_load_dwordx4 v196, s[4:7], s68 offen lds
    v_mfma_f32_16x16x32_bf16 a[96:99], v[160:163], v[104:107], a[96:99]
    ds_read_b64_tr_b16 v[150:151], v197 offset:53120
    ds_read_b32 v174, v222 offset:0
    v_mfma_f32_16x16x32_bf16 a[96:99], v[164:167], v[108:111], a[96:99]
    s_waitcnt lgkmcnt(5)
    buffer_load_dword v173, v207, s[44:47], s78 offen
    v_mfma_f32_16x16x32_bf16 v[68:71], v[140:143], v[84:87], v[68:71]
    ds_read_b128 v[96:99], v204 offset:2048
    v_mfma_f32_16x16x32_bf16 v[68:71], v[136:139], v[80:83], v[68:71]
    ds_read_b128 v[100:103], v205 offset:2048
    v_mfma_f32_16x16x32_bf16 v[64:67], v[136:139], v[72:75], v[64:67]
    ds_read_b128 v[88:91], v204 offset:0
    v_bfe_u32 v215, v0, 2, 3
    v_mfma_f32_16x16x32_bf16 v[64:67], v[140:143], v[76:79], v[64:67]
    s_waitcnt lgkmcnt(3)
    ds_read_b128 v[92:95], v205 offset:0
    v_add3_u32 v214, v214, s62, v215
    v_mfma_f32_16x16x32_bf16 v[52:55], v[148:151], v[84:87], v[52:55]
    s_bfe_u32 s66, s77, 0x40014
    ds_read_b64_tr_b16 v[152:153], v197 offset:43136
    ds_read_b64_tr_b16 v[154:155], v197 offset:43392
    v_mfma_f32_16x16x32_bf16 v[52:55], v[144:147], v[80:83], v[52:55]
    s_mul_i32 s64, s66, 589824
    ds_read_b64_tr_b16 v[156:157], v197 offset:44160
    v_mul_u32_u24 v214, 1152, v214
    v_mfma_f32_16x16x32_bf16 v[48:51], v[144:147], v[72:75], v[48:51]
    s_mul_i32 s65, s66, 73728
    ds_read_b64_tr_b16 v[158:159], v197 offset:44416
    s_add_u32 m0, s59, 8192
    v_mfma_f32_16x16x32_bf16 v[48:51], v[148:151], v[76:79], v[48:51]
    s_waitcnt lgkmcnt(4)
    buffer_load_dwordx4 v206, s[8:11], s64 offen lds
    v_mfma_f32_16x16x32_bf16 v[60:63], v[148:151], v[100:103], v[60:63]
    s_lshl_b32 s78, s66, 7
    ds_read_b64_tr_b16 v[160:161], v197 offset:43648
    v_lshlrev_b32 v178, 16, v174
    v_mfma_f32_16x16x32_bf16 v[60:63], v[144:147], v[96:99], v[60:63]
    s_add_u32 s68, s78, 18432
    ds_read_b64_tr_b16 v[162:163], v197 offset:43904
    s_add_u32 s67, s64, s71
    s_add_u32 m0, s59, 0
    v_mfma_f32_16x16x32_bf16 v[56:59], v[144:147], v[88:91], v[56:59]
    buffer_load_dwordx4 v191, s[8:11], s67 offen lds
    v_mfma_f32_16x16x32_bf16 v[56:59], v[148:151], v[92:95], v[56:59]
    s_waitcnt lgkmcnt(2)
    ds_read_b64_tr_b16 v[164:165], v197 offset:44672
    v_lshlrev_b32 v179, 16, v172
    v_mfma_f32_16x16x32_bf16 v[236:239], v[156:159], v[100:103], v[236:239]
    ds_read_b64_tr_b16 v[166:167], v197 offset:44928
    v_and_b32 v180, 0xffff0000, v174
    v_mfma_f32_16x16x32_bf16 v[236:239], v[152:155], v[96:99], v[236:239]
    v_and_b32 v181, 0xffff0000, v172
    v_fmac_f32 v177, v178, v179
    v_mfma_f32_16x16x32_bf16 v[232:235], v[152:155], v[88:91], v[232:235]
    s_mul_i32 s66, s66, 2304
    ds_read_b64_tr_b16 v[136:137], v197 offset:45184
    v_fmac_f32 v177, v180, v181
    v_mfma_f32_16x16x32_bf16 v[232:235], v[156:159], v[92:95], v[232:235]
    s_add_u32 m0, s59, 1024
    ds_read_b64_tr_b16 v[138:139], v197 offset:45440
    v_and_b32 v216, 3, v0
    v_mfma_f32_16x16x32_bf16 v[228:231], v[156:159], v[84:87], v[228:231]
    buffer_load_dwordx4 v208, s[8:11], s67 offen lds
    v_mfma_f32_16x16x32_bf16 v[228:231], v[152:155], v[80:83], v[228:231]
    ds_read_b64_tr_b16 v[140:141], v197 offset:46208
    v_lshl_add_u32 v215, v216, 2, v214
    v_mfma_f32_16x16x32_bf16 v[224:227], v[152:155], v[72:75], v[224:227]
    ds_read_b64_tr_b16 v[142:143], v197 offset:46464
    v_lshl_add_u32 v214, v216, 4, v214
    v_mfma_f32_16x16x32_bf16 v[224:227], v[156:159], v[76:79], v[224:227]
    s_waitcnt lgkmcnt(4)
    v_accvgpr_write_b32 a235, v215
    v_accvgpr_write_b32 a234, v214
    v_mfma_f32_16x16x32_bf16 v[252:255], v[164:167], v[100:103], v[252:255]
    s_xor_b32 s67, s67, 128
    ds_read_b64_tr_b16 v[144:145], v197 offset:45696
    v_bfe_u32 v214, v0, 3, 2
    v_mfma_f32_16x16x32_bf16 v[252:255], v[160:163], v[96:99], v[252:255]
    s_add_u32 m0, s59, 2048
    ds_read_b64_tr_b16 v[146:147], v197 offset:45952
    v_lshl_add_u32 v214, s58, 2, v214
    v_mfma_f32_16x16x32_bf16 v[248:251], v[160:163], v[88:91], v[248:251]
    buffer_load_dwordx4 v191, s[8:11], s67 offen lds
    v_mfma_f32_16x16x32_bf16 v[248:251], v[164:167], v[92:95], v[248:251]
    ds_read_b64_tr_b16 v[148:149], v197 offset:46720
    v_lshrrev_b32 v215, 5, v0
    v_mfma_f32_16x16x32_bf16 v[244:247], v[164:167], v[84:87], v[244:247]
    ds_read_b64_tr_b16 v[150:151], v197 offset:46976
    v_lshl_add_u32 v214, v214, 1, v215
    v_mfma_f32_16x16x32_bf16 v[244:247], v[160:163], v[80:83], v[244:247]
    v_mad_u32_u24 v214, v214, 18, 16
    v_bfe_u32 v215, v0, 2, 1
    v_mfma_f32_16x16x32_bf16 v[240:243], v[160:163], v[72:75], v[240:243]
    s_add_u32 m0, s59, 9216
    ds_read_b64_tr_b16 v[152:153], v197 offset:47232
    v_add_u32 v214, v214, v215
    v_mfma_f32_16x16x32_bf16 v[240:243], v[164:167], v[76:79], v[240:243]
    s_waitcnt lgkmcnt(5)
    ds_read_b64_tr_b16 v[154:155], v197 offset:47488
    v_mul_u32_u24 v214, 1152, v214
    v_mfma_f32_16x16x32_bf16 a[12:15], v[140:143], v[100:103], a[12:15]
    buffer_load_dwordx4 v192, s[12:15], s65 offen lds
    v_mfma_f32_16x16x32_bf16 a[12:15], v[136:139], v[96:99], a[12:15]
    ds_read_b64_tr_b16 v[156:157], v197 offset:48256
    v_lshl_add_u32 v215, v216, 2, v214
    v_mfma_f32_16x16x32_bf16 a[8:11], v[136:139], v[88:91], a[8:11]
    s_add_u32 m0, s59, 10240
    ds_read_b64_tr_b16 v[158:159], v197 offset:48512
    v_lshl_add_u32 v214, v216, 4, v214
    v_mfma_f32_16x16x32_bf16 a[8:11], v[140:143], v[92:95], a[8:11]
    buffer_load_dword v193, s[12:15], s65 offen lds
    v_mfma_f32_16x16x32_bf16 a[4:7], v[140:143], v[84:87], a[4:7]
    ds_read_b64_tr_b16 v[160:161], v197 offset:47744
    v_accvgpr_write_b32 a237, v215
    v_mfma_f32_16x16x32_bf16 a[4:7], v[136:139], v[80:83], a[4:7]
    ds_read_b64_tr_b16 v[162:163], v197 offset:48000
    v_accvgpr_write_b32 a236, v214
    v_mfma_f32_16x16x32_bf16 a[0:3], v[136:139], v[72:75], a[0:3]
    v_lshrrev_b32 v214, 4, v0
    v_mul_u32_u24 v214, 20768, v214
    v_mfma_f32_16x16x32_bf16 a[0:3], v[140:143], v[76:79], a[0:3]
    s_waitcnt lgkmcnt(6)
    ds_read_b64_tr_b16 v[164:165], v197 offset:48768
    v_add_u32 v214, 61440, v214
    v_mfma_f32_16x16x32_bf16 a[28:31], v[148:151], v[100:103], a[28:31]
    s_add_u32 m0, s59, 10496
    ds_read_b64_tr_b16 v[166:167], v197 offset:49024
    v_bfe_u32 v209, v0, 2, 2
    v_mfma_f32_16x16x32_bf16 a[28:31], v[144:147], v[96:99], a[28:31]
    buffer_load_dword v194, s[16:19], s66 offen lds
    v_mfma_f32_16x16x32_bf16 a[24:27], v[144:147], v[88:91], a[24:27]
L_pe1:
L_r1:
    s_cbranch_execz L_q5
    ds_read_b64_tr_b16 v[136:137], v197 offset:49280
    v_lshl_add_u32 v215, v209, 4, v214
    v_mfma_f32_16x16x32_bf16 a[24:27], v[148:151], v[92:95], a[24:27]
    ds_read_b64_tr_b16 v[138:139], v197 offset:49536
    v_lshl_add_u32 v214, v209, 6, v214
    v_mfma_f32_16x16x32_bf16 a[20:23], v[148:151], v[84:87], a[20:23]
    v_lshl_add_u32 v214, v216, 3, v214
    v_and_b32 v216, 1, v0
    v_mfma_f32_16x16x32_bf16 a[20:23], v[144:147], v[80:83], a[20:23]
    ds_read_b64_tr_b16 v[140:141], v197 offset:50304
    v_lshl_add_u32 v215, v216, 3, v215
    v_mfma_f32_16x16x32_bf16 a[16:19], v[144:147], v[72:75], a[16:19]
    s_add_u32 m0, s59, 3072
    ds_read_b64_tr_b16 v[142:143], v197 offset:50560
    v_accvgpr_write_b32 a238, v214
    v_mfma_f32_16x16x32_bf16 a[16:19], v[148:151], v[76:79], a[16:19]
    s_waitcnt lgkmcnt(8)
    buffer_load_dwordx4 v208, s[8:11], s67 offen lds
    v_mfma_f32_16x16x32_bf16 a[44:47], v[156:159], v[100:103], a[44:47]
    ds_read_b64_tr_b16 v[144:145], v197 offset:49792
    v_accvgpr_write_b32 a239, v215
    v_mfma_f32_16x16x32_bf16 a[44:47], v[152:155], v[96:99], a[44:47]
    s_mul_i32 s62, s58, 3328
    ds_read_b64_tr_b16 v[146:147], v197 offset:50048
    v_mfma_f32_16x16x32_bf16 a[40:43], v[152:155], v[88:91], a[40:43]
    s_add_u32 s62, s62, 145792
    v_and_b32 v218, 15, v0
    v_lshrrev_b32 v219, 4, v0
    v_mfma_f32_16x16x32_bf16 a[40:43], v[156:159], v[92:95], a[40:43]
    s_xor_b32 s67, s67, 384
    ds_read_b64_tr_b16 v[148:149], v197 offset:50816
    v_mul_u32_u24 v211, 104, v218
    v_mfma_f32_16x16x32_bf16 a[36:39], v[156:159], v[84:87], a[36:39]
    s_add_u32 m0, s59, 4096
    ds_read_b64_tr_b16 v[150:151], v197 offset:51072
    v_add_u32 v211, s62, v211
    v_mfma_f32_16x16x32_bf16 a[36:39], v[152:155], v[80:83], a[36:39]
    buffer_load_dwordx4 v191, s[8:11], s67 offen lds
    v_mfma_f32_16x16x32_bf16 a[32:35], v[152:155], v[72:75], a[32:35]
    s_add_u32 m0, s59, 5120
    ds_read_b64_tr_b16 v[152:153], v197 offset:51328
    v_lshl_add_u32 v209, v219, 3, v211
    v_mfma_f32_16x16x32_bf16 a[32:35], v[156:159], v[76:79], a[32:35]
    s_waitcnt lgkmcnt(9)
    ds_read_b64_tr_b16 v[154:155], v197 offset:51584
    v_mov_b32 v211, v209
    v_mfma_f32_16x16x32_bf16 a[60:63], v[164:167], v[100:103], a[60:63]
    s_lshl_b32 s63, s75, 5
    buffer_load_dwordx4 v208, s[8:11], s67 offen lds
    v_mfma_f32_16x16x32_bf16 a[60:63], v[160:163], v[96:99], a[60:63]
    s_lshl3_add_u32 s63, s101, s63
    ds_read_b64_tr_b16 v[156:157], v197 offset:51840
    v_add_u32 v209, s63, v209
    v_mfma_f32_16x16x32_bf16 a[56:59], v[160:163], v[88:91], a[56:59]
    s_mul_i32 s63, s75, -6656
    ds_read_b64_tr_b16 v[158:159], v197 offset:52096
    v_mfma_f32_16x16x32_bf16 a[56:59], v[164:167], v[92:95], a[56:59]
    s_xor_b32 s67, s67, 128
    v_mfma_f32_16x16x32_bf16 a[52:55], v[164:167], v[84:87], a[52:55]
    s_waitcnt vmcnt(10)
    ds_add_u32 v11, v9
    v_mfma_f32_16x16x32_bf16 a[52:55], v[160:163], v[80:83], a[52:55]
    s_add_u32 m0, s59, 6144
    v_mfma_f32_16x16x32_bf16 a[48:51], v[160:163], v[72:75], a[48:51]
    s_add_u32 s63, s63, 3328
    buffer_load_dwordx4 v191, s[8:11], s67 offen lds
    v_mfma_f32_16x16x32_bf16 a[48:51], v[164:167], v[76:79], a[48:51]
    s_waitcnt lgkmcnt(9)
    v_add_u32 v210, s63, v209
    v_cmp_gt_u32 s[82:83], 32, v0
    v_mfma_f32_16x16x32_bf16 a[76:79], v[140:143], v[100:103], a[76:79]
    v_mov_b32 v217, 0x3eae1a93
    v_and_b32 v216, 31, v0
    v_mfma_f32_16x16x32_bf16 a[76:79], v[136:139], v[96:99], a[76:79]
    ds_read_b32 v6, v11
    v_cndmask_b32 v217, 1.0, v217, s[82:83]
    v_mfma_f32_16x16x32_bf16 a[72:75], v[136:139], v[88:91], a[72:75]
    s_add_u32 m0, s59, 7168
    v_mul_u32_u24 v212, 104, v216
    v_add_u32 v212, s62, v212
    v_mfma_f32_16x16x32_bf16 a[72:75], v[140:143], v[92:95], a[72:75]
    buffer_load_dwordx4 v208, s[8:11], s67 offen lds
    v_mfma_f32_16x16x32_bf16 a[68:71], v[140:143], v[84:87], a[68:71]
    v_bfe_u32 v213, v0, 2, 2
    v_lshl_add_u32 v213, v219, 3, v213
    v_mfma_f32_16x16x32_bf16 a[68:71], v[136:139], v[80:83], a[68:71]
    s_add_u32 m0, s72, 129408
    v_mfma_f32_16x16x32_bf16 a[64:67], v[136:139], v[72:75], a[64:67]
    s_waitcnt lgkmcnt(0)
    v_cmp_le_u32 vcc, 20, v6
    v_mfma_f32_16x16x32_bf16 a[64:67], v[140:143], v[76:79], a[64:67]
    s_waitcnt lgkmcnt(6)
    v_mfma_f32_16x16x32_bf16 a[92:95], v[148:151], v[100:103], a[92:95]
    s_cbranch_vccz L_espin4
L_eback4:
    ds_read_b128 v[112:115], v202 offset:18432
    v_mfma_f32_16x16x32_bf16 a[92:95], v[144:147], v[96:99], a[92:95]
    buffer_load_dwordx4 v195, s[4:7], s78 offen lds
    v_mfma_f32_16x16x32_bf16 a[88:91], v[144:147], v[88:91], a[88:91]
    ds_read_b128 v[116:119], v203 offset:18432
    v_mfma_f32_16x16x32_bf16 a[88:91], v[148:151], v[92:95], a[88:91]
    ds_read_b128 v[104:107], v202 offset:16384
    v_mfma_f32_16x16x32_bf16 a[84:87], v[148:151], v[84:87], a[84:87]
    s_add_u32 m0, s72, 131456
    ds_read_b128 v[108:111], v203 offset:16384
    v_mfma_f32_16x16x32_bf16 a[84:87], v[144:147], v[80:83], a[84:87]
    buffer_load_dwordx4 v195, s[4:7], s68 offen lds
    v_mfma_f32_16x16x32_bf16 a[80:83], v[144:147], v[72:75], a[80:83]
    ds_read_b64_tr_b16 v[160:161], v200 offset:0
    ds_read_b64_tr_b16 v[162:163], v200 offset:64
    v_mfma_f32_16x16x32_bf16 a[80:83], v[148:151], v[76:79], a[80:83]
    s_waitcnt lgkmcnt(8)
    ds_read_b64_tr_b16 v[164:165], v200 offset:128
    v_mfma_f32_16x16x32_bf16 a[108:111], v[156:159], v[100:103], a[108:111]
    s_add_u32 m0, s73, 129408
    ds_read_b64_tr_b16 v[166:167], v200 offset:192
    v_mfma_f32_16x16x32_bf16 a[108:111], v[152:155], v[96:99], a[108:111]
    buffer_load_dwordx4 v196, s[4:7], s78 offen lds
    v_mfma_f32_16x16x32_bf16 a[104:107], v[152:155], v[88:91], a[104:107]
    ds_read_b64_tr_b16 v[136:137], v198 offset:9216
    v_mfma_f32_16x16x32_bf16 a[104:107], v[156:159], v[92:95], a[104:107]
    ds_read_b64_tr_b16 v[138:139], v198 offset:9472
    v_mfma_f32_16x16x32_bf16 a[100:103], v[156:159], v[84:87], a[100:103]
    s_add_u32 m0, s73, 131456
    ds_read_b64_tr_b16 v[140:141], v198 offset:9728
    v_mfma_f32_16x16x32_bf16 a[100:103], v[152:155], v[80:83], a[100:103]
    buffer_load_dwordx4 v196, s[4:7], s68 offen lds
    v_mfma_f32_16x16x32_bf16 a[96:99], v[152:155], v[72:75], a[96:99]
    ds_read_b64_tr_b16 v[142:143], v198 offset:9984
    ds_read_b32 v174, v222 offset:16384
    v_mfma_f32_16x16x32_bf16 a[96:99], v[156:159], v[76:79], a[96:99]
    s_waitcnt lgkmcnt(5)
    buffer_load_dword v172, v207, s[44:47], s78 offen
    v_mfma_f32_16x16x32_bf16 v[68:71], v[164:167], v[116:119], v[68:71]
    ds_read_b128 v[128:131], v204 offset:18432
    v_mfma_f32_16x16x32_bf16 v[68:71], v[160:163], v[112:115], v[68:71]
    ds_read_b128 v[132:135], v205 offset:18432
    v_mfma_f32_16x16x32_bf16 v[64:67], v[160:163], v[104:107], v[64:67]
    ds_read_b128 v[120:123], v204 offset:16384
    v_mul_u32_u24 v213, 104, v213
    v_mfma_f32_16x16x32_bf16 v[64:67], v[164:167], v[108:111], v[64:67]
    s_waitcnt lgkmcnt(3)
    ds_read_b128 v[124:127], v205 offset:16384
    v_and_b32 v214, 3, v0
    v_mfma_f32_16x16x32_bf16 v[52:55], v[140:143], v[116:119], v[52:55]
    s_bfe_u32 s66, s77, 0x40018
    ds_read_b64_tr_b16 v[144:145], v198 offset:0
    ds_read_b64_tr_b16 v[146:147], v198 offset:256
    v_mfma_f32_16x16x32_bf16 v[52:55], v[136:139], v[112:115], v[52:55]
    s_mul_i32 s64, s66, 589824
    ds_read_b64_tr_b16 v[148:149], v198 offset:1024
    v_lshl_add_u32 v213, v214, 3, v213
    v_mfma_f32_16x16x32_bf16 v[48:51], v[136:139], v[104:107], v[48:51]
    s_mul_i32 s65, s66, 73728
    ds_read_b64_tr_b16 v[150:151], v198 offset:1280
    s_add_u32 m0, s59, 51328
    v_mfma_f32_16x16x32_bf16 v[48:51], v[140:143], v[108:111], v[48:51]
    s_waitcnt lgkmcnt(4)
    buffer_load_dwordx4 v206, s[8:11], s64 offen lds
    v_mfma_f32_16x16x32_bf16 v[60:63], v[140:143], v[132:135], v[60:63]
    s_lshl_b32 s78, s66, 7
    ds_read_b64_tr_b16 v[152:153], v198 offset:512
    v_lshlrev_b32 v178, 16, v174
    v_mfma_f32_16x16x32_bf16 v[60:63], v[136:139], v[128:131], v[60:63]
    s_add_u32 s68, s78, 18432
    ds_read_b64_tr_b16 v[154:155], v198 offset:768
    s_add_u32 s67, s64, s71
    s_add_u32 m0, s59, 43136
    v_mfma_f32_16x16x32_bf16 v[56:59], v[136:139], v[120:123], v[56:59]
    buffer_load_dwordx4 v191, s[8:11], s67 offen lds
    v_mfma_f32_16x16x32_bf16 v[56:59], v[140:143], v[124:127], v[56:59]
    s_waitcnt lgkmcnt(2)
    ds_read_b64_tr_b16 v[156:157], v198 offset:1536
    v_lshlrev_b32 v179, 16, v173
    v_mfma_f32_16x16x32_bf16 v[236:239], v[148:151], v[132:135], v[236:239]
    ds_read_b64_tr_b16 v[158:159], v198 offset:1792
    v_and_b32 v180, 0xffff0000, v174
    v_mfma_f32_16x16x32_bf16 v[236:239], v[144:147], v[128:131], v[236:239]
    v_and_b32 v181, 0xffff0000, v173
    v_fmac_f32 v177, v178, v179
    v_mfma_f32_16x16x32_bf16 v[232:235], v[144:147], v[120:123], v[232:235]
    s_mul_i32 s66, s66, 2304
    ds_read_b64_tr_b16 v[160:161], v198 offset:2048
    v_fmac_f32 v177, v180, v181
    v_mfma_f32_16x16x32_bf16 v[232:235], v[148:151], v[124:127], v[232:235]
    s_add_u32 m0, s59, 44160
    ds_read_b64_tr_b16 v[162:163], v198 offset:2304
    v_add_u32 v213, s62, v213
    v_mfma_f32_16x16x32_bf16 v[228:231], v[148:151], v[116:119], v[228:231]
    s_mul_i32 s60, s56, 9472
    buffer_load_dwordx4 v208, s[8:11], s67 offen lds
    v_mfma_f32_16x16x32_bf16 v[228:231], v[144:147], v[112:115], v[228:231]
    s_lshl_b32 s62, s58, 10
    ds_read_b64_tr_b16 v[164:165], v198 offset:3072
    v_mfma_f32_16x16x32_bf16 v[224:227], v[144:147], v[104:107], v[224:227]
    s_lshl_b32 s63, s53, 9
    ds_read_b64_tr_b16 v[166:167], v198 offset:3328
    v_mfma_f32_16x16x32_bf16 v[224:227], v[148:151], v[108:111], v[224:227]
    s_waitcnt lgkmcnt(4)
    v_mfma_f32_16x16x32_bf16 v[252:255], v[156:159], v[132:135], v[252:255]
    s_xor_b32 s67, s67, 128
    ds_read_b64_tr_b16 v[136:137], v198 offset:2560
    v_mfma_f32_16x16x32_bf16 v[252:255], v[152:155], v[128:131], v[252:255]
    s_add_u32 m0, s59, 45184
    ds_read_b64_tr_b16 v[138:139], v198 offset:2816
    v_mfma_f32_16x16x32_bf16 v[248:251], v[152:155], v[120:123], v[248:251]
    s_add_u32 s62, s62, s63
    buffer_load_dwordx4 v191, s[8:11], s67 offen lds
    v_mfma_f32_16x16x32_bf16 v[248:251], v[156:159], v[124:127], v[248:251]
    s_add_u32 s62, s62, s60
    ds_read_b64_tr_b16 v[140:141], v198 offset:3584
    v_mfma_f32_16x16x32_bf16 v[244:247], v[156:159], v[116:119], v[244:247]
    s_cmp_lt_u32 s53, 2
    s_cselect_b32 s62, s62, 1073741824
    ds_read_b64_tr_b16 v[142:143], v198 offset:3840
    v_mfma_f32_16x16x32_bf16 v[244:247], v[152:155], v[112:115], v[244:247]
    v_lshl_add_u32 v214, v216, 4, s62
    v_mfma_f32_16x16x32_bf16 v[240:243], v[152:155], v[104:107], v[240:243]
    s_add_u32 m0, s59, 52352
    ds_read_b64_tr_b16 v[144:145], v198 offset:4096
    v_mfma_f32_16x16x32_bf16 v[240:243], v[156:159], v[108:111], v[240:243]
    s_waitcnt lgkmcnt(5)
    ds_read_b64_tr_b16 v[146:147], v198 offset:4352
    v_mfma_f32_16x16x32_bf16 a[12:15], v[164:167], v[132:135], a[12:15]
    s_lshr_b32 s62, s58, 1
    buffer_load_dwordx4 v192, s[12:15], s65 offen lds
    v_mfma_f32_16x16x32_bf16 a[12:15], v[160:163], v[128:131], a[12:15]
    s_lshl_b32 s62, s62, 8
    ds_read_b64_tr_b16 v[148:149], v198 offset:5120
    v_mfma_f32_16x16x32_bf16 a[8:11], v[160:163], v[120:123], a[8:11]
    s_add_u32 m0, s59, 53376
    ds_read_b64_tr_b16 v[150:151], v198 offset:5376
    v_mfma_f32_16x16x32_bf16 a[8:11], v[164:167], v[124:127], a[8:11]
    s_lshl_b32 s63, s75, 2
    buffer_load_dword v193, s[12:15], s65 offen lds
    v_mfma_f32_16x16x32_bf16 a[4:7], v[164:167], v[116:119], a[4:7]
    s_add_u32 s62, s62, s63
    ds_read_b64_tr_b16 v[152:153], v198 offset:4608
    v_mfma_f32_16x16x32_bf16 a[4:7], v[160:163], v[112:115], a[4:7]
    s_add_u32 s62, s62, s60
    ds_read_b64_tr_b16 v[154:155], v198 offset:4864
    v_mfma_f32_16x16x32_bf16 a[0:3], v[160:163], v[104:107], a[0:3]
    s_add_u32 s62, s62, 4096
    v_mfma_f32_16x16x32_bf16 a[0:3], v[164:167], v[108:111], a[0:3]
    s_waitcnt lgkmcnt(6)
    ds_read_b64_tr_b16 v[156:157], v198 offset:5632
    v_mfma_f32_16x16x32_bf16 a[28:31], v[140:143], v[132:135], a[28:31]
    s_add_u32 m0, s59, 53632
    ds_read_b64_tr_b16 v[158:159], v198 offset:5888
    v_mfma_f32_16x16x32_bf16 a[28:31], v[136:139], v[128:131], a[28:31]
    buffer_load_dword v194, s[16:19], s66 offen lds
    v_mfma_f32_16x16x32_bf16 a[24:27], v[136:139], v[120:123], a[24:27]
    s_cmp_eq_u32 s53, 4
    s_cselect_b32 s62, s62, 1073741824
    ds_read_b64_tr_b16 v[160:161], v198 offset:6144
    v_mfma_f32_16x16x32_bf16 a[24:27], v[140:143], v[124:127], a[24:27]
    ds_read_b64_tr_b16 v[162:163], v198 offset:6400
    v_lshl_add_u32 v215, v216, 3, s62
    v_mfma_f32_16x16x32_bf16 a[20:23], v[140:143], v[116:119], a[20:23]
    v_mov_b32 v221, 1073741824
    v_cndmask_b32 v214, v221, v214, s[82:83]
    v_mfma_f32_16x16x32_bf16 a[20:23], v[136:139], v[112:115], a[20:23]
    ds_read_b64_tr_b16 v[164:165], v198 offset:7168
    v_cndmask_b32 v215, v221, v215, s[82:83]
    v_mfma_f32_16x16x32_bf16 a[16:19], v[136:139], v[104:107], a[16:19]
    s_add_u32 m0, s59, 46208
    ds_read_b64_tr_b16 v[166:167], v198 offset:7424
    v_mfma_f32_16x16x32_bf16 a[16:19], v[140:143], v[108:111], a[16:19]
    s_waitcnt lgkmcnt(8)
    buffer_load_dwordx4 v208, s[8:11], s67 offen lds
    v_mfma_f32_16x16x32_bf16 a[44:47], v[148:151], v[132:135], a[44:47]
    s_mul_i32 s62, s58, 1216
    ds_read_b64_tr_b16 v[136:137], v198 offset:6656
    v_mfma_f32_16x16x32_bf16 a[44:47], v[144:147], v[128:131], a[44:47]
    s_add_u32 s62, s62, s60
    ds_read_b64_tr_b16 v[138:139], v198 offset:6912
    v_mfma_f32_16x16x32_bf16 a[40:43], v[144:147], v[120:123], a[40:43]
    s_add_u32 s62, s62, 4480
    v_mfma_f32_16x16x32_bf16 a[40:43], v[148:151], v[124:127], a[40:43]
    s_xor_b32 s67, s67, 384
    ds_read_b64_tr_b16 v[140:141], v198 offset:7680
    v_mfma_f32_16x16x32_bf16 a[36:39], v[148:151], v[116:119], a[36:39]
    s_add_u32 m0, s59, 47232
    ds_read_b64_tr_b16 v[142:143], v198 offset:7936
    v_mfma_f32_16x16x32_bf16 a[36:39], v[144:147], v[112:115], a[36:39]
    buffer_load_dwordx4 v191, s[8:11], s67 offen lds
    v_mfma_f32_16x16x32_bf16 a[32:35], v[144:147], v[104:107], a[32:35]
    s_add_u32 m0, s59, 48256
    ds_read_b64_tr_b16 v[144:145], v198 offset:8192
    v_mfma_f32_16x16x32_bf16 a[32:35], v[148:151], v[108:111], a[32:35]
    s_waitcnt lgkmcnt(9)
    ds_read_b64_tr_b16 v[146:147], v198 offset:8448
    v_mfma_f32_16x16x32_bf16 a[60:63], v[156:159], v[132:135], a[60:63]
    buffer_load_dwordx4 v208, s[8:11], s67 offen lds
    v_mfma_f32_16x16x32_bf16 a[60:63], v[152:155], v[128:131], a[60:63]
    s_cmp_eq_u32 s53, 3
    s_cselect_b32 s63, 128, 0
    ds_read_b64_tr_b16 v[148:149], v198 offset:8704
    v_mfma_f32_16x16x32_bf16 a[56:59], v[152:155], v[120:123], a[56:59]
    ds_read_b64_tr_b16 v[150:151], v198 offset:8960
    v_mfma_f32_16x16x32_bf16 a[56:59], v[156:159], v[124:127], a[56:59]
    s_xor_b32 s67, s67, 128
    v_mfma_f32_16x16x32_bf16 a[52:55], v[156:159], v[116:119], a[52:55]
    s_waitcnt vmcnt(10)
    ds_add_u32 v11, v9
    v_mfma_f32_16x16x32_bf16 a[52:55], v[152:155], v[112:115], a[52:55]
    s_add_u32 m0, s59, 49280
    v_mfma_f32_16x16x32_bf16 a[48:51], v[152:155], v[104:107], a[48:51]
    buffer_load_dwordx4 v191, s[8:11], s67 offen lds
    v_mfma_f32_16x16x32_bf16 a[48:51], v[156:159], v[108:111], a[48:51]
    s_waitcnt lgkmcnt(9)
    v_mfma_f32_16x16x32_bf16 a[76:79], v[164:167], v[132:135], a[76:79]
    s_cmp_eq_u32 s53, 5
    s_cselect_b32 s63, 160, s63
    s_cselect_b32 s61, 13, 8
    s_cselect_b32 s60, 13, 99
    v_mfma_f32_16x16x32_bf16 a[76:79], v[160:163], v[128:131], a[76:79]
    s_add_u32 s62, s62, s63
    ds_read_b32 v6, v11
    v_mfma_f32_16x16x32_bf16 a[72:75], v[160:163], v[120:123], a[72:75]
    s_add_u32 m0, s59, 50304
    v_mfma_f32_16x16x32_bf16 a[72:75], v[164:167], v[124:127], a[72:75]
    s_lshr_b32 s63, 0x2c, s53
    buffer_load_dwordx4 v208, s[8:11], s67 offen lds
    v_mfma_f32_16x16x32_bf16 a[68:71], v[164:167], v[116:119], a[68:71]
    s_bitcmp1_b32 s63, 0
    s_cselect_b32 s61, s61, 99
    v_mul_u32_u24 v216, 304, v219
    v_mfma_f32_16x16x32_bf16 a[68:71], v[160:163], v[112:115], a[68:71]
    s_add_u32 m0, s72, 145792
    v_mfma_f32_16x16x32_bf16 a[64:67], v[160:163], v[104:107], a[64:67]
    s_waitcnt lgkmcnt(0)
    v_cmp_le_u32 vcc, 24, v6
    v_mfma_f32_16x16x32_bf16 a[64:67], v[164:167], v[108:111], a[64:67]
    s_waitcnt lgkmcnt(6)
    v_mfma_f32_16x16x32_bf16 a[92:95], v[140:143], v[132:135], a[92:95]
    s_cbranch_vccz L_espin5
L_eback5:
    ds_read_b128 v[80:83], v202 offset:2048
    v_mfma_f32_16x16x32_bf16 a[92:95], v[136:139], v[128:131], a[92:95]
    buffer_load_dwordx4 v195, s[4:7], s78 offen lds
    v_mfma_f32_16x16x32_bf16 a[88:91], v[136:139], v[120:123], a[88:91]
    ds_read_b128 v[84:87], v203 offset:2048
    v_mfma_f32_16x16x32_bf16 a[88:91], v[140:143], v[124:127], a[88:91]
    ds_read_b128 v[72:75], v202 offset:0
    v_mfma_f32_16x16x32_bf16 a[84:87], v[140:143], v[116:119], a[84:87]
    s_add_u32 m0, s72, 147840
    ds_read_b128 v[76:79], v203 offset:0
    v_mfma_f32_16x16x32_bf16 a[84:87], v[136:139], v[112:115], a[84:87]
    buffer_load_dwordx4 v195, s[4:7], s68 offen lds
    v_mfma_f32_16x16x32_bf16 a[80:83], v[136:139], v[104:107], a[80:83]
    ds_read_b64_tr_b16 v[152:153], v199 offset:0
    ds_read_b64_tr_b16 v[154:155], v199 offset:64
    v_mfma_f32_16x16x32_bf16 a[80:83], v[140:143], v[108:111], a[80:83]
    s_waitcnt lgkmcnt(8)
    ds_read_b64_tr_b16 v[156:157], v199 offset:128
    v_mfma_f32_16x16x32_bf16 a[108:111], v[148:151], v[132:135], a[108:111]
    s_add_u32 m0, s73, 145792
    ds_read_b64_tr_b16 v[158:159], v199 offset:192
    v_mfma_f32_16x16x32_bf16 a[108:111], v[144:147], v[128:131], a[108:111]
    buffer_load_dwordx4 v196, s[4:7], s78 offen lds
    v_mfma_f32_16x16x32_bf16 a[104:107], v[144:147], v[120:123], a[104:107]
    ds_read_b64_tr_b16 v[160:161], v197 offset:9216
    v_mfma_f32_16x16x32_bf16 a[104:107], v[148:151], v[124:127], a[104:107]
    ds_read_b64_tr_b16 v[162:163], v197 offset:9472
    v_mfma_f32_16x16x32_bf16 a[100:103], v[148:151], v[116:119], a[100:103]
    s_add_u32 m0, s73, 147840
    ds_read_b64_tr_b16 v[164:165], v197 offset:9728
    v_mfma_f32_16x16x32_bf16 a[100:103], v[144:147], v[112:115], a[100:103]
    buffer_load_dwordx4 v196, s[4:7], s68 offen lds
    v_mfma_f32_16x16x32_bf16 a[96:99], v[144:147], v[104:107], a[96:99]
    ds_read_b64_tr_b16 v[166:167], v197 offset:9984
    ds_read_b32 v174, v222 offset:0
    v_mfma_f32_16x16x32_bf16 a[96:99], v[148:151], v[108:111], a[96:99]
    s_waitcnt lgkmcnt(5)
    buffer_load_dword v173, v207, s[44:47], s78 offen
    v_mfma_f32_16x16x32_bf16 v[68:71], v[156:159], v[84:87], v[68:71]
    ds_read_b128 v[96:99], v204 offset:2048
    v_mfma_f32_16x16x32_bf16 v[68:71], v[152:155], v[80:83], v[68:71]
    ds_read_b128 v[100:103], v205 offset:2048
    v_mfma_f32_16x16x32_bf16 v[64:67], v[152:155], v[72:75], v[64:67]
    ds_read_b128 v[88:91], v204 offset:0
    v_lshl_add_u32 v216, v218, 4, v216
    v_mfma_f32_16x16x32_bf16 v[64:67], v[156:159], v[76:79], v[64:67]
    s_waitcnt lgkmcnt(3)
    ds_read_b128 v[92:95], v205 offset:0
    v_add_u32 v216, s62, v216
    v_mfma_f32_16x16x32_bf16 v[52:55], v[164:167], v[84:87], v[52:55]
    s_bfe_u32 s66, s77, 0x4001c
    ds_read_b64_tr_b16 v[136:137], v197 offset:0
    ds_read_b64_tr_b16 v[138:139], v197 offset:256
    v_mfma_f32_16x16x32_bf16 v[52:55], v[160:163], v[80:83], v[52:55]
    s_mul_i32 s64, s66, 589824
    ds_read_b64_tr_b16 v[140:141], v197 offset:1024
    v_cmp_eq_u32 s[82:83], s60, v218
    v_mfma_f32_16x16x32_bf16 v[48:51], v[160:163], v[72:75], v[48:51]
    s_mul_i32 s65, s66, 73728
    ds_read_b64_tr_b16 v[142:143], v197 offset:1280
    s_add_u32 m0, s59, 94464
    v_mfma_f32_16x16x32_bf16 v[48:51], v[164:167], v[76:79], v[48:51]
    s_waitcnt lgkmcnt(4)
    buffer_load_dwordx4 v206, s[8:11], s64 offen lds
    v_mfma_f32_16x16x32_bf16 v[60:63], v[164:167], v[100:103], v[60:63]
    s_lshl_b32 s78, s66, 7
    ds_read_b64_tr_b16 v[144:145], v197 offset:512
    v_lshlrev_b32 v178, 16, v174
    v_mfma_f32_16x16x32_bf16 v[60:63], v[160:163], v[96:99], v[60:63]
    s_add_u32 s68, s78, 18432
    ds_read_b64_tr_b16 v[146:147], v197 offset:768
    s_add_u32 s67, s64, s71
    s_add_u32 m0, s59, 86272
    v_mfma_f32_16x16x32_bf16 v[56:59], v[160:163], v[88:91], v[56:59]
    buffer_load_dwordx4 v191, s[8:11], s67 offen lds
    v_mfma_f32_16x16x32_bf16 v[56:59], v[164:167], v[92:95], v[56:59]
    s_waitcnt lgkmcnt(2)
    ds_read_b64_tr_b16 v[148:149], v197 offset:1536
    v_lshlrev_b32 v179, 16, v172
    v_mfma_f32_16x16x32_bf16 v[236:239], v[140:143], v[100:103], v[236:239]
    ds_read_b64_tr_b16 v[150:151], v197 offset:1792
    v_and_b32 v180, 0xffff0000, v174
    v_mfma_f32_16x16x32_bf16 v[236:239], v[136:139], v[96:99], v[236:239]
    v_and_b32 v181, 0xffff0000, v172
    v_fmac_f32 v177, v178, v179
    v_mfma_f32_16x16x32_bf16 v[232:235], v[136:139], v[88:91], v[232:235]
    s_mul_i32 s66, s66, 2304
    ds_read_b64_tr_b16 v[152:153], v197 offset:2048
    v_fmac_f32 v177, v180, v181
    v_mfma_f32_16x16x32_bf16 v[232:235], v[140:143], v[92:95], v[232:235]
    s_add_u32 m0, s59, 87296
    ds_read_b64_tr_b16 v[154:155], v197 offset:2304
    v_add_u32 v219, 48, v216
    v_mfma_f32_16x16x32_bf16 v[228:231], v[140:143], v[84:87], v[228:231]
    buffer_load_dwordx4 v208, s[8:11], s67 offen lds
    v_mfma_f32_16x16x32_bf16 v[228:231], v[136:139], v[80:83], v[228:231]
    ds_read_b64_tr_b16 v[156:157], v197 offset:3072
    v_cmp_le_u32 s[54:55], s61, v218
    v_mfma_f32_16x16x32_bf16 v[224:227], v[136:139], v[72:75], v[224:227]
    ds_read_b64_tr_b16 v[158:159], v197 offset:3328
    v_cndmask_b32 v216, v216, v219, s[82:83]
    v_mfma_f32_16x16x32_bf16 v[224:227], v[140:143], v[76:79], v[224:227]
    s_waitcnt lgkmcnt(4)
    v_mov_b32 v218, 0x3f803f80
    v_cndmask_b32 v216, v221, v216, s[54:55]
    v_mfma_f32_16x16x32_bf16 v[252:255], v[148:151], v[100:103], v[252:255]
    s_xor_b32 s67, s67, 128
    ds_read_b64_tr_b16 v[160:161], v197 offset:2560
    v_lshrrev_b32 v219, 5, v0
    v_mfma_f32_16x16x32_bf16 v[252:255], v[144:147], v[96:99], v[252:255]
    s_add_u32 m0, s59, 88320
    ds_read_b64_tr_b16 v[162:163], v197 offset:2816
    v_lshlrev_b32 v189, 1, v207
    v_mfma_f32_16x16x32_bf16 v[248:251], v[144:147], v[88:91], v[248:251]
    buffer_load_dwordx4 v191, s[8:11], s67 offen lds
    v_mfma_f32_16x16x32_bf16 v[248:251], v[148:151], v[92:95], v[248:251]
    ds_read_b64_tr_b16 v[164:165], v197 offset:3584
    v_lshl_add_u32 v189, v219, 30, v189
    v_mfma_f32_16x16x32_bf16 v[244:247], v[148:151], v[84:87], v[244:247]
    ds_read_b64_tr_b16 v[166:167], v197 offset:3840
    v_lshl_add_u32 v219, v219, 4, v212
    v_mfma_f32_16x16x32_bf16 v[244:247], v[144:147], v[80:83], v[244:247]
    v_mfma_f32_16x16x32_bf16 v[240:243], v[144:147], v[72:75], v[240:243]
    s_add_u32 m0, s59, 95488
    ds_read_b64_tr_b16 v[136:137], v197 offset:4096
    v_mfma_f32_16x16x32_bf16 v[240:243], v[148:151], v[76:79], v[240:243]
    s_waitcnt lgkmcnt(5)
    ds_read_b64_tr_b16 v[138:139], v197 offset:4352
    v_mfma_f32_16x16x32_bf16 a[12:15], v[156:159], v[100:103], a[12:15]
    buffer_load_dwordx4 v192, s[12:15], s65 offen lds
    v_mfma_f32_16x16x32_bf16 a[12:15], v[152:155], v[96:99], a[12:15]
    ds_read_b64_tr_b16 v[140:141], v197 offset:5120
    v_mfma_f32_16x16x32_bf16 a[8:11], v[152:155], v[88:91], a[8:11]
    s_add_u32 m0, s59, 96512
    ds_read_b64_tr_b16 v[142:143], v197 offset:5376
    v_mfma_f32_16x16x32_bf16 a[8:11], v[156:159], v[92:95], a[8:11]
    buffer_load_dword v193, s[12:15], s65 offen lds
    v_mfma_f32_16x16x32_bf16 a[4:7], v[156:159], v[84:87], a[4:7]
    ds_read_b64_tr_b16 v[144:145], v197 offset:4608
    v_mfma_f32_16x16x32_bf16 a[4:7], v[152:155], v[80:83], a[4:7]
    ds_read_b64_tr_b16 v[146:147], v197 offset:4864
    v_mfma_f32_16x16x32_bf16 a[0:3], v[152:155], v[72:75], a[0:3]
    v_mfma_f32_16x16x32_bf16 a[0:3], v[156:159], v[76:79], a[0:3]
    s_waitcnt lgkmcnt(6)
    ds_read_b64_tr_b16 v[148:149], v197 offset:5632
    v_mfma_f32_16x16x32_bf16 a[28:31], v[164:167], v[100:103], a[28:31]
    s_add_u32 m0, s59, 96768
    ds_read_b64_tr_b16 v[150:151], v197 offset:5888
    v_mfma_f32_16x16x32_bf16 a[28:31], v[160:163], v[96:99], a[28:31]
    buffer_load_dword v194, s[16:19], s66 offen lds
    v_mfma_f32_16x16x32_bf16 a[24:27], v[160:163], v[88:91], a[24:27]
    ds_read_b64_tr_b16 v[152:153], v197 offset:6144
    v_mfma_f32_16x16x32_bf16 a[24:27], v[164:167], v[92:95], a[24:27]
    ds_read_b64_tr_b16 v[154:155], v197 offset:6400
    v_mfma_f32_16x16x32_bf16 a[20:23], v[164:167], v[84:87], a[20:23]
    v_mfma_f32_16x16x32_bf16 a[20:23], v[160:163], v[80:83], a[20:23]
    ds_read_b64_tr_b16 v[156:157], v197 offset:7168
    v_mfma_f32_16x16x32_bf16 a[16:19], v[160:163], v[72:75], a[16:19]
    s_add_u32 m0, s59, 89344
    ds_read_b64_tr_b16 v[158:159], v197 offset:7424
    v_mfma_f32_16x16x32_bf16 a[16:19], v[164:167], v[76:79], a[16:19]
    s_waitcnt lgkmcnt(8)
    buffer_load_dwordx4 v208, s[8:11], s67 offen lds
    v_mfma_f32_16x16x32_bf16 a[44:47], v[140:143], v[100:103], a[44:47]
    ds_read_b64_tr_b16 v[160:161], v197 offset:6656
    v_mfma_f32_16x16x32_bf16 a[44:47], v[136:139], v[96:99], a[44:47]
    ds_read_b64_tr_b16 v[162:163], v197 offset:6912
    v_mfma_f32_16x16x32_bf16 a[40:43], v[136:139], v[88:91], a[40:43]
    v_mfma_f32_16x16x32_bf16 a[40:43], v[140:143], v[92:95], a[40:43]
    s_xor_b32 s67, s67, 384
    ds_read_b64_tr_b16 v[164:165], v197 offset:7680
    v_mfma_f32_16x16x32_bf16 a[36:39], v[140:143], v[84:87], a[36:39]
    s_add_u32 m0, s59, 90368
    ds_read_b64_tr_b16 v[166:167], v197 offset:7936
    v_mfma_f32_16x16x32_bf16 a[36:39], v[136:139], v[80:83], a[36:39]
    buffer_load_dwordx4 v191, s[8:11], s67 offen lds
    v_mfma_f32_16x16x32_bf16 a[32:35], v[136:139], v[72:75], a[32:35]
    s_add_u32 m0, s59, 91392
    ds_read_b64_tr_b16 v[136:137], v197 offset:8192
    v_mfma_f32_16x16x32_bf16 a[32:35], v[140:143], v[76:79], a[32:35]
    s_waitcnt lgkmcnt(9)
    ds_read_b64_tr_b16 v[138:139], v197 offset:8448
    v_mfma_f32_16x16x32_bf16 a[60:63], v[148:151], v[100:103], a[60:63]
    buffer_load_dwordx4 v208, s[8:11], s67 offen lds
    v_mfma_f32_16x16x32_bf16 a[60:63], v[144:147], v[96:99], a[60:63]
    ds_read_b64_tr_b16 v[140:141], v197 offset:8704
    v_mfma_f32_16x16x32_bf16 a[56:59], v[144:147], v[88:91], a[56:59]
    ds_read_b64_tr_b16 v[142:143], v197 offset:8960
    v_mfma_f32_16x16x32_bf16 a[56:59], v[148:151], v[92:95], a[56:59]
    s_xor_b32 s67, s67, 128
    v_mfma_f32_16x16x32_bf16 a[52:55], v[148:151], v[84:87], a[52:55]
    s_waitcnt vmcnt(10)
    ds_add_u32 v11, v9
    v_mfma_f32_16x16x32_bf16 a[52:55], v[144:147], v[80:83], a[52:55]
    s_add_u32 m0, s59, 92416
    v_mfma_f32_16x16x32_bf16 a[48:51], v[144:147], v[72:75], a[48:51]
    buffer_load_dwordx4 v191, s[8:11], s67 offen lds
    v_mfma_f32_16x16x32_bf16 a[48:51], v[148:151], v[76:79], a[48:51]
    s_waitcnt lgkmcnt(9)
    v_mfma_f32_16x16x32_bf16 a[76:79], v[156:159], v[100:103], a[76:79]
    v_mfma_f32_16x16x32_bf16 a[76:79], v[152:155], v[96:99], a[76:79]
    ds_read_b32 v6, v11
    v_mfma_f32_16x16x32_bf16 a[72:75], v[152:155], v[88:91], a[72:75]
    s_add_u32 m0, s59, 93440
    v_mfma_f32_16x16x32_bf16 a[72:75], v[156:159], v[92:95], a[72:75]
    buffer_load_dwordx4 v208, s[8:11], s67 offen lds
    v_mfma_f32_16x16x32_bf16 a[68:71], v[156:159], v[84:87], a[68:71]
    v_mfma_f32_16x16x32_bf16 a[68:71], v[152:155], v[80:83], a[68:71]
    s_add_u32 m0, s72, 129408
    v_mfma_f32_16x16x32_bf16 a[64:67], v[152:155], v[72:75], a[64:67]
    s_waitcnt lgkmcnt(0)
    v_cmp_le_u32 vcc, 28, v6
    v_mfma_f32_16x16x32_bf16 a[64:67], v[156:159], v[76:79], a[64:67]
    s_waitcnt lgkmcnt(6)
    v_mfma_f32_16x16x32_bf16 a[92:95], v[164:167], v[100:103], a[92:95]
    s_cbranch_vccz L_espin6
L_eback6:
    ds_read_b128 v[112:115], v202 offset:18432
    v_mfma_f32_16x16x32_bf16 a[92:95], v[160:163], v[96:99], a[92:95]
    buffer_load_dwordx4 v195, s[4:7], s78 offen lds
    v_mfma_f32_16x16x32_bf16 a[88:91], v[160:163], v[88:91], a[88:91]
    ds_read_b128 v[116:119], v203 offset:18432
    v_mfma_f32_16x16x32_bf16 a[88:91], v[164:167], v[92:95], a[88:91]
L_pe0:
L_r2:
    s_cbranch_execz L_q4
    ds_read_b128 v[104:107], v202 offset:16384
    v_mfma_f32_16x16x32_bf16 a[84:87], v[164:167], v[84:87], a[84:87]
    s_add_u32 m0, s72, 131456
    ds_read_b128 v[108:111], v203 offset:16384
    v_mfma_f32_16x16x32_bf16 a[84:87], v[160:163], v[80:83], a[84:87]
    buffer_load_dwordx4 v195, s[4:7], s68 offen lds
    v_mfma_f32_16x16x32_bf16 a[80:83], v[160:163], v[72:75], a[80:83]
    ds_read_b64_tr_b16 v[144:145], v199 offset:43136
    ds_read_b64_tr_b16 v[146:147], v199 offset:43200
    v_mfma_f32_16x16x32_bf16 a[80:83], v[164:167], v[76:79], a[80:83]
    s_waitcnt lgkmcnt(8)
    ds_read_b64_tr_b16 v[148:149], v199 offset:43264
    v_mfma_f32_16x16x32_bf16 a[108:111], v[140:143], v[100:103], a[108:111]
    s_add_u32 m0, s73, 129408
    ds_read_b64_tr_b16 v[150:151], v199 offset:43328
    v_mfma_f32_16x16x32_bf16 a[108:111], v[136:139], v[96:99], a[108:111]
    buffer_load_dwordx4 v196, s[4:7], s78 offen lds
    v_mfma_f32_16x16x32_bf16 a[104:107], v[136:139], v[88:91], a[104:107]
    ds_read_b64_tr_b16 v[152:153], v197 offset:52352
    v_mfma_f32_16x16x32_bf16 a[104:107], v[140:143], v[92:95], a[104:107]
    ds_read_b64_tr_b16 v[154:155], v197 offset:52608
    v_mfma_f32_16x16x32_bf16 a[100:103], v[140:143], v[84:87], a[100:103]
    s_add_u32 m0, s73, 131456
    ds_read_b64_tr_b16 v[156:157], v197 offset:52864
    v_mfma_f32_16x16x32_bf16 a[100:103], v[136:139], v[80:83], a[100:103]
    buffer_load_dwordx4 v196, s[4:7], s68 offen lds
    v_mfma_f32_16x16x32_bf16 a[96:99], v[136:139], v[72:75], a[96:99]
    ds_read_b64_tr_b16 v[158:159], v197 offset:53120
    ds_read_b32 v174, v222 offset:16384
    v_mfma_f32_16x16x32_bf16 a[96:99], v[140:143], v[76:79], a[96:99]
    s_waitcnt lgkmcnt(5)
    buffer_load_dword v172, v207, s[44:47], s78 offen
    v_mfma_f32_16x16x32_bf16 v[68:71], v[148:151], v[116:119], v[68:71]
    s_xor_b32 s64, s71, 0
    ds_read_b128 v[128:131], v204 offset:18432
    v_mfma_f32_16x16x32_bf16 v[68:71], v[144:147], v[112:115], v[68:71]
    s_mul_i32 s64, s64, 576
    ds_read_b128 v[132:135], v205 offset:18432
    v_mfma_f32_16x16x32_bf16 v[64:67], v[144:147], v[104:107], v[64:67]
    s_add_u32 m0, s59, 0
    ds_read_b128 v[120:123], v204 offset:16384
    s_lshr_b32 s19, s100, 1
    v_mfma_f32_16x16x32_bf16 v[64:67], v[148:151], v[108:111], v[64:67]
    s_waitcnt lgkmcnt(3)
    ds_read_b128 v[124:127], v205 offset:16384
    buffer_load_dwordx4 v2, s[20:23], s64 offen offset:0 lds
    v_mfma_f32_16x16x32_bf16 v[52:55], v[156:159], v[116:119], v[52:55]
    s_lshl3_add_u32 s19, s56, s19
    ds_read_b64_tr_b16 v[160:161], v197 offset:43136
    ds_read_b64_tr_b16 v[162:163], v197 offset:43392
    v_mfma_f32_16x16x32_bf16 v[52:55], v[152:155], v[112:115], v[52:55]
    s_lshl2_add_u32 s19, s19, s58
    ds_read_b64_tr_b16 v[164:165], v197 offset:44160
    s_lshl_b32 s19, s19, 8
    v_mfma_f32_16x16x32_bf16 v[48:51], v[152:155], v[104:107], v[48:51]
    s_add_u32 m0, s59, 896
    ds_read_b64_tr_b16 v[166:167], v197 offset:44416
    s_add_u32 s19, s19, 3407872
    v_mfma_f32_16x16x32_bf16 v[48:51], v[156:159], v[108:111], v[48:51]
    s_waitcnt lgkmcnt(4)
    buffer_load_dwordx4 v2, s[20:23], s64 offen offset:128 lds
    v_mfma_f32_16x16x32_bf16 v[60:63], v[156:159], v[132:135], v[60:63]
    s_lshl_b32 s72, s58, 10
    ds_read_b64_tr_b16 v[136:137], v197 offset:43648
    v_lshlrev_b32 v178, 16, v174
    v_mfma_f32_16x16x32_bf16 v[60:63], v[152:155], v[128:131], v[60:63]
    s_add_u32 m0, s59, 1792
    ds_read_b64_tr_b16 v[138:139], v197 offset:43904
    v_lshlrev_b32 v179, 16, v173
    v_mfma_f32_16x16x32_bf16 v[56:59], v[152:155], v[120:123], v[56:59]
    s_mul_i32 s73, s58, 20768
    buffer_load_dwordx4 v2, s[20:23], s64 offen offset:256 lds
    v_mfma_f32_16x16x32_bf16 v[56:59], v[156:159], v[124:127], v[56:59]
    s_waitcnt lgkmcnt(2)
    ds_read_b64_tr_b16 v[140:141], v197 offset:44672
    v_and_b32 v180, 0xffff0000, v174
    v_mfma_f32_16x16x32_bf16 v[236:239], v[164:167], v[132:135], v[236:239]
    s_add_u32 m0, s59, 2688
    ds_read_b64_tr_b16 v[142:143], v197 offset:44928
    v_and_b32 v181, 0xffff0000, v173
    v_mfma_f32_16x16x32_bf16 v[236:239], v[160:163], v[128:131], v[236:239]
    s_add_u32 s73, s73, 61440
    buffer_load_dwordx4 v2, s[20:23], s64 offen offset:384 lds
    v_mfma_f32_16x16x32_bf16 v[232:235], v[160:163], v[120:123], v[232:235]
    s_lshl_b32 s55, s56, 4
    ds_read_b64_tr_b16 v[144:145], v197 offset:45184
    v_fmac_f32 v177, v178, v179
    v_mfma_f32_16x16x32_bf16 v[232:235], v[164:167], v[124:127], v[232:235]
    ds_read_b64_tr_b16 v[146:147], v197 offset:45440
    v_fmac_f32 v177, v180, v181
    v_mfma_f32_16x16x32_bf16 v[228:231], v[164:167], v[116:119], v[228:231]
    s_cmp_lt_u32 s53, 8
    s_cselect_b32 s55, s55, 0x1000
    v_mfma_f32_16x16x32_bf16 v[228:231], v[160:163], v[112:115], v[228:231]
    s_cmp_eq_u32 s58, 0
    s_cselect_b32 s55, s55, 0x1000
    ds_read_b64_tr_b16 v[148:149], v197 offset:46208
    v_mfma_f32_16x16x32_bf16 v[224:227], v[160:163], v[104:107], v[224:227]
    s_add_u32 m0, s59, 3584
    ds_read_b64_tr_b16 v[150:151], v197 offset:46464
    s_lshl_b32 s62, s56, 5
    v_mfma_f32_16x16x32_bf16 v[224:227], v[164:167], v[108:111], v[224:227]
    s_waitcnt lgkmcnt(4)
    buffer_load_dwordx4 v2, s[20:23], s64 offen offset:512 lds
    v_mfma_f32_16x16x32_bf16 v[252:255], v[140:143], v[132:135], v[252:255]
    s_add_u32 s62, s62, s57
    ds_read_b64_tr_b16 v[152:153], v197 offset:45696
    s_mul_i32 s62, s62, 73728
    v_mfma_f32_16x16x32_bf16 v[252:255], v[136:139], v[128:131], v[252:255]
    s_add_u32 m0, s59, 4480
    ds_read_b64_tr_b16 v[154:155], v197 offset:45952
    s_lshr_b32 s63, s58, 1
    v_mfma_f32_16x16x32_bf16 v[248:251], v[136:139], v[120:123], v[248:251]
    s_mul_i32 s63, s63, 36864
    buffer_load_dwordx4 v2, s[20:23], s64 offen offset:640 lds
    v_mfma_f32_16x16x32_bf16 v[248:251], v[140:143], v[124:127], v[248:251]
    s_add_u32 s62, s62, s63
    ds_read_b64_tr_b16 v[156:157], v197 offset:46720
    s_add_u32 s62, s62, 4194304
    v_mfma_f32_16x16x32_bf16 v[244:247], v[140:143], v[116:119], v[244:247]
    s_add_u32 m0, s59, 5376
    ds_read_b64_tr_b16 v[158:159], v197 offset:46976
    s_mul_i32 s63, s75, 1179648
    v_mfma_f32_16x16x32_bf16 v[244:247], v[136:139], v[112:115], v[244:247]
    s_add_u32 s18, s62, s63
    buffer_load_dwordx4 v2, s[20:23], s64 offen offset:768 lds
    v_mfma_f32_16x16x32_bf16 v[240:243], v[136:139], v[104:107], v[240:243]
    s_sub_u32 s37, s62, s63
    ds_read_b64_tr_b16 v[160:161], v197 offset:47232
    s_add_u32 s37, s37, 1179648
    v_mfma_f32_16x16x32_bf16 v[240:243], v[140:143], v[108:111], v[240:243]
    s_waitcnt lgkmcnt(5)
    ds_read_b64_tr_b16 v[162:163], v197 offset:47488
    s_mul_i32 s63, s75, 20480
    v_mfma_f32_16x16x32_bf16 a[12:15], v[148:151], v[132:135], a[12:15]
    s_add_u32 s36, s18, s63
    s_add_u32 s37, s37, s63
    s_add_u32 s18, s18, 16384
    v_mfma_f32_16x16x32_bf16 a[12:15], v[144:147], v[128:131], a[12:15]
    s_lshl_b32 s63, s56, 1
    ds_read_b64_tr_b16 v[164:165], v197 offset:48256
    s_lshr_b32 s62, s57, 3
    v_mfma_f32_16x16x32_bf16 a[8:11], v[144:147], v[120:123], a[8:11]
    s_add_u32 m0, s59, 6272
    ds_read_b64_tr_b16 v[166:167], v197 offset:48512
    s_add_u32 s63, s63, s62
    v_mfma_f32_16x16x32_bf16 a[8:11], v[148:151], v[124:127], a[8:11]
    s_mul_i32 s38, s63, 1179648
    buffer_load_dwordx4 v2, s[20:23], s64 offen offset:896 lds
    v_mfma_f32_16x16x32_bf16 a[4:7], v[148:151], v[116:119], a[4:7]
    s_lshl_b32 s54, s63, 2
    ds_read_b64_tr_b16 v[136:137], v197 offset:47744
    s_add_u32 s54, s54, s58
    v_mfma_f32_16x16x32_bf16 a[4:7], v[144:147], v[112:115], a[4:7]
    s_add_u32 m0, s59, 7168
    ds_read_b64_tr_b16 v[138:139], v197 offset:48000
    s_lshl_b32 s47, s54, 11
    v_mfma_f32_16x16x32_bf16 a[0:3], v[144:147], v[104:107], a[0:3]
    s_add_u32 s47, s47, 3145852
    buffer_load_dwordx4 v2, s[20:23], s64 offen offset:1024 lds
    v_mfma_f32_16x16x32_bf16 a[0:3], v[148:151], v[108:111], a[0:3]
    s_waitcnt lgkmcnt(6)
    ds_read_b64_tr_b16 v[140:141], v197 offset:48768
    s_lshr_b32 s53, s54, 1
    v_mfma_f32_16x16x32_bf16 a[28:31], v[156:159], v[132:135], a[28:31]
    s_and_b32 s66, s57, 1
    ds_read_b64_tr_b16 v[142:143], v197 offset:49024
    s_mul_i32 s66, s66, -331776
    v_mfma_f32_16x16x32_bf16 a[28:31], v[152:155], v[128:131], a[28:31]
    s_add_u32 s66, s66, 294912
    s_mul_i32 s53, s53, 36864
    s_add_u32 s53, s53, 655360
    v_mfma_f32_16x16x32_bf16 a[24:27], v[152:155], v[120:123], a[24:27]
    s_mul_i32 s54, s54, 18432
    ds_read_b64_tr_b16 v[144:145], v197 offset:49280
    s_lshl_b32 s45, s56, 5
    v_mfma_f32_16x16x32_bf16 a[24:27], v[156:159], v[124:127], a[24:27]
    s_add_u32 s45, s45, s62
    ds_read_b64_tr_b16 v[146:147], v197 offset:49536
    s_lshl_b32 s45, s45, 1
    v_mfma_f32_16x16x32_bf16 a[20:23], v[156:159], v[116:119], a[20:23]
    s_bfe_u32 s62, s57, 0x10002
    s_lshl_b32 s44, s56, 5
    s_add_u32 s44, s44, s62
    v_mfma_f32_16x16x32_bf16 a[20:23], v[152:155], v[112:115], a[20:23]
    s_lshl_b32 s44, s44, 8
    ds_read_b64_tr_b16 v[148:149], v197 offset:50304
    s_add_u32 s44, s44, 196608
    v_mfma_f32_16x16x32_bf16 a[16:19], v[152:155], v[104:107], a[16:19]
    s_lshr_b32 s62, s58, 1
    ds_read_b64_tr_b16 v[150:151], v197 offset:50560
    s_add_u32 s45, s45, s62
    v_mfma_f32_16x16x32_bf16 a[16:19], v[156:159], v[108:111], a[16:19]
    s_waitcnt lgkmcnt(8)
    s_lshl_b32 s45, s45, 7
    s_add_u32 s45, s45, 327680
    v_mfma_f32_16x16x32_bf16 a[44:47], v[164:167], v[132:135], a[44:47]
    s_lshl_b32 s62, s56, 2
    ds_read_b64_tr_b16 v[152:153], v197 offset:49792
    s_add_u32 s62, s62, s58
    v_mfma_f32_16x16x32_bf16 a[44:47], v[160:163], v[128:131], a[44:47]
    s_lshl_b32 s46, s62, 12
    ds_read_b64_tr_b16 v[154:155], v197 offset:50048
    s_add_u32 s46, s46, 3145852
    v_mfma_f32_16x16x32_bf16 a[40:43], v[160:163], v[120:123], a[40:43]
    s_mul_i32 s52, s62, 36864
    s_add_u32 s52, s52, 655360
    s_and_b32 s62, s57, 7
    v_mfma_f32_16x16x32_bf16 a[40:43], v[164:167], v[124:127], a[40:43]
    s_mul_i32 s62, s62, 144
    ds_read_b64_tr_b16 v[156:157], v197 offset:50816
    s_add_u32 s54, s54, s62
    v_mfma_f32_16x16x32_bf16 a[36:39], v[164:167], v[116:119], a[36:39]
    s_and_b32 s63, s57, 1
    ds_read_b64_tr_b16 v[158:159], v197 offset:51072
    s_lshl_b32 s60, s63, 4
    v_mfma_f32_16x16x32_bf16 a[36:39], v[160:163], v[112:115], a[36:39]
    s_add_u32 s60, s60, s62
    s_xor_b32 s63, s63, 1
    s_lshl_b32 s61, s63, 7
    v_mfma_f32_16x16x32_bf16 a[32:35], v[160:163], v[104:107], a[32:35]
    s_add_u32 s61, s61, s62
    ds_read_b64_tr_b16 v[160:161], v197 offset:51328
    s_lshl_b32 s62, s58, 8
    v_mfma_f32_16x16x32_bf16 a[32:35], v[164:167], v[108:111], a[32:35]
    s_waitcnt lgkmcnt(9)
    ds_read_b64_tr_b16 v[162:163], v197 offset:51584
    s_add_u32 s38, s38, s62
    v_mfma_f32_16x16x32_bf16 a[60:63], v[140:143], v[132:135], a[60:63]
    s_add_u32 s38, s38, 4194304
    s_lshl_b32 s62, s61, 6
    s_add_u32 s39, s38, s62
    v_mfma_f32_16x16x32_bf16 a[60:63], v[136:139], v[128:131], a[60:63]
    s_lshl_b32 s62, s60, 6
    ds_read_b64_tr_b16 v[164:165], v197 offset:51840
    s_add_u32 s38, s38, s62
    v_mfma_f32_16x16x32_bf16 a[56:59], v[136:139], v[120:123], a[56:59]
    s_lshl_b32 s4, s100, 10
    ds_read_b64_tr_b16 v[166:167], v197 offset:52096
    s_add_u32 s4, s4, s52
    v_mfma_f32_16x16x32_bf16 a[56:59], v[140:143], v[124:127], a[56:59]
    s_lshl_b32 s5, s100, 7
    s_add_u32 s5, s5, s52
    s_add_u32 s5, s5, 16384
    v_mfma_f32_16x16x32_bf16 a[52:55], v[140:143], v[116:119], a[52:55]
    s_waitcnt vmcnt(9)
    ds_add_u32 v11, v9
    s_add_u32 s7, s4, 18432
    v_mfma_f32_16x16x32_bf16 a[52:55], v[136:139], v[112:115], a[52:55]
    s_add_u32 s8, s5, 18432
    s_mov_b32 s6, s3
    s_sub_u32 s9, s45, 131072
    v_mfma_f32_16x16x32_bf16 a[48:51], v[136:139], v[104:107], a[48:51]
    s_lshl_b32 s62, s76, 12
    s_add_u32 s13, s62, s53
    s_xor_b32 s63, s62, 4096
    v_mfma_f32_16x16x32_bf16 a[48:51], v[140:143], v[108:111], a[48:51]
    s_waitcnt lgkmcnt(9)
    s_add_u32 s14, s63, s53
    s_xor_b32 s63, s62, 8192
    v_mfma_f32_16x16x32_bf16 a[76:79], v[148:151], v[132:135], a[76:79]
    s_add_u32 s15, s63, s53
    s_xor_b32 s63, s62, 12288
    s_add_u32 s16, s63, s53
    v_mfma_f32_16x16x32_bf16 a[76:79], v[144:147], v[128:131], a[76:79]
    s_add_u32 s17, s53, 16384
    ds_read_b32 v6, v11
    s_mov_b32 s10, 0x45000000
    v_mfma_f32_16x16x32_bf16 a[72:75], v[144:147], v[120:123], a[72:75]
    s_mov_b32 s11, 0x45000000
    v_mfma_f32_16x16x32_bf16 a[72:75], v[148:151], v[124:127], a[72:75]
    v_mfma_f32_16x16x32_bf16 a[68:71], v[148:151], v[116:119], a[68:71]
    v_mfma_f32_16x16x32_bf16 a[68:71], v[144:147], v[112:115], a[68:71]
    v_mfma_f32_16x16x32_bf16 a[64:67], v[144:147], v[104:107], a[64:67]
    s_waitcnt lgkmcnt(0)
    v_cmp_le_u32 vcc, 32, v6
    v_mfma_f32_16x16x32_bf16 a[64:67], v[148:151], v[108:111], a[64:67]
    s_waitcnt lgkmcnt(6)
    v_mfma_f32_16x16x32_bf16 a[92:95], v[156:159], v[132:135], a[92:95]
    s_cbranch_vccz L_espin7
L_eback7:
    ds_read_b128 v[80:83], v202 offset:2048
    v_mfma_f32_16x16x32_bf16 a[92:95], v[152:155], v[128:131], a[92:95]
    buffer_store_dwordx4 v[168:171], v175, s[28:31], 0 offen sc1
    v_mfma_f32_16x16x32_bf16 a[88:91], v[152:155], v[120:123], a[88:91]
    ds_read_b128 v[84:87], v203 offset:2048
    v_mfma_f32_16x16x32_bf16 a[88:91], v[156:159], v[124:127], a[88:91]
    ds_read_b128 v[72:75], v202 offset:0
    v_mfma_f32_16x16x32_bf16 a[84:87], v[156:159], v[116:119], a[84:87]
    ds_read_b128 v[76:79], v203 offset:0
    v_mfma_f32_16x16x32_bf16 a[84:87], v[152:155], v[112:115], a[84:87]
    buffer_store_dwordx4 v[184:187], v182, s[28:31], 0 offen sc1
    v_mfma_f32_16x16x32_bf16 a[80:83], v[152:155], v[104:107], a[80:83]
    ds_read_b64_tr_b16 v[136:137], v200 offset:0
    ds_read_b64_tr_b16 v[138:139], v200 offset:64
    v_mfma_f32_16x16x32_bf16 a[80:83], v[156:159], v[108:111], a[80:83]
    s_waitcnt lgkmcnt(8)
    ds_read_b64_tr_b16 v[140:141], v200 offset:128
    v_mfma_f32_16x16x32_bf16 a[108:111], v[164:167], v[132:135], a[108:111]
    ds_read_b64_tr_b16 v[142:143], v200 offset:192
    v_mfma_f32_16x16x32_bf16 a[108:111], v[160:163], v[128:131], a[108:111]
    buffer_store_dword v184, v183, s[28:31], 0 offen sc1
    v_mfma_f32_16x16x32_bf16 a[104:107], v[160:163], v[120:123], a[104:107]
    ds_read_b64_tr_b16 v[144:145], v198 offset:9216
    v_mfma_f32_16x16x32_bf16 a[104:107], v[164:167], v[124:127], a[104:107]
    ds_read_b64_tr_b16 v[146:147], v198 offset:9472
    v_mfma_f32_16x16x32_bf16 a[100:103], v[164:167], v[116:119], a[100:103]
    ds_read_b64_tr_b16 v[148:149], v198 offset:9728
    v_mfma_f32_16x16x32_bf16 a[100:103], v[160:163], v[112:115], a[100:103]
    global_load_dword v8, v12, s[0:1]
    v_mfma_f32_16x16x32_bf16 a[96:99], v[160:163], v[104:107], a[96:99]
    ds_read_b64_tr_b16 v[150:151], v198 offset:9984
    ds_read_b32 v174, v222 offset:0
    v_mfma_f32_16x16x32_bf16 a[96:99], v[164:167], v[108:111], a[96:99]
    s_waitcnt lgkmcnt(5)
    v_mfma_f32_16x16x32_bf16 v[68:71], v[140:143], v[84:87], v[68:71]
    ds_read_b128 v[96:99], v204 offset:2048
    v_mfma_f32_16x16x32_bf16 v[68:71], v[136:139], v[80:83], v[68:71]
    ds_read_b128 v[100:103], v205 offset:2048
    v_mfma_f32_16x16x32_bf16 v[64:67], v[136:139], v[72:75], v[64:67]
    ds_read_b128 v[88:91], v204 offset:0
    v_mfma_f32_16x16x32_bf16 v[64:67], v[140:143], v[76:79], v[64:67]
    s_waitcnt lgkmcnt(3)
    ds_read_b128 v[92:95], v205 offset:0
    v_mfma_f32_16x16x32_bf16 v[52:55], v[148:151], v[84:87], v[52:55]
    s_xor_b32 s64, s71, 64
    ds_read_b64_tr_b16 v[152:153], v198 offset:0
    ds_read_b64_tr_b16 v[154:155], v198 offset:256
    v_mfma_f32_16x16x32_bf16 v[52:55], v[144:147], v[80:83], v[52:55]
    s_mul_i32 s64, s64, 576
    ds_read_b64_tr_b16 v[156:157], v198 offset:1024
    v_mfma_f32_16x16x32_bf16 v[48:51], v[144:147], v[72:75], v[48:51]
    s_add_u32 m0, s59, 43136
    ds_read_b64_tr_b16 v[158:159], v198 offset:1280
    v_mfma_f32_16x16x32_bf16 v[48:51], v[148:151], v[76:79], v[48:51]
    s_waitcnt lgkmcnt(4)
    buffer_load_dwordx4 v2, s[20:23], s64 offen offset:0 lds
    v_mfma_f32_16x16x32_bf16 v[60:63], v[148:151], v[100:103], v[60:63]
    ds_read_b64_tr_b16 v[160:161], v198 offset:512
    v_lshlrev_b32 v178, 16, v174
    v_mfma_f32_16x16x32_bf16 v[60:63], v[144:147], v[96:99], v[60:63]
    ds_read_b64_tr_b16 v[162:163], v198 offset:768
    v_lshlrev_b32 v179, 16, v172
    v_mfma_f32_16x16x32_bf16 v[56:59], v[144:147], v[88:91], v[56:59]
    v_and_b32 v180, 0xffff0000, v174
    v_and_b32 v181, 0xffff0000, v172
    v_mfma_f32_16x16x32_bf16 v[56:59], v[148:151], v[92:95], v[56:59]
    s_waitcnt lgkmcnt(2)
    ds_read_b64_tr_b16 v[164:165], v198 offset:1536
    v_fmac_f32 v177, v178, v179
    v_mfma_f32_16x16x32_bf16 v[236:239], v[156:159], v[100:103], v[236:239]
    s_add_u32 m0, s59, 44032
    ds_read_b64_tr_b16 v[166:167], v198 offset:1792
    v_fmac_f32 v177, v180, v181
    v_mfma_f32_16x16x32_bf16 v[236:239], v[152:155], v[96:99], v[236:239]
    buffer_load_dwordx4 v2, s[20:23], s64 offen offset:128 lds
    v_mfma_f32_16x16x32_bf16 v[232:235], v[152:155], v[88:91], v[232:235]
    ds_read_b64_tr_b16 v[136:137], v198 offset:2048
    v_add_f32_dpp v177, v177, v177 row_shr:1 row_mask:0xf bank_mask:0xf bound_ctrl:1
    v_mul_f32 v68, v217, v68
    v_mfma_f32_16x16x32_bf16 v[232:235], v[156:159], v[92:95], v[232:235]
    ds_read_b64_tr_b16 v[138:139], v198 offset:2304
    v_mul_f32 v69, v217, v69
    v_mul_f32 v70, v217, v70
    v_mfma_f32_16x16x32_bf16 v[228:231], v[156:159], v[84:87], v[228:231]
    v_add_f32_dpp v177, v177, v177 row_shr:2 row_mask:0xf bank_mask:0xf bound_ctrl:1
    v_mul_f32 v71, v217, v71
    v_cvt_pk_bf16_f32 v68, v68, v69
    v_mfma_f32_16x16x32_bf16 v[228:231], v[152:155], v[80:83], v[228:231]
    ds_read_b64_tr_b16 v[140:141], v198 offset:3072
    v_cvt_pk_bf16_f32 v69, v70, v71
    v_mfma_f32_16x16x32_bf16 v[224:227], v[152:155], v[72:75], v[224:227]
    s_add_u32 m0, s59, 44928
    ds_read_b64_tr_b16 v[142:143], v198 offset:3328
    v_add_f32_dpp v177, v177, v177 row_shr:4 row_mask:0xf bank_mask:0xf bound_ctrl:1
    ds_write_b64 v211, v[68:69] offset:1728
    v_mfma_f32_16x16x32_bf16 v[224:227], v[156:159], v[76:79], v[224:227]
    s_waitcnt lgkmcnt(5)
    buffer_load_dwordx4 v2, s[20:23], s64 offen offset:256 lds
    v_mul_f32 v64, v217, v64
    v_mfma_f32_16x16x32_bf16 v[252:255], v[164:167], v[100:103], v[252:255]
    ds_read_b64_tr_b16 v[144:145], v198 offset:2560
    v_add_f32_dpp v177, v177, v177 row_shr:8 row_mask:0xf bank_mask:0xf bound_ctrl:1
    v_mul_f32 v65, v217, v65
    v_mfma_f32_16x16x32_bf16 v[252:255], v[160:163], v[96:99], v[252:255]
    ds_read_b64_tr_b16 v[146:147], v198 offset:2816
    v_mul_f32 v66, v217, v66
    v_mul_f32 v67, v217, v67
    v_mfma_f32_16x16x32_bf16 v[248:251], v[160:163], v[88:91], v[248:251]
    v_add_f32_dpp v177, v177, v177 row_bcast:15 row_mask:0xa bank_mask:0xf
    v_cvt_pk_bf16_f32 v64, v64, v65
    v_cvt_pk_bf16_f32 v65, v66, v67
    v_mfma_f32_16x16x32_bf16 v[248:251], v[164:167], v[92:95], v[248:251]
    ds_read_b64_tr_b16 v[148:149], v198 offset:3584
    ds_write_b64 v211, v[64:65] offset:64
    v_mfma_f32_16x16x32_bf16 v[244:247], v[164:167], v[84:87], v[244:247]
    ds_read_b64_tr_b16 v[150:151], v198 offset:3840
    v_mul_f32 v177, 0xbfb8aa3b, v177
    v_mfma_f32_16x16x32_bf16 v[244:247], v[160:163], v[80:83], v[244:247]
    ds_read2_b64 v[168:171], v212 offset0:10 offset1:11
    ds_read_b64_tr_b16 v[184:185], v213 offset:64
    ds_read_b64_tr_b16 v[186:187], v213 offset:480
    v_mfma_f32_16x16x32_bf16 v[240:243], v[160:163], v[72:75], v[240:243]
    s_add_u32 m0, s59, 45824
    ds_read_b64_tr_b16 v[152:153], v198 offset:4096
    v_exp_f32 v177, v177
    ds_read_b64 v[182:183], v212 offset:72
    v_mfma_f32_16x16x32_bf16 v[240:243], v[164:167], v[76:79], v[240:243]
    s_waitcnt lgkmcnt(11)
    ds_read_b64_tr_b16 v[154:155], v198 offset:4352
    v_mul_f32 v52, 0x3eae1a93, v52
    v_mul_f32 v53, 0x3eae1a93, v53
    v_mfma_f32_16x16x32_bf16 a[12:15], v[140:143], v[100:103], a[12:15]
    buffer_load_dwordx4 v2, s[20:23], s64 offen offset:384 lds
    v_add_f32 v177, 1.0, v177
    v_mul_f32 v54, 0x3eae1a93, v54
    v_mfma_f32_16x16x32_bf16 a[12:15], v[136:139], v[96:99], a[12:15]
    ds_read_b64_tr_b16 v[156:157], v198 offset:5120
    v_mul_f32 v55, 0x3eae1a93, v55
    v_cvt_pk_bf16_f32 v52, v52, v53
    v_mfma_f32_16x16x32_bf16 a[8:11], v[136:139], v[88:91], a[8:11]
    ds_read_b64_tr_b16 v[158:159], v198 offset:5376
    v_rcp_f32 v177, v177
    v_cvt_pk_bf16_f32 v53, v54, v55
    v_mfma_f32_16x16x32_bf16 a[8:11], v[140:143], v[92:95], a[8:11]
    ds_write_b64 v209, v[52:53] offset:1664
    v_mfma_f32_16x16x32_bf16 a[4:7], v[140:143], v[84:87], a[4:7]
    ds_read_b64_tr_b16 v[160:161], v198 offset:4608
    v_mul_f32 v48, 0x3eae1a93, v48
    v_mul_f32 v49, 0x3eae1a93, v49
    v_mfma_f32_16x16x32_bf16 a[4:7], v[136:139], v[80:83], a[4:7]
    s_add_u32 m0, s59, 46720
    ds_read_b64_tr_b16 v[162:163], v198 offset:4864
    buffer_store_dword v177, v220, s[28:31], 0 offen sc1
    v_mul_f32 v50, 0x3eae1a93, v50
    v_mul_f32 v51, 0x3eae1a93, v51
    v_mfma_f32_16x16x32_bf16 a[0:3], v[136:139], v[72:75], a[0:3]
    buffer_load_dwordx4 v2, s[20:23], s64 offen offset:512 lds
    v_cvt_pk_bf16_f32 v48, v48, v49
    v_mfma_f32_16x16x32_bf16 a[0:3], v[140:143], v[76:79], a[0:3]
    s_waitcnt lgkmcnt(11)
    ds_read_b64_tr_b16 v[164:165], v198 offset:5632
    v_cvt_pk_bf16_f32 v49, v50, v51
    v_mfma_f32_16x16x32_bf16 a[28:31], v[148:151], v[100:103], a[28:31]
    ds_read_b64_tr_b16 v[166:167], v198 offset:5888
    ds_write_b64 v209, v[48:49] offset:0
    v_mfma_f32_16x16x32_bf16 a[28:31], v[144:147], v[96:99], a[28:31]
    v_mul_f32 v60, 0x3eae1a93, v60
    v_mul_f32 v61, 0x3eae1a93, v61
    v_mul_f32 v62, 0x3eae1a93, v62
    v_mfma_f32_16x16x32_bf16 a[24:27], v[144:147], v[88:91], a[24:27]
    ds_read_b64_tr_b16 v[136:137], v198 offset:6144
    v_mul_f32 v63, 0x3eae1a93, v63
    v_cvt_pk_bf16_f32 v60, v60, v61
    v_mfma_f32_16x16x32_bf16 a[24:27], v[148:151], v[92:95], a[24:27]
    s_add_u32 m0, s59, 47616
    ds_read_b64_tr_b16 v[138:139], v198 offset:6400
    v_cvt_pk_bf16_f32 v61, v62, v63
    v_mfma_f32_16x16x32_bf16 a[20:23], v[148:151], v[84:87], a[20:23]
    buffer_load_dwordx4 v2, s[20:23], s64 offen offset:640 lds
    ds_write_b64 v210, v[60:61] offset:1664
    v_mfma_f32_16x16x32_bf16 a[20:23], v[144:147], v[80:83], a[20:23]
    ds_read_b64_tr_b16 v[140:141], v198 offset:7168
    v_mul_f32 v56, 0x3eae1a93, v56
    v_mfma_f32_16x16x32_bf16 a[16:19], v[144:147], v[72:75], a[16:19]
    ds_read_b64_tr_b16 v[142:143], v198 offset:7424
    v_mul_f32 v57, 0x3eae1a93, v57
    v_mul_f32 v58, 0x3eae1a93, v58
    v_mfma_f32_16x16x32_bf16 a[16:19], v[148:151], v[76:79], a[16:19]
    s_waitcnt lgkmcnt(11)
    v_mul_f32 v59, 0x3eae1a93, v59
    v_cvt_pk_bf16_f32 v56, v56, v57
    v_cvt_pk_bf16_f32 v57, v58, v59
    v_mfma_f32_16x16x32_bf16 a[44:47], v[156:159], v[100:103], a[44:47]
    ds_read_b64_tr_b16 v[144:145], v198 offset:6656
    ds_write_b64 v210, v[56:57] offset:0
    v_mfma_f32_16x16x32_bf16 a[44:47], v[152:155], v[96:99], a[44:47]
    ds_read_b64_tr_b16 v[146:147], v198 offset:6912
    s_waitcnt lgkmcnt(15)
    v_mfma_f32_16x16x32_bf16 a[40:43], v[152:155], v[88:91], a[40:43]
    v_cndmask_b32 v184, v184, v218, s[82:83]
    v_cndmask_b32 v185, v185, v218, s[82:83]
    v_cndmask_b32 v186, v186, v218, s[82:83]
    v_mfma_f32_16x16x32_bf16 a[40:43], v[156:159], v[92:95], a[40:43]
    ds_read_b64_tr_b16 v[148:149], v198 offset:7680
    v_cndmask_b32 v187, v187, v218, s[82:83]
    v_mfma_f32_16x16x32_bf16 a[36:39], v[156:159], v[84:87], a[36:39]
    s_add_u32 m0, s59, 48512
    ds_read_b64_tr_b16 v[150:151], v198 offset:7936
    v_mfma_f32_16x16x32_bf16 a[36:39], v[152:155], v[80:83], a[36:39]
    buffer_load_dwordx4 v2, s[20:23], s64 offen offset:768 lds
    buffer_store_dwordx4 v[168:171], v214, s[28:31], 0 offen sc1
    v_mfma_f32_16x16x32_bf16 a[32:35], v[152:155], v[72:75], a[32:35]
    ds_read_b64_tr_b16 v[152:153], v198 offset:8192
    v_mfma_f32_16x16x32_bf16 a[32:35], v[156:159], v[76:79], a[32:35]
    s_waitcnt lgkmcnt(12)
    ds_read_b64_tr_b16 v[154:155], v198 offset:8448
    buffer_store_dword v171, v215, s[28:31], 0 offen sc1
    v_mfma_f32_16x16x32_bf16 a[60:63], v[164:167], v[100:103], a[60:63]
    v_mfma_f32_16x16x32_bf16 a[60:63], v[160:163], v[96:99], a[60:63]
    ds_read_b64_tr_b16 v[156:157], v198 offset:8704
    buffer_store_dwordx4 v[184:187], v216, s[28:31], 0 offen sc1
    v_mfma_f32_16x16x32_bf16 a[56:59], v[160:163], v[88:91], a[56:59]
    s_add_u32 m0, s59, 49408
    ds_read_b64_tr_b16 v[158:159], v198 offset:8960
    v_mfma_f32_16x16x32_bf16 a[56:59], v[164:167], v[92:95], a[56:59]
    buffer_load_dwordx4 v2, s[20:23], s64 offen offset:896 lds
    buffer_store_dwordx2 v[182:183], v189, s[28:31], s19 offen sc1
    v_mfma_f32_16x16x32_bf16 a[52:55], v[164:167], v[84:87], a[52:55]
    s_waitcnt vmcnt(26)
    ds_add_u32 v11, v9
    v_mul_f32 v36, v224, v224
    v_mul_f32 v37, v225, v225
    v_mfma_f32_16x16x32_bf16 a[52:55], v[160:163], v[80:83], a[52:55]
    v_mul_f32 v38, v226, v226
    v_mul_f32 v39, v227, v227
    v_mfma_f32_16x16x32_bf16 a[48:51], v[160:163], v[72:75], a[48:51]
    s_add_u32 m0, s59, 50304
    v_fma_f32 v36, v36, s70, v5
    v_fma_f32 v37, v37, s70, v5
    v_fma_f32 v38, v38, s70, v5
    v_mfma_f32_16x16x32_bf16 a[48:51], v[164:167], v[76:79], a[48:51]
    s_waitcnt lgkmcnt(10)
    v_fma_f32 v39, v39, s70, v5
    v_mul_f32 v36, v36, v224
    v_mfma_f32_16x16x32_bf16 a[76:79], v[140:143], v[100:103], a[76:79]
    buffer_load_dwordx4 v2, s[20:23], s64 offen offset:1024 lds
    v_mul_f32 v37, v37, v225
    v_mfma_f32_16x16x32_bf16 a[76:79], v[136:139], v[96:99], a[76:79]
    ds_read_b32 v6, v11
    v_mul_f32 v38, v38, v226
    v_mfma_f32_16x16x32_bf16 a[72:75], v[136:139], v[88:91], a[72:75]
    v_mul_f32 v39, v39, v227
    v_exp_f32 v36, v36
    v_mfma_f32_16x16x32_bf16 a[72:75], v[140:143], v[92:95], a[72:75]
    v_exp_f32 v37, v37
    v_mfma_f32_16x16x32_bf16 a[68:71], v[140:143], v[84:87], a[68:71]
    v_exp_f32 v38, v38
    v_mfma_f32_16x16x32_bf16 a[68:71], v[136:139], v[80:83], a[68:71]
    v_exp_f32 v39, v39
    v_add_f32 v36, 1.0, v36
    v_mfma_f32_16x16x32_bf16 a[64:67], v[136:139], v[72:75], a[64:67]
    s_waitcnt lgkmcnt(0)
    v_cmp_le_u32 vcc, 36, v6
    v_add_f32 v37, 1.0, v37
    v_add_f32 v38, 1.0, v38
    v_mfma_f32_16x16x32_bf16 a[64:67], v[140:143], v[76:79], a[64:67]
    s_waitcnt lgkmcnt(6)
    v_add_f32 v39, 1.0, v39
    v_rcp_f32 v36, v36
    v_mfma_f32_16x16x32_bf16 a[92:95], v[148:151], v[100:103], a[92:95]
    s_cbranch_vccz L_espin8
L_eback8:
    v_rcp_f32 v37, v37
    v_mfma_f32_16x16x32_bf16 a[92:95], v[144:147], v[96:99], a[92:95]
    v_rcp_f32 v38, v38
    v_mfma_f32_16x16x32_bf16 a[88:91], v[144:147], v[88:91], a[88:91]
    v_rcp_f32 v39, v39
    v_mul_f32 v36, v36, v224
    v_mfma_f32_16x16x32_bf16 a[88:91], v[148:151], v[92:95], a[88:91]
    v_mul_f32 v37, v37, v225
    v_mul_f32 v38, v38, v226
    v_mfma_f32_16x16x32_bf16 a[84:87], v[148:151], v[84:87], a[84:87]
    v_mul_f32 v39, v39, v227
    v_cvt_pk_bf16_f32 v40, v36, v37
    v_cvt_pk_bf16_f32 v41, v38, v39
    v_mfma_f32_16x16x32_bf16 a[84:87], v[144:147], v[80:83], a[84:87]
    ds_write_b64 v3, v[40:41] offset:0
    v_mfma_f32_16x16x32_bf16 a[80:83], v[144:147], v[72:75], a[80:83]
    v_mul_f32 v36, v228, v228
    v_mfma_f32_16x16x32_bf16 a[80:83], v[148:151], v[76:79], a[80:83]
    s_waitcnt lgkmcnt(3)
    v_mul_f32 v37, v229, v229
    v_mul_f32 v38, v230, v230
    v_mul_f32 v39, v231, v231
    v_mfma_f32_16x16x32_bf16 a[108:111], v[156:159], v[100:103], a[108:111]
    v_fma_f32 v36, v36, s70, v5
    v_fma_f32 v37, v37, s70, v5
    v_mfma_f32_16x16x32_bf16 a[108:111], v[152:155], v[96:99], a[108:111]
    v_fma_f32 v38, v38, s70, v5
    v_fma_f32 v39, v39, s70, v5
    v_mfma_f32_16x16x32_bf16 a[104:107], v[152:155], v[88:91], a[104:107]
    v_mul_f32 v36, v36, v228
    v_mul_f32 v37, v37, v229
    v_mfma_f32_16x16x32_bf16 a[104:107], v[156:159], v[92:95], a[104:107]
L_pe3:
L_r3:
    s_cbranch_execz L_q9
    v_mul_f32 v38, v38, v230
    v_mul_f32 v39, v39, v231
    v_mfma_f32_16x16x32_bf16 a[100:103], v[156:159], v[84:87], a[100:103]
    v_exp_f32 v36, v36
    v_mfma_f32_16x16x32_bf16 a[100:103], v[152:155], v[80:83], a[100:103]
    v_exp_f32 v37, v37
    v_mfma_f32_16x16x32_bf16 a[96:99], v[152:155], v[72:75], a[96:99]
    v_exp_f32 v38, v38
    v_mfma_f32_16x16x32_bf16 a[96:99], v[156:159], v[76:79], a[96:99]
    v_exp_f32 v39, v39
    v_add_f32 v36, 1.0, v36
    v_add_f32 v37, 1.0, v37
    v_add_f32 v38, 1.0, v38
    v_add_f32 v39, 1.0, v39
    v_rcp_f32 v36, v36
    v_rcp_f32 v37, v37
    v_rcp_f32 v38, v38
    v_rcp_f32 v39, v39
    v_mul_f32 v36, v36, v228
    v_mul_f32 v37, v37, v229
    v_mul_f32 v38, v38, v230
    v_mul_f32 v39, v39, v231
    v_cvt_pk_bf16_f32 v42, v36, v37
    v_cvt_pk_bf16_f32 v43, v38, v39
    ds_write_b64 v3, v[42:43] offset:256
    v_mul_f32 v36, v232, v232
    v_mul_f32 v37, v233, v233
    v_mul_f32 v38, v234, v234
    v_mul_f32 v39, v235, v235
    v_fma_f32 v36, v36, s70, v5
    v_fma_f32 v37, v37, s70, v5
    v_fma_f32 v38, v38, s70, v5
    v_fma_f32 v39, v39, s70, v5
    v_mul_f32 v36, v36, v232
    v_mul_f32 v37, v37, v233
    v_mul_f32 v38, v38, v234
    v_mul_f32 v39, v39, v235
    v_exp_f32 v36, v36
    v_exp_f32 v37, v37
    v_exp_f32 v38, v38
    v_exp_f32 v39, v39
    v_add_f32 v36, 1.0, v36
    v_add_f32 v37, 1.0, v37
    v_add_f32 v38, 1.0, v38
    v_add_f32 v39, 1.0, v39
    v_rcp_f32 v36, v36
    v_rcp_f32 v37, v37
    v_rcp_f32 v38, v38
    v_rcp_f32 v39, v39
    v_mul_f32 v36, v36, v232
    v_mul_f32 v37, v37, v233
    v_mul_f32 v38, v38, v234
    v_mul_f32 v39, v39, v235
    v_cvt_pk_bf16_f32 v40, v36, v37
    v_cvt_pk_bf16_f32 v41, v38, v39
    ds_write_b64 v3, v[40:41] offset:1024
    v_mul_f32 v36, v236, v236
    v_mul_f32 v37, v237, v237
    v_mul_f32 v38, v238, v238
    v_mul_f32 v39, v239, v239
    v_fma_f32 v36, v36, s70, v5
    v_fma_f32 v37, v37, s70, v5
    v_fma_f32 v38, v38, s70, v5
    v_fma_f32 v39, v39, s70, v5
    v_mul_f32 v36, v36, v236
    v_mul_f32 v37, v37, v237
    v_mul_f32 v38, v38, v238
    v_mul_f32 v39, v39, v239
    v_exp_f32 v36, v36
    v_exp_f32 v37, v37
    v_exp_f32 v38, v38
    v_exp_f32 v39, v39
    v_add_f32 v36, 1.0, v36
    v_add_f32 v37, 1.0, v37
    v_add_f32 v38, 1.0, v38
    v_add_f32 v39, 1.0, v39
    v_rcp_f32 v36, v36
    v_rcp_f32 v37, v37
    v_rcp_f32 v38, v38
    v_rcp_f32 v39, v39
    v_mul_f32 v36, v36, v236
    v_mul_f32 v37, v37, v237
    v_mul_f32 v38, v38, v238
    v_mul_f32 v39, v39, v239
    v_cvt_pk_bf16_f32 v42, v36, v37
    v_cvt_pk_bf16_f32 v43, v38, v39
    ds_write_b64 v3, v[42:43] offset:1280
    s_branch L_join
L_codeend:
    s_endpgm
.section .rodata,"a"
.p2align 6
.amdhsa_kernel gated_mix__grouped_kv_mqa__dense_activation_gelu__prompt_kernel
  .amdhsa_next_free_vgpr 512
  .amdhsa_next_free_sgpr 102
  .amdhsa_accum_offset 256
  .amdhsa_group_segment_fixed_size 0
  .amdhsa_kernarg_size 112
  .amdhsa_user_sgpr_count 2
  .amdhsa_user_sgpr_kernarg_segment_ptr 1
  .amdhsa_system_sgpr_workgroup_id_x 1
.end_amdhsa_kernel
```
